```python
import torch

def _softmax(x, axis=-1):
    return torch.softmax(x, dim=axis)
def _gelu(x):
    return torch.nn.functional.gelu(x, approximate="tanh")
def _silu(x):
    return torch.nn.functional.silu(x)
def _sigmoid(x):
    return torch.sigmoid(x)
def _layernorm(x, axis=-1, eps=1e-5):
    m = x.mean(dim=axis, keepdim=True)
    v = x.var(dim=axis, keepdim=True, unbiased=False)
    return (x - m) / torch.sqrt(v + eps)
def _scatter_add(tgt, idx, src, axis=0):
    return tgt.clone().index_add_(axis, idx, src)
def _segment_sum(src, seg, n):
    out = torch.zeros((n,) + src.shape[1:], dtype=src.dtype)
    return out.index_add_(0, seg, src)
def _pad(x, pw):
    flat = tuple(v for pair in reversed(pw) for v in pair)
    return torch.nn.functional.pad(x, flat)

kernel_name = 'concat_heads__mha_block_cached__gqa_block_cached__near_ridge'

def setup_inputs():

    _w = (lambda a: (lambda t: t.to(torch.bfloat16) if t.is_floating_point() else t)(torch.as_tensor(a)))
    def _A_setup():
        B, Sq, D = 16, 112, 640
        H, Sk, Dh = 32, 512, 192
        return {
            "x": _w((lambda *s: torch.randn(*s, dtype=torch.bfloat16) * 0.8)(B, Sq, D)),
            "k_cache": _w((lambda *s: torch.randn(*s, dtype=torch.bfloat16) * 0.8)(B, H, Sk, Dh)),
            "v_cache": _w((lambda *s: torch.randn(*s, dtype=torch.bfloat16) * 0.05)(B, H, Sk, Dh)),
            "wq": _w((lambda *s: torch.randn(*s, dtype=torch.bfloat16) * 0.8)(D, H * Dh) * (D ** -0.5)),
            "wo": _w((lambda *s: torch.randn(*s, dtype=torch.bfloat16) * 0.05)(H * Dh, D) * ((H * Dh) ** -0.5)),
        }
    _A_in = _A_setup()

    def _B_setup():
        B, Sq, D = 16, 112, 640
        Hq, Hkv, Sk, Dh = 32, 32, 512, 192
        assert Hq % Hkv == 0, (Hq, Hkv)
        return {
            "x": _w((lambda *s: torch.randn(*s, dtype=torch.bfloat16) * 0.8)(B, Sq, D)),
            "k_cache": _w((lambda *s: torch.randn(*s, dtype=torch.bfloat16) * 0.8)(B, Hkv, Sk, Dh)),
            "v_cache": _w((lambda *s: torch.randn(*s, dtype=torch.bfloat16) * 0.05)(B, Hkv, Sk, Dh)),
            "wq": _w((lambda *s: torch.randn(*s, dtype=torch.bfloat16) * 0.8)(D, Hq * Dh) * (D ** -0.5)),
            "wo": _w((lambda *s: torch.randn(*s, dtype=torch.bfloat16) * 0.05)(Hq * Dh, D) * ((Hq * Dh) ** -0.5)),
        }
    _B_in = _B_setup()

    return {
        "A_x": _A_in["x"],
        "A_k_cache": _A_in["k_cache"],
        "A_v_cache": _A_in["v_cache"],
        "A_wq": _A_in["wq"],
        "A_wo": _A_in["wo"],
        "B_x": _B_in["x"],
        "B_k_cache": _B_in["k_cache"],
        "B_v_cache": _B_in["v_cache"],
        "B_wq": _B_in["wq"],
        "B_wo": _B_in["wo"],
    }

def reference(A_x, A_k_cache, A_v_cache, A_wq, A_wo, B_x, B_k_cache, B_v_cache, B_wq, B_wo):
    def _A_ref(x, k_cache, v_cache, wq, wo):
        B, Sq, D = x.shape
        H, Dh = 32, 192
        q = (lambda x, *d: x.permute(*d))((x @ wq).reshape(B, Sq, H, Dh), 0, 2, 1, 3)
        scores = torch.einsum("bhqd,bhkd->bhqk", q, k_cache) * (Dh ** -0.5)
        p = _softmax(scores, axis=-1)
        o = torch.einsum("bhqk,bhkd->bhqd", p, v_cache)
        return (lambda x, *d: x.permute(*d))(o, 0, 2, 1, 3).reshape(B, Sq, H * Dh) @ wo

    def _B_ref(x, k_cache, v_cache, wq, wo):
        B, Sq, D = x.shape
        Hq, Dh = 32, 192
        Hkv = k_cache.shape[1]
        rep = Hq // Hkv
        q = (lambda x, *d: x.permute(*d))((x @ wq).reshape(B, Sq, Hq, Dh), 0, 2, 1, 3)
        k = (lambda x, n, axis: torch.repeat_interleave(x, n, dim=axis))(k_cache, rep, axis=1)
        v = (lambda x, n, axis: torch.repeat_interleave(x, n, dim=axis))(v_cache, rep, axis=1)
        scores = torch.einsum("bhqd,bhkd->bhqk", q, k) * (Dh ** -0.5)
        p = _softmax(scores, axis=-1)
        o = torch.einsum("bhqk,bhkd->bhqd", p, v)
        return (lambda x, *d: x.permute(*d))(o, 0, 2, 1, 3).reshape(B, Sq, Hq * Dh) @ wo

    a = _A_ref(A_x, A_k_cache, A_v_cache, A_wq, A_wo)
    b = _B_ref(B_x, B_k_cache, B_v_cache, B_wq, B_wo)
    return torch.concatenate([a, b], axis=-1)
```

```asm
; @launch grid=(256,1,1) block=(512,1,1) lds=161792
.amdgcn_target "amdgcn-amd-amdhsa--gfx950"
.text
.globl concat_heads__mha_block_cached__gqa_block_cached__near_ridge_kernel
.p2align 8
.type concat_heads__mha_block_cached__gqa_block_cached__near_ridge_kernel,@function
concat_heads__mha_block_cached__gqa_block_cached__near_ridge_kernel:
    s_cmp_ge_u32 s2, 256
    s_cbranch_scc1 k1_end
    s_load_dwordx16 s[4:19], s[0:1], 0
    s_load_dwordx8 s[20:27], s[0:1], 64
    s_load_dwordx2 s[28:29], s[0:1], 96
    v_lshrrev_b32 v1, 6, v0
    v_and_b32 v2, 63, v0
    v_readfirstlane_b32 s52, v1
    s_and_b32 s62, s2, 7
    s_lshr_b32 s63, s2, 3
    s_and_b32 s54, s62, 3
    s_lshl_b32 s54, s54, 1
    s_and_b32 s53, s63, 1
    s_add_u32 s54, s54, s53
    s_lshr_b32 s53, s63, 1
    s_and_b32 s56, s52, 3
    s_lshr_b32 s74, s52, 2
    s_mul_i32 s60, s56, 3072
    s_mov_b32 s34, 786432
    s_mov_b32 s35, 0x20000
    s_mov_b32 s38, 786432
    s_mov_b32 s39, 0x20000
    s_mov_b32 s43, 0x20000
    s_mov_b32 s46, 983040
    s_mov_b32 s47, 0x20000
    s_mov_b32 s50, 143360
    s_mov_b32 s51, 0x20000
    s_mov_b32 s78, 35840
    s_mov_b32 s79, 0x20000
    s_cmp_ge_u32 s52, 4
    s_cbranch_scc1 k1_q1
k1_q0:
    v_mbcnt_lo_u32_b32 v2, -1, 0
    v_mbcnt_hi_u32_b32 v2, -1, v2
    v_and_b32 v3, 15, v2
    v_lshrrev_b32 v4, 4, v2
    v_lshrrev_b32 v5, 2, v2
    v_and_b32 v6, 3, v5
    v_and_b32 v7, 3, v2
    v_lshrrev_b32 v8, 3, v2
    v_and_b32 v9, 7, v2
    v_lshrrev_b32 v13, 1, v8
    v_and_b32 v13, 3, v13
    v_lshlrev_b32 v13, 1, v13
    v_xor_b32 v13, v9, v13
    v_lshlrev_b32 v13, 4, v13
    v_mul_u32_u24 v14, 1280, v8
    v_add_u32 v246, v13, v14
    v_mul_u32_u24 v14, 384, v8
    v_add_u32 v255, v13, v14
    s_mul_i32 s70, s56, 10240
    s_lshl_b32 s71, s56, 10
    s_sub_u32 s73, s71, 2048
    s_add_u32 s73, s73, 159744
    s_and_b32 s62, s56, 1
    s_lshl_b32 s62, s62, 2
    v_xor_b32 v16, s62, v9
    s_mul_i32 s58, s56, 98304
    v_add_u32 v10, 0, v8
    v_mul_u32_u24 v11, 43, v10
    v_lshrrev_b32 v11, 7, v11
    v_mul_u32_u24 v12, 3, v11
    v_sub_u32 v12, v10, v12
    v_lshrrev_b32 v13, 1, v11
    v_and_b32 v14, 1, v13
    v_xor_b32 v14, v16, v14
    v_lshlrev_b32 v14, 4, v14
    v_lshl_add_u32 v14, v12, 7, v14
    v_mul_u32_u24 v15, 12288, v11
    v_add_u32 v14, v14, v15
    v_subrev_u32 v243, 0, v14
    v_add_u32 v10, 8, v8
    v_mul_u32_u24 v11, 43, v10
    v_lshrrev_b32 v11, 7, v11
    v_mul_u32_u24 v12, 3, v11
    v_sub_u32 v12, v10, v12
    v_lshrrev_b32 v13, 1, v11
    v_and_b32 v14, 1, v13
    v_xor_b32 v14, v16, v14
    v_lshlrev_b32 v14, 4, v14
    v_lshl_add_u32 v14, v12, 7, v14
    v_mul_u32_u24 v15, 12288, v11
    v_add_u32 v14, v14, v15
    v_subrev_u32 v244, 1024, v14
    v_add_u32 v10, 16, v8
    v_mul_u32_u24 v11, 43, v10
    v_lshrrev_b32 v11, 7, v11
    v_mul_u32_u24 v12, 3, v11
    v_sub_u32 v12, v10, v12
    v_lshrrev_b32 v13, 1, v11
    v_and_b32 v14, 1, v13
    v_xor_b32 v14, v16, v14
    v_lshlrev_b32 v14, 4, v14
    v_lshl_add_u32 v14, v12, 7, v14
    v_mul_u32_u24 v15, 12288, v11
    v_add_u32 v14, v14, v15
    v_subrev_u32 v245, 2048, v14
    s_waitcnt lgkmcnt(0)
    s_and_b32 s62, s2, 7
    s_cmp_lt_u32 s62, 4
    s_cselect_b64 s[4:5], s[4:5], s[14:15]
    s_cselect_b64 s[10:11], s[10:11], s[20:21]
    s_mul_i32 s63, s53, 143360
    s_add_u32 s48, s4, s63
    s_addc_u32 s49, s5, 0
    s_mul_i32 s63, s54, 1536
    s_add_u32 s40, s10, s63
    s_addc_u32 s41, s11, 0
    s_sub_u32 s42, 7864320, s63
    s_add_u32 m0, s71, 0
    s_add_u32 s63, s70, 0
    buffer_load_dwordx4 v246, s[48:51], s63 offen  lds
    s_add_u32 m0, s71, 4096
    s_add_u32 s63, s70, 40960
    buffer_load_dwordx4 v246, s[48:51], s63 offen  lds
    s_add_u32 m0, s71, 8192
    s_add_u32 s63, s70, 81920
    buffer_load_dwordx4 v246, s[48:51], s63 offen  lds
    s_add_u32 s63, s71, 12288
    s_cmp_ge_u32 s56, 2
    s_cselect_b32 m0, s73, s63
    s_add_u32 s63, s70, 122880
    buffer_load_dwordx4 v246, s[48:51], s63 offen  lds
    s_add_u32 m0, s60, 94208
    s_add_u32 s62, s58, 0
    buffer_load_dwordx4 v243, s[40:43], s62 offen  lds
    buffer_load_dwordx4 v244, s[40:43], s62 offen offset:1024  lds
    buffer_load_dwordx4 v245, s[40:43], s62 offen offset:2048  lds
    s_add_u32 m0, s60, 106496
    s_add_u32 s62, s58, 384
    buffer_load_dwordx4 v243, s[40:43], s62 offen  lds
    buffer_load_dwordx4 v244, s[40:43], s62 offen offset:1024  lds
    buffer_load_dwordx4 v245, s[40:43], s62 offen offset:2048  lds
    s_add_u32 m0, s60, 118784
    s_add_u32 s62, s58, 768
    buffer_load_dwordx4 v243, s[40:43], s62 offen  lds
    buffer_load_dwordx4 v244, s[40:43], s62 offen offset:1024  lds
    buffer_load_dwordx4 v245, s[40:43], s62 offen offset:2048  lds
    s_and_b32 s62, s2, 7
    s_cmp_lt_u32 s62, 4
    s_cselect_b64 s[6:7], s[6:7], s[16:17]
    s_cselect_b64 s[8:9], s[8:9], s[18:19]
    s_cselect_b64 s[12:13], s[12:13], s[22:23]
    s_cselect_b32 s3, 0, 16
    s_add_u32 s3, s3, s53
    s_lshl_b32 s62, s53, 3
    s_add_u32 s62, s62, s54
    s_mul_i32 s63, s62, 786432
    s_add_u32 s32, s6, s63
    s_addc_u32 s33, s7, 0
    s_add_u32 s36, s8, s63
    s_addc_u32 s37, s9, 0
    s_mul_i32 s63, s54, 983040
    s_add_u32 s44, s12, s63
    s_addc_u32 s45, s13, 0
    s_lshl_b32 s62, s3, 3
    s_add_u32 s62, s62, s54
    s_mul_i32 s61, s62, 143360
    s_mul_i32 s63, s56, 35840
    s_add_u32 s61, s61, s63
    s_add_u32 s61, s61, 1048576
    s_add_u32 s76, s28, s61
    s_addc_u32 s77, s29, 0
    v_mul_u32_u24 v10, 43, v2
    v_lshrrev_b32 v10, 9, v10
    v_mul_u32_u24 v11, 12, v10
    v_sub_u32 v11, v2, v11
    v_min_u32 v10, 1, v10
    v_mul_u32_u24 v10, 12288, v10
    v_lshl_add_u32 v254, v11, 7, v10
    s_mul_i32 s8, s53, 24576
    s_add_u32 s62, s52, 2
    s_mul_i32 s62, s62, 393216
    s_add_u32 s62, s62, s8
    buffer_load_dword v247, v254, s[40:43], s62 offen
    v_lshrrev_b32 v8, 1, v3
    v_and_b32 v8, 3, v8
    v_lshlrev_b32 v8, 1, v8
    v_xor_b32 v8, v4, v8
    v_lshlrev_b32 v8, 4, v8
    v_lshl_add_u32 v9, v3, 7, v8
    v_add_u32 v238, 0, v9
    v_xor_b32 v239, 64, v238
    v_lshl_add_u32 v8, v4, 3, v6
    v_mul_u32_u24 v9, 384, v8
    v_lshrrev_b32 v8, 1, v6
    v_and_b32 v11, 1, v4
    v_lshl_add_u32 v8, v11, 2, v8
    v_xor_b32 v8, v7, v8
    v_lshl_add_u32 v9, v8, 4, v9
    v_lshlrev_b32 v12, 3, v11
    v_lshl_add_u32 v12, v2, 4, v12
    v_and_b32 v11, 1, v7
    v_lshl_add_u32 v11, v11, 3, v9
    s_mov_b32 s66, 0x3dd53b95
    s_mov_b32 s67, s66
    s_mul_i32 s62, s56, 3
    s_add_u32 s62, s62, 0
    s_and_b32 s61, s62, 2
    s_lshl_b32 s61, s61, 5
    s_and_b32 s63, s62, 1
    s_lshl_b32 s63, s63, 3
    v_xor_b32 v248, s63, v12
    s_or_b32 s61, s61, s63
    v_xor_b32 v13, s61, v11
    s_lshr_b32 s63, s62, 2
    s_lshl_b32 s63, s63, 7
    v_add_u32 v13, s63, v13
    v_add_u32 v235, 43008, v13
    v_add_u32 v232, 94208, v13
    s_lshr_b32 s62, s62, 1
    s_mul_i32 s63, s62, 7168
    v_add_u32 v248, s63, v248
    s_mul_i32 s62, s56, 3
    s_add_u32 s62, s62, 1
    s_and_b32 s61, s62, 2
    s_lshl_b32 s61, s61, 5
    s_and_b32 s63, s62, 1
    s_lshl_b32 s63, s63, 3
    v_xor_b32 v249, s63, v12
    s_or_b32 s61, s61, s63
    v_xor_b32 v13, s61, v11
    s_lshr_b32 s63, s62, 2
    s_lshl_b32 s63, s63, 7
    v_add_u32 v13, s63, v13
    v_add_u32 v236, 43008, v13
    v_add_u32 v233, 94208, v13
    s_lshr_b32 s62, s62, 1
    s_mul_i32 s63, s62, 7168
    v_add_u32 v249, s63, v249
    s_mul_i32 s62, s56, 3
    s_add_u32 s62, s62, 2
    s_and_b32 s61, s62, 2
    s_lshl_b32 s61, s61, 5
    s_and_b32 s63, s62, 1
    s_lshl_b32 s63, s63, 3
    v_xor_b32 v250, s63, v12
    s_or_b32 s61, s61, s63
    v_xor_b32 v13, s61, v11
    s_lshr_b32 s63, s62, 2
    s_lshl_b32 s63, s63, 7
    v_add_u32 v13, s63, v13
    v_add_u32 v237, 43008, v13
    v_add_u32 v234, 94208, v13
    s_lshr_b32 s62, s62, 1
    s_mul_i32 s63, s62, 7168
    v_add_u32 v250, s63, v250
    s_waitcnt vmcnt(1)
    s_barrier
    ds_read_b64_tr_b16 v[168:169], v232 offset:0
    ds_read_b64_tr_b16 v[170:171], v232 offset:1536
    ds_read_b128 v[216:219], v238 offset:0
    ds_read_b128 v[220:223], v238 offset:2048
    ds_read_b64_tr_b16 v[172:173], v233 offset:0
    ds_read_b64_tr_b16 v[174:175], v233 offset:1536
    ds_read_b64_tr_b16 v[176:177], v234 offset:0
    ds_read_b64_tr_b16 v[178:179], v234 offset:1536
    ds_read_b128 v[224:227], v238 offset:4096
    ds_read_b128 v[228:231], v238 offset:6144
    s_add_u32 m0, s60, 43008
    s_add_u32 s62, s58, 393216
    buffer_load_dwordx4 v243, s[40:43], s62 offen  lds
    buffer_load_dwordx4 v244, s[40:43], s62 offen offset:1024  lds
    buffer_load_dwordx4 v245, s[40:43], s62 offen offset:2048  lds
    s_add_u32 m0, s60, 55296
    s_add_u32 s62, s58, 393600
    buffer_load_dwordx4 v243, s[40:43], s62 offen  lds
    buffer_load_dwordx4 v244, s[40:43], s62 offen offset:1024  lds
    buffer_load_dwordx4 v245, s[40:43], s62 offen offset:2048  lds
    s_add_u32 m0, s60, 67584
    s_add_u32 s62, s58, 393984
    buffer_load_dwordx4 v243, s[40:43], s62 offen  lds
    buffer_load_dwordx4 v244, s[40:43], s62 offen offset:1024  lds
    buffer_load_dwordx4 v245, s[40:43], s62 offen offset:2048  lds
    s_add_u32 m0, s71, 14336
    s_add_u32 s63, s70, 128
    buffer_load_dwordx4 v246, s[48:51], s63 offen  lds
    s_add_u32 m0, s71, 18432
    s_add_u32 s63, s70, 41088
    buffer_load_dwordx4 v246, s[48:51], s63 offen  lds
    s_add_u32 m0, s71, 22528
    s_add_u32 s63, s70, 82048
    buffer_load_dwordx4 v246, s[48:51], s63 offen  lds
    s_add_u32 s63, s71, 26624
    s_cmp_ge_u32 s56, 2
    s_cselect_b32 m0, s73, s63
    s_add_u32 s63, s70, 123008
    buffer_load_dwordx4 v246, s[48:51], s63 offen  lds
    s_waitcnt lgkmcnt(7)
    v_mfma_f32_16x16x32_bf16 v[0:3], v[168:171], v[216:219], 0
    s_waitcnt lgkmcnt(4)
    v_mfma_f32_16x16x32_bf16 v[4:7], v[172:175], v[216:219], 0
    s_waitcnt lgkmcnt(2)
    v_mfma_f32_16x16x32_bf16 v[8:11], v[176:179], v[216:219], 0
    ds_read_b128 v[216:219], v238 offset:8192
    v_mfma_f32_16x16x32_bf16 v[12:15], v[168:171], v[220:223], 0
    s_waitcnt vmcnt(7)
    s_barrier
    s_add_u32 m0, s60, 94208
    s_add_u32 s62, s58, 786432
    buffer_load_dwordx4 v243, s[40:43], s62 offen  lds
    buffer_load_dwordx4 v244, s[40:43], s62 offen offset:1024  lds
    buffer_load_dwordx4 v245, s[40:43], s62 offen offset:2048  lds
    s_add_u32 m0, s60, 106496
    s_add_u32 s62, s58, 786816
    buffer_load_dwordx4 v243, s[40:43], s62 offen  lds
    buffer_load_dwordx4 v244, s[40:43], s62 offen offset:1024  lds
    buffer_load_dwordx4 v245, s[40:43], s62 offen offset:2048  lds
    s_add_u32 m0, s60, 118784
    s_add_u32 s62, s58, 787200
    buffer_load_dwordx4 v243, s[40:43], s62 offen  lds
    buffer_load_dwordx4 v244, s[40:43], s62 offen offset:1024  lds
    buffer_load_dwordx4 v245, s[40:43], s62 offen offset:2048  lds
    s_add_u32 m0, s71, 28672
    s_add_u32 s63, s70, 256
    buffer_load_dwordx4 v246, s[48:51], s63 offen  lds
    s_add_u32 m0, s71, 32768
    s_add_u32 s63, s70, 41216
    buffer_load_dwordx4 v246, s[48:51], s63 offen  lds
    s_add_u32 m0, s71, 36864
    s_add_u32 s63, s70, 82176
    buffer_load_dwordx4 v246, s[48:51], s63 offen  lds
    s_add_u32 s63, s71, 40960
    s_cmp_ge_u32 s56, 2
    s_cselect_b32 m0, s73, s63
    s_add_u32 s63, s70, 123136
    buffer_load_dwordx4 v246, s[48:51], s63 offen  lds
    s_cmp_lg_u32 s52, 0
    s_cbranch_scc1 qp_wt0
    s_add_u32 s61, s8, 2359296
    buffer_load_dword v247, v254, s[40:43], s61 offen
qp_wt0:
    v_mfma_f32_16x16x32_bf16 v[16:19], v[172:175], v[220:223], 0
    v_mfma_f32_16x16x32_bf16 v[20:23], v[176:179], v[220:223], 0
    ds_read_b128 v[220:223], v238 offset:10240
    s_waitcnt lgkmcnt(3)
    v_mfma_f32_16x16x32_bf16 v[24:27], v[168:171], v[224:227], 0
    ds_read_b64_tr_b16 v[192:193], v235 offset:0
    v_mfma_f32_16x16x32_bf16 v[28:31], v[172:175], v[224:227], 0
    ds_read_b64_tr_b16 v[194:195], v235 offset:1536
    v_mfma_f32_16x16x32_bf16 v[32:35], v[176:179], v[224:227], 0
    ds_read_b128 v[224:227], v238 offset:12288
    s_waitcnt lgkmcnt(5)
    v_mfma_f32_16x16x32_bf16 v[36:39], v[168:171], v[228:231], 0
    ds_read_b64_tr_b16 v[196:197], v236 offset:0
    v_mfma_f32_16x16x32_bf16 v[40:43], v[172:175], v[228:231], 0
    ds_read_b64_tr_b16 v[198:199], v236 offset:1536
    v_mfma_f32_16x16x32_bf16 v[44:47], v[176:179], v[228:231], 0
    ds_read_b128 v[228:231], v239 offset:0
    s_waitcnt lgkmcnt(7)
    v_mfma_f32_16x16x32_bf16 v[48:51], v[168:171], v[216:219], 0
    ds_read_b64_tr_b16 v[200:201], v237 offset:0
    v_mfma_f32_16x16x32_bf16 v[52:55], v[172:175], v[216:219], 0
    ds_read_b64_tr_b16 v[202:203], v237 offset:1536
    s_waitcnt lgkmcnt(0)
    s_waitcnt vmcnt(17)
    s_barrier
    s_add_u32 m0, s60, 43008
    s_add_u32 s62, s58, 1179648
    buffer_load_dwordx4 v243, s[40:43], s62 offen  lds
    buffer_load_dwordx4 v244, s[40:43], s62 offen offset:1024  lds
    buffer_load_dwordx4 v245, s[40:43], s62 offen offset:2048  lds
    s_add_u32 m0, s60, 55296
    s_add_u32 s62, s58, 1180032
    buffer_load_dwordx4 v243, s[40:43], s62 offen  lds
    buffer_load_dwordx4 v244, s[40:43], s62 offen offset:1024  lds
    buffer_load_dwordx4 v245, s[40:43], s62 offen offset:2048  lds
    v_mfma_f32_16x16x32_bf16 v[56:59], v[176:179], v[216:219], 0
    ds_read_b128 v[216:219], v239 offset:2048
    v_mfma_f32_16x16x32_bf16 v[60:63], v[168:171], v[220:223], 0
    v_mfma_f32_16x16x32_bf16 v[64:67], v[172:175], v[220:223], 0
    v_mfma_f32_16x16x32_bf16 v[68:71], v[176:179], v[220:223], 0
    ds_read_b128 v[220:223], v239 offset:4096
    v_mfma_f32_16x16x32_bf16 v[72:75], v[168:171], v[224:227], 0
    v_mfma_f32_16x16x32_bf16 v[76:79], v[172:175], v[224:227], 0
    v_mfma_f32_16x16x32_bf16 v[80:83], v[176:179], v[224:227], 0
    ds_read_b128 v[224:227], v239 offset:6144
    v_mfma_f32_16x16x32_bf16 v[0:3], v[192:195], v[228:231], v[0:3]
    v_mfma_f32_16x16x32_bf16 v[4:7], v[196:199], v[228:231], v[4:7]
    v_mfma_f32_16x16x32_bf16 v[8:11], v[200:203], v[228:231], v[8:11]
    ds_read_b128 v[228:231], v239 offset:8192
    s_waitcnt lgkmcnt(3)
    v_mfma_f32_16x16x32_bf16 v[12:15], v[192:195], v[216:219], v[12:15]
    s_waitcnt vmcnt(13)
    s_barrier
    s_add_u32 m0, s60, 67584
    s_add_u32 s62, s58, 1180416
    buffer_load_dwordx4 v243, s[40:43], s62 offen  lds
    buffer_load_dwordx4 v244, s[40:43], s62 offen offset:1024  lds
    buffer_load_dwordx4 v245, s[40:43], s62 offen offset:2048  lds
    s_cmp_lg_u32 s52, 1
    s_cbranch_scc1 qp_wt1
    s_add_u32 s61, s8, 2752512
    buffer_load_dword v247, v254, s[40:43], s61 offen
qp_wt1:
    v_mfma_f32_16x16x32_bf16 v[16:19], v[196:199], v[216:219], v[16:19]
    v_mfma_f32_16x16x32_bf16 v[20:23], v[200:203], v[216:219], v[20:23]
    ds_read_b128 v[216:219], v239 offset:10240
    s_waitcnt lgkmcnt(3)
    v_mfma_f32_16x16x32_bf16 v[24:27], v[192:195], v[220:223], v[24:27]
    ds_read_b64_tr_b16 v[168:169], v232 offset:0
    v_mfma_f32_16x16x32_bf16 v[28:31], v[196:199], v[220:223], v[28:31]
    ds_read_b64_tr_b16 v[170:171], v232 offset:1536
    v_mfma_f32_16x16x32_bf16 v[32:35], v[200:203], v[220:223], v[32:35]
    ds_read_b128 v[220:223], v239 offset:12288
    s_waitcnt lgkmcnt(5)
    v_mfma_f32_16x16x32_bf16 v[36:39], v[192:195], v[224:227], v[36:39]
    ds_read_b64_tr_b16 v[172:173], v233 offset:0
    v_mfma_f32_16x16x32_bf16 v[40:43], v[196:199], v[224:227], v[40:43]
    ds_read_b64_tr_b16 v[174:175], v233 offset:1536
    v_mfma_f32_16x16x32_bf16 v[44:47], v[200:203], v[224:227], v[44:47]
    ds_read_b128 v[224:227], v238 offset:14336
    s_waitcnt lgkmcnt(7)
    v_mfma_f32_16x16x32_bf16 v[48:51], v[192:195], v[228:231], v[48:51]
    ds_read_b64_tr_b16 v[176:177], v234 offset:0
    v_mfma_f32_16x16x32_bf16 v[52:55], v[196:199], v[228:231], v[52:55]
    ds_read_b64_tr_b16 v[178:179], v234 offset:1536
    s_waitcnt lgkmcnt(0)
    s_waitcnt vmcnt(13)
    s_barrier
    s_add_u32 m0, s60, 94208
    s_add_u32 s62, s58, 1572864
    buffer_load_dwordx4 v243, s[40:43], s62 offen  lds
    buffer_load_dwordx4 v244, s[40:43], s62 offen offset:1024  lds
    buffer_load_dwordx4 v245, s[40:43], s62 offen offset:2048  lds
    s_add_u32 m0, s60, 106496
    s_add_u32 s62, s58, 1573248
    buffer_load_dwordx4 v243, s[40:43], s62 offen  lds
    buffer_load_dwordx4 v244, s[40:43], s62 offen offset:1024  lds
    buffer_load_dwordx4 v245, s[40:43], s62 offen offset:2048  lds
    v_mfma_f32_16x16x32_bf16 v[56:59], v[200:203], v[228:231], v[56:59]
    ds_read_b128 v[228:231], v238 offset:16384
    v_mfma_f32_16x16x32_bf16 v[60:63], v[192:195], v[216:219], v[60:63]
    v_mfma_f32_16x16x32_bf16 v[64:67], v[196:199], v[216:219], v[64:67]
    v_mfma_f32_16x16x32_bf16 v[68:71], v[200:203], v[216:219], v[68:71]
    ds_read_b128 v[216:219], v238 offset:18432
    v_mfma_f32_16x16x32_bf16 v[72:75], v[192:195], v[220:223], v[72:75]
    v_mfma_f32_16x16x32_bf16 v[76:79], v[196:199], v[220:223], v[76:79]
    v_mfma_f32_16x16x32_bf16 v[80:83], v[200:203], v[220:223], v[80:83]
    ds_read_b128 v[220:223], v238 offset:20480
    v_mfma_f32_16x16x32_bf16 v[0:3], v[168:171], v[224:227], v[0:3]
    v_mfma_f32_16x16x32_bf16 v[4:7], v[172:175], v[224:227], v[4:7]
    v_mfma_f32_16x16x32_bf16 v[8:11], v[176:179], v[224:227], v[8:11]
    ds_read_b128 v[224:227], v238 offset:22528
    s_waitcnt lgkmcnt(3)
    v_mfma_f32_16x16x32_bf16 v[12:15], v[168:171], v[228:231], v[12:15]
    s_waitcnt vmcnt(9)
    s_barrier
    s_add_u32 m0, s60, 118784
    s_add_u32 s62, s58, 1573632
    buffer_load_dwordx4 v243, s[40:43], s62 offen  lds
    buffer_load_dwordx4 v244, s[40:43], s62 offen offset:1024  lds
    buffer_load_dwordx4 v245, s[40:43], s62 offen offset:2048  lds
    s_add_u32 m0, s71, 0
    s_add_u32 s63, s70, 384
    buffer_load_dwordx4 v246, s[48:51], s63 offen  lds
    s_add_u32 m0, s71, 4096
    s_add_u32 s63, s70, 41344
    buffer_load_dwordx4 v246, s[48:51], s63 offen  lds
    s_add_u32 m0, s71, 8192
    s_add_u32 s63, s70, 82304
    buffer_load_dwordx4 v246, s[48:51], s63 offen  lds
    s_add_u32 s63, s71, 12288
    s_cmp_ge_u32 s56, 2
    s_cselect_b32 m0, s73, s63
    s_add_u32 s63, s70, 123264
    buffer_load_dwordx4 v246, s[48:51], s63 offen  lds
    s_cmp_lg_u32 s52, 2
    s_cbranch_scc1 qp_wt2
    s_add_u32 s61, s8, 3145728
    buffer_load_dword v247, v254, s[40:43], s61 offen
qp_wt2:
    v_mfma_f32_16x16x32_bf16 v[16:19], v[172:175], v[228:231], v[16:19]
    v_mfma_f32_16x16x32_bf16 v[20:23], v[176:179], v[228:231], v[20:23]
    ds_read_b128 v[228:231], v238 offset:24576
    s_waitcnt lgkmcnt(3)
    v_mfma_f32_16x16x32_bf16 v[24:27], v[168:171], v[216:219], v[24:27]
    ds_read_b64_tr_b16 v[192:193], v235 offset:0
    v_mfma_f32_16x16x32_bf16 v[28:31], v[172:175], v[216:219], v[28:31]
    ds_read_b64_tr_b16 v[194:195], v235 offset:1536
    v_mfma_f32_16x16x32_bf16 v[32:35], v[176:179], v[216:219], v[32:35]
    ds_read_b128 v[216:219], v238 offset:26624
    s_waitcnt lgkmcnt(5)
    v_mfma_f32_16x16x32_bf16 v[36:39], v[168:171], v[220:223], v[36:39]
    ds_read_b64_tr_b16 v[196:197], v236 offset:0
    v_mfma_f32_16x16x32_bf16 v[40:43], v[172:175], v[220:223], v[40:43]
    ds_read_b64_tr_b16 v[198:199], v236 offset:1536
    v_mfma_f32_16x16x32_bf16 v[44:47], v[176:179], v[220:223], v[44:47]
    ds_read_b128 v[220:223], v239 offset:14336
    s_waitcnt lgkmcnt(7)
    v_mfma_f32_16x16x32_bf16 v[48:51], v[168:171], v[224:227], v[48:51]
    ds_read_b64_tr_b16 v[200:201], v237 offset:0
    v_mfma_f32_16x16x32_bf16 v[52:55], v[172:175], v[224:227], v[52:55]
    ds_read_b64_tr_b16 v[202:203], v237 offset:1536
    s_waitcnt lgkmcnt(0)
    s_waitcnt vmcnt(13)
    s_barrier
    s_add_u32 m0, s60, 43008
    s_add_u32 s62, s58, 1966080
    buffer_load_dwordx4 v243, s[40:43], s62 offen  lds
    buffer_load_dwordx4 v244, s[40:43], s62 offen offset:1024  lds
    buffer_load_dwordx4 v245, s[40:43], s62 offen offset:2048  lds
    s_add_u32 m0, s60, 55296
    s_add_u32 s62, s58, 1966464
    buffer_load_dwordx4 v243, s[40:43], s62 offen  lds
    buffer_load_dwordx4 v244, s[40:43], s62 offen offset:1024  lds
    buffer_load_dwordx4 v245, s[40:43], s62 offen offset:2048  lds
    v_mfma_f32_16x16x32_bf16 v[56:59], v[176:179], v[224:227], v[56:59]
    ds_read_b128 v[224:227], v239 offset:16384
    v_mfma_f32_16x16x32_bf16 v[60:63], v[168:171], v[228:231], v[60:63]
    v_mfma_f32_16x16x32_bf16 v[64:67], v[172:175], v[228:231], v[64:67]
    v_mfma_f32_16x16x32_bf16 v[68:71], v[176:179], v[228:231], v[68:71]
    ds_read_b128 v[228:231], v239 offset:18432
    v_mfma_f32_16x16x32_bf16 v[72:75], v[168:171], v[216:219], v[72:75]
    v_mfma_f32_16x16x32_bf16 v[76:79], v[172:175], v[216:219], v[76:79]
    v_mfma_f32_16x16x32_bf16 v[80:83], v[176:179], v[216:219], v[80:83]
    ds_read_b128 v[216:219], v239 offset:20480
    v_mfma_f32_16x16x32_bf16 v[0:3], v[192:195], v[220:223], v[0:3]
    v_mfma_f32_16x16x32_bf16 v[4:7], v[196:199], v[220:223], v[4:7]
    v_mfma_f32_16x16x32_bf16 v[8:11], v[200:203], v[220:223], v[8:11]
    ds_read_b128 v[220:223], v239 offset:22528
    s_waitcnt lgkmcnt(3)
    v_mfma_f32_16x16x32_bf16 v[12:15], v[192:195], v[224:227], v[12:15]
    s_waitcnt vmcnt(13)
    s_barrier
    s_add_u32 m0, s60, 67584
    s_add_u32 s62, s58, 1966848
    buffer_load_dwordx4 v243, s[40:43], s62 offen  lds
    buffer_load_dwordx4 v244, s[40:43], s62 offen offset:1024  lds
    buffer_load_dwordx4 v245, s[40:43], s62 offen offset:2048  lds
    s_cmp_lg_u32 s52, 3
    s_cbranch_scc1 qp_wt3
    s_add_u32 s61, s8, 3538944
    buffer_load_dword v247, v254, s[40:43], s61 offen
qp_wt3:
    v_mfma_f32_16x16x32_bf16 v[16:19], v[196:199], v[224:227], v[16:19]
    v_mfma_f32_16x16x32_bf16 v[20:23], v[200:203], v[224:227], v[20:23]
    ds_read_b128 v[224:227], v239 offset:24576
    s_waitcnt lgkmcnt(3)
    v_mfma_f32_16x16x32_bf16 v[24:27], v[192:195], v[228:231], v[24:27]
    ds_read_b64_tr_b16 v[168:169], v232 offset:0
    v_mfma_f32_16x16x32_bf16 v[28:31], v[196:199], v[228:231], v[28:31]
    ds_read_b64_tr_b16 v[170:171], v232 offset:1536
    v_mfma_f32_16x16x32_bf16 v[32:35], v[200:203], v[228:231], v[32:35]
    ds_read_b128 v[228:231], v239 offset:26624
    s_waitcnt lgkmcnt(5)
    v_mfma_f32_16x16x32_bf16 v[36:39], v[192:195], v[216:219], v[36:39]
    ds_read_b64_tr_b16 v[172:173], v233 offset:0
    v_mfma_f32_16x16x32_bf16 v[40:43], v[196:199], v[216:219], v[40:43]
    ds_read_b64_tr_b16 v[174:175], v233 offset:1536
    v_mfma_f32_16x16x32_bf16 v[44:47], v[200:203], v[216:219], v[44:47]
    ds_read_b128 v[216:219], v238 offset:28672
    s_waitcnt lgkmcnt(7)
    v_mfma_f32_16x16x32_bf16 v[48:51], v[192:195], v[220:223], v[48:51]
    ds_read_b64_tr_b16 v[176:177], v234 offset:0
    v_mfma_f32_16x16x32_bf16 v[52:55], v[196:199], v[220:223], v[52:55]
    ds_read_b64_tr_b16 v[178:179], v234 offset:1536
    s_waitcnt lgkmcnt(0)
    s_waitcnt vmcnt(13)
    s_barrier
    s_add_u32 m0, s60, 94208
    s_add_u32 s62, s58, 2359296
    buffer_load_dwordx4 v243, s[40:43], s62 offen  lds
    buffer_load_dwordx4 v244, s[40:43], s62 offen offset:1024  lds
    buffer_load_dwordx4 v245, s[40:43], s62 offen offset:2048  lds
    s_add_u32 m0, s60, 106496
    s_add_u32 s62, s58, 2359680
    buffer_load_dwordx4 v243, s[40:43], s62 offen  lds
    buffer_load_dwordx4 v244, s[40:43], s62 offen offset:1024  lds
    buffer_load_dwordx4 v245, s[40:43], s62 offen offset:2048  lds
    v_mfma_f32_16x16x32_bf16 v[56:59], v[200:203], v[220:223], v[56:59]
    ds_read_b128 v[220:223], v238 offset:30720
    v_mfma_f32_16x16x32_bf16 v[60:63], v[192:195], v[224:227], v[60:63]
    v_mfma_f32_16x16x32_bf16 v[64:67], v[196:199], v[224:227], v[64:67]
    v_mfma_f32_16x16x32_bf16 v[68:71], v[200:203], v[224:227], v[68:71]
    ds_read_b128 v[224:227], v238 offset:32768
    v_mfma_f32_16x16x32_bf16 v[72:75], v[192:195], v[228:231], v[72:75]
    v_mfma_f32_16x16x32_bf16 v[76:79], v[196:199], v[228:231], v[76:79]
    v_mfma_f32_16x16x32_bf16 v[80:83], v[200:203], v[228:231], v[80:83]
    ds_read_b128 v[228:231], v238 offset:34816
    v_mfma_f32_16x16x32_bf16 v[0:3], v[168:171], v[216:219], v[0:3]
    v_mfma_f32_16x16x32_bf16 v[4:7], v[172:175], v[216:219], v[4:7]
    v_mfma_f32_16x16x32_bf16 v[8:11], v[176:179], v[216:219], v[8:11]
    ds_read_b128 v[216:219], v238 offset:36864
    s_waitcnt lgkmcnt(3)
    v_mfma_f32_16x16x32_bf16 v[12:15], v[168:171], v[220:223], v[12:15]
    s_waitcnt vmcnt(9)
    s_barrier
    s_add_u32 m0, s60, 118784
    s_add_u32 s62, s58, 2360064
    buffer_load_dwordx4 v243, s[40:43], s62 offen  lds
    buffer_load_dwordx4 v244, s[40:43], s62 offen offset:1024  lds
    buffer_load_dwordx4 v245, s[40:43], s62 offen offset:2048  lds
    s_add_u32 m0, s71, 14336
    s_add_u32 s63, s70, 512
    buffer_load_dwordx4 v246, s[48:51], s63 offen  lds
    s_add_u32 m0, s71, 18432
    s_add_u32 s63, s70, 41472
    buffer_load_dwordx4 v246, s[48:51], s63 offen  lds
    s_add_u32 m0, s71, 22528
    s_add_u32 s63, s70, 82432
    buffer_load_dwordx4 v246, s[48:51], s63 offen  lds
    s_add_u32 s63, s71, 26624
    s_cmp_ge_u32 s56, 2
    s_cselect_b32 m0, s73, s63
    s_add_u32 s63, s70, 123392
    buffer_load_dwordx4 v246, s[48:51], s63 offen  lds
    s_cmp_lg_u32 s52, 0
    s_cbranch_scc1 qp_wt4
    s_add_u32 s61, s8, 3932160
    buffer_load_dword v247, v254, s[40:43], s61 offen
qp_wt4:
    v_mfma_f32_16x16x32_bf16 v[16:19], v[172:175], v[220:223], v[16:19]
    v_mfma_f32_16x16x32_bf16 v[20:23], v[176:179], v[220:223], v[20:23]
    ds_read_b128 v[220:223], v238 offset:38912
    s_waitcnt lgkmcnt(3)
    v_mfma_f32_16x16x32_bf16 v[24:27], v[168:171], v[224:227], v[24:27]
    ds_read_b64_tr_b16 v[192:193], v235 offset:0
    v_mfma_f32_16x16x32_bf16 v[28:31], v[172:175], v[224:227], v[28:31]
    ds_read_b64_tr_b16 v[194:195], v235 offset:1536
    v_mfma_f32_16x16x32_bf16 v[32:35], v[176:179], v[224:227], v[32:35]
    ds_read_b128 v[224:227], v238 offset:40960
    s_waitcnt lgkmcnt(5)
    v_mfma_f32_16x16x32_bf16 v[36:39], v[168:171], v[228:231], v[36:39]
    ds_read_b64_tr_b16 v[196:197], v236 offset:0
    v_mfma_f32_16x16x32_bf16 v[40:43], v[172:175], v[228:231], v[40:43]
    ds_read_b64_tr_b16 v[198:199], v236 offset:1536
    v_mfma_f32_16x16x32_bf16 v[44:47], v[176:179], v[228:231], v[44:47]
    ds_read_b128 v[228:231], v239 offset:28672
    s_waitcnt lgkmcnt(7)
    v_mfma_f32_16x16x32_bf16 v[48:51], v[168:171], v[216:219], v[48:51]
    ds_read_b64_tr_b16 v[200:201], v237 offset:0
    v_mfma_f32_16x16x32_bf16 v[52:55], v[172:175], v[216:219], v[52:55]
    ds_read_b64_tr_b16 v[202:203], v237 offset:1536
    s_waitcnt lgkmcnt(0)
    s_waitcnt vmcnt(13)
    s_barrier
    s_add_u32 m0, s60, 43008
    s_add_u32 s62, s58, 2752512
    buffer_load_dwordx4 v243, s[40:43], s62 offen  lds
    buffer_load_dwordx4 v244, s[40:43], s62 offen offset:1024  lds
    buffer_load_dwordx4 v245, s[40:43], s62 offen offset:2048  lds
    s_add_u32 m0, s60, 55296
    s_add_u32 s62, s58, 2752896
    buffer_load_dwordx4 v243, s[40:43], s62 offen  lds
    buffer_load_dwordx4 v244, s[40:43], s62 offen offset:1024  lds
    buffer_load_dwordx4 v245, s[40:43], s62 offen offset:2048  lds
    v_mfma_f32_16x16x32_bf16 v[56:59], v[176:179], v[216:219], v[56:59]
    ds_read_b128 v[216:219], v239 offset:30720
    v_mfma_f32_16x16x32_bf16 v[60:63], v[168:171], v[220:223], v[60:63]
    v_mfma_f32_16x16x32_bf16 v[64:67], v[172:175], v[220:223], v[64:67]
    v_mfma_f32_16x16x32_bf16 v[68:71], v[176:179], v[220:223], v[68:71]
    ds_read_b128 v[220:223], v239 offset:32768
    v_mfma_f32_16x16x32_bf16 v[72:75], v[168:171], v[224:227], v[72:75]
    v_mfma_f32_16x16x32_bf16 v[76:79], v[172:175], v[224:227], v[76:79]
    v_mfma_f32_16x16x32_bf16 v[80:83], v[176:179], v[224:227], v[80:83]
    ds_read_b128 v[224:227], v239 offset:34816
    v_mfma_f32_16x16x32_bf16 v[0:3], v[192:195], v[228:231], v[0:3]
    v_mfma_f32_16x16x32_bf16 v[4:7], v[196:199], v[228:231], v[4:7]
    v_mfma_f32_16x16x32_bf16 v[8:11], v[200:203], v[228:231], v[8:11]
    ds_read_b128 v[228:231], v239 offset:36864
    s_waitcnt lgkmcnt(3)
    v_mfma_f32_16x16x32_bf16 v[12:15], v[192:195], v[216:219], v[12:15]
    s_waitcnt vmcnt(13)
    s_barrier
    s_add_u32 m0, s60, 67584
    s_add_u32 s62, s58, 2753280
    buffer_load_dwordx4 v243, s[40:43], s62 offen  lds
    buffer_load_dwordx4 v244, s[40:43], s62 offen offset:1024  lds
    buffer_load_dwordx4 v245, s[40:43], s62 offen offset:2048  lds
    s_cmp_lg_u32 s52, 1
    s_cbranch_scc1 qp_wt5
    s_add_u32 s61, s8, 4325376
    buffer_load_dword v247, v254, s[40:43], s61 offen
qp_wt5:
    v_mfma_f32_16x16x32_bf16 v[16:19], v[196:199], v[216:219], v[16:19]
    v_mfma_f32_16x16x32_bf16 v[20:23], v[200:203], v[216:219], v[20:23]
    ds_read_b128 v[216:219], v239 offset:38912
    s_waitcnt lgkmcnt(3)
    v_mfma_f32_16x16x32_bf16 v[24:27], v[192:195], v[220:223], v[24:27]
    ds_read_b64_tr_b16 v[168:169], v232 offset:0
    v_mfma_f32_16x16x32_bf16 v[28:31], v[196:199], v[220:223], v[28:31]
    ds_read_b64_tr_b16 v[170:171], v232 offset:1536
    v_mfma_f32_16x16x32_bf16 v[32:35], v[200:203], v[220:223], v[32:35]
    ds_read_b128 v[220:223], v239 offset:40960
    s_waitcnt lgkmcnt(5)
    v_mfma_f32_16x16x32_bf16 v[36:39], v[192:195], v[224:227], v[36:39]
    ds_read_b64_tr_b16 v[172:173], v233 offset:0
    v_mfma_f32_16x16x32_bf16 v[40:43], v[196:199], v[224:227], v[40:43]
    ds_read_b64_tr_b16 v[174:175], v233 offset:1536
    v_mfma_f32_16x16x32_bf16 v[44:47], v[200:203], v[224:227], v[44:47]
    ds_read_b128 v[224:227], v238 offset:0
    s_waitcnt lgkmcnt(7)
    v_mfma_f32_16x16x32_bf16 v[48:51], v[192:195], v[228:231], v[48:51]
    ds_read_b64_tr_b16 v[176:177], v234 offset:0
    v_mfma_f32_16x16x32_bf16 v[52:55], v[196:199], v[228:231], v[52:55]
    ds_read_b64_tr_b16 v[178:179], v234 offset:1536
    s_waitcnt lgkmcnt(0)
    s_waitcnt vmcnt(13)
    s_barrier
    s_add_u32 m0, s60, 94208
    s_add_u32 s62, s58, 3145728
    buffer_load_dwordx4 v243, s[40:43], s62 offen  lds
    buffer_load_dwordx4 v244, s[40:43], s62 offen offset:1024  lds
    buffer_load_dwordx4 v245, s[40:43], s62 offen offset:2048  lds
    s_add_u32 m0, s60, 106496
    s_add_u32 s62, s58, 3146112
    buffer_load_dwordx4 v243, s[40:43], s62 offen  lds
    buffer_load_dwordx4 v244, s[40:43], s62 offen offset:1024  lds
    buffer_load_dwordx4 v245, s[40:43], s62 offen offset:2048  lds
    v_mfma_f32_16x16x32_bf16 v[56:59], v[200:203], v[228:231], v[56:59]
    ds_read_b128 v[228:231], v238 offset:2048
    v_mfma_f32_16x16x32_bf16 v[60:63], v[192:195], v[216:219], v[60:63]
    v_mfma_f32_16x16x32_bf16 v[64:67], v[196:199], v[216:219], v[64:67]
    v_mfma_f32_16x16x32_bf16 v[68:71], v[200:203], v[216:219], v[68:71]
    ds_read_b128 v[216:219], v238 offset:4096
    v_mfma_f32_16x16x32_bf16 v[72:75], v[192:195], v[220:223], v[72:75]
    v_mfma_f32_16x16x32_bf16 v[76:79], v[196:199], v[220:223], v[76:79]
    v_mfma_f32_16x16x32_bf16 v[80:83], v[200:203], v[220:223], v[80:83]
    ds_read_b128 v[220:223], v238 offset:6144
    v_mfma_f32_16x16x32_bf16 v[0:3], v[168:171], v[224:227], v[0:3]
    v_mfma_f32_16x16x32_bf16 v[4:7], v[172:175], v[224:227], v[4:7]
    v_mfma_f32_16x16x32_bf16 v[8:11], v[176:179], v[224:227], v[8:11]
    ds_read_b128 v[224:227], v238 offset:8192
    s_waitcnt lgkmcnt(3)
    v_mfma_f32_16x16x32_bf16 v[12:15], v[168:171], v[228:231], v[12:15]
    s_waitcnt vmcnt(9)
    s_barrier
    s_add_u32 m0, s60, 118784
    s_add_u32 s62, s58, 3146496
    buffer_load_dwordx4 v243, s[40:43], s62 offen  lds
    buffer_load_dwordx4 v244, s[40:43], s62 offen offset:1024  lds
    buffer_load_dwordx4 v245, s[40:43], s62 offen offset:2048  lds
    s_add_u32 m0, s71, 28672
    s_add_u32 s63, s70, 640
    buffer_load_dwordx4 v246, s[48:51], s63 offen  lds
    s_add_u32 m0, s71, 32768
    s_add_u32 s63, s70, 41600
    buffer_load_dwordx4 v246, s[48:51], s63 offen  lds
    s_add_u32 m0, s71, 36864
    s_add_u32 s63, s70, 82560
    buffer_load_dwordx4 v246, s[48:51], s63 offen  lds
    s_add_u32 s63, s71, 40960
    s_cmp_ge_u32 s56, 2
    s_cselect_b32 m0, s73, s63
    s_add_u32 s63, s70, 123520
    buffer_load_dwordx4 v246, s[48:51], s63 offen  lds
    s_cmp_lg_u32 s52, 2
    s_cbranch_scc1 qp_wt6
    s_add_u32 s61, s8, 4718592
    buffer_load_dword v247, v254, s[40:43], s61 offen
qp_wt6:
    v_mfma_f32_16x16x32_bf16 v[16:19], v[172:175], v[228:231], v[16:19]
    v_mfma_f32_16x16x32_bf16 v[20:23], v[176:179], v[228:231], v[20:23]
    ds_read_b128 v[228:231], v238 offset:10240
    s_waitcnt lgkmcnt(3)
    v_mfma_f32_16x16x32_bf16 v[24:27], v[168:171], v[216:219], v[24:27]
    ds_read_b64_tr_b16 v[192:193], v235 offset:0
    v_mfma_f32_16x16x32_bf16 v[28:31], v[172:175], v[216:219], v[28:31]
    ds_read_b64_tr_b16 v[194:195], v235 offset:1536
    v_mfma_f32_16x16x32_bf16 v[32:35], v[176:179], v[216:219], v[32:35]
    ds_read_b128 v[216:219], v238 offset:12288
    s_waitcnt lgkmcnt(5)
    v_mfma_f32_16x16x32_bf16 v[36:39], v[168:171], v[220:223], v[36:39]
    ds_read_b64_tr_b16 v[196:197], v236 offset:0
    v_mfma_f32_16x16x32_bf16 v[40:43], v[172:175], v[220:223], v[40:43]
    ds_read_b64_tr_b16 v[198:199], v236 offset:1536
    v_mfma_f32_16x16x32_bf16 v[44:47], v[176:179], v[220:223], v[44:47]
    ds_read_b128 v[220:223], v239 offset:0
    s_waitcnt lgkmcnt(7)
    v_mfma_f32_16x16x32_bf16 v[48:51], v[168:171], v[224:227], v[48:51]
    ds_read_b64_tr_b16 v[200:201], v237 offset:0
    v_mfma_f32_16x16x32_bf16 v[52:55], v[172:175], v[224:227], v[52:55]
    ds_read_b64_tr_b16 v[202:203], v237 offset:1536
    s_waitcnt lgkmcnt(0)
    s_waitcnt vmcnt(13)
    s_barrier
    s_add_u32 m0, s60, 43008
    s_add_u32 s62, s58, 3538944
    buffer_load_dwordx4 v243, s[40:43], s62 offen  lds
    buffer_load_dwordx4 v244, s[40:43], s62 offen offset:1024  lds
    buffer_load_dwordx4 v245, s[40:43], s62 offen offset:2048  lds
    s_add_u32 m0, s60, 55296
    s_add_u32 s62, s58, 3539328
    buffer_load_dwordx4 v243, s[40:43], s62 offen  lds
    buffer_load_dwordx4 v244, s[40:43], s62 offen offset:1024  lds
    buffer_load_dwordx4 v245, s[40:43], s62 offen offset:2048  lds
    v_mfma_f32_16x16x32_bf16 v[56:59], v[176:179], v[224:227], v[56:59]
    ds_read_b128 v[224:227], v239 offset:2048
    v_mfma_f32_16x16x32_bf16 v[60:63], v[168:171], v[228:231], v[60:63]
    v_mfma_f32_16x16x32_bf16 v[64:67], v[172:175], v[228:231], v[64:67]
    v_mfma_f32_16x16x32_bf16 v[68:71], v[176:179], v[228:231], v[68:71]
    ds_read_b128 v[228:231], v239 offset:4096
    v_mfma_f32_16x16x32_bf16 v[72:75], v[168:171], v[216:219], v[72:75]
    v_mfma_f32_16x16x32_bf16 v[76:79], v[172:175], v[216:219], v[76:79]
    v_mfma_f32_16x16x32_bf16 v[80:83], v[176:179], v[216:219], v[80:83]
    ds_read_b128 v[216:219], v239 offset:6144
    v_mfma_f32_16x16x32_bf16 v[0:3], v[192:195], v[220:223], v[0:3]
    v_mfma_f32_16x16x32_bf16 v[4:7], v[196:199], v[220:223], v[4:7]
    v_mfma_f32_16x16x32_bf16 v[8:11], v[200:203], v[220:223], v[8:11]
    ds_read_b128 v[220:223], v239 offset:8192
    s_waitcnt lgkmcnt(3)
    v_mfma_f32_16x16x32_bf16 v[12:15], v[192:195], v[224:227], v[12:15]
    s_waitcnt vmcnt(13)
    s_barrier
    s_add_u32 m0, s60, 67584
    s_add_u32 s62, s58, 3539712
    buffer_load_dwordx4 v243, s[40:43], s62 offen  lds
    buffer_load_dwordx4 v244, s[40:43], s62 offen offset:1024  lds
    buffer_load_dwordx4 v245, s[40:43], s62 offen offset:2048  lds
    s_cmp_lg_u32 s52, 3
    s_cbranch_scc1 qp_wt7
    s_add_u32 s61, s8, 5111808
    buffer_load_dword v247, v254, s[40:43], s61 offen
qp_wt7:
    v_mfma_f32_16x16x32_bf16 v[16:19], v[196:199], v[224:227], v[16:19]
    v_mfma_f32_16x16x32_bf16 v[20:23], v[200:203], v[224:227], v[20:23]
    ds_read_b128 v[224:227], v239 offset:10240
    s_waitcnt lgkmcnt(3)
    v_mfma_f32_16x16x32_bf16 v[24:27], v[192:195], v[228:231], v[24:27]
    ds_read_b64_tr_b16 v[168:169], v232 offset:0
    v_mfma_f32_16x16x32_bf16 v[28:31], v[196:199], v[228:231], v[28:31]
    ds_read_b64_tr_b16 v[170:171], v232 offset:1536
    v_mfma_f32_16x16x32_bf16 v[32:35], v[200:203], v[228:231], v[32:35]
    ds_read_b128 v[228:231], v239 offset:12288
    s_waitcnt lgkmcnt(5)
    v_mfma_f32_16x16x32_bf16 v[36:39], v[192:195], v[216:219], v[36:39]
    ds_read_b64_tr_b16 v[172:173], v233 offset:0
    v_mfma_f32_16x16x32_bf16 v[40:43], v[196:199], v[216:219], v[40:43]
    ds_read_b64_tr_b16 v[174:175], v233 offset:1536
    v_mfma_f32_16x16x32_bf16 v[44:47], v[200:203], v[216:219], v[44:47]
    ds_read_b128 v[216:219], v238 offset:14336
    s_waitcnt lgkmcnt(7)
    v_mfma_f32_16x16x32_bf16 v[48:51], v[192:195], v[220:223], v[48:51]
    ds_read_b64_tr_b16 v[176:177], v234 offset:0
    v_mfma_f32_16x16x32_bf16 v[52:55], v[196:199], v[220:223], v[52:55]
    ds_read_b64_tr_b16 v[178:179], v234 offset:1536
    s_waitcnt lgkmcnt(0)
    s_waitcnt vmcnt(13)
    s_barrier
    s_add_u32 m0, s60, 94208
    s_add_u32 s62, s58, 3932160
    buffer_load_dwordx4 v243, s[40:43], s62 offen  lds
    buffer_load_dwordx4 v244, s[40:43], s62 offen offset:1024  lds
    buffer_load_dwordx4 v245, s[40:43], s62 offen offset:2048  lds
    s_add_u32 m0, s60, 106496
    s_add_u32 s62, s58, 3932544
    buffer_load_dwordx4 v243, s[40:43], s62 offen  lds
    buffer_load_dwordx4 v244, s[40:43], s62 offen offset:1024  lds
    buffer_load_dwordx4 v245, s[40:43], s62 offen offset:2048  lds
    v_mfma_f32_16x16x32_bf16 v[56:59], v[200:203], v[220:223], v[56:59]
    ds_read_b128 v[220:223], v238 offset:16384
    v_mfma_f32_16x16x32_bf16 v[60:63], v[192:195], v[224:227], v[60:63]
    v_mfma_f32_16x16x32_bf16 v[64:67], v[196:199], v[224:227], v[64:67]
    v_mfma_f32_16x16x32_bf16 v[68:71], v[200:203], v[224:227], v[68:71]
    ds_read_b128 v[224:227], v238 offset:18432
    v_mfma_f32_16x16x32_bf16 v[72:75], v[192:195], v[228:231], v[72:75]
    v_mfma_f32_16x16x32_bf16 v[76:79], v[196:199], v[228:231], v[76:79]
    v_mfma_f32_16x16x32_bf16 v[80:83], v[200:203], v[228:231], v[80:83]
    ds_read_b128 v[228:231], v238 offset:20480
    v_mfma_f32_16x16x32_bf16 v[0:3], v[168:171], v[216:219], v[0:3]
    v_mfma_f32_16x16x32_bf16 v[4:7], v[172:175], v[216:219], v[4:7]
    v_mfma_f32_16x16x32_bf16 v[8:11], v[176:179], v[216:219], v[8:11]
    ds_read_b128 v[216:219], v238 offset:22528
    s_waitcnt lgkmcnt(3)
    v_mfma_f32_16x16x32_bf16 v[12:15], v[168:171], v[220:223], v[12:15]
    s_waitcnt vmcnt(9)
    s_barrier
    s_add_u32 m0, s60, 118784
    s_add_u32 s62, s58, 3932928
    buffer_load_dwordx4 v243, s[40:43], s62 offen  lds
    buffer_load_dwordx4 v244, s[40:43], s62 offen offset:1024  lds
    buffer_load_dwordx4 v245, s[40:43], s62 offen offset:2048  lds
    s_add_u32 m0, s71, 0
    s_add_u32 s63, s70, 768
    buffer_load_dwordx4 v246, s[48:51], s63 offen  lds
    s_add_u32 m0, s71, 4096
    s_add_u32 s63, s70, 41728
    buffer_load_dwordx4 v246, s[48:51], s63 offen  lds
    s_add_u32 m0, s71, 8192
    s_add_u32 s63, s70, 82688
    buffer_load_dwordx4 v246, s[48:51], s63 offen  lds
    s_add_u32 s63, s71, 12288
    s_cmp_ge_u32 s56, 2
    s_cselect_b32 m0, s73, s63
    s_add_u32 s63, s70, 123648
    buffer_load_dwordx4 v246, s[48:51], s63 offen  lds
    s_cmp_lg_u32 s52, 0
    s_cbranch_scc1 qp_wt8
    s_add_u32 s61, s8, 5505024
    buffer_load_dword v247, v254, s[40:43], s61 offen
qp_wt8:
    v_mfma_f32_16x16x32_bf16 v[16:19], v[172:175], v[220:223], v[16:19]
    v_mfma_f32_16x16x32_bf16 v[20:23], v[176:179], v[220:223], v[20:23]
    ds_read_b128 v[220:223], v238 offset:24576
    s_waitcnt lgkmcnt(3)
    v_mfma_f32_16x16x32_bf16 v[24:27], v[168:171], v[224:227], v[24:27]
    ds_read_b64_tr_b16 v[192:193], v235 offset:0
    v_mfma_f32_16x16x32_bf16 v[28:31], v[172:175], v[224:227], v[28:31]
    ds_read_b64_tr_b16 v[194:195], v235 offset:1536
    v_mfma_f32_16x16x32_bf16 v[32:35], v[176:179], v[224:227], v[32:35]
    ds_read_b128 v[224:227], v238 offset:26624
    s_waitcnt lgkmcnt(5)
    v_mfma_f32_16x16x32_bf16 v[36:39], v[168:171], v[228:231], v[36:39]
    ds_read_b64_tr_b16 v[196:197], v236 offset:0
    v_mfma_f32_16x16x32_bf16 v[40:43], v[172:175], v[228:231], v[40:43]
    ds_read_b64_tr_b16 v[198:199], v236 offset:1536
    v_mfma_f32_16x16x32_bf16 v[44:47], v[176:179], v[228:231], v[44:47]
    ds_read_b128 v[228:231], v239 offset:14336
    s_waitcnt lgkmcnt(7)
    v_mfma_f32_16x16x32_bf16 v[48:51], v[168:171], v[216:219], v[48:51]
    ds_read_b64_tr_b16 v[200:201], v237 offset:0
    v_mfma_f32_16x16x32_bf16 v[52:55], v[172:175], v[216:219], v[52:55]
    ds_read_b64_tr_b16 v[202:203], v237 offset:1536
    s_waitcnt lgkmcnt(0)
    s_waitcnt vmcnt(13)
    s_barrier
    s_add_u32 m0, s60, 43008
    s_add_u32 s62, s58, 4325376
    buffer_load_dwordx4 v243, s[40:43], s62 offen  lds
    buffer_load_dwordx4 v244, s[40:43], s62 offen offset:1024  lds
    buffer_load_dwordx4 v245, s[40:43], s62 offen offset:2048  lds
    s_add_u32 m0, s60, 55296
    s_add_u32 s62, s58, 4325760
    buffer_load_dwordx4 v243, s[40:43], s62 offen  lds
    buffer_load_dwordx4 v244, s[40:43], s62 offen offset:1024  lds
    buffer_load_dwordx4 v245, s[40:43], s62 offen offset:2048  lds
    v_mfma_f32_16x16x32_bf16 v[56:59], v[176:179], v[216:219], v[56:59]
    ds_read_b128 v[216:219], v239 offset:16384
    v_mfma_f32_16x16x32_bf16 v[60:63], v[168:171], v[220:223], v[60:63]
    v_mfma_f32_16x16x32_bf16 v[64:67], v[172:175], v[220:223], v[64:67]
    v_mfma_f32_16x16x32_bf16 v[68:71], v[176:179], v[220:223], v[68:71]
    ds_read_b128 v[220:223], v239 offset:18432
    v_mfma_f32_16x16x32_bf16 v[72:75], v[168:171], v[224:227], v[72:75]
    v_mfma_f32_16x16x32_bf16 v[76:79], v[172:175], v[224:227], v[76:79]
    v_mfma_f32_16x16x32_bf16 v[80:83], v[176:179], v[224:227], v[80:83]
    ds_read_b128 v[224:227], v239 offset:20480
    v_mfma_f32_16x16x32_bf16 v[0:3], v[192:195], v[228:231], v[0:3]
    v_mfma_f32_16x16x32_bf16 v[4:7], v[196:199], v[228:231], v[4:7]
    v_mfma_f32_16x16x32_bf16 v[8:11], v[200:203], v[228:231], v[8:11]
    ds_read_b128 v[228:231], v239 offset:22528
    s_waitcnt lgkmcnt(3)
    v_mfma_f32_16x16x32_bf16 v[12:15], v[192:195], v[216:219], v[12:15]
    s_waitcnt vmcnt(13)
    s_barrier
    s_add_u32 m0, s60, 67584
    s_add_u32 s62, s58, 4326144
    buffer_load_dwordx4 v243, s[40:43], s62 offen  lds
    buffer_load_dwordx4 v244, s[40:43], s62 offen offset:1024  lds
    buffer_load_dwordx4 v245, s[40:43], s62 offen offset:2048  lds
    s_cmp_lg_u32 s52, 1
    s_cbranch_scc1 qp_wt9
    s_add_u32 s61, s8, 5898240
    buffer_load_dword v247, v254, s[40:43], s61 offen
qp_wt9:
    v_mfma_f32_16x16x32_bf16 v[16:19], v[196:199], v[216:219], v[16:19]
    v_mfma_f32_16x16x32_bf16 v[20:23], v[200:203], v[216:219], v[20:23]
    ds_read_b128 v[216:219], v239 offset:24576
    s_waitcnt lgkmcnt(3)
    v_mfma_f32_16x16x32_bf16 v[24:27], v[192:195], v[220:223], v[24:27]
    ds_read_b64_tr_b16 v[168:169], v232 offset:0
    v_mfma_f32_16x16x32_bf16 v[28:31], v[196:199], v[220:223], v[28:31]
    ds_read_b64_tr_b16 v[170:171], v232 offset:1536
    v_mfma_f32_16x16x32_bf16 v[32:35], v[200:203], v[220:223], v[32:35]
    ds_read_b128 v[220:223], v239 offset:26624
    s_waitcnt lgkmcnt(5)
    v_mfma_f32_16x16x32_bf16 v[36:39], v[192:195], v[224:227], v[36:39]
    ds_read_b64_tr_b16 v[172:173], v233 offset:0
    v_mfma_f32_16x16x32_bf16 v[40:43], v[196:199], v[224:227], v[40:43]
    ds_read_b64_tr_b16 v[174:175], v233 offset:1536
    v_mfma_f32_16x16x32_bf16 v[44:47], v[200:203], v[224:227], v[44:47]
    ds_read_b128 v[224:227], v238 offset:28672
    s_waitcnt lgkmcnt(7)
    v_mfma_f32_16x16x32_bf16 v[48:51], v[192:195], v[228:231], v[48:51]
    ds_read_b64_tr_b16 v[176:177], v234 offset:0
    v_mfma_f32_16x16x32_bf16 v[52:55], v[196:199], v[228:231], v[52:55]
    ds_read_b64_tr_b16 v[178:179], v234 offset:1536
    s_waitcnt lgkmcnt(0)
    s_waitcnt vmcnt(13)
    s_barrier
    s_add_u32 m0, s60, 94208
    s_add_u32 s62, s58, 4718592
    buffer_load_dwordx4 v243, s[40:43], s62 offen  lds
    buffer_load_dwordx4 v244, s[40:43], s62 offen offset:1024  lds
    buffer_load_dwordx4 v245, s[40:43], s62 offen offset:2048  lds
    s_add_u32 m0, s60, 106496
    s_add_u32 s62, s58, 4718976
    buffer_load_dwordx4 v243, s[40:43], s62 offen  lds
    buffer_load_dwordx4 v244, s[40:43], s62 offen offset:1024  lds
    buffer_load_dwordx4 v245, s[40:43], s62 offen offset:2048  lds
    v_mfma_f32_16x16x32_bf16 v[56:59], v[200:203], v[228:231], v[56:59]
    ds_read_b128 v[228:231], v238 offset:30720
    v_mfma_f32_16x16x32_bf16 v[60:63], v[192:195], v[216:219], v[60:63]
    v_mfma_f32_16x16x32_bf16 v[64:67], v[196:199], v[216:219], v[64:67]
    v_mfma_f32_16x16x32_bf16 v[68:71], v[200:203], v[216:219], v[68:71]
    ds_read_b128 v[216:219], v238 offset:32768
    v_mfma_f32_16x16x32_bf16 v[72:75], v[192:195], v[220:223], v[72:75]
    v_mfma_f32_16x16x32_bf16 v[76:79], v[196:199], v[220:223], v[76:79]
    v_mfma_f32_16x16x32_bf16 v[80:83], v[200:203], v[220:223], v[80:83]
    ds_read_b128 v[220:223], v238 offset:34816
    v_mfma_f32_16x16x32_bf16 v[0:3], v[168:171], v[224:227], v[0:3]
    v_mfma_f32_16x16x32_bf16 v[4:7], v[172:175], v[224:227], v[4:7]
    v_mfma_f32_16x16x32_bf16 v[8:11], v[176:179], v[224:227], v[8:11]
    ds_read_b128 v[224:227], v238 offset:36864
    s_waitcnt lgkmcnt(3)
    v_mfma_f32_16x16x32_bf16 v[12:15], v[168:171], v[228:231], v[12:15]
    s_waitcnt vmcnt(9)
    s_barrier
    s_add_u32 m0, s60, 118784
    s_add_u32 s62, s58, 4719360
    buffer_load_dwordx4 v243, s[40:43], s62 offen  lds
    buffer_load_dwordx4 v244, s[40:43], s62 offen offset:1024  lds
    buffer_load_dwordx4 v245, s[40:43], s62 offen offset:2048  lds
    s_add_u32 m0, s71, 14336
    s_add_u32 s63, s70, 896
    buffer_load_dwordx4 v246, s[48:51], s63 offen  lds
    s_add_u32 m0, s71, 18432
    s_add_u32 s63, s70, 41856
    buffer_load_dwordx4 v246, s[48:51], s63 offen  lds
    s_add_u32 m0, s71, 22528
    s_add_u32 s63, s70, 82816
    buffer_load_dwordx4 v246, s[48:51], s63 offen  lds
    s_add_u32 s63, s71, 26624
    s_cmp_ge_u32 s56, 2
    s_cselect_b32 m0, s73, s63
    s_add_u32 s63, s70, 123776
    buffer_load_dwordx4 v246, s[48:51], s63 offen  lds
    s_cmp_lg_u32 s52, 2
    s_cbranch_scc1 qp_wt10
    s_add_u32 s61, s8, 6291456
    buffer_load_dword v247, v254, s[40:43], s61 offen
qp_wt10:
    v_mfma_f32_16x16x32_bf16 v[16:19], v[172:175], v[228:231], v[16:19]
    v_mfma_f32_16x16x32_bf16 v[20:23], v[176:179], v[228:231], v[20:23]
    ds_read_b128 v[228:231], v238 offset:38912
    s_waitcnt lgkmcnt(3)
    v_mfma_f32_16x16x32_bf16 v[24:27], v[168:171], v[216:219], v[24:27]
    ds_read_b64_tr_b16 v[192:193], v235 offset:0
    v_mfma_f32_16x16x32_bf16 v[28:31], v[172:175], v[216:219], v[28:31]
    ds_read_b64_tr_b16 v[194:195], v235 offset:1536
    v_mfma_f32_16x16x32_bf16 v[32:35], v[176:179], v[216:219], v[32:35]
    ds_read_b128 v[216:219], v238 offset:40960
    s_waitcnt lgkmcnt(5)
    v_mfma_f32_16x16x32_bf16 v[36:39], v[168:171], v[220:223], v[36:39]
    ds_read_b64_tr_b16 v[196:197], v236 offset:0
    v_mfma_f32_16x16x32_bf16 v[40:43], v[172:175], v[220:223], v[40:43]
    ds_read_b64_tr_b16 v[198:199], v236 offset:1536
    v_mfma_f32_16x16x32_bf16 v[44:47], v[176:179], v[220:223], v[44:47]
    ds_read_b128 v[220:223], v239 offset:28672
    s_waitcnt lgkmcnt(7)
    v_mfma_f32_16x16x32_bf16 v[48:51], v[168:171], v[224:227], v[48:51]
    ds_read_b64_tr_b16 v[200:201], v237 offset:0
    v_mfma_f32_16x16x32_bf16 v[52:55], v[172:175], v[224:227], v[52:55]
    ds_read_b64_tr_b16 v[202:203], v237 offset:1536
    s_waitcnt lgkmcnt(0)
    s_waitcnt vmcnt(13)
    s_barrier
    s_add_u32 m0, s60, 43008
    s_add_u32 s62, s58, 5111808
    buffer_load_dwordx4 v243, s[40:43], s62 offen  lds
    buffer_load_dwordx4 v244, s[40:43], s62 offen offset:1024  lds
    buffer_load_dwordx4 v245, s[40:43], s62 offen offset:2048  lds
    s_add_u32 m0, s60, 55296
    s_add_u32 s62, s58, 5112192
    buffer_load_dwordx4 v243, s[40:43], s62 offen  lds
    buffer_load_dwordx4 v244, s[40:43], s62 offen offset:1024  lds
    buffer_load_dwordx4 v245, s[40:43], s62 offen offset:2048  lds
    v_mfma_f32_16x16x32_bf16 v[56:59], v[176:179], v[224:227], v[56:59]
    ds_read_b128 v[224:227], v239 offset:30720
    v_mfma_f32_16x16x32_bf16 v[60:63], v[168:171], v[228:231], v[60:63]
    v_mfma_f32_16x16x32_bf16 v[64:67], v[172:175], v[228:231], v[64:67]
    v_mfma_f32_16x16x32_bf16 v[68:71], v[176:179], v[228:231], v[68:71]
    ds_read_b128 v[228:231], v239 offset:32768
    v_mfma_f32_16x16x32_bf16 v[72:75], v[168:171], v[216:219], v[72:75]
    v_mfma_f32_16x16x32_bf16 v[76:79], v[172:175], v[216:219], v[76:79]
    v_mfma_f32_16x16x32_bf16 v[80:83], v[176:179], v[216:219], v[80:83]
    ds_read_b128 v[216:219], v239 offset:34816
    v_mfma_f32_16x16x32_bf16 v[0:3], v[192:195], v[220:223], v[0:3]
    v_mfma_f32_16x16x32_bf16 v[4:7], v[196:199], v[220:223], v[4:7]
    v_mfma_f32_16x16x32_bf16 v[8:11], v[200:203], v[220:223], v[8:11]
    ds_read_b128 v[220:223], v239 offset:36864
    s_waitcnt lgkmcnt(3)
    v_mfma_f32_16x16x32_bf16 v[12:15], v[192:195], v[224:227], v[12:15]
    s_waitcnt vmcnt(13)
    s_barrier
    s_add_u32 m0, s60, 67584
    s_add_u32 s62, s58, 5112576
    buffer_load_dwordx4 v243, s[40:43], s62 offen  lds
    buffer_load_dwordx4 v244, s[40:43], s62 offen offset:1024  lds
    buffer_load_dwordx4 v245, s[40:43], s62 offen offset:2048  lds
    s_cmp_lg_u32 s52, 3
    s_cbranch_scc1 qp_wt11
    s_add_u32 s61, s8, 6684672
    buffer_load_dword v247, v254, s[40:43], s61 offen
qp_wt11:
    v_mfma_f32_16x16x32_bf16 v[16:19], v[196:199], v[224:227], v[16:19]
    v_mfma_f32_16x16x32_bf16 v[20:23], v[200:203], v[224:227], v[20:23]
    ds_read_b128 v[224:227], v239 offset:38912
    s_waitcnt lgkmcnt(3)
    v_mfma_f32_16x16x32_bf16 v[24:27], v[192:195], v[228:231], v[24:27]
    ds_read_b64_tr_b16 v[168:169], v232 offset:0
    v_mfma_f32_16x16x32_bf16 v[28:31], v[196:199], v[228:231], v[28:31]
    ds_read_b64_tr_b16 v[170:171], v232 offset:1536
    v_mfma_f32_16x16x32_bf16 v[32:35], v[200:203], v[228:231], v[32:35]
    ds_read_b128 v[228:231], v239 offset:40960
    s_waitcnt lgkmcnt(5)
    v_mfma_f32_16x16x32_bf16 v[36:39], v[192:195], v[216:219], v[36:39]
    ds_read_b64_tr_b16 v[172:173], v233 offset:0
    v_mfma_f32_16x16x32_bf16 v[40:43], v[196:199], v[216:219], v[40:43]
    ds_read_b64_tr_b16 v[174:175], v233 offset:1536
    v_mfma_f32_16x16x32_bf16 v[44:47], v[200:203], v[216:219], v[44:47]
    ds_read_b128 v[216:219], v238 offset:0
    s_waitcnt lgkmcnt(7)
    v_mfma_f32_16x16x32_bf16 v[48:51], v[192:195], v[220:223], v[48:51]
    ds_read_b64_tr_b16 v[176:177], v234 offset:0
    v_mfma_f32_16x16x32_bf16 v[52:55], v[196:199], v[220:223], v[52:55]
    ds_read_b64_tr_b16 v[178:179], v234 offset:1536
    s_waitcnt lgkmcnt(0)
    s_waitcnt vmcnt(13)
    s_barrier
    s_add_u32 m0, s60, 94208
    s_add_u32 s62, s58, 5505024
    buffer_load_dwordx4 v243, s[40:43], s62 offen  lds
    buffer_load_dwordx4 v244, s[40:43], s62 offen offset:1024  lds
    buffer_load_dwordx4 v245, s[40:43], s62 offen offset:2048  lds
    s_add_u32 m0, s60, 106496
    s_add_u32 s62, s58, 5505408
    buffer_load_dwordx4 v243, s[40:43], s62 offen  lds
    buffer_load_dwordx4 v244, s[40:43], s62 offen offset:1024  lds
    buffer_load_dwordx4 v245, s[40:43], s62 offen offset:2048  lds
    v_mfma_f32_16x16x32_bf16 v[56:59], v[200:203], v[220:223], v[56:59]
    ds_read_b128 v[220:223], v238 offset:2048
    v_mfma_f32_16x16x32_bf16 v[60:63], v[192:195], v[224:227], v[60:63]
    v_mfma_f32_16x16x32_bf16 v[64:67], v[196:199], v[224:227], v[64:67]
    v_mfma_f32_16x16x32_bf16 v[68:71], v[200:203], v[224:227], v[68:71]
    ds_read_b128 v[224:227], v238 offset:4096
    v_mfma_f32_16x16x32_bf16 v[72:75], v[192:195], v[228:231], v[72:75]
    v_mfma_f32_16x16x32_bf16 v[76:79], v[196:199], v[228:231], v[76:79]
    v_mfma_f32_16x16x32_bf16 v[80:83], v[200:203], v[228:231], v[80:83]
    ds_read_b128 v[228:231], v238 offset:6144
    v_mfma_f32_16x16x32_bf16 v[0:3], v[168:171], v[216:219], v[0:3]
    v_mfma_f32_16x16x32_bf16 v[4:7], v[172:175], v[216:219], v[4:7]
    v_mfma_f32_16x16x32_bf16 v[8:11], v[176:179], v[216:219], v[8:11]
    ds_read_b128 v[216:219], v238 offset:8192
    s_waitcnt lgkmcnt(3)
    v_mfma_f32_16x16x32_bf16 v[12:15], v[168:171], v[220:223], v[12:15]
    s_waitcnt vmcnt(9)
    s_barrier
    s_add_u32 m0, s60, 118784
    s_add_u32 s62, s58, 5505792
    buffer_load_dwordx4 v243, s[40:43], s62 offen  lds
    buffer_load_dwordx4 v244, s[40:43], s62 offen offset:1024  lds
    buffer_load_dwordx4 v245, s[40:43], s62 offen offset:2048  lds
    s_add_u32 m0, s71, 28672
    s_add_u32 s63, s70, 1024
    buffer_load_dwordx4 v246, s[48:51], s63 offen  lds
    s_add_u32 m0, s71, 32768
    s_add_u32 s63, s70, 41984
    buffer_load_dwordx4 v246, s[48:51], s63 offen  lds
    s_add_u32 m0, s71, 36864
    s_add_u32 s63, s70, 82944
    buffer_load_dwordx4 v246, s[48:51], s63 offen  lds
    s_add_u32 s63, s71, 40960
    s_cmp_ge_u32 s56, 2
    s_cselect_b32 m0, s73, s63
    s_add_u32 s63, s70, 123904
    buffer_load_dwordx4 v246, s[48:51], s63 offen  lds
    s_cmp_lg_u32 s52, 0
    s_cbranch_scc1 qp_wt12
    s_add_u32 s61, s8, 7077888
    buffer_load_dword v247, v254, s[40:43], s61 offen
qp_wt12:
    v_mfma_f32_16x16x32_bf16 v[16:19], v[172:175], v[220:223], v[16:19]
    v_mfma_f32_16x16x32_bf16 v[20:23], v[176:179], v[220:223], v[20:23]
    ds_read_b128 v[220:223], v238 offset:10240
    s_waitcnt lgkmcnt(3)
    v_mfma_f32_16x16x32_bf16 v[24:27], v[168:171], v[224:227], v[24:27]
    ds_read_b64_tr_b16 v[192:193], v235 offset:0
    v_mfma_f32_16x16x32_bf16 v[28:31], v[172:175], v[224:227], v[28:31]
    ds_read_b64_tr_b16 v[194:195], v235 offset:1536
    v_mfma_f32_16x16x32_bf16 v[32:35], v[176:179], v[224:227], v[32:35]
    ds_read_b128 v[224:227], v238 offset:12288
    s_waitcnt lgkmcnt(5)
    v_mfma_f32_16x16x32_bf16 v[36:39], v[168:171], v[228:231], v[36:39]
    ds_read_b64_tr_b16 v[196:197], v236 offset:0
    v_mfma_f32_16x16x32_bf16 v[40:43], v[172:175], v[228:231], v[40:43]
    ds_read_b64_tr_b16 v[198:199], v236 offset:1536
    v_mfma_f32_16x16x32_bf16 v[44:47], v[176:179], v[228:231], v[44:47]
    ds_read_b128 v[228:231], v239 offset:0
    s_waitcnt lgkmcnt(7)
    v_mfma_f32_16x16x32_bf16 v[48:51], v[168:171], v[216:219], v[48:51]
    ds_read_b64_tr_b16 v[200:201], v237 offset:0
    v_mfma_f32_16x16x32_bf16 v[52:55], v[172:175], v[216:219], v[52:55]
    ds_read_b64_tr_b16 v[202:203], v237 offset:1536
    s_waitcnt lgkmcnt(0)
    s_waitcnt vmcnt(13)
    s_barrier
    s_add_u32 m0, s60, 43008
    s_add_u32 s62, s58, 5898240
    buffer_load_dwordx4 v243, s[40:43], s62 offen  lds
    buffer_load_dwordx4 v244, s[40:43], s62 offen offset:1024  lds
    buffer_load_dwordx4 v245, s[40:43], s62 offen offset:2048  lds
    s_add_u32 m0, s60, 55296
    s_add_u32 s62, s58, 5898624
    buffer_load_dwordx4 v243, s[40:43], s62 offen  lds
    buffer_load_dwordx4 v244, s[40:43], s62 offen offset:1024  lds
    buffer_load_dwordx4 v245, s[40:43], s62 offen offset:2048  lds
    v_mfma_f32_16x16x32_bf16 v[56:59], v[176:179], v[216:219], v[56:59]
    ds_read_b128 v[216:219], v239 offset:2048
    v_mfma_f32_16x16x32_bf16 v[60:63], v[168:171], v[220:223], v[60:63]
    v_mfma_f32_16x16x32_bf16 v[64:67], v[172:175], v[220:223], v[64:67]
    v_mfma_f32_16x16x32_bf16 v[68:71], v[176:179], v[220:223], v[68:71]
    ds_read_b128 v[220:223], v239 offset:4096
    v_mfma_f32_16x16x32_bf16 v[72:75], v[168:171], v[224:227], v[72:75]
    v_mfma_f32_16x16x32_bf16 v[76:79], v[172:175], v[224:227], v[76:79]
    v_mfma_f32_16x16x32_bf16 v[80:83], v[176:179], v[224:227], v[80:83]
    ds_read_b128 v[224:227], v239 offset:6144
    v_mfma_f32_16x16x32_bf16 v[0:3], v[192:195], v[228:231], v[0:3]
    v_mfma_f32_16x16x32_bf16 v[4:7], v[196:199], v[228:231], v[4:7]
    v_mfma_f32_16x16x32_bf16 v[8:11], v[200:203], v[228:231], v[8:11]
    ds_read_b128 v[228:231], v239 offset:8192
    s_waitcnt lgkmcnt(3)
    v_mfma_f32_16x16x32_bf16 v[12:15], v[192:195], v[216:219], v[12:15]
    s_waitcnt vmcnt(13)
    s_barrier
    s_add_u32 m0, s60, 67584
    s_add_u32 s62, s58, 5899008
    buffer_load_dwordx4 v243, s[40:43], s62 offen  lds
    buffer_load_dwordx4 v244, s[40:43], s62 offen offset:1024  lds
    buffer_load_dwordx4 v245, s[40:43], s62 offen offset:2048  lds
    s_cmp_lg_u32 s52, 1
    s_cbranch_scc1 qp_wt13
    s_add_u32 s61, s8, 7471104
    buffer_load_dword v247, v254, s[40:43], s61 offen
qp_wt13:
    v_mfma_f32_16x16x32_bf16 v[16:19], v[196:199], v[216:219], v[16:19]
    v_mfma_f32_16x16x32_bf16 v[20:23], v[200:203], v[216:219], v[20:23]
    ds_read_b128 v[216:219], v239 offset:10240
    s_waitcnt lgkmcnt(3)
    v_mfma_f32_16x16x32_bf16 v[24:27], v[192:195], v[220:223], v[24:27]
    ds_read_b64_tr_b16 v[168:169], v232 offset:0
    v_mfma_f32_16x16x32_bf16 v[28:31], v[196:199], v[220:223], v[28:31]
    ds_read_b64_tr_b16 v[170:171], v232 offset:1536
    v_mfma_f32_16x16x32_bf16 v[32:35], v[200:203], v[220:223], v[32:35]
    ds_read_b128 v[220:223], v239 offset:12288
    s_waitcnt lgkmcnt(5)
    v_mfma_f32_16x16x32_bf16 v[36:39], v[192:195], v[224:227], v[36:39]
    ds_read_b64_tr_b16 v[172:173], v233 offset:0
    v_mfma_f32_16x16x32_bf16 v[40:43], v[196:199], v[224:227], v[40:43]
    ds_read_b64_tr_b16 v[174:175], v233 offset:1536
    v_mfma_f32_16x16x32_bf16 v[44:47], v[200:203], v[224:227], v[44:47]
    ds_read_b128 v[224:227], v238 offset:14336
    s_waitcnt lgkmcnt(7)
    v_mfma_f32_16x16x32_bf16 v[48:51], v[192:195], v[228:231], v[48:51]
    ds_read_b64_tr_b16 v[176:177], v234 offset:0
    v_mfma_f32_16x16x32_bf16 v[52:55], v[196:199], v[228:231], v[52:55]
    ds_read_b64_tr_b16 v[178:179], v234 offset:1536
    s_waitcnt lgkmcnt(0)
    s_waitcnt vmcnt(13)
    s_barrier
    s_add_u32 m0, s60, 94208
    s_add_u32 s62, s58, 6291456
    buffer_load_dwordx4 v243, s[40:43], s62 offen  lds
    buffer_load_dwordx4 v244, s[40:43], s62 offen offset:1024  lds
    buffer_load_dwordx4 v245, s[40:43], s62 offen offset:2048  lds
    s_add_u32 m0, s60, 106496
    s_add_u32 s62, s58, 6291840
    buffer_load_dwordx4 v243, s[40:43], s62 offen  lds
    buffer_load_dwordx4 v244, s[40:43], s62 offen offset:1024  lds
    buffer_load_dwordx4 v245, s[40:43], s62 offen offset:2048  lds
    v_mfma_f32_16x16x32_bf16 v[56:59], v[200:203], v[228:231], v[56:59]
    ds_read_b128 v[228:231], v238 offset:16384
    v_mfma_f32_16x16x32_bf16 v[60:63], v[192:195], v[216:219], v[60:63]
    v_mfma_f32_16x16x32_bf16 v[64:67], v[196:199], v[216:219], v[64:67]
    v_mfma_f32_16x16x32_bf16 v[68:71], v[200:203], v[216:219], v[68:71]
    ds_read_b128 v[216:219], v238 offset:18432
    v_mfma_f32_16x16x32_bf16 v[72:75], v[192:195], v[220:223], v[72:75]
    v_mfma_f32_16x16x32_bf16 v[76:79], v[196:199], v[220:223], v[76:79]
    v_mfma_f32_16x16x32_bf16 v[80:83], v[200:203], v[220:223], v[80:83]
    ds_read_b128 v[220:223], v238 offset:20480
    v_mfma_f32_16x16x32_bf16 v[0:3], v[168:171], v[224:227], v[0:3]
    v_mfma_f32_16x16x32_bf16 v[4:7], v[172:175], v[224:227], v[4:7]
    v_mfma_f32_16x16x32_bf16 v[8:11], v[176:179], v[224:227], v[8:11]
    ds_read_b128 v[224:227], v238 offset:22528
    s_waitcnt lgkmcnt(3)
    v_mfma_f32_16x16x32_bf16 v[12:15], v[168:171], v[228:231], v[12:15]
    s_waitcnt vmcnt(9)
    s_barrier
    s_add_u32 m0, s60, 118784
    s_add_u32 s62, s58, 6292224
    buffer_load_dwordx4 v243, s[40:43], s62 offen  lds
    buffer_load_dwordx4 v244, s[40:43], s62 offen offset:1024  lds
    buffer_load_dwordx4 v245, s[40:43], s62 offen offset:2048  lds
    s_add_u32 m0, s71, 145408
    s_add_u32 s63, s70, 1152
    buffer_load_dwordx4 v246, s[48:51], s63 offen  lds
    s_add_u32 m0, s71, 149504
    s_add_u32 s63, s70, 42112
    buffer_load_dwordx4 v246, s[48:51], s63 offen  lds
    s_add_u32 m0, s71, 153600
    s_add_u32 s63, s70, 83072
    buffer_load_dwordx4 v246, s[48:51], s63 offen  lds
    s_add_u32 s63, s71, 157696
    s_cmp_ge_u32 s56, 2
    s_cselect_b32 m0, s73, s63
    s_add_u32 s63, s70, 124032
    buffer_load_dwordx4 v246, s[48:51], s63 offen  lds
    v_mfma_f32_16x16x32_bf16 v[16:19], v[172:175], v[228:231], v[16:19]
    v_mfma_f32_16x16x32_bf16 v[20:23], v[176:179], v[228:231], v[20:23]
    ds_read_b128 v[228:231], v238 offset:24576
    s_waitcnt lgkmcnt(3)
    v_mfma_f32_16x16x32_bf16 v[24:27], v[168:171], v[216:219], v[24:27]
    ds_read_b64_tr_b16 v[192:193], v235 offset:0
    v_mfma_f32_16x16x32_bf16 v[28:31], v[172:175], v[216:219], v[28:31]
    ds_read_b64_tr_b16 v[194:195], v235 offset:1536
    v_mfma_f32_16x16x32_bf16 v[32:35], v[176:179], v[216:219], v[32:35]
    ds_read_b128 v[216:219], v238 offset:26624
    s_waitcnt lgkmcnt(5)
    v_mfma_f32_16x16x32_bf16 v[36:39], v[168:171], v[220:223], v[36:39]
    ds_read_b64_tr_b16 v[196:197], v236 offset:0
    v_mfma_f32_16x16x32_bf16 v[40:43], v[172:175], v[220:223], v[40:43]
    ds_read_b64_tr_b16 v[198:199], v236 offset:1536
    v_mfma_f32_16x16x32_bf16 v[44:47], v[176:179], v[220:223], v[44:47]
    ds_read_b128 v[220:223], v239 offset:14336
    s_waitcnt lgkmcnt(7)
    v_mfma_f32_16x16x32_bf16 v[48:51], v[168:171], v[224:227], v[48:51]
    ds_read_b64_tr_b16 v[200:201], v237 offset:0
    v_mfma_f32_16x16x32_bf16 v[52:55], v[172:175], v[224:227], v[52:55]
    ds_read_b64_tr_b16 v[202:203], v237 offset:1536
    s_waitcnt lgkmcnt(0)
    s_waitcnt vmcnt(13)
    s_barrier
    s_add_u32 m0, s60, 43008
    s_add_u32 s62, s58, 6684672
    buffer_load_dwordx4 v243, s[40:43], s62 offen  lds
    buffer_load_dwordx4 v244, s[40:43], s62 offen offset:1024  lds
    buffer_load_dwordx4 v245, s[40:43], s62 offen offset:2048  lds
    s_add_u32 m0, s60, 55296
    s_add_u32 s62, s58, 6685056
    buffer_load_dwordx4 v243, s[40:43], s62 offen  lds
    buffer_load_dwordx4 v244, s[40:43], s62 offen offset:1024  lds
    buffer_load_dwordx4 v245, s[40:43], s62 offen offset:2048  lds
    v_mfma_f32_16x16x32_bf16 v[56:59], v[176:179], v[224:227], v[56:59]
    ds_read_b128 v[224:227], v239 offset:16384
    v_mfma_f32_16x16x32_bf16 v[60:63], v[168:171], v[228:231], v[60:63]
    v_mfma_f32_16x16x32_bf16 v[64:67], v[172:175], v[228:231], v[64:67]
    v_mfma_f32_16x16x32_bf16 v[68:71], v[176:179], v[228:231], v[68:71]
    ds_read_b128 v[228:231], v239 offset:18432
    v_mfma_f32_16x16x32_bf16 v[72:75], v[168:171], v[216:219], v[72:75]
    v_mfma_f32_16x16x32_bf16 v[76:79], v[172:175], v[216:219], v[76:79]
    v_mfma_f32_16x16x32_bf16 v[80:83], v[176:179], v[216:219], v[80:83]
    ds_read_b128 v[216:219], v239 offset:20480
    v_mfma_f32_16x16x32_bf16 v[0:3], v[192:195], v[220:223], v[0:3]
    v_mfma_f32_16x16x32_bf16 v[4:7], v[196:199], v[220:223], v[4:7]
    v_mfma_f32_16x16x32_bf16 v[8:11], v[200:203], v[220:223], v[8:11]
    ds_read_b128 v[220:223], v239 offset:22528
    s_waitcnt lgkmcnt(3)
    v_mfma_f32_16x16x32_bf16 v[12:15], v[192:195], v[224:227], v[12:15]
    s_waitcnt vmcnt(13)
    s_barrier
    s_add_u32 m0, s60, 67584
    s_add_u32 s62, s58, 6685440
    buffer_load_dwordx4 v243, s[40:43], s62 offen  lds
    buffer_load_dwordx4 v244, s[40:43], s62 offen offset:1024  lds
    buffer_load_dwordx4 v245, s[40:43], s62 offen offset:2048  lds
    v_mfma_f32_16x16x32_bf16 v[16:19], v[196:199], v[224:227], v[16:19]
    v_mfma_f32_16x16x32_bf16 v[20:23], v[200:203], v[224:227], v[20:23]
    ds_read_b128 v[224:227], v239 offset:24576
    s_waitcnt lgkmcnt(3)
    v_mfma_f32_16x16x32_bf16 v[24:27], v[192:195], v[228:231], v[24:27]
    ds_read_b64_tr_b16 v[168:169], v232 offset:0
    v_mfma_f32_16x16x32_bf16 v[28:31], v[196:199], v[228:231], v[28:31]
    ds_read_b64_tr_b16 v[170:171], v232 offset:1536
    v_mfma_f32_16x16x32_bf16 v[32:35], v[200:203], v[228:231], v[32:35]
    ds_read_b128 v[228:231], v239 offset:26624
    s_waitcnt lgkmcnt(5)
    v_mfma_f32_16x16x32_bf16 v[36:39], v[192:195], v[216:219], v[36:39]
    ds_read_b64_tr_b16 v[172:173], v233 offset:0
    v_mfma_f32_16x16x32_bf16 v[40:43], v[196:199], v[216:219], v[40:43]
    ds_read_b64_tr_b16 v[174:175], v233 offset:1536
    v_mfma_f32_16x16x32_bf16 v[44:47], v[200:203], v[216:219], v[44:47]
    ds_read_b128 v[216:219], v238 offset:28672
    s_waitcnt lgkmcnt(7)
    v_mfma_f32_16x16x32_bf16 v[48:51], v[192:195], v[220:223], v[48:51]
    ds_read_b64_tr_b16 v[176:177], v234 offset:0
    v_mfma_f32_16x16x32_bf16 v[52:55], v[196:199], v[220:223], v[52:55]
    ds_read_b64_tr_b16 v[178:179], v234 offset:1536
    s_waitcnt lgkmcnt(0)
    s_waitcnt vmcnt(13)
    s_barrier
    s_add_u32 m0, s60, 94208
    s_add_u32 s62, s58, 7077888
    buffer_load_dwordx4 v243, s[40:43], s62 offen  lds
    buffer_load_dwordx4 v244, s[40:43], s62 offen offset:1024  lds
    buffer_load_dwordx4 v245, s[40:43], s62 offen offset:2048  lds
    s_add_u32 m0, s60, 106496
    s_add_u32 s62, s58, 7078272
    buffer_load_dwordx4 v243, s[40:43], s62 offen  lds
    buffer_load_dwordx4 v244, s[40:43], s62 offen offset:1024  lds
    buffer_load_dwordx4 v245, s[40:43], s62 offen offset:2048  lds
    v_mfma_f32_16x16x32_bf16 v[56:59], v[200:203], v[220:223], v[56:59]
    ds_read_b128 v[220:223], v238 offset:30720
    v_mfma_f32_16x16x32_bf16 v[60:63], v[192:195], v[224:227], v[60:63]
    v_mfma_f32_16x16x32_bf16 v[64:67], v[196:199], v[224:227], v[64:67]
    v_mfma_f32_16x16x32_bf16 v[68:71], v[200:203], v[224:227], v[68:71]
    ds_read_b128 v[224:227], v238 offset:32768
    v_mfma_f32_16x16x32_bf16 v[72:75], v[192:195], v[228:231], v[72:75]
    v_mfma_f32_16x16x32_bf16 v[76:79], v[196:199], v[228:231], v[76:79]
    v_mfma_f32_16x16x32_bf16 v[80:83], v[200:203], v[228:231], v[80:83]
    ds_read_b128 v[228:231], v238 offset:34816
    v_mfma_f32_16x16x32_bf16 v[0:3], v[168:171], v[216:219], v[0:3]
    v_mfma_f32_16x16x32_bf16 v[4:7], v[172:175], v[216:219], v[4:7]
    v_mfma_f32_16x16x32_bf16 v[8:11], v[176:179], v[216:219], v[8:11]
    ds_read_b128 v[216:219], v238 offset:36864
    s_waitcnt lgkmcnt(3)
    v_mfma_f32_16x16x32_bf16 v[12:15], v[168:171], v[220:223], v[12:15]
    s_waitcnt vmcnt(9)
    s_barrier
    s_add_u32 m0, s60, 118784
    s_add_u32 s62, s58, 7078656
    buffer_load_dwordx4 v243, s[40:43], s62 offen  lds
    buffer_load_dwordx4 v244, s[40:43], s62 offen offset:1024  lds
    buffer_load_dwordx4 v245, s[40:43], s62 offen offset:2048  lds
    v_mfma_f32_16x16x32_bf16 v[16:19], v[172:175], v[220:223], v[16:19]
    v_mfma_f32_16x16x32_bf16 v[20:23], v[176:179], v[220:223], v[20:23]
    ds_read_b128 v[220:223], v238 offset:38912
    s_waitcnt lgkmcnt(3)
    v_mfma_f32_16x16x32_bf16 v[24:27], v[168:171], v[224:227], v[24:27]
    ds_read_b64_tr_b16 v[192:193], v235 offset:0
    v_mfma_f32_16x16x32_bf16 v[28:31], v[172:175], v[224:227], v[28:31]
    ds_read_b64_tr_b16 v[194:195], v235 offset:1536
    v_mfma_f32_16x16x32_bf16 v[32:35], v[176:179], v[224:227], v[32:35]
    ds_read_b128 v[224:227], v238 offset:40960
    s_waitcnt lgkmcnt(5)
    v_mfma_f32_16x16x32_bf16 v[36:39], v[168:171], v[228:231], v[36:39]
    ds_read_b64_tr_b16 v[196:197], v236 offset:0
    v_mfma_f32_16x16x32_bf16 v[40:43], v[172:175], v[228:231], v[40:43]
    ds_read_b64_tr_b16 v[198:199], v236 offset:1536
    v_mfma_f32_16x16x32_bf16 v[44:47], v[176:179], v[228:231], v[44:47]
    ds_read_b128 v[228:231], v239 offset:28672
    s_waitcnt lgkmcnt(7)
    v_mfma_f32_16x16x32_bf16 v[48:51], v[168:171], v[216:219], v[48:51]
    ds_read_b64_tr_b16 v[200:201], v237 offset:0
    v_mfma_f32_16x16x32_bf16 v[52:55], v[172:175], v[216:219], v[52:55]
    ds_read_b64_tr_b16 v[202:203], v237 offset:1536
    s_waitcnt lgkmcnt(0)
    s_waitcnt vmcnt(9)
    s_barrier
    s_add_u32 m0, s60, 43008
    s_add_u32 s62, s58, 7471104
    buffer_load_dwordx4 v243, s[40:43], s62 offen  lds
    buffer_load_dwordx4 v244, s[40:43], s62 offen offset:1024  lds
    buffer_load_dwordx4 v245, s[40:43], s62 offen offset:2048  lds
    s_add_u32 m0, s60, 55296
    s_add_u32 s62, s58, 7471488
    buffer_load_dwordx4 v243, s[40:43], s62 offen  lds
    buffer_load_dwordx4 v244, s[40:43], s62 offen offset:1024  lds
    buffer_load_dwordx4 v245, s[40:43], s62 offen offset:2048  lds
    v_mfma_f32_16x16x32_bf16 v[56:59], v[176:179], v[216:219], v[56:59]
    ds_read_b128 v[216:219], v239 offset:30720
    v_mfma_f32_16x16x32_bf16 v[60:63], v[168:171], v[220:223], v[60:63]
    v_mfma_f32_16x16x32_bf16 v[64:67], v[172:175], v[220:223], v[64:67]
    v_mfma_f32_16x16x32_bf16 v[68:71], v[176:179], v[220:223], v[68:71]
    ds_read_b128 v[220:223], v239 offset:32768
    v_mfma_f32_16x16x32_bf16 v[72:75], v[168:171], v[224:227], v[72:75]
    v_mfma_f32_16x16x32_bf16 v[76:79], v[172:175], v[224:227], v[76:79]
    v_mfma_f32_16x16x32_bf16 v[80:83], v[176:179], v[224:227], v[80:83]
    ds_read_b128 v[224:227], v239 offset:34816
    v_add_u32 v238, 145408, v238
    v_mfma_f32_16x16x32_bf16 v[0:3], v[192:195], v[228:231], v[0:3]
    v_mfma_f32_16x16x32_bf16 v[4:7], v[196:199], v[228:231], v[4:7]
    v_mfma_f32_16x16x32_bf16 v[8:11], v[200:203], v[228:231], v[8:11]
    ds_read_b128 v[228:231], v239 offset:36864
    s_waitcnt lgkmcnt(3)
    v_mfma_f32_16x16x32_bf16 v[12:15], v[192:195], v[216:219], v[12:15]
    s_waitcnt vmcnt(9)
    s_barrier
    s_add_u32 m0, s60, 67584
    s_add_u32 s62, s58, 7471872
    buffer_load_dwordx4 v243, s[40:43], s62 offen  lds
    buffer_load_dwordx4 v244, s[40:43], s62 offen offset:1024  lds
    buffer_load_dwordx4 v245, s[40:43], s62 offen offset:2048  lds
    v_mfma_f32_16x16x32_bf16 v[16:19], v[196:199], v[216:219], v[16:19]
    v_mfma_f32_16x16x32_bf16 v[20:23], v[200:203], v[216:219], v[20:23]
    ds_read_b128 v[216:219], v239 offset:38912
    s_waitcnt lgkmcnt(3)
    v_mfma_f32_16x16x32_bf16 v[24:27], v[192:195], v[220:223], v[24:27]
    ds_read_b64_tr_b16 v[168:169], v232 offset:0
    v_mfma_f32_16x16x32_bf16 v[28:31], v[196:199], v[220:223], v[28:31]
    ds_read_b64_tr_b16 v[170:171], v232 offset:1536
    v_mfma_f32_16x16x32_bf16 v[32:35], v[200:203], v[220:223], v[32:35]
    ds_read_b128 v[220:223], v239 offset:40960
    s_waitcnt lgkmcnt(5)
    v_mfma_f32_16x16x32_bf16 v[36:39], v[192:195], v[224:227], v[36:39]
    ds_read_b64_tr_b16 v[172:173], v233 offset:0
    v_mfma_f32_16x16x32_bf16 v[40:43], v[196:199], v[224:227], v[40:43]
    ds_read_b64_tr_b16 v[174:175], v233 offset:1536
    v_mfma_f32_16x16x32_bf16 v[44:47], v[200:203], v[224:227], v[44:47]
    ds_read_b128 v[224:227], v238 offset:0
    s_waitcnt lgkmcnt(7)
    v_mfma_f32_16x16x32_bf16 v[48:51], v[192:195], v[228:231], v[48:51]
    ds_read_b64_tr_b16 v[176:177], v234 offset:0
    v_mfma_f32_16x16x32_bf16 v[52:55], v[196:199], v[228:231], v[52:55]
    ds_read_b64_tr_b16 v[178:179], v234 offset:1536
    s_waitcnt lgkmcnt(0)
    s_waitcnt vmcnt(9)
    s_barrier
    v_mfma_f32_16x16x32_bf16 v[56:59], v[200:203], v[228:231], v[56:59]
    ds_read_b128 v[228:231], v238 offset:2048
    v_mfma_f32_16x16x32_bf16 v[60:63], v[192:195], v[216:219], v[60:63]
    v_mfma_f32_16x16x32_bf16 v[64:67], v[196:199], v[216:219], v[64:67]
    v_mfma_f32_16x16x32_bf16 v[68:71], v[200:203], v[216:219], v[68:71]
    ds_read_b128 v[216:219], v238 offset:4096
    v_mfma_f32_16x16x32_bf16 v[72:75], v[192:195], v[220:223], v[72:75]
    v_mfma_f32_16x16x32_bf16 v[76:79], v[196:199], v[220:223], v[76:79]
    v_mfma_f32_16x16x32_bf16 v[80:83], v[200:203], v[220:223], v[80:83]
    ds_read_b128 v[220:223], v238 offset:6144
    v_add_u32 v239, 145408, v239
    v_mfma_f32_16x16x32_bf16 v[0:3], v[168:171], v[224:227], v[0:3]
    v_mfma_f32_16x16x32_bf16 v[4:7], v[172:175], v[224:227], v[4:7]
    v_mfma_f32_16x16x32_bf16 v[8:11], v[176:179], v[224:227], v[8:11]
    ds_read_b128 v[224:227], v238 offset:8192
    s_waitcnt lgkmcnt(3)
    v_mfma_f32_16x16x32_bf16 v[12:15], v[168:171], v[228:231], v[12:15]
    s_waitcnt vmcnt(3)
    s_barrier
    v_mfma_f32_16x16x32_bf16 v[16:19], v[172:175], v[228:231], v[16:19]
    v_mfma_f32_16x16x32_bf16 v[20:23], v[176:179], v[228:231], v[20:23]
    ds_read_b128 v[228:231], v238 offset:10240
    s_waitcnt lgkmcnt(3)
    v_mfma_f32_16x16x32_bf16 v[24:27], v[168:171], v[216:219], v[24:27]
    ds_read_b64_tr_b16 v[192:193], v235 offset:0
    v_mfma_f32_16x16x32_bf16 v[28:31], v[172:175], v[216:219], v[28:31]
    ds_read_b64_tr_b16 v[194:195], v235 offset:1536
    v_mfma_f32_16x16x32_bf16 v[32:35], v[176:179], v[216:219], v[32:35]
    ds_read_b128 v[216:219], v238 offset:12288
    s_waitcnt lgkmcnt(5)
    v_mfma_f32_16x16x32_bf16 v[36:39], v[168:171], v[220:223], v[36:39]
    ds_read_b64_tr_b16 v[196:197], v236 offset:0
    v_mfma_f32_16x16x32_bf16 v[40:43], v[172:175], v[220:223], v[40:43]
    ds_read_b64_tr_b16 v[198:199], v236 offset:1536
    v_mfma_f32_16x16x32_bf16 v[44:47], v[176:179], v[220:223], v[44:47]
    ds_read_b128 v[220:223], v239 offset:0
    s_waitcnt lgkmcnt(7)
    v_mfma_f32_16x16x32_bf16 v[48:51], v[168:171], v[224:227], v[48:51]
    ds_read_b64_tr_b16 v[200:201], v237 offset:0
    v_mfma_f32_16x16x32_bf16 v[52:55], v[172:175], v[224:227], v[52:55]
    ds_read_b64_tr_b16 v[202:203], v237 offset:1536
    s_waitcnt lgkmcnt(0)
    s_waitcnt vmcnt(0)
    s_barrier
    v_mfma_f32_16x16x32_bf16 v[56:59], v[176:179], v[224:227], v[56:59]
    ds_read_b128 v[224:227], v239 offset:2048
    v_mfma_f32_16x16x32_bf16 v[60:63], v[168:171], v[228:231], v[60:63]
    v_mfma_f32_16x16x32_bf16 v[64:67], v[172:175], v[228:231], v[64:67]
    v_mfma_f32_16x16x32_bf16 v[68:71], v[176:179], v[228:231], v[68:71]
    ds_read_b128 v[228:231], v239 offset:4096
    v_mfma_f32_16x16x32_bf16 v[72:75], v[168:171], v[216:219], v[72:75]
    v_mfma_f32_16x16x32_bf16 v[76:79], v[172:175], v[216:219], v[76:79]
    v_mfma_f32_16x16x32_bf16 v[80:83], v[176:179], v[216:219], v[80:83]
    ds_read_b128 v[216:219], v239 offset:6144
    v_mfma_f32_16x16x32_bf16 v[0:3], v[192:195], v[220:223], v[0:3]
    v_mfma_f32_16x16x32_bf16 v[4:7], v[196:199], v[220:223], v[4:7]
    v_mfma_f32_16x16x32_bf16 v[8:11], v[200:203], v[220:223], v[8:11]
    ds_read_b128 v[220:223], v239 offset:8192
    s_waitcnt lgkmcnt(3)
    v_mfma_f32_16x16x32_bf16 v[12:15], v[192:195], v[224:227], v[12:15]
    v_mfma_f32_16x16x32_bf16 v[16:19], v[196:199], v[224:227], v[16:19]
    s_nop 1
    v_pk_mul_f32 v[0:1], v[0:1], s[66:67]
    v_pk_mul_f32 v[2:3], v[2:3], s[66:67]
    v_cvt_pk_bf16_f32 v0, v0, v1
    v_cvt_pk_bf16_f32 v1, v2, v3
    ds_write_b64 v248, v[0:1] offset:0
    v_mfma_f32_16x16x32_bf16 v[20:23], v[200:203], v[224:227], v[20:23]
    ds_read_b128 v[224:227], v239 offset:10240
    v_pk_mul_f32 v[4:5], v[4:5], s[66:67]
    v_pk_mul_f32 v[6:7], v[6:7], s[66:67]
    v_cvt_pk_bf16_f32 v4, v4, v5
    v_cvt_pk_bf16_f32 v5, v6, v7
    ds_write_b64 v249, v[4:5] offset:0
    s_waitcnt lgkmcnt(3)
    v_mfma_f32_16x16x32_bf16 v[24:27], v[192:195], v[228:231], v[24:27]
    v_pk_mul_f32 v[8:9], v[8:9], s[66:67]
    v_pk_mul_f32 v[10:11], v[10:11], s[66:67]
    v_cvt_pk_bf16_f32 v8, v8, v9
    v_cvt_pk_bf16_f32 v9, v10, v11
    ds_write_b64 v250, v[8:9] offset:0
    v_mfma_f32_16x16x32_bf16 v[28:31], v[196:199], v[228:231], v[28:31]
    v_pk_mul_f32 v[12:13], v[12:13], s[66:67]
    v_pk_mul_f32 v[14:15], v[14:15], s[66:67]
    v_cvt_pk_bf16_f32 v12, v12, v13
    v_cvt_pk_bf16_f32 v13, v14, v15
    ds_write_b64 v248, v[12:13] offset:1024
    v_mfma_f32_16x16x32_bf16 v[32:35], v[200:203], v[228:231], v[32:35]
    ds_read_b128 v[228:231], v239 offset:12288
    v_pk_mul_f32 v[16:17], v[16:17], s[66:67]
    v_pk_mul_f32 v[18:19], v[18:19], s[66:67]
    v_cvt_pk_bf16_f32 v16, v16, v17
    v_cvt_pk_bf16_f32 v17, v18, v19
    ds_write_b64 v249, v[16:17] offset:1024
    s_waitcnt lgkmcnt(3)
    v_mfma_f32_16x16x32_bf16 v[36:39], v[192:195], v[216:219], v[36:39]
    v_pk_mul_f32 v[20:21], v[20:21], s[66:67]
    v_pk_mul_f32 v[22:23], v[22:23], s[66:67]
    v_cvt_pk_bf16_f32 v20, v20, v21
    v_cvt_pk_bf16_f32 v21, v22, v23
    ds_write_b64 v250, v[20:21] offset:1024
    v_mfma_f32_16x16x32_bf16 v[40:43], v[196:199], v[216:219], v[40:43]
    v_pk_mul_f32 v[24:25], v[24:25], s[66:67]
    v_pk_mul_f32 v[26:27], v[26:27], s[66:67]
    v_cvt_pk_bf16_f32 v24, v24, v25
    v_cvt_pk_bf16_f32 v25, v26, v27
    ds_write_b64 v248, v[24:25] offset:2048
    v_mfma_f32_16x16x32_bf16 v[44:47], v[200:203], v[216:219], v[44:47]
    v_pk_mul_f32 v[28:29], v[28:29], s[66:67]
    v_pk_mul_f32 v[30:31], v[30:31], s[66:67]
    v_cvt_pk_bf16_f32 v28, v28, v29
    v_cvt_pk_bf16_f32 v29, v30, v31
    ds_write_b64 v249, v[28:29] offset:2048
    s_waitcnt lgkmcnt(2)
    v_mfma_f32_16x16x32_bf16 v[48:51], v[192:195], v[220:223], v[48:51]
    v_pk_mul_f32 v[32:33], v[32:33], s[66:67]
    v_pk_mul_f32 v[34:35], v[34:35], s[66:67]
    v_cvt_pk_bf16_f32 v32, v32, v33
    v_cvt_pk_bf16_f32 v33, v34, v35
    ds_write_b64 v250, v[32:33] offset:2048
    v_mfma_f32_16x16x32_bf16 v[52:55], v[196:199], v[220:223], v[52:55]
    v_pk_mul_f32 v[36:37], v[36:37], s[66:67]
    v_pk_mul_f32 v[38:39], v[38:39], s[66:67]
    v_cvt_pk_bf16_f32 v36, v36, v37
    v_cvt_pk_bf16_f32 v37, v38, v39
    ds_write_b64 v248, v[36:37] offset:3072
    v_mfma_f32_16x16x32_bf16 v[56:59], v[200:203], v[220:223], v[56:59]
    v_pk_mul_f32 v[40:41], v[40:41], s[66:67]
    v_pk_mul_f32 v[42:43], v[42:43], s[66:67]
    v_cvt_pk_bf16_f32 v40, v40, v41
    v_cvt_pk_bf16_f32 v41, v42, v43
    ds_write_b64 v249, v[40:41] offset:3072
    s_waitcnt lgkmcnt(1)
    v_mfma_f32_16x16x32_bf16 v[60:63], v[192:195], v[224:227], v[60:63]
    v_pk_mul_f32 v[44:45], v[44:45], s[66:67]
    v_pk_mul_f32 v[46:47], v[46:47], s[66:67]
    v_cvt_pk_bf16_f32 v44, v44, v45
    v_cvt_pk_bf16_f32 v45, v46, v47
    ds_write_b64 v250, v[44:45] offset:3072
    v_mfma_f32_16x16x32_bf16 v[64:67], v[196:199], v[224:227], v[64:67]
    v_pk_mul_f32 v[48:49], v[48:49], s[66:67]
    v_pk_mul_f32 v[50:51], v[50:51], s[66:67]
    v_cvt_pk_bf16_f32 v48, v48, v49
    v_cvt_pk_bf16_f32 v49, v50, v51
    ds_write_b64 v248, v[48:49] offset:4096
    v_mfma_f32_16x16x32_bf16 v[68:71], v[200:203], v[224:227], v[68:71]
    v_pk_mul_f32 v[52:53], v[52:53], s[66:67]
    v_pk_mul_f32 v[54:55], v[54:55], s[66:67]
    v_cvt_pk_bf16_f32 v52, v52, v53
    v_cvt_pk_bf16_f32 v53, v54, v55
    ds_write_b64 v249, v[52:53] offset:4096
    s_waitcnt lgkmcnt(0)
    v_mfma_f32_16x16x32_bf16 v[72:75], v[192:195], v[228:231], v[72:75]
    v_pk_mul_f32 v[56:57], v[56:57], s[66:67]
    v_pk_mul_f32 v[58:59], v[58:59], s[66:67]
    v_cvt_pk_bf16_f32 v56, v56, v57
    v_cvt_pk_bf16_f32 v57, v58, v59
    ds_write_b64 v250, v[56:57] offset:4096
    v_mfma_f32_16x16x32_bf16 v[76:79], v[196:199], v[228:231], v[76:79]
    v_pk_mul_f32 v[60:61], v[60:61], s[66:67]
    v_pk_mul_f32 v[62:63], v[62:63], s[66:67]
    v_cvt_pk_bf16_f32 v60, v60, v61
    v_cvt_pk_bf16_f32 v61, v62, v63
    ds_write_b64 v248, v[60:61] offset:5120
    v_mfma_f32_16x16x32_bf16 v[80:83], v[200:203], v[228:231], v[80:83]
    v_pk_mul_f32 v[64:65], v[64:65], s[66:67]
    v_pk_mul_f32 v[66:67], v[66:67], s[66:67]
    v_cvt_pk_bf16_f32 v64, v64, v65
    v_cvt_pk_bf16_f32 v65, v66, v67
    ds_write_b64 v249, v[64:65] offset:5120
    v_pk_mul_f32 v[68:69], v[68:69], s[66:67]
    v_pk_mul_f32 v[70:71], v[70:71], s[66:67]
    v_cvt_pk_bf16_f32 v68, v68, v69
    v_cvt_pk_bf16_f32 v69, v70, v71
    ds_write_b64 v250, v[68:69] offset:5120
    v_pk_mul_f32 v[72:73], v[72:73], s[66:67]
    v_pk_mul_f32 v[74:75], v[74:75], s[66:67]
    v_cvt_pk_bf16_f32 v72, v72, v73
    v_cvt_pk_bf16_f32 v73, v74, v75
    ds_write_b64 v248, v[72:73] offset:6144
    v_pk_mul_f32 v[76:77], v[76:77], s[66:67]
    v_pk_mul_f32 v[78:79], v[78:79], s[66:67]
    v_cvt_pk_bf16_f32 v76, v76, v77
    v_cvt_pk_bf16_f32 v77, v78, v79
    ds_write_b64 v249, v[76:77] offset:6144
    v_pk_mul_f32 v[80:81], v[80:81], s[66:67]
    v_pk_mul_f32 v[82:83], v[82:83], s[66:67]
    v_cvt_pk_bf16_f32 v80, v80, v81
    v_cvt_pk_bf16_f32 v81, v82, v83
    ds_write_b64 v250, v[80:81] offset:6144
    s_cmp_eq_u32 s52, 3
    s_cbranch_scc1 k1_light
    v_mbcnt_lo_u32_b32 v216, -1, 0
    v_mbcnt_hi_u32_b32 v216, -1, v216
    v_and_b32 v217, 15, v216
    v_lshrrev_b32 v218, 4, v216
    v_lshrrev_b32 v219, 2, v216
    v_and_b32 v220, 3, v219
    v_and_b32 v221, 3, v216
    v_lshrrev_b32 v222, 3, v216
    v_and_b32 v223, 7, v216
    s_waitcnt lgkmcnt(0)
    s_lshl_b32 s62, s52, 11
    s_add_u32 s62, s62, 0
    v_lshl_add_u32 v250, v216, 4, s62
    v_lshrrev_b32 v222, 1, v217
    v_and_b32 v222, 3, v222
    v_lshlrev_b32 v222, 1, v222
    v_xor_b32 v222, v218, v222
    v_lshlrev_b32 v222, 4, v222
    v_lshl_add_u32 v222, v217, 7, v222
    v_add_u32 v244, 94208, v222
    v_xor_b32 v245, 64, v244
    v_lshrrev_b32 v222, 1, v219
    v_and_b32 v222, 3, v222
    v_lshlrev_b32 v222, 5, v222
    v_lshl_add_u32 v222, v219, 7, v222
    v_lshl_add_u32 v222, v221, 3, v222
    v_add_u32 v246, 94208, v222
    v_xor_b32 v247, 32, v246
    v_xor_b32 v248, 64, v246
    v_xor_b32 v249, 96, v246
    s_mov_b32 s68, 0x40004000
    s_mov_b32 s55, 1
    v_mov_b32 v208, 0x3f803f80
    v_mov_b32 v209, 0x3f803f80
    v_mov_b32 v210, 0x3f803f80
    v_mov_b32 v211, 0x3f803f80
t0_unit_h:
    s_barrier
    s_cmp_gt_u32 s55, 3
    s_cbranch_scc1 t0_q3_h
    ds_read_b128 v[96:99], v250 offset:0
    ds_read_b128 v[120:123], v250 offset:1024
    ds_read_b128 v[100:103], v250 offset:7168
    ds_read_b128 v[124:127], v250 offset:8192
    ds_read_b128 v[104:107], v250 offset:14336
    ds_read_b128 v[128:131], v250 offset:15360
    ds_read_b128 v[108:111], v250 offset:21504
    ds_read_b128 v[132:135], v250 offset:22528
    ds_read_b128 v[112:115], v250 offset:28672
    ds_read_b128 v[136:139], v250 offset:29696
    ds_read_b128 v[116:119], v250 offset:35840
    ds_read_b128 v[140:143], v250 offset:36864
    s_cmp_lg_u32 s55, 1
    s_cbranch_scc1 t0_w_h
    s_branch t0_noo_h
t0_q3_h:
    s_cmp_eq_u32 s55, 5
    s_cbranch_scc1 t0_w_h
    v_add_u32 v251, 75776, v250
    ds_read_b128 v[96:99], v251 offset:0
    ds_read_b128 v[120:123], v251 offset:1024
    ds_read_b128 v[100:103], v251 offset:6144
    ds_read_b128 v[124:127], v251 offset:7168
    ds_read_b128 v[104:107], v251 offset:12288
    ds_read_b128 v[128:131], v251 offset:13312
    ds_read_b128 v[108:111], v250 offset:21504
    ds_read_b128 v[132:135], v250 offset:22528
    ds_read_b128 v[112:115], v250 offset:28672
    ds_read_b128 v[136:139], v250 offset:29696
    ds_read_b128 v[116:119], v250 offset:35840
    ds_read_b128 v[140:143], v250 offset:36864
t0_w_h:
    s_waitcnt lgkmcnt(0)
    ds_write_b128 v250, v[144:147] offset:0
    ds_write_b128 v250, v[148:151] offset:1024
    ds_write_b128 v250, v[152:155] offset:7168
    ds_write_b128 v250, v[156:159] offset:8192
    ds_write_b128 v250, v[160:163] offset:14336
    ds_write_b128 v250, v[164:167] offset:15360
    ds_write_b128 v250, v[168:171] offset:21504
    ds_write_b128 v250, v[172:175] offset:22528
    ds_write_b128 v250, v[176:179] offset:28672
    ds_write_b128 v250, v[180:183] offset:29696
    ds_write_b128 v250, v[192:195] offset:35840
    ds_write_b128 v250, v[196:199] offset:36864
    s_cmp_eq_u32 s55, 5
    s_cbranch_scc1 t0_exit_h
t0_noo_h:
    ds_read_b128 v[212:215], v244 offset:0
    ds_read_b128 v[216:219], v244 offset:2048
    ds_read_b128 v[220:223], v245 offset:0
    ds_read_b128 v[224:227], v245 offset:2048
    s_waitcnt lgkmcnt(2)
    v_mfma_f32_16x16x32_bf16 v[144:147], v[212:215], v[96:99], 0
    ds_read_b128 v[228:231], v244 offset:4096
    v_mfma_f32_16x16x32_bf16 v[152:155], v[212:215], v[120:123], 0
    s_barrier
    v_mfma_f32_16x16x32_bf16 v[148:151], v[216:219], v[96:99], 0
    ds_read_b128 v[232:235], v244 offset:6144
    v_mfma_f32_16x16x32_bf16 v[156:159], v[216:219], v[120:123], 0
    s_waitcnt lgkmcnt(2)
    v_mfma_f32_16x16x32_bf16 v[144:147], v[220:223], v[100:103], v[144:147]
    ds_read_b128 v[236:239], v245 offset:4096
    v_mfma_f32_16x16x32_bf16 v[152:155], v[220:223], v[124:127], v[152:155]
    v_mfma_f32_16x16x32_bf16 v[148:151], v[224:227], v[100:103], v[148:151]
    ds_read_b128 v[240:243], v245 offset:6144
    v_mfma_f32_16x16x32_bf16 v[156:159], v[224:227], v[124:127], v[156:159]
    s_barrier
    s_waitcnt lgkmcnt(2)
    v_mfma_f32_16x16x32_bf16 v[144:147], v[228:231], v[104:107], v[144:147]
    ds_read_b128 v[212:215], v244 offset:8192
    v_mfma_f32_16x16x32_bf16 v[152:155], v[228:231], v[128:131], v[152:155]
    v_mfma_f32_16x16x32_bf16 v[148:151], v[232:235], v[104:107], v[148:151]
    ds_read_b128 v[216:219], v244 offset:10240
    v_mfma_f32_16x16x32_bf16 v[156:159], v[232:235], v[128:131], v[156:159]
    s_waitcnt lgkmcnt(2)
    v_mfma_f32_16x16x32_bf16 v[144:147], v[236:239], v[108:111], v[144:147]
    ds_read_b128 v[220:223], v245 offset:8192
    v_mfma_f32_16x16x32_bf16 v[152:155], v[236:239], v[132:135], v[152:155]
    v_mfma_f32_16x16x32_bf16 v[148:151], v[240:243], v[108:111], v[148:151]
    ds_read_b128 v[224:227], v245 offset:10240
    v_mfma_f32_16x16x32_bf16 v[156:159], v[240:243], v[132:135], v[156:159]
    s_waitcnt lgkmcnt(2)
    v_mfma_f32_16x16x32_bf16 v[144:147], v[212:215], v[112:115], v[144:147]
    ds_read_b128 v[228:231], v244 offset:12288
    v_mfma_f32_16x16x32_bf16 v[152:155], v[212:215], v[136:139], v[152:155]
    v_mfma_f32_16x16x32_bf16 v[148:151], v[216:219], v[112:115], v[148:151]
    ds_read_b128 v[232:235], v244 offset:14336
    v_mfma_f32_16x16x32_bf16 v[156:159], v[216:219], v[136:139], v[156:159]
    s_waitcnt lgkmcnt(2)
    v_mfma_f32_16x16x32_bf16 v[144:147], v[220:223], v[116:119], v[144:147]
    ds_read_b128 v[236:239], v245 offset:12288
    v_mfma_f32_16x16x32_bf16 v[152:155], v[220:223], v[140:143], v[152:155]
    v_mfma_f32_16x16x32_bf16 v[148:151], v[224:227], v[116:119], v[148:151]
    ds_read_b128 v[240:243], v245 offset:14336
    v_mfma_f32_16x16x32_bf16 v[156:159], v[224:227], v[140:143], v[156:159]
    s_nop 2
    v_max3_f32 v252, v144, v145, v146
    s_nop 1
    v_max3_f32 v252, v252, v147, v148
    v_max3_f32 v252, v252, v149, v150
    v_max_f32 v252, v252, v151
    v_mov_b32 v253, v252
    s_nop 1
    v_permlane32_swap_b32 v253, v252
    v_max_f32 v252, v252, v253
    v_mov_b32 v253, v252
    s_nop 1
    v_permlane16_swap_b32 v253, v252
    v_max_f32 v252, v252, v253
    v_add_f32 v252, 0x40e00000, v252
    v_sub_f32 v192, 0, v252
    v_sub_f32 v193, 0, v252
    v_sub_f32 v194, 0, v252
    v_sub_f32 v195, 0, v252
    v_sub_f32 v144, v144, v252
    v_sub_f32 v145, v145, v252
    v_sub_f32 v146, v146, v252
    v_sub_f32 v147, v147, v252
    v_sub_f32 v148, v148, v252
    v_sub_f32 v149, v149, v252
    v_sub_f32 v150, v150, v252
    v_sub_f32 v151, v151, v252
    v_max3_f32 v252, v152, v153, v154
    v_max3_f32 v252, v252, v155, v156
    v_max3_f32 v252, v252, v157, v158
    v_max_f32 v252, v252, v159
    v_mov_b32 v253, v252
    s_nop 1
    v_permlane32_swap_b32 v253, v252
    v_max_f32 v252, v252, v253
    v_mov_b32 v253, v252
    s_nop 1
    v_permlane16_swap_b32 v253, v252
    v_max_f32 v252, v252, v253
    v_add_f32 v252, 0x40e00000, v252
    v_sub_f32 v196, 0, v252
    v_sub_f32 v197, 0, v252
    v_sub_f32 v198, 0, v252
    v_sub_f32 v199, 0, v252
    v_sub_f32 v152, v152, v252
    v_sub_f32 v153, v153, v252
    v_sub_f32 v154, v154, v252
    v_sub_f32 v155, v155, v252
    v_sub_f32 v156, v156, v252
    v_sub_f32 v157, v157, v252
    v_sub_f32 v158, v158, v252
    v_sub_f32 v159, v159, v252
    s_waitcnt lgkmcnt(2)
    v_mfma_f32_16x16x32_bf16 v[160:163], v[228:231], v[96:99], v[192:195]
    ds_read_b128 v[212:215], v244 offset:16384
    v_exp_f32 v252, v144
    v_mfma_f32_16x16x32_bf16 v[168:171], v[228:231], v[120:123], v[196:199]
    v_exp_f32 v253, v145
    v_mfma_f32_16x16x32_bf16 v[164:167], v[232:235], v[96:99], v[192:195]
    ds_read_b128 v[216:219], v244 offset:18432
    v_exp_f32 v254, v146
    v_mfma_f32_16x16x32_bf16 v[172:175], v[232:235], v[120:123], v[196:199]
    v_exp_f32 v255, v147
    s_waitcnt lgkmcnt(2)
    v_mfma_f32_16x16x32_bf16 v[160:163], v[236:239], v[100:103], v[160:163]
    ds_read_b128 v[220:223], v245 offset:16384
    v_cvt_pk_bf16_f32 v176, v252, v253
    v_mfma_f32_16x16x32_bf16 v[168:171], v[236:239], v[124:127], v[168:171]
    v_exp_f32 v252, v148
    v_mfma_f32_16x16x32_bf16 v[164:167], v[240:243], v[100:103], v[164:167]
    ds_read_b128 v[224:227], v245 offset:18432
    v_exp_f32 v253, v149
    v_mfma_f32_16x16x32_bf16 v[172:175], v[240:243], v[124:127], v[172:175]
    v_cvt_pk_bf16_f32 v177, v254, v255
    v_exp_f32 v254, v150
    s_barrier
    s_waitcnt lgkmcnt(2)
    v_mfma_f32_16x16x32_bf16 v[160:163], v[212:215], v[104:107], v[160:163]
    ds_read_b128 v[228:231], v244 offset:20480
    v_mfma_f32_16x16x32_bf16 v[168:171], v[212:215], v[128:131], v[168:171]
    v_exp_f32 v255, v151
    v_cvt_pk_bf16_f32 v178, v252, v253
    v_mfma_f32_16x16x32_bf16 v[164:167], v[216:219], v[104:107], v[164:167]
    ds_read_b128 v[232:235], v244 offset:22528
    v_exp_f32 v252, v152
    v_mfma_f32_16x16x32_bf16 v[172:175], v[216:219], v[128:131], v[172:175]
    v_exp_f32 v253, v153
    s_waitcnt lgkmcnt(2)
    v_mfma_f32_16x16x32_bf16 v[160:163], v[220:223], v[108:111], v[160:163]
    ds_read_b128 v[236:239], v245 offset:20480
    v_cvt_pk_bf16_f32 v179, v254, v255
    v_mfma_f32_16x16x32_bf16 v[168:171], v[220:223], v[132:135], v[168:171]
    v_exp_f32 v254, v154
    v_mfma_f32_16x16x32_bf16 v[164:167], v[224:227], v[108:111], v[164:167]
    ds_read_b128 v[240:243], v245 offset:22528
    v_exp_f32 v255, v155
    v_mfma_f32_16x16x32_bf16 v[172:175], v[224:227], v[132:135], v[172:175]
    v_cvt_pk_bf16_f32 v180, v252, v253
    v_exp_f32 v252, v156
    s_waitcnt lgkmcnt(2)
    v_mfma_f32_16x16x32_bf16 v[160:163], v[228:231], v[112:115], v[160:163]
    ds_read_b64_tr_b16 v[212:213], v246 offset:24576
    v_mfma_f32_16x16x32_bf16 v[168:171], v[228:231], v[136:139], v[168:171]
    ds_read_b64_tr_b16 v[214:215], v246 offset:26624
    v_exp_f32 v253, v157
    v_cvt_pk_bf16_f32 v181, v254, v255
    v_mfma_f32_16x16x32_bf16 v[164:167], v[232:235], v[112:115], v[164:167]
    ds_read_b64_tr_b16 v[216:217], v247 offset:24576
    v_exp_f32 v254, v158
    v_mfma_f32_16x16x32_bf16 v[172:175], v[232:235], v[136:139], v[172:175]
    ds_read_b64_tr_b16 v[218:219], v247 offset:26624
    v_exp_f32 v255, v159
    s_waitcnt lgkmcnt(4)
    v_mfma_f32_16x16x32_bf16 v[160:163], v[236:239], v[116:119], v[160:163]
    ds_read_b64_tr_b16 v[220:221], v248 offset:24576
    v_cvt_pk_bf16_f32 v182, v252, v253
    v_mfma_f32_16x16x32_bf16 v[168:171], v[236:239], v[140:143], v[168:171]
    ds_read_b64_tr_b16 v[222:223], v248 offset:26624
    v_cvt_pk_bf16_f32 v183, v254, v255
    v_or3_b32 v251, v176, v177, v178
    v_mfma_f32_16x16x32_bf16 v[164:167], v[240:243], v[116:119], v[164:167]
    ds_read_b64_tr_b16 v[224:225], v249 offset:24576
    v_or3_b32 v251, v251, v179, v180
    v_or3_b32 v251, v251, v181, v182
    v_mfma_f32_16x16x32_bf16 v[172:175], v[240:243], v[140:143], v[172:175]
    ds_read_b64_tr_b16 v[226:227], v249 offset:26624
    v_bitop3_b32 v251, v251, v183, s68 bitop3:0xa8
    v_cmp_ne_u32 vcc, 0, v251
    s_cbranch_vccz t0_okq0_h
    s_call_b64 s[30:31], t0_rare0_h
t0_okq0_h:
    s_waitcnt lgkmcnt(4)
    v_mfma_f32_16x16x32_bf16 v[0:3], v[212:215], v[176:179], 0
    ds_read_b64_tr_b16 v[228:229], v246 offset:28672
    v_mfma_f32_16x16x32_bf16 v[48:51], v[212:215], v[180:183], 0
    ds_read_b64_tr_b16 v[230:231], v246 offset:30720
    v_mfma_f32_16x16x32_bf16 v[4:7], v[216:219], v[176:179], 0
    ds_read_b64_tr_b16 v[232:233], v247 offset:28672
    v_mfma_f32_16x16x32_bf16 v[52:55], v[216:219], v[180:183], 0
    ds_read_b64_tr_b16 v[234:235], v247 offset:30720
    v_exp_f32 v252, v160
    s_waitcnt lgkmcnt(4)
    v_mfma_f32_16x16x32_bf16 v[8:11], v[220:223], v[176:179], 0
    ds_read_b64_tr_b16 v[236:237], v248 offset:28672
    v_mfma_f32_16x16x32_bf16 v[56:59], v[220:223], v[180:183], 0
    ds_read_b64_tr_b16 v[238:239], v248 offset:30720
    v_exp_f32 v253, v161
    v_mfma_f32_16x16x32_bf16 v[12:15], v[224:227], v[176:179], 0
    ds_read_b64_tr_b16 v[240:241], v249 offset:28672
    v_mfma_f32_16x16x32_bf16 v[60:63], v[224:227], v[180:183], 0
    ds_read_b64_tr_b16 v[242:243], v249 offset:30720
    v_exp_f32 v254, v162
    s_barrier
    s_waitcnt lgkmcnt(4)
    v_mfma_f32_16x16x32_bf16 v[16:19], v[228:231], v[176:179], 0
    ds_read_b64_tr_b16 v[212:213], v246 offset:32768
    v_mfma_f32_16x16x32_bf16 v[64:67], v[228:231], v[180:183], 0
    ds_read_b64_tr_b16 v[214:215], v246 offset:34816
    v_mfma_f32_16x16x32_bf16 v[200:203], v[208:211], v[176:179], 0
    ds_read_b64_tr_b16 v[216:217], v247 offset:32768
    v_exp_f32 v255, v163
    v_mfma_f32_16x16x32_bf16 v[204:207], v[208:211], v[180:183], 0
    ds_read_b64_tr_b16 v[218:219], v247 offset:34816
    v_mfma_f32_16x16x32_bf16 v[20:23], v[232:235], v[176:179], 0
    v_cvt_pk_bf16_f32 v184, v252, v253
    v_mfma_f32_16x16x32_bf16 v[68:71], v[232:235], v[180:183], 0
    v_exp_f32 v252, v164
    s_waitcnt lgkmcnt(4)
    v_mfma_f32_16x16x32_bf16 v[24:27], v[236:239], v[176:179], 0
    ds_read_b64_tr_b16 v[220:221], v248 offset:32768
    v_mfma_f32_16x16x32_bf16 v[72:75], v[236:239], v[180:183], 0
    ds_read_b64_tr_b16 v[222:223], v248 offset:34816
    v_mfma_f32_16x16x32_bf16 v[28:31], v[240:243], v[176:179], 0
    ds_read_b64_tr_b16 v[224:225], v249 offset:32768
    v_exp_f32 v253, v165
    v_mfma_f32_16x16x32_bf16 v[76:79], v[240:243], v[180:183], 0
    ds_read_b64_tr_b16 v[226:227], v249 offset:34816
    s_waitcnt lgkmcnt(4)
    v_mfma_f32_16x16x32_bf16 v[32:35], v[212:215], v[176:179], 0
    ds_read_b128 v[228:231], v244 offset:36864
    v_cvt_pk_bf16_f32 v185, v254, v255
    v_mfma_f32_16x16x32_bf16 v[80:83], v[212:215], v[180:183], 0
    v_exp_f32 v254, v166
    v_mfma_f32_16x16x32_bf16 v[36:39], v[216:219], v[176:179], 0
    ds_read_b128 v[232:235], v244 offset:38912
    v_mfma_f32_16x16x32_bf16 v[84:87], v[216:219], v[180:183], 0
    s_waitcnt lgkmcnt(2)
    v_mfma_f32_16x16x32_bf16 v[40:43], v[220:223], v[176:179], 0
    ds_read_b128 v[236:239], v245 offset:36864
    v_exp_f32 v255, v167
    v_mfma_f32_16x16x32_bf16 v[88:91], v[220:223], v[180:183], 0
    v_mfma_f32_16x16x32_bf16 v[44:47], v[224:227], v[176:179], 0
    ds_read_b128 v[240:243], v245 offset:38912
    v_cvt_pk_bf16_f32 v186, v252, v253
    v_mfma_f32_16x16x32_bf16 v[92:95], v[224:227], v[180:183], 0
    v_cvt_pk_bf16_f32 v187, v254, v255
    s_waitcnt lgkmcnt(2)
    v_mfma_f32_16x16x32_bf16 v[144:147], v[228:231], v[96:99], v[192:195]
    ds_read_b128 v[212:215], v244 offset:40960
    v_exp_f32 v252, v168
    v_mfma_f32_16x16x32_bf16 v[152:155], v[228:231], v[120:123], v[196:199]
    v_mfma_f32_16x16x32_bf16 v[148:151], v[232:235], v[96:99], v[192:195]
    ds_read_b128 v[216:219], v244 offset:43008
    v_exp_f32 v253, v169
    v_mfma_f32_16x16x32_bf16 v[156:159], v[232:235], v[120:123], v[196:199]
    s_waitcnt lgkmcnt(2)
    v_mfma_f32_16x16x32_bf16 v[144:147], v[236:239], v[100:103], v[144:147]
    ds_read_b128 v[220:223], v245 offset:40960
    v_exp_f32 v254, v170
    v_mfma_f32_16x16x32_bf16 v[152:155], v[236:239], v[124:127], v[152:155]
    v_mfma_f32_16x16x32_bf16 v[148:151], v[240:243], v[100:103], v[148:151]
    ds_read_b128 v[224:227], v245 offset:43008
    v_exp_f32 v255, v171
    v_mfma_f32_16x16x32_bf16 v[156:159], v[240:243], v[124:127], v[156:159]
    s_barrier
    s_waitcnt lgkmcnt(2)
    v_mfma_f32_16x16x32_bf16 v[144:147], v[212:215], v[104:107], v[144:147]
    ds_read_b128 v[228:231], v244 offset:45056
    v_cvt_pk_bf16_f32 v188, v252, v253
    v_mfma_f32_16x16x32_bf16 v[152:155], v[212:215], v[128:131], v[152:155]
    v_exp_f32 v252, v172
    v_mfma_f32_16x16x32_bf16 v[148:151], v[216:219], v[104:107], v[148:151]
    ds_read_b128 v[232:235], v244 offset:47104
    v_mfma_f32_16x16x32_bf16 v[156:159], v[216:219], v[128:131], v[156:159]
    v_exp_f32 v253, v173
    s_waitcnt lgkmcnt(2)
    v_mfma_f32_16x16x32_bf16 v[144:147], v[220:223], v[108:111], v[144:147]
    ds_read_b128 v[236:239], v245 offset:45056
    v_cvt_pk_bf16_f32 v189, v254, v255
    v_mfma_f32_16x16x32_bf16 v[152:155], v[220:223], v[132:135], v[152:155]
    v_mfma_f32_16x16x32_bf16 v[148:151], v[224:227], v[108:111], v[148:151]
    ds_read_b128 v[240:243], v245 offset:47104
    v_exp_f32 v254, v174
    v_mfma_f32_16x16x32_bf16 v[156:159], v[224:227], v[132:135], v[156:159]
    s_waitcnt lgkmcnt(2)
    v_mfma_f32_16x16x32_bf16 v[144:147], v[228:231], v[112:115], v[144:147]
    ds_read_b64_tr_b16 v[212:213], v246 offset:49152
    v_exp_f32 v255, v175
    v_mfma_f32_16x16x32_bf16 v[152:155], v[228:231], v[136:139], v[152:155]
    ds_read_b64_tr_b16 v[214:215], v246 offset:51200
    v_cvt_pk_bf16_f32 v190, v252, v253
    v_mfma_f32_16x16x32_bf16 v[148:151], v[232:235], v[112:115], v[148:151]
    ds_read_b64_tr_b16 v[216:217], v247 offset:49152
    v_cvt_pk_bf16_f32 v191, v254, v255
    v_mfma_f32_16x16x32_bf16 v[156:159], v[232:235], v[136:139], v[156:159]
    ds_read_b64_tr_b16 v[218:219], v247 offset:51200
    v_or3_b32 v251, v184, v185, v186
    s_waitcnt lgkmcnt(4)
    v_mfma_f32_16x16x32_bf16 v[144:147], v[236:239], v[116:119], v[144:147]
    ds_read_b64_tr_b16 v[220:221], v248 offset:49152
    v_or3_b32 v251, v251, v187, v188
    v_mfma_f32_16x16x32_bf16 v[152:155], v[236:239], v[140:143], v[152:155]
    ds_read_b64_tr_b16 v[222:223], v248 offset:51200
    v_or3_b32 v251, v251, v189, v190
    v_mfma_f32_16x16x32_bf16 v[148:151], v[240:243], v[116:119], v[148:151]
    ds_read_b64_tr_b16 v[224:225], v249 offset:49152
    v_bitop3_b32 v251, v251, v191, s68 bitop3:0xa8
    v_mfma_f32_16x16x32_bf16 v[156:159], v[240:243], v[140:143], v[156:159]
    ds_read_b64_tr_b16 v[226:227], v249 offset:51200
    v_cmp_ne_u32 vcc, 0, v251
    s_cbranch_vccz t0_okq1_h
    s_call_b64 s[30:31], t0_rare1_h
t0_okq1_h:
    s_waitcnt lgkmcnt(4)
    v_mfma_f32_16x16x32_bf16 v[0:3], v[212:215], v[184:187], v[0:3]
    ds_read_b64_tr_b16 v[228:229], v246 offset:53248
    v_mfma_f32_16x16x32_bf16 v[48:51], v[212:215], v[188:191], v[48:51]
    ds_read_b64_tr_b16 v[230:231], v246 offset:55296
    v_mfma_f32_16x16x32_bf16 v[4:7], v[216:219], v[184:187], v[4:7]
    ds_read_b64_tr_b16 v[232:233], v247 offset:53248
    v_mfma_f32_16x16x32_bf16 v[52:55], v[216:219], v[188:191], v[52:55]
    ds_read_b64_tr_b16 v[234:235], v247 offset:55296
    v_exp_f32 v252, v144
    s_waitcnt lgkmcnt(4)
    v_mfma_f32_16x16x32_bf16 v[8:11], v[220:223], v[184:187], v[8:11]
    ds_read_b64_tr_b16 v[236:237], v248 offset:53248
    v_mfma_f32_16x16x32_bf16 v[56:59], v[220:223], v[188:191], v[56:59]
    ds_read_b64_tr_b16 v[238:239], v248 offset:55296
    v_exp_f32 v253, v145
    v_mfma_f32_16x16x32_bf16 v[12:15], v[224:227], v[184:187], v[12:15]
    ds_read_b64_tr_b16 v[240:241], v249 offset:53248
    v_mfma_f32_16x16x32_bf16 v[60:63], v[224:227], v[188:191], v[60:63]
    ds_read_b64_tr_b16 v[242:243], v249 offset:55296
    v_exp_f32 v254, v146
    s_barrier
    s_waitcnt lgkmcnt(4)
    v_mfma_f32_16x16x32_bf16 v[16:19], v[228:231], v[184:187], v[16:19]
    ds_read_b64_tr_b16 v[212:213], v246 offset:57344
    v_mfma_f32_16x16x32_bf16 v[64:67], v[228:231], v[188:191], v[64:67]
    ds_read_b64_tr_b16 v[214:215], v246 offset:59392
    v_mfma_f32_16x16x32_bf16 v[200:203], v[208:211], v[184:187], v[200:203]
    ds_read_b64_tr_b16 v[216:217], v247 offset:57344
    v_exp_f32 v255, v147
    v_mfma_f32_16x16x32_bf16 v[204:207], v[208:211], v[188:191], v[204:207]
    ds_read_b64_tr_b16 v[218:219], v247 offset:59392
    v_mfma_f32_16x16x32_bf16 v[20:23], v[232:235], v[184:187], v[20:23]
    v_cvt_pk_bf16_f32 v176, v252, v253
    v_mfma_f32_16x16x32_bf16 v[68:71], v[232:235], v[188:191], v[68:71]
    v_exp_f32 v252, v148
    s_waitcnt lgkmcnt(4)
    v_mfma_f32_16x16x32_bf16 v[24:27], v[236:239], v[184:187], v[24:27]
    ds_read_b64_tr_b16 v[220:221], v248 offset:57344
    v_mfma_f32_16x16x32_bf16 v[72:75], v[236:239], v[188:191], v[72:75]
    ds_read_b64_tr_b16 v[222:223], v248 offset:59392
    v_mfma_f32_16x16x32_bf16 v[28:31], v[240:243], v[184:187], v[28:31]
    ds_read_b64_tr_b16 v[224:225], v249 offset:57344
    v_exp_f32 v253, v149
    v_mfma_f32_16x16x32_bf16 v[76:79], v[240:243], v[188:191], v[76:79]
    ds_read_b64_tr_b16 v[226:227], v249 offset:59392
    s_waitcnt lgkmcnt(4)
    v_mfma_f32_16x16x32_bf16 v[32:35], v[212:215], v[184:187], v[32:35]
    ds_read_b128 v[228:231], v244 offset:61440
    v_cvt_pk_bf16_f32 v177, v254, v255
    v_mfma_f32_16x16x32_bf16 v[80:83], v[212:215], v[188:191], v[80:83]
    v_exp_f32 v254, v150
    v_mfma_f32_16x16x32_bf16 v[36:39], v[216:219], v[184:187], v[36:39]
    ds_read_b128 v[232:235], v244 offset:63488
    v_mfma_f32_16x16x32_bf16 v[84:87], v[216:219], v[188:191], v[84:87]
    s_waitcnt lgkmcnt(2)
    v_mfma_f32_16x16x32_bf16 v[40:43], v[220:223], v[184:187], v[40:43]
    ds_read_b128 v[236:239], v245 offset:61440
    v_exp_f32 v255, v151
    v_mfma_f32_16x16x32_bf16 v[88:91], v[220:223], v[188:191], v[88:91]
    v_mfma_f32_16x16x32_bf16 v[44:47], v[224:227], v[184:187], v[44:47]
    ds_read_b128 v[240:243], v245 offset:63488
    v_cvt_pk_bf16_f32 v178, v252, v253
    v_mfma_f32_16x16x32_bf16 v[92:95], v[224:227], v[188:191], v[92:95]
    v_cvt_pk_bf16_f32 v179, v254, v255
    s_waitcnt lgkmcnt(2)
    v_mfma_f32_16x16x32_bf16 v[160:163], v[228:231], v[96:99], v[192:195]
    ds_read_b128 v[212:215], v244 offset:0
    v_exp_f32 v252, v152
    v_mfma_f32_16x16x32_bf16 v[168:171], v[228:231], v[120:123], v[196:199]
    v_mfma_f32_16x16x32_bf16 v[164:167], v[232:235], v[96:99], v[192:195]
    ds_read_b128 v[216:219], v244 offset:2048
    v_exp_f32 v253, v153
    v_mfma_f32_16x16x32_bf16 v[172:175], v[232:235], v[120:123], v[196:199]
    s_waitcnt lgkmcnt(2)
    v_mfma_f32_16x16x32_bf16 v[160:163], v[236:239], v[100:103], v[160:163]
    ds_read_b128 v[220:223], v245 offset:0
    v_exp_f32 v254, v154
    v_mfma_f32_16x16x32_bf16 v[168:171], v[236:239], v[124:127], v[168:171]
    v_mfma_f32_16x16x32_bf16 v[164:167], v[240:243], v[100:103], v[164:167]
    ds_read_b128 v[224:227], v245 offset:2048
    v_exp_f32 v255, v155
    v_mfma_f32_16x16x32_bf16 v[172:175], v[240:243], v[124:127], v[172:175]
    s_waitcnt lgkmcnt(2)
    v_mfma_f32_16x16x32_bf16 v[160:163], v[212:215], v[104:107], v[160:163]
    ds_read_b128 v[228:231], v244 offset:4096
    v_cvt_pk_bf16_f32 v180, v252, v253
    v_mfma_f32_16x16x32_bf16 v[168:171], v[212:215], v[128:131], v[168:171]
    v_exp_f32 v252, v156
    v_mfma_f32_16x16x32_bf16 v[164:167], v[216:219], v[104:107], v[164:167]
    ds_read_b128 v[232:235], v244 offset:6144
    v_mfma_f32_16x16x32_bf16 v[172:175], v[216:219], v[128:131], v[172:175]
    v_exp_f32 v253, v157
    s_waitcnt lgkmcnt(2)
    v_mfma_f32_16x16x32_bf16 v[160:163], v[220:223], v[108:111], v[160:163]
    ds_read_b128 v[236:239], v245 offset:4096
    v_cvt_pk_bf16_f32 v181, v254, v255
    v_mfma_f32_16x16x32_bf16 v[168:171], v[220:223], v[132:135], v[168:171]
    v_mfma_f32_16x16x32_bf16 v[164:167], v[224:227], v[108:111], v[164:167]
    ds_read_b128 v[240:243], v245 offset:6144
    v_exp_f32 v254, v158
    v_mfma_f32_16x16x32_bf16 v[172:175], v[224:227], v[132:135], v[172:175]
    s_barrier
    s_waitcnt lgkmcnt(2)
    v_mfma_f32_16x16x32_bf16 v[160:163], v[228:231], v[112:115], v[160:163]
    ds_read_b64_tr_b16 v[212:213], v246 offset:8192
    v_exp_f32 v255, v159
    v_mfma_f32_16x16x32_bf16 v[168:171], v[228:231], v[136:139], v[168:171]
    ds_read_b64_tr_b16 v[214:215], v246 offset:10240
    v_cvt_pk_bf16_f32 v182, v252, v253
    v_mfma_f32_16x16x32_bf16 v[164:167], v[232:235], v[112:115], v[164:167]
    ds_read_b64_tr_b16 v[216:217], v247 offset:8192
    v_cvt_pk_bf16_f32 v183, v254, v255
    v_mfma_f32_16x16x32_bf16 v[172:175], v[232:235], v[136:139], v[172:175]
    ds_read_b64_tr_b16 v[218:219], v247 offset:10240
    v_or3_b32 v251, v176, v177, v178
    s_waitcnt lgkmcnt(4)
    v_mfma_f32_16x16x32_bf16 v[160:163], v[236:239], v[116:119], v[160:163]
    ds_read_b64_tr_b16 v[220:221], v248 offset:8192
    v_or3_b32 v251, v251, v179, v180
    v_mfma_f32_16x16x32_bf16 v[168:171], v[236:239], v[140:143], v[168:171]
    ds_read_b64_tr_b16 v[222:223], v248 offset:10240
    v_or3_b32 v251, v251, v181, v182
    v_mfma_f32_16x16x32_bf16 v[164:167], v[240:243], v[116:119], v[164:167]
    ds_read_b64_tr_b16 v[224:225], v249 offset:8192
    v_bitop3_b32 v251, v251, v183, s68 bitop3:0xa8
    v_mfma_f32_16x16x32_bf16 v[172:175], v[240:243], v[140:143], v[172:175]
    ds_read_b64_tr_b16 v[226:227], v249 offset:10240
    v_cmp_ne_u32 vcc, 0, v251
    s_cbranch_vccz t0_okq2_h
    s_call_b64 s[30:31], t0_rare0_h
t0_okq2_h:
    s_waitcnt lgkmcnt(4)
    v_mfma_f32_16x16x32_bf16 v[0:3], v[212:215], v[176:179], v[0:3]
    ds_read_b64_tr_b16 v[228:229], v246 offset:12288
    v_mfma_f32_16x16x32_bf16 v[48:51], v[212:215], v[180:183], v[48:51]
    ds_read_b64_tr_b16 v[230:231], v246 offset:14336
    v_mfma_f32_16x16x32_bf16 v[4:7], v[216:219], v[176:179], v[4:7]
    ds_read_b64_tr_b16 v[232:233], v247 offset:12288
    v_mfma_f32_16x16x32_bf16 v[52:55], v[216:219], v[180:183], v[52:55]
    ds_read_b64_tr_b16 v[234:235], v247 offset:14336
    v_exp_f32 v252, v160
    s_waitcnt lgkmcnt(4)
    v_mfma_f32_16x16x32_bf16 v[8:11], v[220:223], v[176:179], v[8:11]
    ds_read_b64_tr_b16 v[236:237], v248 offset:12288
    v_mfma_f32_16x16x32_bf16 v[56:59], v[220:223], v[180:183], v[56:59]
    ds_read_b64_tr_b16 v[238:239], v248 offset:14336
    v_exp_f32 v253, v161
    v_mfma_f32_16x16x32_bf16 v[12:15], v[224:227], v[176:179], v[12:15]
    ds_read_b64_tr_b16 v[240:241], v249 offset:12288
    v_mfma_f32_16x16x32_bf16 v[60:63], v[224:227], v[180:183], v[60:63]
    ds_read_b64_tr_b16 v[242:243], v249 offset:14336
    v_exp_f32 v254, v162
    s_waitcnt lgkmcnt(4)
    v_mfma_f32_16x16x32_bf16 v[16:19], v[228:231], v[176:179], v[16:19]
    ds_read_b64_tr_b16 v[212:213], v246 offset:16384
    v_mfma_f32_16x16x32_bf16 v[64:67], v[228:231], v[180:183], v[64:67]
    ds_read_b64_tr_b16 v[214:215], v246 offset:18432
    v_mfma_f32_16x16x32_bf16 v[200:203], v[208:211], v[176:179], v[200:203]
    ds_read_b64_tr_b16 v[216:217], v247 offset:16384
    v_exp_f32 v255, v163
    v_mfma_f32_16x16x32_bf16 v[204:207], v[208:211], v[180:183], v[204:207]
    ds_read_b64_tr_b16 v[218:219], v247 offset:18432
    v_mfma_f32_16x16x32_bf16 v[20:23], v[232:235], v[176:179], v[20:23]
    v_cvt_pk_bf16_f32 v184, v252, v253
    v_mfma_f32_16x16x32_bf16 v[68:71], v[232:235], v[180:183], v[68:71]
    v_exp_f32 v252, v164
    s_waitcnt lgkmcnt(4)
    v_mfma_f32_16x16x32_bf16 v[24:27], v[236:239], v[176:179], v[24:27]
    ds_read_b64_tr_b16 v[220:221], v248 offset:16384
    v_mfma_f32_16x16x32_bf16 v[72:75], v[236:239], v[180:183], v[72:75]
    ds_read_b64_tr_b16 v[222:223], v248 offset:18432
    v_mfma_f32_16x16x32_bf16 v[28:31], v[240:243], v[176:179], v[28:31]
    ds_read_b64_tr_b16 v[224:225], v249 offset:16384
    v_exp_f32 v253, v165
    v_mfma_f32_16x16x32_bf16 v[76:79], v[240:243], v[180:183], v[76:79]
    ds_read_b64_tr_b16 v[226:227], v249 offset:18432
    s_barrier
    s_waitcnt lgkmcnt(4)
    v_mfma_f32_16x16x32_bf16 v[32:35], v[212:215], v[176:179], v[32:35]
    ds_read_b128 v[228:231], v244 offset:20480
    v_cvt_pk_bf16_f32 v185, v254, v255
    v_mfma_f32_16x16x32_bf16 v[80:83], v[212:215], v[180:183], v[80:83]
    v_exp_f32 v254, v166
    v_mfma_f32_16x16x32_bf16 v[36:39], v[216:219], v[176:179], v[36:39]
    ds_read_b128 v[232:235], v244 offset:22528
    v_mfma_f32_16x16x32_bf16 v[84:87], v[216:219], v[180:183], v[84:87]
    s_waitcnt lgkmcnt(2)
    v_mfma_f32_16x16x32_bf16 v[40:43], v[220:223], v[176:179], v[40:43]
    ds_read_b128 v[236:239], v245 offset:20480
    v_exp_f32 v255, v167
    v_mfma_f32_16x16x32_bf16 v[88:91], v[220:223], v[180:183], v[88:91]
    v_mfma_f32_16x16x32_bf16 v[44:47], v[224:227], v[176:179], v[44:47]
    ds_read_b128 v[240:243], v245 offset:22528
    v_cvt_pk_bf16_f32 v186, v252, v253
    v_mfma_f32_16x16x32_bf16 v[92:95], v[224:227], v[180:183], v[92:95]
    v_cvt_pk_bf16_f32 v187, v254, v255
    s_waitcnt lgkmcnt(2)
    v_mfma_f32_16x16x32_bf16 v[144:147], v[228:231], v[96:99], v[192:195]
    ds_read_b128 v[212:215], v244 offset:24576
    v_exp_f32 v252, v168
    v_mfma_f32_16x16x32_bf16 v[152:155], v[228:231], v[120:123], v[196:199]
    v_mfma_f32_16x16x32_bf16 v[148:151], v[232:235], v[96:99], v[192:195]
    ds_read_b128 v[216:219], v244 offset:26624
    v_exp_f32 v253, v169
    v_mfma_f32_16x16x32_bf16 v[156:159], v[232:235], v[120:123], v[196:199]
    s_waitcnt lgkmcnt(2)
    v_mfma_f32_16x16x32_bf16 v[144:147], v[236:239], v[100:103], v[144:147]
    ds_read_b128 v[220:223], v245 offset:24576
    v_exp_f32 v254, v170
    v_mfma_f32_16x16x32_bf16 v[152:155], v[236:239], v[124:127], v[152:155]
    v_mfma_f32_16x16x32_bf16 v[148:151], v[240:243], v[100:103], v[148:151]
    ds_read_b128 v[224:227], v245 offset:26624
    v_exp_f32 v255, v171
    v_mfma_f32_16x16x32_bf16 v[156:159], v[240:243], v[124:127], v[156:159]
    s_waitcnt lgkmcnt(2)
    v_mfma_f32_16x16x32_bf16 v[144:147], v[212:215], v[104:107], v[144:147]
    ds_read_b128 v[228:231], v244 offset:28672
    v_cvt_pk_bf16_f32 v188, v252, v253
    v_mfma_f32_16x16x32_bf16 v[152:155], v[212:215], v[128:131], v[152:155]
    v_exp_f32 v252, v172
    v_mfma_f32_16x16x32_bf16 v[148:151], v[216:219], v[104:107], v[148:151]
    ds_read_b128 v[232:235], v244 offset:30720
    v_mfma_f32_16x16x32_bf16 v[156:159], v[216:219], v[128:131], v[156:159]
    v_exp_f32 v253, v173
    s_waitcnt lgkmcnt(2)
    v_mfma_f32_16x16x32_bf16 v[144:147], v[220:223], v[108:111], v[144:147]
    ds_read_b128 v[236:239], v245 offset:28672
    v_cvt_pk_bf16_f32 v189, v254, v255
    v_mfma_f32_16x16x32_bf16 v[152:155], v[220:223], v[132:135], v[152:155]
    v_mfma_f32_16x16x32_bf16 v[148:151], v[224:227], v[108:111], v[148:151]
    ds_read_b128 v[240:243], v245 offset:30720
    v_exp_f32 v254, v174
    v_mfma_f32_16x16x32_bf16 v[156:159], v[224:227], v[132:135], v[156:159]
    s_barrier
    s_waitcnt lgkmcnt(2)
    v_mfma_f32_16x16x32_bf16 v[144:147], v[228:231], v[112:115], v[144:147]
    ds_read_b64_tr_b16 v[212:213], v246 offset:32768
    v_exp_f32 v255, v175
    v_mfma_f32_16x16x32_bf16 v[152:155], v[228:231], v[136:139], v[152:155]
    ds_read_b64_tr_b16 v[214:215], v246 offset:34816
    v_cvt_pk_bf16_f32 v190, v252, v253
    v_mfma_f32_16x16x32_bf16 v[148:151], v[232:235], v[112:115], v[148:151]
    ds_read_b64_tr_b16 v[216:217], v247 offset:32768
    v_cvt_pk_bf16_f32 v191, v254, v255
    v_mfma_f32_16x16x32_bf16 v[156:159], v[232:235], v[136:139], v[156:159]
    ds_read_b64_tr_b16 v[218:219], v247 offset:34816
    v_or3_b32 v251, v184, v185, v186
    s_waitcnt lgkmcnt(4)
    v_mfma_f32_16x16x32_bf16 v[144:147], v[236:239], v[116:119], v[144:147]
    ds_read_b64_tr_b16 v[220:221], v248 offset:32768
    v_or3_b32 v251, v251, v187, v188
    v_mfma_f32_16x16x32_bf16 v[152:155], v[236:239], v[140:143], v[152:155]
    ds_read_b64_tr_b16 v[222:223], v248 offset:34816
    v_or3_b32 v251, v251, v189, v190
    v_mfma_f32_16x16x32_bf16 v[148:151], v[240:243], v[116:119], v[148:151]
    ds_read_b64_tr_b16 v[224:225], v249 offset:32768
    v_bitop3_b32 v251, v251, v191, s68 bitop3:0xa8
    v_mfma_f32_16x16x32_bf16 v[156:159], v[240:243], v[140:143], v[156:159]
    ds_read_b64_tr_b16 v[226:227], v249 offset:34816
    v_cmp_ne_u32 vcc, 0, v251
    s_cbranch_vccz t0_okq3_h
    s_call_b64 s[30:31], t0_rare1_h
t0_okq3_h:
    s_waitcnt lgkmcnt(4)
    v_mfma_f32_16x16x32_bf16 v[0:3], v[212:215], v[184:187], v[0:3]
    ds_read_b64_tr_b16 v[228:229], v246 offset:36864
    v_mfma_f32_16x16x32_bf16 v[48:51], v[212:215], v[188:191], v[48:51]
    ds_read_b64_tr_b16 v[230:231], v246 offset:38912
    v_mfma_f32_16x16x32_bf16 v[4:7], v[216:219], v[184:187], v[4:7]
    ds_read_b64_tr_b16 v[232:233], v247 offset:36864
    v_mfma_f32_16x16x32_bf16 v[52:55], v[216:219], v[188:191], v[52:55]
    ds_read_b64_tr_b16 v[234:235], v247 offset:38912
    v_exp_f32 v252, v144
    s_waitcnt lgkmcnt(4)
    v_mfma_f32_16x16x32_bf16 v[8:11], v[220:223], v[184:187], v[8:11]
    ds_read_b64_tr_b16 v[236:237], v248 offset:36864
    v_mfma_f32_16x16x32_bf16 v[56:59], v[220:223], v[188:191], v[56:59]
    ds_read_b64_tr_b16 v[238:239], v248 offset:38912
    v_exp_f32 v253, v145
    v_mfma_f32_16x16x32_bf16 v[12:15], v[224:227], v[184:187], v[12:15]
    ds_read_b64_tr_b16 v[240:241], v249 offset:36864
    v_mfma_f32_16x16x32_bf16 v[60:63], v[224:227], v[188:191], v[60:63]
    ds_read_b64_tr_b16 v[242:243], v249 offset:38912
    v_exp_f32 v254, v146
    s_waitcnt lgkmcnt(4)
    v_mfma_f32_16x16x32_bf16 v[16:19], v[228:231], v[184:187], v[16:19]
    ds_read_b64_tr_b16 v[212:213], v246 offset:40960
    v_mfma_f32_16x16x32_bf16 v[64:67], v[228:231], v[188:191], v[64:67]
    ds_read_b64_tr_b16 v[214:215], v246 offset:43008
    v_mfma_f32_16x16x32_bf16 v[200:203], v[208:211], v[184:187], v[200:203]
    ds_read_b64_tr_b16 v[216:217], v247 offset:40960
    v_exp_f32 v255, v147
    v_mfma_f32_16x16x32_bf16 v[204:207], v[208:211], v[188:191], v[204:207]
    ds_read_b64_tr_b16 v[218:219], v247 offset:43008
    v_mfma_f32_16x16x32_bf16 v[20:23], v[232:235], v[184:187], v[20:23]
    v_cvt_pk_bf16_f32 v176, v252, v253
    v_mfma_f32_16x16x32_bf16 v[68:71], v[232:235], v[188:191], v[68:71]
    v_exp_f32 v252, v148
    s_waitcnt lgkmcnt(4)
    v_mfma_f32_16x16x32_bf16 v[24:27], v[236:239], v[184:187], v[24:27]
    ds_read_b64_tr_b16 v[220:221], v248 offset:40960
    v_mfma_f32_16x16x32_bf16 v[72:75], v[236:239], v[188:191], v[72:75]
    ds_read_b64_tr_b16 v[222:223], v248 offset:43008
    v_mfma_f32_16x16x32_bf16 v[28:31], v[240:243], v[184:187], v[28:31]
    ds_read_b64_tr_b16 v[224:225], v249 offset:40960
    v_exp_f32 v253, v149
    v_mfma_f32_16x16x32_bf16 v[76:79], v[240:243], v[188:191], v[76:79]
    ds_read_b64_tr_b16 v[226:227], v249 offset:43008
    s_barrier
    s_waitcnt lgkmcnt(4)
    v_mfma_f32_16x16x32_bf16 v[32:35], v[212:215], v[184:187], v[32:35]
    ds_read_b128 v[228:231], v244 offset:45056
    v_cvt_pk_bf16_f32 v177, v254, v255
    v_mfma_f32_16x16x32_bf16 v[80:83], v[212:215], v[188:191], v[80:83]
    v_exp_f32 v254, v150
    v_mfma_f32_16x16x32_bf16 v[36:39], v[216:219], v[184:187], v[36:39]
    ds_read_b128 v[232:235], v244 offset:47104
    v_mfma_f32_16x16x32_bf16 v[84:87], v[216:219], v[188:191], v[84:87]
    s_waitcnt lgkmcnt(2)
    v_mfma_f32_16x16x32_bf16 v[40:43], v[220:223], v[184:187], v[40:43]
    ds_read_b128 v[236:239], v245 offset:45056
    v_exp_f32 v255, v151
    v_mfma_f32_16x16x32_bf16 v[88:91], v[220:223], v[188:191], v[88:91]
    v_mfma_f32_16x16x32_bf16 v[44:47], v[224:227], v[184:187], v[44:47]
    ds_read_b128 v[240:243], v245 offset:47104
    v_cvt_pk_bf16_f32 v178, v252, v253
    v_mfma_f32_16x16x32_bf16 v[92:95], v[224:227], v[188:191], v[92:95]
    v_cvt_pk_bf16_f32 v179, v254, v255
    s_waitcnt lgkmcnt(2)
    v_mfma_f32_16x16x32_bf16 v[160:163], v[228:231], v[96:99], v[192:195]
    ds_read_b128 v[212:215], v244 offset:49152
    v_exp_f32 v252, v152
    v_mfma_f32_16x16x32_bf16 v[168:171], v[228:231], v[120:123], v[196:199]
    v_mfma_f32_16x16x32_bf16 v[164:167], v[232:235], v[96:99], v[192:195]
    ds_read_b128 v[216:219], v244 offset:51200
    v_exp_f32 v253, v153
    v_mfma_f32_16x16x32_bf16 v[172:175], v[232:235], v[120:123], v[196:199]
    s_waitcnt lgkmcnt(2)
    v_mfma_f32_16x16x32_bf16 v[160:163], v[236:239], v[100:103], v[160:163]
    ds_read_b128 v[220:223], v245 offset:49152
    v_exp_f32 v254, v154
    v_mfma_f32_16x16x32_bf16 v[168:171], v[236:239], v[124:127], v[168:171]
    v_mfma_f32_16x16x32_bf16 v[164:167], v[240:243], v[100:103], v[164:167]
    ds_read_b128 v[224:227], v245 offset:51200
    v_exp_f32 v255, v155
    v_mfma_f32_16x16x32_bf16 v[172:175], v[240:243], v[124:127], v[172:175]
    s_waitcnt lgkmcnt(2)
    v_mfma_f32_16x16x32_bf16 v[160:163], v[212:215], v[104:107], v[160:163]
    ds_read_b128 v[228:231], v244 offset:53248
    v_cvt_pk_bf16_f32 v180, v252, v253
    v_mfma_f32_16x16x32_bf16 v[168:171], v[212:215], v[128:131], v[168:171]
    v_exp_f32 v252, v156
    v_mfma_f32_16x16x32_bf16 v[164:167], v[216:219], v[104:107], v[164:167]
    ds_read_b128 v[232:235], v244 offset:55296
    v_mfma_f32_16x16x32_bf16 v[172:175], v[216:219], v[128:131], v[172:175]
    v_exp_f32 v253, v157
    s_waitcnt lgkmcnt(2)
    v_mfma_f32_16x16x32_bf16 v[160:163], v[220:223], v[108:111], v[160:163]
    ds_read_b128 v[236:239], v245 offset:53248
    v_cvt_pk_bf16_f32 v181, v254, v255
    v_mfma_f32_16x16x32_bf16 v[168:171], v[220:223], v[132:135], v[168:171]
    v_mfma_f32_16x16x32_bf16 v[164:167], v[224:227], v[108:111], v[164:167]
    ds_read_b128 v[240:243], v245 offset:55296
    v_exp_f32 v254, v158
    v_mfma_f32_16x16x32_bf16 v[172:175], v[224:227], v[132:135], v[172:175]
    s_barrier
    s_waitcnt lgkmcnt(2)
    v_mfma_f32_16x16x32_bf16 v[160:163], v[228:231], v[112:115], v[160:163]
    ds_read_b64_tr_b16 v[212:213], v246 offset:57344
    v_exp_f32 v255, v159
    v_mfma_f32_16x16x32_bf16 v[168:171], v[228:231], v[136:139], v[168:171]
    ds_read_b64_tr_b16 v[214:215], v246 offset:59392
    v_cvt_pk_bf16_f32 v182, v252, v253
    v_mfma_f32_16x16x32_bf16 v[164:167], v[232:235], v[112:115], v[164:167]
    ds_read_b64_tr_b16 v[216:217], v247 offset:57344
    v_cvt_pk_bf16_f32 v183, v254, v255
    v_mfma_f32_16x16x32_bf16 v[172:175], v[232:235], v[136:139], v[172:175]
    ds_read_b64_tr_b16 v[218:219], v247 offset:59392
    v_or3_b32 v251, v176, v177, v178
    s_waitcnt lgkmcnt(4)
    v_mfma_f32_16x16x32_bf16 v[160:163], v[236:239], v[116:119], v[160:163]
    ds_read_b64_tr_b16 v[220:221], v248 offset:57344
    v_or3_b32 v251, v251, v179, v180
    v_mfma_f32_16x16x32_bf16 v[168:171], v[236:239], v[140:143], v[168:171]
    ds_read_b64_tr_b16 v[222:223], v248 offset:59392
    v_or3_b32 v251, v251, v181, v182
    v_mfma_f32_16x16x32_bf16 v[164:167], v[240:243], v[116:119], v[164:167]
    ds_read_b64_tr_b16 v[224:225], v249 offset:57344
    v_bitop3_b32 v251, v251, v183, s68 bitop3:0xa8
    v_mfma_f32_16x16x32_bf16 v[172:175], v[240:243], v[140:143], v[172:175]
    ds_read_b64_tr_b16 v[226:227], v249 offset:59392
    v_cmp_ne_u32 vcc, 0, v251
    s_cbranch_vccz t0_okq4_h
    s_call_b64 s[30:31], t0_rare0_h
t0_okq4_h:
    s_waitcnt lgkmcnt(4)
    v_mfma_f32_16x16x32_bf16 v[0:3], v[212:215], v[176:179], v[0:3]
    ds_read_b64_tr_b16 v[228:229], v246 offset:61440
    v_mfma_f32_16x16x32_bf16 v[48:51], v[212:215], v[180:183], v[48:51]
    ds_read_b64_tr_b16 v[230:231], v246 offset:63488
    v_mfma_f32_16x16x32_bf16 v[4:7], v[216:219], v[176:179], v[4:7]
    ds_read_b64_tr_b16 v[232:233], v247 offset:61440
    v_mfma_f32_16x16x32_bf16 v[52:55], v[216:219], v[180:183], v[52:55]
    ds_read_b64_tr_b16 v[234:235], v247 offset:63488
    v_exp_f32 v252, v160
    s_waitcnt lgkmcnt(4)
    v_mfma_f32_16x16x32_bf16 v[8:11], v[220:223], v[176:179], v[8:11]
    ds_read_b64_tr_b16 v[236:237], v248 offset:61440
    v_mfma_f32_16x16x32_bf16 v[56:59], v[220:223], v[180:183], v[56:59]
    ds_read_b64_tr_b16 v[238:239], v248 offset:63488
    v_exp_f32 v253, v161
    v_mfma_f32_16x16x32_bf16 v[12:15], v[224:227], v[176:179], v[12:15]
    ds_read_b64_tr_b16 v[240:241], v249 offset:61440
    v_mfma_f32_16x16x32_bf16 v[60:63], v[224:227], v[180:183], v[60:63]
    ds_read_b64_tr_b16 v[242:243], v249 offset:63488
    v_exp_f32 v254, v162
    s_waitcnt lgkmcnt(4)
    v_mfma_f32_16x16x32_bf16 v[16:19], v[228:231], v[176:179], v[16:19]
    ds_read_b64_tr_b16 v[212:213], v246 offset:0
    v_mfma_f32_16x16x32_bf16 v[64:67], v[228:231], v[180:183], v[64:67]
    ds_read_b64_tr_b16 v[214:215], v246 offset:2048
    v_mfma_f32_16x16x32_bf16 v[200:203], v[208:211], v[176:179], v[200:203]
    ds_read_b64_tr_b16 v[216:217], v247 offset:0
    v_exp_f32 v255, v163
    v_mfma_f32_16x16x32_bf16 v[204:207], v[208:211], v[180:183], v[204:207]
    ds_read_b64_tr_b16 v[218:219], v247 offset:2048
    v_mfma_f32_16x16x32_bf16 v[20:23], v[232:235], v[176:179], v[20:23]
    v_cvt_pk_bf16_f32 v184, v252, v253
    v_mfma_f32_16x16x32_bf16 v[68:71], v[232:235], v[180:183], v[68:71]
    v_exp_f32 v252, v164
    s_waitcnt lgkmcnt(4)
    v_mfma_f32_16x16x32_bf16 v[24:27], v[236:239], v[176:179], v[24:27]
    ds_read_b64_tr_b16 v[220:221], v248 offset:0
    v_mfma_f32_16x16x32_bf16 v[72:75], v[236:239], v[180:183], v[72:75]
    ds_read_b64_tr_b16 v[222:223], v248 offset:2048
    v_mfma_f32_16x16x32_bf16 v[28:31], v[240:243], v[176:179], v[28:31]
    ds_read_b64_tr_b16 v[224:225], v249 offset:0
    v_exp_f32 v253, v165
    v_mfma_f32_16x16x32_bf16 v[76:79], v[240:243], v[180:183], v[76:79]
    ds_read_b64_tr_b16 v[226:227], v249 offset:2048
    s_waitcnt lgkmcnt(4)
    v_mfma_f32_16x16x32_bf16 v[32:35], v[212:215], v[176:179], v[32:35]
    ds_read_b128 v[228:231], v244 offset:4096
    v_cvt_pk_bf16_f32 v185, v254, v255
    v_mfma_f32_16x16x32_bf16 v[80:83], v[212:215], v[180:183], v[80:83]
    v_exp_f32 v254, v166
    v_mfma_f32_16x16x32_bf16 v[36:39], v[216:219], v[176:179], v[36:39]
    ds_read_b128 v[232:235], v244 offset:6144
    v_mfma_f32_16x16x32_bf16 v[84:87], v[216:219], v[180:183], v[84:87]
    s_waitcnt lgkmcnt(2)
    v_mfma_f32_16x16x32_bf16 v[40:43], v[220:223], v[176:179], v[40:43]
    ds_read_b128 v[236:239], v245 offset:4096
    v_exp_f32 v255, v167
    v_mfma_f32_16x16x32_bf16 v[88:91], v[220:223], v[180:183], v[88:91]
    v_mfma_f32_16x16x32_bf16 v[44:47], v[224:227], v[176:179], v[44:47]
    ds_read_b128 v[240:243], v245 offset:6144
    v_cvt_pk_bf16_f32 v186, v252, v253
    v_mfma_f32_16x16x32_bf16 v[92:95], v[224:227], v[180:183], v[92:95]
    v_cvt_pk_bf16_f32 v187, v254, v255
    s_barrier
    s_waitcnt lgkmcnt(2)
    v_mfma_f32_16x16x32_bf16 v[144:147], v[228:231], v[96:99], v[192:195]
    ds_read_b128 v[212:215], v244 offset:8192
    v_exp_f32 v252, v168
    v_mfma_f32_16x16x32_bf16 v[152:155], v[228:231], v[120:123], v[196:199]
    v_mfma_f32_16x16x32_bf16 v[148:151], v[232:235], v[96:99], v[192:195]
    ds_read_b128 v[216:219], v244 offset:10240
    v_exp_f32 v253, v169
    v_mfma_f32_16x16x32_bf16 v[156:159], v[232:235], v[120:123], v[196:199]
    s_waitcnt lgkmcnt(2)
    v_mfma_f32_16x16x32_bf16 v[144:147], v[236:239], v[100:103], v[144:147]
    ds_read_b128 v[220:223], v245 offset:8192
    v_exp_f32 v254, v170
    v_mfma_f32_16x16x32_bf16 v[152:155], v[236:239], v[124:127], v[152:155]
    v_mfma_f32_16x16x32_bf16 v[148:151], v[240:243], v[100:103], v[148:151]
    ds_read_b128 v[224:227], v245 offset:10240
    v_exp_f32 v255, v171
    v_mfma_f32_16x16x32_bf16 v[156:159], v[240:243], v[124:127], v[156:159]
    s_waitcnt lgkmcnt(2)
    v_mfma_f32_16x16x32_bf16 v[144:147], v[212:215], v[104:107], v[144:147]
    ds_read_b128 v[228:231], v244 offset:12288
    v_cvt_pk_bf16_f32 v188, v252, v253
    v_mfma_f32_16x16x32_bf16 v[152:155], v[212:215], v[128:131], v[152:155]
    v_exp_f32 v252, v172
    v_mfma_f32_16x16x32_bf16 v[148:151], v[216:219], v[104:107], v[148:151]
    ds_read_b128 v[232:235], v244 offset:14336
    v_mfma_f32_16x16x32_bf16 v[156:159], v[216:219], v[128:131], v[156:159]
    v_exp_f32 v253, v173
    s_waitcnt lgkmcnt(2)
    v_mfma_f32_16x16x32_bf16 v[144:147], v[220:223], v[108:111], v[144:147]
    ds_read_b128 v[236:239], v245 offset:12288
    v_cvt_pk_bf16_f32 v189, v254, v255
    v_mfma_f32_16x16x32_bf16 v[152:155], v[220:223], v[132:135], v[152:155]
    v_mfma_f32_16x16x32_bf16 v[148:151], v[224:227], v[108:111], v[148:151]
    ds_read_b128 v[240:243], v245 offset:14336
    v_exp_f32 v254, v174
    v_mfma_f32_16x16x32_bf16 v[156:159], v[224:227], v[132:135], v[156:159]
    s_waitcnt lgkmcnt(2)
    v_mfma_f32_16x16x32_bf16 v[144:147], v[228:231], v[112:115], v[144:147]
    ds_read_b64_tr_b16 v[212:213], v246 offset:16384
    v_exp_f32 v255, v175
    v_mfma_f32_16x16x32_bf16 v[152:155], v[228:231], v[136:139], v[152:155]
    ds_read_b64_tr_b16 v[214:215], v246 offset:18432
    v_cvt_pk_bf16_f32 v190, v252, v253
    v_mfma_f32_16x16x32_bf16 v[148:151], v[232:235], v[112:115], v[148:151]
    ds_read_b64_tr_b16 v[216:217], v247 offset:16384
    v_cvt_pk_bf16_f32 v191, v254, v255
    v_mfma_f32_16x16x32_bf16 v[156:159], v[232:235], v[136:139], v[156:159]
    ds_read_b64_tr_b16 v[218:219], v247 offset:18432
    v_or3_b32 v251, v184, v185, v186
    s_waitcnt lgkmcnt(4)
    v_mfma_f32_16x16x32_bf16 v[144:147], v[236:239], v[116:119], v[144:147]
    ds_read_b64_tr_b16 v[220:221], v248 offset:16384
    v_or3_b32 v251, v251, v187, v188
    v_mfma_f32_16x16x32_bf16 v[152:155], v[236:239], v[140:143], v[152:155]
    ds_read_b64_tr_b16 v[222:223], v248 offset:18432
    v_or3_b32 v251, v251, v189, v190
    v_mfma_f32_16x16x32_bf16 v[148:151], v[240:243], v[116:119], v[148:151]
    ds_read_b64_tr_b16 v[224:225], v249 offset:16384
    v_bitop3_b32 v251, v251, v191, s68 bitop3:0xa8
    v_mfma_f32_16x16x32_bf16 v[156:159], v[240:243], v[140:143], v[156:159]
    ds_read_b64_tr_b16 v[226:227], v249 offset:18432
    v_cmp_ne_u32 vcc, 0, v251
    s_cbranch_vccz t0_okq5_h
    s_call_b64 s[30:31], t0_rare1_h
t0_okq5_h:
    s_barrier
    s_waitcnt lgkmcnt(4)
    v_mfma_f32_16x16x32_bf16 v[0:3], v[212:215], v[184:187], v[0:3]
    ds_read_b64_tr_b16 v[228:229], v246 offset:20480
    v_mfma_f32_16x16x32_bf16 v[48:51], v[212:215], v[188:191], v[48:51]
    ds_read_b64_tr_b16 v[230:231], v246 offset:22528
    v_mfma_f32_16x16x32_bf16 v[4:7], v[216:219], v[184:187], v[4:7]
    ds_read_b64_tr_b16 v[232:233], v247 offset:20480
    v_mfma_f32_16x16x32_bf16 v[52:55], v[216:219], v[188:191], v[52:55]
    ds_read_b64_tr_b16 v[234:235], v247 offset:22528
    v_exp_f32 v252, v144
    s_waitcnt lgkmcnt(4)
    v_mfma_f32_16x16x32_bf16 v[8:11], v[220:223], v[184:187], v[8:11]
    ds_read_b64_tr_b16 v[236:237], v248 offset:20480
    v_mfma_f32_16x16x32_bf16 v[56:59], v[220:223], v[188:191], v[56:59]
    ds_read_b64_tr_b16 v[238:239], v248 offset:22528
    v_exp_f32 v253, v145
    v_mfma_f32_16x16x32_bf16 v[12:15], v[224:227], v[184:187], v[12:15]
    ds_read_b64_tr_b16 v[240:241], v249 offset:20480
    v_mfma_f32_16x16x32_bf16 v[60:63], v[224:227], v[188:191], v[60:63]
    ds_read_b64_tr_b16 v[242:243], v249 offset:22528
    v_exp_f32 v254, v146
    s_waitcnt lgkmcnt(4)
    v_mfma_f32_16x16x32_bf16 v[16:19], v[228:231], v[184:187], v[16:19]
    ds_read_b64_tr_b16 v[212:213], v246 offset:24576
    v_mfma_f32_16x16x32_bf16 v[64:67], v[228:231], v[188:191], v[64:67]
    ds_read_b64_tr_b16 v[214:215], v246 offset:26624
    v_mfma_f32_16x16x32_bf16 v[200:203], v[208:211], v[184:187], v[200:203]
    ds_read_b64_tr_b16 v[216:217], v247 offset:24576
    v_exp_f32 v255, v147
    v_mfma_f32_16x16x32_bf16 v[204:207], v[208:211], v[188:191], v[204:207]
    ds_read_b64_tr_b16 v[218:219], v247 offset:26624
    v_mfma_f32_16x16x32_bf16 v[20:23], v[232:235], v[184:187], v[20:23]
    v_cvt_pk_bf16_f32 v176, v252, v253
    v_mfma_f32_16x16x32_bf16 v[68:71], v[232:235], v[188:191], v[68:71]
    v_exp_f32 v252, v148
    s_waitcnt lgkmcnt(4)
    v_mfma_f32_16x16x32_bf16 v[24:27], v[236:239], v[184:187], v[24:27]
    ds_read_b64_tr_b16 v[220:221], v248 offset:24576
    v_mfma_f32_16x16x32_bf16 v[72:75], v[236:239], v[188:191], v[72:75]
    ds_read_b64_tr_b16 v[222:223], v248 offset:26624
    v_mfma_f32_16x16x32_bf16 v[28:31], v[240:243], v[184:187], v[28:31]
    ds_read_b64_tr_b16 v[224:225], v249 offset:24576
    v_exp_f32 v253, v149
    v_mfma_f32_16x16x32_bf16 v[76:79], v[240:243], v[188:191], v[76:79]
    ds_read_b64_tr_b16 v[226:227], v249 offset:26624
    s_waitcnt lgkmcnt(4)
    v_mfma_f32_16x16x32_bf16 v[32:35], v[212:215], v[184:187], v[32:35]
    ds_read_b128 v[228:231], v244 offset:28672
    v_cvt_pk_bf16_f32 v177, v254, v255
    v_mfma_f32_16x16x32_bf16 v[80:83], v[212:215], v[188:191], v[80:83]
    v_exp_f32 v254, v150
    v_mfma_f32_16x16x32_bf16 v[36:39], v[216:219], v[184:187], v[36:39]
    ds_read_b128 v[232:235], v244 offset:30720
    v_mfma_f32_16x16x32_bf16 v[84:87], v[216:219], v[188:191], v[84:87]
    s_waitcnt lgkmcnt(2)
    v_mfma_f32_16x16x32_bf16 v[40:43], v[220:223], v[184:187], v[40:43]
    ds_read_b128 v[236:239], v245 offset:28672
    v_exp_f32 v255, v151
    v_mfma_f32_16x16x32_bf16 v[88:91], v[220:223], v[188:191], v[88:91]
    v_mfma_f32_16x16x32_bf16 v[44:47], v[224:227], v[184:187], v[44:47]
    ds_read_b128 v[240:243], v245 offset:30720
    v_cvt_pk_bf16_f32 v178, v252, v253
    v_mfma_f32_16x16x32_bf16 v[92:95], v[224:227], v[188:191], v[92:95]
    v_cvt_pk_bf16_f32 v179, v254, v255
    s_barrier
    s_waitcnt lgkmcnt(2)
    v_mfma_f32_16x16x32_bf16 v[160:163], v[228:231], v[96:99], v[192:195]
    ds_read_b128 v[212:215], v244 offset:32768
    v_exp_f32 v252, v152
    v_mfma_f32_16x16x32_bf16 v[168:171], v[228:231], v[120:123], v[196:199]
    v_mfma_f32_16x16x32_bf16 v[164:167], v[232:235], v[96:99], v[192:195]
    ds_read_b128 v[216:219], v244 offset:34816
    v_exp_f32 v253, v153
    v_mfma_f32_16x16x32_bf16 v[172:175], v[232:235], v[120:123], v[196:199]
    s_waitcnt lgkmcnt(2)
    v_mfma_f32_16x16x32_bf16 v[160:163], v[236:239], v[100:103], v[160:163]
    ds_read_b128 v[220:223], v245 offset:32768
    v_exp_f32 v254, v154
    v_mfma_f32_16x16x32_bf16 v[168:171], v[236:239], v[124:127], v[168:171]
    v_mfma_f32_16x16x32_bf16 v[164:167], v[240:243], v[100:103], v[164:167]
    ds_read_b128 v[224:227], v245 offset:34816
    v_exp_f32 v255, v155
    v_mfma_f32_16x16x32_bf16 v[172:175], v[240:243], v[124:127], v[172:175]
    s_waitcnt lgkmcnt(2)
    v_mfma_f32_16x16x32_bf16 v[160:163], v[212:215], v[104:107], v[160:163]
    ds_read_b128 v[228:231], v244 offset:36864
    v_cvt_pk_bf16_f32 v180, v252, v253
    v_mfma_f32_16x16x32_bf16 v[168:171], v[212:215], v[128:131], v[168:171]
    v_exp_f32 v252, v156
    v_mfma_f32_16x16x32_bf16 v[164:167], v[216:219], v[104:107], v[164:167]
    ds_read_b128 v[232:235], v244 offset:38912
    v_mfma_f32_16x16x32_bf16 v[172:175], v[216:219], v[128:131], v[172:175]
    v_exp_f32 v253, v157
    s_waitcnt lgkmcnt(2)
    v_mfma_f32_16x16x32_bf16 v[160:163], v[220:223], v[108:111], v[160:163]
    ds_read_b128 v[236:239], v245 offset:36864
    v_cvt_pk_bf16_f32 v181, v254, v255
    v_mfma_f32_16x16x32_bf16 v[168:171], v[220:223], v[132:135], v[168:171]
    v_mfma_f32_16x16x32_bf16 v[164:167], v[224:227], v[108:111], v[164:167]
    ds_read_b128 v[240:243], v245 offset:38912
    v_exp_f32 v254, v158
    v_mfma_f32_16x16x32_bf16 v[172:175], v[224:227], v[132:135], v[172:175]
    s_waitcnt lgkmcnt(2)
    v_mfma_f32_16x16x32_bf16 v[160:163], v[228:231], v[112:115], v[160:163]
    ds_read_b64_tr_b16 v[212:213], v246 offset:40960
    v_exp_f32 v255, v159
    v_mfma_f32_16x16x32_bf16 v[168:171], v[228:231], v[136:139], v[168:171]
    ds_read_b64_tr_b16 v[214:215], v246 offset:43008
    v_cvt_pk_bf16_f32 v182, v252, v253
    v_mfma_f32_16x16x32_bf16 v[164:167], v[232:235], v[112:115], v[164:167]
    ds_read_b64_tr_b16 v[216:217], v247 offset:40960
    v_cvt_pk_bf16_f32 v183, v254, v255
    v_mfma_f32_16x16x32_bf16 v[172:175], v[232:235], v[136:139], v[172:175]
    ds_read_b64_tr_b16 v[218:219], v247 offset:43008
    v_or3_b32 v251, v176, v177, v178
    s_waitcnt lgkmcnt(4)
    v_mfma_f32_16x16x32_bf16 v[160:163], v[236:239], v[116:119], v[160:163]
    ds_read_b64_tr_b16 v[220:221], v248 offset:40960
    v_or3_b32 v251, v251, v179, v180
    v_mfma_f32_16x16x32_bf16 v[168:171], v[236:239], v[140:143], v[168:171]
    ds_read_b64_tr_b16 v[222:223], v248 offset:43008
    v_or3_b32 v251, v251, v181, v182
    v_mfma_f32_16x16x32_bf16 v[164:167], v[240:243], v[116:119], v[164:167]
    ds_read_b64_tr_b16 v[224:225], v249 offset:40960
    v_bitop3_b32 v251, v251, v183, s68 bitop3:0xa8
    v_mfma_f32_16x16x32_bf16 v[172:175], v[240:243], v[140:143], v[172:175]
    ds_read_b64_tr_b16 v[226:227], v249 offset:43008
    v_cmp_ne_u32 vcc, 0, v251
    s_cbranch_vccz t0_okq6_h
    s_call_b64 s[30:31], t0_rare0_h
t0_okq6_h:
    s_barrier
    s_waitcnt lgkmcnt(4)
    v_mfma_f32_16x16x32_bf16 v[0:3], v[212:215], v[176:179], v[0:3]
    ds_read_b64_tr_b16 v[228:229], v246 offset:45056
    v_mfma_f32_16x16x32_bf16 v[48:51], v[212:215], v[180:183], v[48:51]
    ds_read_b64_tr_b16 v[230:231], v246 offset:47104
    v_mfma_f32_16x16x32_bf16 v[4:7], v[216:219], v[176:179], v[4:7]
    ds_read_b64_tr_b16 v[232:233], v247 offset:45056
    v_mfma_f32_16x16x32_bf16 v[52:55], v[216:219], v[180:183], v[52:55]
    ds_read_b64_tr_b16 v[234:235], v247 offset:47104
    v_exp_f32 v252, v160
    s_waitcnt lgkmcnt(4)
    v_mfma_f32_16x16x32_bf16 v[8:11], v[220:223], v[176:179], v[8:11]
    ds_read_b64_tr_b16 v[236:237], v248 offset:45056
    v_mfma_f32_16x16x32_bf16 v[56:59], v[220:223], v[180:183], v[56:59]
    ds_read_b64_tr_b16 v[238:239], v248 offset:47104
    v_exp_f32 v253, v161
    v_mfma_f32_16x16x32_bf16 v[12:15], v[224:227], v[176:179], v[12:15]
    ds_read_b64_tr_b16 v[240:241], v249 offset:45056
    v_mfma_f32_16x16x32_bf16 v[60:63], v[224:227], v[180:183], v[60:63]
    ds_read_b64_tr_b16 v[242:243], v249 offset:47104
    v_exp_f32 v254, v162
    s_waitcnt lgkmcnt(4)
    v_mfma_f32_16x16x32_bf16 v[16:19], v[228:231], v[176:179], v[16:19]
    ds_read_b64_tr_b16 v[212:213], v246 offset:49152
    v_mfma_f32_16x16x32_bf16 v[64:67], v[228:231], v[180:183], v[64:67]
    ds_read_b64_tr_b16 v[214:215], v246 offset:51200
    v_mfma_f32_16x16x32_bf16 v[200:203], v[208:211], v[176:179], v[200:203]
    ds_read_b64_tr_b16 v[216:217], v247 offset:49152
    v_exp_f32 v255, v163
    v_mfma_f32_16x16x32_bf16 v[204:207], v[208:211], v[180:183], v[204:207]
    ds_read_b64_tr_b16 v[218:219], v247 offset:51200
    v_mfma_f32_16x16x32_bf16 v[20:23], v[232:235], v[176:179], v[20:23]
    v_cvt_pk_bf16_f32 v184, v252, v253
    v_mfma_f32_16x16x32_bf16 v[68:71], v[232:235], v[180:183], v[68:71]
    v_exp_f32 v252, v164
    s_waitcnt lgkmcnt(4)
    v_mfma_f32_16x16x32_bf16 v[24:27], v[236:239], v[176:179], v[24:27]
    ds_read_b64_tr_b16 v[220:221], v248 offset:49152
    v_mfma_f32_16x16x32_bf16 v[72:75], v[236:239], v[180:183], v[72:75]
    ds_read_b64_tr_b16 v[222:223], v248 offset:51200
    v_mfma_f32_16x16x32_bf16 v[28:31], v[240:243], v[176:179], v[28:31]
    ds_read_b64_tr_b16 v[224:225], v249 offset:49152
    v_exp_f32 v253, v165
    v_mfma_f32_16x16x32_bf16 v[76:79], v[240:243], v[180:183], v[76:79]
    ds_read_b64_tr_b16 v[226:227], v249 offset:51200
    s_waitcnt lgkmcnt(4)
    v_mfma_f32_16x16x32_bf16 v[32:35], v[212:215], v[176:179], v[32:35]
    ds_read_b128 v[228:231], v244 offset:53248
    v_cvt_pk_bf16_f32 v185, v254, v255
    v_mfma_f32_16x16x32_bf16 v[80:83], v[212:215], v[180:183], v[80:83]
    v_exp_f32 v254, v166
    v_mfma_f32_16x16x32_bf16 v[36:39], v[216:219], v[176:179], v[36:39]
    ds_read_b128 v[232:235], v244 offset:55296
    v_mfma_f32_16x16x32_bf16 v[84:87], v[216:219], v[180:183], v[84:87]
    s_waitcnt lgkmcnt(2)
    v_mfma_f32_16x16x32_bf16 v[40:43], v[220:223], v[176:179], v[40:43]
    ds_read_b128 v[236:239], v245 offset:53248
    v_exp_f32 v255, v167
    v_mfma_f32_16x16x32_bf16 v[88:91], v[220:223], v[180:183], v[88:91]
    v_mfma_f32_16x16x32_bf16 v[44:47], v[224:227], v[176:179], v[44:47]
    ds_read_b128 v[240:243], v245 offset:55296
    v_cvt_pk_bf16_f32 v186, v252, v253
    v_mfma_f32_16x16x32_bf16 v[92:95], v[224:227], v[180:183], v[92:95]
    v_cvt_pk_bf16_f32 v187, v254, v255
    s_barrier
    s_waitcnt lgkmcnt(2)
    v_mfma_f32_16x16x32_bf16 v[144:147], v[228:231], v[96:99], v[192:195]
    ds_read_b128 v[212:215], v244 offset:57344
    v_exp_f32 v252, v168
    v_mfma_f32_16x16x32_bf16 v[152:155], v[228:231], v[120:123], v[196:199]
    v_mfma_f32_16x16x32_bf16 v[148:151], v[232:235], v[96:99], v[192:195]
    ds_read_b128 v[216:219], v244 offset:59392
    v_exp_f32 v253, v169
    v_mfma_f32_16x16x32_bf16 v[156:159], v[232:235], v[120:123], v[196:199]
    s_waitcnt lgkmcnt(2)
    v_mfma_f32_16x16x32_bf16 v[144:147], v[236:239], v[100:103], v[144:147]
    ds_read_b128 v[220:223], v245 offset:57344
    v_exp_f32 v254, v170
    v_mfma_f32_16x16x32_bf16 v[152:155], v[236:239], v[124:127], v[152:155]
    v_mfma_f32_16x16x32_bf16 v[148:151], v[240:243], v[100:103], v[148:151]
    ds_read_b128 v[224:227], v245 offset:59392
    v_exp_f32 v255, v171
    v_mfma_f32_16x16x32_bf16 v[156:159], v[240:243], v[124:127], v[156:159]
    s_waitcnt lgkmcnt(2)
    v_mfma_f32_16x16x32_bf16 v[144:147], v[212:215], v[104:107], v[144:147]
    ds_read_b128 v[228:231], v244 offset:61440
    v_cvt_pk_bf16_f32 v188, v252, v253
    v_mfma_f32_16x16x32_bf16 v[152:155], v[212:215], v[128:131], v[152:155]
    v_exp_f32 v252, v172
    v_mfma_f32_16x16x32_bf16 v[148:151], v[216:219], v[104:107], v[148:151]
    ds_read_b128 v[232:235], v244 offset:63488
    v_mfma_f32_16x16x32_bf16 v[156:159], v[216:219], v[128:131], v[156:159]
    v_exp_f32 v253, v173
    s_waitcnt lgkmcnt(2)
    v_mfma_f32_16x16x32_bf16 v[144:147], v[220:223], v[108:111], v[144:147]
    ds_read_b128 v[236:239], v245 offset:61440
    v_cvt_pk_bf16_f32 v189, v254, v255
    v_mfma_f32_16x16x32_bf16 v[152:155], v[220:223], v[132:135], v[152:155]
    v_mfma_f32_16x16x32_bf16 v[148:151], v[224:227], v[108:111], v[148:151]
    ds_read_b128 v[240:243], v245 offset:63488
    v_exp_f32 v254, v174
    v_mfma_f32_16x16x32_bf16 v[156:159], v[224:227], v[132:135], v[156:159]
    s_waitcnt lgkmcnt(2)
    v_mfma_f32_16x16x32_bf16 v[144:147], v[228:231], v[112:115], v[144:147]
    ds_read_b64_tr_b16 v[212:213], v246 offset:0
    v_exp_f32 v255, v175
    v_mfma_f32_16x16x32_bf16 v[152:155], v[228:231], v[136:139], v[152:155]
    ds_read_b64_tr_b16 v[214:215], v246 offset:2048
    v_cvt_pk_bf16_f32 v190, v252, v253
    v_mfma_f32_16x16x32_bf16 v[148:151], v[232:235], v[112:115], v[148:151]
    ds_read_b64_tr_b16 v[216:217], v247 offset:0
    v_cvt_pk_bf16_f32 v191, v254, v255
    v_mfma_f32_16x16x32_bf16 v[156:159], v[232:235], v[136:139], v[156:159]
    ds_read_b64_tr_b16 v[218:219], v247 offset:2048
    v_or3_b32 v251, v184, v185, v186
    s_waitcnt lgkmcnt(4)
    v_mfma_f32_16x16x32_bf16 v[144:147], v[236:239], v[116:119], v[144:147]
    ds_read_b64_tr_b16 v[220:221], v248 offset:0
    v_or3_b32 v251, v251, v187, v188
    v_mfma_f32_16x16x32_bf16 v[152:155], v[236:239], v[140:143], v[152:155]
    ds_read_b64_tr_b16 v[222:223], v248 offset:2048
    v_or3_b32 v251, v251, v189, v190
    v_mfma_f32_16x16x32_bf16 v[148:151], v[240:243], v[116:119], v[148:151]
    ds_read_b64_tr_b16 v[224:225], v249 offset:0
    v_bitop3_b32 v251, v251, v191, s68 bitop3:0xa8
    v_mfma_f32_16x16x32_bf16 v[156:159], v[240:243], v[140:143], v[156:159]
    ds_read_b64_tr_b16 v[226:227], v249 offset:2048
    v_cmp_ne_u32 vcc, 0, v251
    s_cbranch_vccz t0_okq7_h
    s_call_b64 s[30:31], t0_rare1_h
t0_okq7_h:
    s_waitcnt lgkmcnt(4)
    v_mfma_f32_16x16x32_bf16 v[0:3], v[212:215], v[184:187], v[0:3]
    ds_read_b64_tr_b16 v[228:229], v246 offset:4096
    v_mfma_f32_16x16x32_bf16 v[48:51], v[212:215], v[188:191], v[48:51]
    ds_read_b64_tr_b16 v[230:231], v246 offset:6144
    v_mfma_f32_16x16x32_bf16 v[4:7], v[216:219], v[184:187], v[4:7]
    ds_read_b64_tr_b16 v[232:233], v247 offset:4096
    v_mfma_f32_16x16x32_bf16 v[52:55], v[216:219], v[188:191], v[52:55]
    ds_read_b64_tr_b16 v[234:235], v247 offset:6144
    v_exp_f32 v252, v144
    s_waitcnt lgkmcnt(4)
    v_mfma_f32_16x16x32_bf16 v[8:11], v[220:223], v[184:187], v[8:11]
    ds_read_b64_tr_b16 v[236:237], v248 offset:4096
    v_mfma_f32_16x16x32_bf16 v[56:59], v[220:223], v[188:191], v[56:59]
    ds_read_b64_tr_b16 v[238:239], v248 offset:6144
    v_exp_f32 v253, v145
    v_mfma_f32_16x16x32_bf16 v[12:15], v[224:227], v[184:187], v[12:15]
    ds_read_b64_tr_b16 v[240:241], v249 offset:4096
    v_mfma_f32_16x16x32_bf16 v[60:63], v[224:227], v[188:191], v[60:63]
    ds_read_b64_tr_b16 v[242:243], v249 offset:6144
    v_exp_f32 v254, v146
    s_barrier
    s_waitcnt lgkmcnt(4)
    v_mfma_f32_16x16x32_bf16 v[16:19], v[228:231], v[184:187], v[16:19]
    ds_read_b64_tr_b16 v[212:213], v246 offset:8192
    v_mfma_f32_16x16x32_bf16 v[64:67], v[228:231], v[188:191], v[64:67]
    ds_read_b64_tr_b16 v[214:215], v246 offset:10240
    v_mfma_f32_16x16x32_bf16 v[200:203], v[208:211], v[184:187], v[200:203]
    ds_read_b64_tr_b16 v[216:217], v247 offset:8192
    v_exp_f32 v255, v147
    v_mfma_f32_16x16x32_bf16 v[204:207], v[208:211], v[188:191], v[204:207]
    ds_read_b64_tr_b16 v[218:219], v247 offset:10240
    v_mfma_f32_16x16x32_bf16 v[20:23], v[232:235], v[184:187], v[20:23]
    v_cvt_pk_bf16_f32 v176, v252, v253
    v_mfma_f32_16x16x32_bf16 v[68:71], v[232:235], v[188:191], v[68:71]
    v_exp_f32 v252, v148
    s_waitcnt lgkmcnt(4)
    v_mfma_f32_16x16x32_bf16 v[24:27], v[236:239], v[184:187], v[24:27]
    ds_read_b64_tr_b16 v[220:221], v248 offset:8192
    v_mfma_f32_16x16x32_bf16 v[72:75], v[236:239], v[188:191], v[72:75]
    ds_read_b64_tr_b16 v[222:223], v248 offset:10240
    v_mfma_f32_16x16x32_bf16 v[28:31], v[240:243], v[184:187], v[28:31]
    ds_read_b64_tr_b16 v[224:225], v249 offset:8192
    v_exp_f32 v253, v149
    v_mfma_f32_16x16x32_bf16 v[76:79], v[240:243], v[188:191], v[76:79]
    ds_read_b64_tr_b16 v[226:227], v249 offset:10240
    s_waitcnt lgkmcnt(4)
    v_mfma_f32_16x16x32_bf16 v[32:35], v[212:215], v[184:187], v[32:35]
    ds_read_b128 v[228:231], v244 offset:12288
    v_cvt_pk_bf16_f32 v177, v254, v255
    v_mfma_f32_16x16x32_bf16 v[80:83], v[212:215], v[188:191], v[80:83]
    v_exp_f32 v254, v150
    v_mfma_f32_16x16x32_bf16 v[36:39], v[216:219], v[184:187], v[36:39]
    ds_read_b128 v[232:235], v244 offset:14336
    v_mfma_f32_16x16x32_bf16 v[84:87], v[216:219], v[188:191], v[84:87]
    s_waitcnt lgkmcnt(2)
    v_mfma_f32_16x16x32_bf16 v[40:43], v[220:223], v[184:187], v[40:43]
    ds_read_b128 v[236:239], v245 offset:12288
    v_exp_f32 v255, v151
    v_mfma_f32_16x16x32_bf16 v[88:91], v[220:223], v[188:191], v[88:91]
    v_mfma_f32_16x16x32_bf16 v[44:47], v[224:227], v[184:187], v[44:47]
    ds_read_b128 v[240:243], v245 offset:14336
    v_cvt_pk_bf16_f32 v178, v252, v253
    v_mfma_f32_16x16x32_bf16 v[92:95], v[224:227], v[188:191], v[92:95]
    v_cvt_pk_bf16_f32 v179, v254, v255
    s_waitcnt lgkmcnt(2)
    v_mfma_f32_16x16x32_bf16 v[160:163], v[228:231], v[96:99], v[192:195]
    ds_read_b128 v[212:215], v244 offset:16384
    v_exp_f32 v252, v152
    v_mfma_f32_16x16x32_bf16 v[168:171], v[228:231], v[120:123], v[196:199]
    v_mfma_f32_16x16x32_bf16 v[164:167], v[232:235], v[96:99], v[192:195]
    ds_read_b128 v[216:219], v244 offset:18432
    v_exp_f32 v253, v153
    v_mfma_f32_16x16x32_bf16 v[172:175], v[232:235], v[120:123], v[196:199]
    s_waitcnt lgkmcnt(2)
    v_mfma_f32_16x16x32_bf16 v[160:163], v[236:239], v[100:103], v[160:163]
    ds_read_b128 v[220:223], v245 offset:16384
    v_exp_f32 v254, v154
    v_mfma_f32_16x16x32_bf16 v[168:171], v[236:239], v[124:127], v[168:171]
    v_mfma_f32_16x16x32_bf16 v[164:167], v[240:243], v[100:103], v[164:167]
    ds_read_b128 v[224:227], v245 offset:18432
    v_exp_f32 v255, v155
    v_mfma_f32_16x16x32_bf16 v[172:175], v[240:243], v[124:127], v[172:175]
    s_barrier
    s_waitcnt lgkmcnt(2)
    v_mfma_f32_16x16x32_bf16 v[160:163], v[212:215], v[104:107], v[160:163]
    ds_read_b128 v[228:231], v244 offset:20480
    v_cvt_pk_bf16_f32 v180, v252, v253
    v_mfma_f32_16x16x32_bf16 v[168:171], v[212:215], v[128:131], v[168:171]
    v_exp_f32 v252, v156
    v_mfma_f32_16x16x32_bf16 v[164:167], v[216:219], v[104:107], v[164:167]
    ds_read_b128 v[232:235], v244 offset:22528
    v_mfma_f32_16x16x32_bf16 v[172:175], v[216:219], v[128:131], v[172:175]
    v_exp_f32 v253, v157
    s_waitcnt lgkmcnt(2)
    v_mfma_f32_16x16x32_bf16 v[160:163], v[220:223], v[108:111], v[160:163]
    ds_read_b128 v[236:239], v245 offset:20480
    v_cvt_pk_bf16_f32 v181, v254, v255
    v_mfma_f32_16x16x32_bf16 v[168:171], v[220:223], v[132:135], v[168:171]
    v_mfma_f32_16x16x32_bf16 v[164:167], v[224:227], v[108:111], v[164:167]
    ds_read_b128 v[240:243], v245 offset:22528
    v_exp_f32 v254, v158
    v_mfma_f32_16x16x32_bf16 v[172:175], v[224:227], v[132:135], v[172:175]
    s_waitcnt lgkmcnt(2)
    v_mfma_f32_16x16x32_bf16 v[160:163], v[228:231], v[112:115], v[160:163]
    ds_read_b64_tr_b16 v[212:213], v246 offset:24576
    v_exp_f32 v255, v159
    v_mfma_f32_16x16x32_bf16 v[168:171], v[228:231], v[136:139], v[168:171]
    ds_read_b64_tr_b16 v[214:215], v246 offset:26624
    v_cvt_pk_bf16_f32 v182, v252, v253
    v_mfma_f32_16x16x32_bf16 v[164:167], v[232:235], v[112:115], v[164:167]
    ds_read_b64_tr_b16 v[216:217], v247 offset:24576
    v_cvt_pk_bf16_f32 v183, v254, v255
    v_mfma_f32_16x16x32_bf16 v[172:175], v[232:235], v[136:139], v[172:175]
    ds_read_b64_tr_b16 v[218:219], v247 offset:26624
    v_or3_b32 v251, v176, v177, v178
    s_waitcnt lgkmcnt(4)
    v_mfma_f32_16x16x32_bf16 v[160:163], v[236:239], v[116:119], v[160:163]
    ds_read_b64_tr_b16 v[220:221], v248 offset:24576
    v_or3_b32 v251, v251, v179, v180
    v_mfma_f32_16x16x32_bf16 v[168:171], v[236:239], v[140:143], v[168:171]
    ds_read_b64_tr_b16 v[222:223], v248 offset:26624
    v_or3_b32 v251, v251, v181, v182
    v_mfma_f32_16x16x32_bf16 v[164:167], v[240:243], v[116:119], v[164:167]
    ds_read_b64_tr_b16 v[224:225], v249 offset:24576
    v_bitop3_b32 v251, v251, v183, s68 bitop3:0xa8
    v_mfma_f32_16x16x32_bf16 v[172:175], v[240:243], v[140:143], v[172:175]
    ds_read_b64_tr_b16 v[226:227], v249 offset:26624
    v_cmp_ne_u32 vcc, 0, v251
    s_cbranch_vccz t0_okq8_h
    s_call_b64 s[30:31], t0_rare0_h
t0_okq8_h:
    s_waitcnt lgkmcnt(4)
    v_mfma_f32_16x16x32_bf16 v[0:3], v[212:215], v[176:179], v[0:3]
    ds_read_b64_tr_b16 v[228:229], v246 offset:28672
    v_mfma_f32_16x16x32_bf16 v[48:51], v[212:215], v[180:183], v[48:51]
    ds_read_b64_tr_b16 v[230:231], v246 offset:30720
    v_mfma_f32_16x16x32_bf16 v[4:7], v[216:219], v[176:179], v[4:7]
    ds_read_b64_tr_b16 v[232:233], v247 offset:28672
    v_mfma_f32_16x16x32_bf16 v[52:55], v[216:219], v[180:183], v[52:55]
    ds_read_b64_tr_b16 v[234:235], v247 offset:30720
    v_exp_f32 v252, v160
    s_waitcnt lgkmcnt(4)
    v_mfma_f32_16x16x32_bf16 v[8:11], v[220:223], v[176:179], v[8:11]
    ds_read_b64_tr_b16 v[236:237], v248 offset:28672
    v_mfma_f32_16x16x32_bf16 v[56:59], v[220:223], v[180:183], v[56:59]
    ds_read_b64_tr_b16 v[238:239], v248 offset:30720
    v_exp_f32 v253, v161
    v_mfma_f32_16x16x32_bf16 v[12:15], v[224:227], v[176:179], v[12:15]
    ds_read_b64_tr_b16 v[240:241], v249 offset:28672
    v_mfma_f32_16x16x32_bf16 v[60:63], v[224:227], v[180:183], v[60:63]
    ds_read_b64_tr_b16 v[242:243], v249 offset:30720
    v_exp_f32 v254, v162
    s_barrier
    s_waitcnt lgkmcnt(4)
    v_mfma_f32_16x16x32_bf16 v[16:19], v[228:231], v[176:179], v[16:19]
    ds_read_b64_tr_b16 v[212:213], v246 offset:32768
    v_mfma_f32_16x16x32_bf16 v[64:67], v[228:231], v[180:183], v[64:67]
    ds_read_b64_tr_b16 v[214:215], v246 offset:34816
    v_mfma_f32_16x16x32_bf16 v[200:203], v[208:211], v[176:179], v[200:203]
    ds_read_b64_tr_b16 v[216:217], v247 offset:32768
    v_exp_f32 v255, v163
    v_mfma_f32_16x16x32_bf16 v[204:207], v[208:211], v[180:183], v[204:207]
    ds_read_b64_tr_b16 v[218:219], v247 offset:34816
    v_mfma_f32_16x16x32_bf16 v[20:23], v[232:235], v[176:179], v[20:23]
    v_cvt_pk_bf16_f32 v184, v252, v253
    v_mfma_f32_16x16x32_bf16 v[68:71], v[232:235], v[180:183], v[68:71]
    v_exp_f32 v252, v164
    s_waitcnt lgkmcnt(4)
    v_mfma_f32_16x16x32_bf16 v[24:27], v[236:239], v[176:179], v[24:27]
    ds_read_b64_tr_b16 v[220:221], v248 offset:32768
    v_mfma_f32_16x16x32_bf16 v[72:75], v[236:239], v[180:183], v[72:75]
    ds_read_b64_tr_b16 v[222:223], v248 offset:34816
    v_mfma_f32_16x16x32_bf16 v[28:31], v[240:243], v[176:179], v[28:31]
    ds_read_b64_tr_b16 v[224:225], v249 offset:32768
    v_exp_f32 v253, v165
    v_mfma_f32_16x16x32_bf16 v[76:79], v[240:243], v[180:183], v[76:79]
    ds_read_b64_tr_b16 v[226:227], v249 offset:34816
    s_waitcnt lgkmcnt(4)
    v_mfma_f32_16x16x32_bf16 v[32:35], v[212:215], v[176:179], v[32:35]
    ds_read_b128 v[228:231], v244 offset:36864
    v_cvt_pk_bf16_f32 v185, v254, v255
    v_mfma_f32_16x16x32_bf16 v[80:83], v[212:215], v[180:183], v[80:83]
    v_exp_f32 v254, v166
    v_mfma_f32_16x16x32_bf16 v[36:39], v[216:219], v[176:179], v[36:39]
    ds_read_b128 v[232:235], v244 offset:38912
    v_mfma_f32_16x16x32_bf16 v[84:87], v[216:219], v[180:183], v[84:87]
    s_waitcnt lgkmcnt(2)
    v_mfma_f32_16x16x32_bf16 v[40:43], v[220:223], v[176:179], v[40:43]
    ds_read_b128 v[236:239], v245 offset:36864
    v_exp_f32 v255, v167
    v_mfma_f32_16x16x32_bf16 v[88:91], v[220:223], v[180:183], v[88:91]
    v_mfma_f32_16x16x32_bf16 v[44:47], v[224:227], v[176:179], v[44:47]
    ds_read_b128 v[240:243], v245 offset:38912
    v_cvt_pk_bf16_f32 v186, v252, v253
    v_mfma_f32_16x16x32_bf16 v[92:95], v[224:227], v[180:183], v[92:95]
    v_cvt_pk_bf16_f32 v187, v254, v255
    s_waitcnt lgkmcnt(2)
    v_mfma_f32_16x16x32_bf16 v[144:147], v[228:231], v[96:99], v[192:195]
    ds_read_b128 v[212:215], v244 offset:40960
    v_exp_f32 v252, v168
    v_mfma_f32_16x16x32_bf16 v[152:155], v[228:231], v[120:123], v[196:199]
    v_mfma_f32_16x16x32_bf16 v[148:151], v[232:235], v[96:99], v[192:195]
    ds_read_b128 v[216:219], v244 offset:43008
    v_exp_f32 v253, v169
    v_mfma_f32_16x16x32_bf16 v[156:159], v[232:235], v[120:123], v[196:199]
    s_waitcnt lgkmcnt(2)
    v_mfma_f32_16x16x32_bf16 v[144:147], v[236:239], v[100:103], v[144:147]
    ds_read_b128 v[220:223], v245 offset:40960
    v_exp_f32 v254, v170
    v_mfma_f32_16x16x32_bf16 v[152:155], v[236:239], v[124:127], v[152:155]
    v_mfma_f32_16x16x32_bf16 v[148:151], v[240:243], v[100:103], v[148:151]
    ds_read_b128 v[224:227], v245 offset:43008
    v_exp_f32 v255, v171
    v_mfma_f32_16x16x32_bf16 v[156:159], v[240:243], v[124:127], v[156:159]
    s_barrier
    s_waitcnt lgkmcnt(2)
    v_mfma_f32_16x16x32_bf16 v[144:147], v[212:215], v[104:107], v[144:147]
    ds_read_b128 v[228:231], v244 offset:45056
    v_cvt_pk_bf16_f32 v188, v252, v253
    v_mfma_f32_16x16x32_bf16 v[152:155], v[212:215], v[128:131], v[152:155]
    v_exp_f32 v252, v172
    v_mfma_f32_16x16x32_bf16 v[148:151], v[216:219], v[104:107], v[148:151]
    ds_read_b128 v[232:235], v244 offset:47104
    v_mfma_f32_16x16x32_bf16 v[156:159], v[216:219], v[128:131], v[156:159]
    v_exp_f32 v253, v173
    s_waitcnt lgkmcnt(2)
    v_mfma_f32_16x16x32_bf16 v[144:147], v[220:223], v[108:111], v[144:147]
    ds_read_b128 v[236:239], v245 offset:45056
    v_cvt_pk_bf16_f32 v189, v254, v255
    v_mfma_f32_16x16x32_bf16 v[152:155], v[220:223], v[132:135], v[152:155]
    v_mfma_f32_16x16x32_bf16 v[148:151], v[224:227], v[108:111], v[148:151]
    ds_read_b128 v[240:243], v245 offset:47104
    v_exp_f32 v254, v174
    v_mfma_f32_16x16x32_bf16 v[156:159], v[224:227], v[132:135], v[156:159]
    s_waitcnt lgkmcnt(2)
    v_mfma_f32_16x16x32_bf16 v[144:147], v[228:231], v[112:115], v[144:147]
    ds_read_b64_tr_b16 v[212:213], v246 offset:49152
    v_exp_f32 v255, v175
    v_mfma_f32_16x16x32_bf16 v[152:155], v[228:231], v[136:139], v[152:155]
    ds_read_b64_tr_b16 v[214:215], v246 offset:51200
    v_cvt_pk_bf16_f32 v190, v252, v253
    v_mfma_f32_16x16x32_bf16 v[148:151], v[232:235], v[112:115], v[148:151]
    ds_read_b64_tr_b16 v[216:217], v247 offset:49152
    v_cvt_pk_bf16_f32 v191, v254, v255
    v_mfma_f32_16x16x32_bf16 v[156:159], v[232:235], v[136:139], v[156:159]
    ds_read_b64_tr_b16 v[218:219], v247 offset:51200
    v_or3_b32 v251, v184, v185, v186
    s_waitcnt lgkmcnt(4)
    v_mfma_f32_16x16x32_bf16 v[144:147], v[236:239], v[116:119], v[144:147]
    ds_read_b64_tr_b16 v[220:221], v248 offset:49152
    v_or3_b32 v251, v251, v187, v188
    v_mfma_f32_16x16x32_bf16 v[152:155], v[236:239], v[140:143], v[152:155]
    ds_read_b64_tr_b16 v[222:223], v248 offset:51200
    v_or3_b32 v251, v251, v189, v190
    v_mfma_f32_16x16x32_bf16 v[148:151], v[240:243], v[116:119], v[148:151]
    ds_read_b64_tr_b16 v[224:225], v249 offset:49152
    v_bitop3_b32 v251, v251, v191, s68 bitop3:0xa8
    v_mfma_f32_16x16x32_bf16 v[156:159], v[240:243], v[140:143], v[156:159]
    ds_read_b64_tr_b16 v[226:227], v249 offset:51200
    v_cmp_ne_u32 vcc, 0, v251
    s_cbranch_vccz t0_okq9_h
    s_call_b64 s[30:31], t0_rare1_h
t0_okq9_h:
    s_waitcnt lgkmcnt(4)
    v_mfma_f32_16x16x32_bf16 v[0:3], v[212:215], v[184:187], v[0:3]
    ds_read_b64_tr_b16 v[228:229], v246 offset:53248
    v_mfma_f32_16x16x32_bf16 v[48:51], v[212:215], v[188:191], v[48:51]
    ds_read_b64_tr_b16 v[230:231], v246 offset:55296
    v_mfma_f32_16x16x32_bf16 v[4:7], v[216:219], v[184:187], v[4:7]
    ds_read_b64_tr_b16 v[232:233], v247 offset:53248
    v_mfma_f32_16x16x32_bf16 v[52:55], v[216:219], v[188:191], v[52:55]
    ds_read_b64_tr_b16 v[234:235], v247 offset:55296
    v_exp_f32 v252, v144
    s_waitcnt lgkmcnt(4)
    v_mfma_f32_16x16x32_bf16 v[8:11], v[220:223], v[184:187], v[8:11]
    ds_read_b64_tr_b16 v[236:237], v248 offset:53248
    v_mfma_f32_16x16x32_bf16 v[56:59], v[220:223], v[188:191], v[56:59]
    ds_read_b64_tr_b16 v[238:239], v248 offset:55296
    v_exp_f32 v253, v145
    v_mfma_f32_16x16x32_bf16 v[12:15], v[224:227], v[184:187], v[12:15]
    ds_read_b64_tr_b16 v[240:241], v249 offset:53248
    v_mfma_f32_16x16x32_bf16 v[60:63], v[224:227], v[188:191], v[60:63]
    ds_read_b64_tr_b16 v[242:243], v249 offset:55296
    v_exp_f32 v254, v146
    s_barrier
    s_waitcnt lgkmcnt(4)
    v_mfma_f32_16x16x32_bf16 v[16:19], v[228:231], v[184:187], v[16:19]
    ds_read_b64_tr_b16 v[212:213], v246 offset:57344
    v_mfma_f32_16x16x32_bf16 v[64:67], v[228:231], v[188:191], v[64:67]
    ds_read_b64_tr_b16 v[214:215], v246 offset:59392
    v_mfma_f32_16x16x32_bf16 v[200:203], v[208:211], v[184:187], v[200:203]
    ds_read_b64_tr_b16 v[216:217], v247 offset:57344
    v_exp_f32 v255, v147
    v_mfma_f32_16x16x32_bf16 v[204:207], v[208:211], v[188:191], v[204:207]
    ds_read_b64_tr_b16 v[218:219], v247 offset:59392
    v_mfma_f32_16x16x32_bf16 v[20:23], v[232:235], v[184:187], v[20:23]
    v_cvt_pk_bf16_f32 v176, v252, v253
    v_mfma_f32_16x16x32_bf16 v[68:71], v[232:235], v[188:191], v[68:71]
    v_exp_f32 v252, v148
    s_waitcnt lgkmcnt(4)
    v_mfma_f32_16x16x32_bf16 v[24:27], v[236:239], v[184:187], v[24:27]
    ds_read_b64_tr_b16 v[220:221], v248 offset:57344
    v_mfma_f32_16x16x32_bf16 v[72:75], v[236:239], v[188:191], v[72:75]
    ds_read_b64_tr_b16 v[222:223], v248 offset:59392
    v_mfma_f32_16x16x32_bf16 v[28:31], v[240:243], v[184:187], v[28:31]
    ds_read_b64_tr_b16 v[224:225], v249 offset:57344
    v_exp_f32 v253, v149
    v_mfma_f32_16x16x32_bf16 v[76:79], v[240:243], v[188:191], v[76:79]
    ds_read_b64_tr_b16 v[226:227], v249 offset:59392
    s_waitcnt lgkmcnt(4)
    v_mfma_f32_16x16x32_bf16 v[32:35], v[212:215], v[184:187], v[32:35]
    ds_read_b128 v[228:231], v244 offset:61440
    v_cvt_pk_bf16_f32 v177, v254, v255
    v_mfma_f32_16x16x32_bf16 v[80:83], v[212:215], v[188:191], v[80:83]
    v_exp_f32 v254, v150
    v_mfma_f32_16x16x32_bf16 v[36:39], v[216:219], v[184:187], v[36:39]
    ds_read_b128 v[232:235], v244 offset:63488
    v_mfma_f32_16x16x32_bf16 v[84:87], v[216:219], v[188:191], v[84:87]
    s_waitcnt lgkmcnt(2)
    v_mfma_f32_16x16x32_bf16 v[40:43], v[220:223], v[184:187], v[40:43]
    ds_read_b128 v[236:239], v245 offset:61440
    v_exp_f32 v255, v151
    v_mfma_f32_16x16x32_bf16 v[88:91], v[220:223], v[188:191], v[88:91]
    v_mfma_f32_16x16x32_bf16 v[44:47], v[224:227], v[184:187], v[44:47]
    ds_read_b128 v[240:243], v245 offset:63488
    v_cvt_pk_bf16_f32 v178, v252, v253
    v_mfma_f32_16x16x32_bf16 v[92:95], v[224:227], v[188:191], v[92:95]
    v_cvt_pk_bf16_f32 v179, v254, v255
    s_waitcnt lgkmcnt(2)
    v_mfma_f32_16x16x32_bf16 v[160:163], v[228:231], v[96:99], v[192:195]
    ds_read_b128 v[212:215], v244 offset:0
    v_exp_f32 v252, v152
    v_mfma_f32_16x16x32_bf16 v[168:171], v[228:231], v[120:123], v[196:199]
    v_mfma_f32_16x16x32_bf16 v[164:167], v[232:235], v[96:99], v[192:195]
    ds_read_b128 v[216:219], v244 offset:2048
    v_exp_f32 v253, v153
    v_mfma_f32_16x16x32_bf16 v[172:175], v[232:235], v[120:123], v[196:199]
    s_waitcnt lgkmcnt(2)
    v_mfma_f32_16x16x32_bf16 v[160:163], v[236:239], v[100:103], v[160:163]
    ds_read_b128 v[220:223], v245 offset:0
    v_exp_f32 v254, v154
    v_mfma_f32_16x16x32_bf16 v[168:171], v[236:239], v[124:127], v[168:171]
    v_mfma_f32_16x16x32_bf16 v[164:167], v[240:243], v[100:103], v[164:167]
    ds_read_b128 v[224:227], v245 offset:2048
    v_exp_f32 v255, v155
    v_mfma_f32_16x16x32_bf16 v[172:175], v[240:243], v[124:127], v[172:175]
    s_waitcnt lgkmcnt(2)
    v_mfma_f32_16x16x32_bf16 v[160:163], v[212:215], v[104:107], v[160:163]
    ds_read_b128 v[228:231], v244 offset:4096
    v_cvt_pk_bf16_f32 v180, v252, v253
    v_mfma_f32_16x16x32_bf16 v[168:171], v[212:215], v[128:131], v[168:171]
    v_exp_f32 v252, v156
    v_mfma_f32_16x16x32_bf16 v[164:167], v[216:219], v[104:107], v[164:167]
    ds_read_b128 v[232:235], v244 offset:6144
    v_mfma_f32_16x16x32_bf16 v[172:175], v[216:219], v[128:131], v[172:175]
    v_exp_f32 v253, v157
    s_waitcnt lgkmcnt(2)
    v_mfma_f32_16x16x32_bf16 v[160:163], v[220:223], v[108:111], v[160:163]
    ds_read_b128 v[236:239], v245 offset:4096
    v_cvt_pk_bf16_f32 v181, v254, v255
    v_mfma_f32_16x16x32_bf16 v[168:171], v[220:223], v[132:135], v[168:171]
    v_mfma_f32_16x16x32_bf16 v[164:167], v[224:227], v[108:111], v[164:167]
    ds_read_b128 v[240:243], v245 offset:6144
    v_exp_f32 v254, v158
    v_mfma_f32_16x16x32_bf16 v[172:175], v[224:227], v[132:135], v[172:175]
    s_barrier
    s_waitcnt lgkmcnt(2)
    v_mfma_f32_16x16x32_bf16 v[160:163], v[228:231], v[112:115], v[160:163]
    ds_read_b64_tr_b16 v[212:213], v246 offset:8192
    v_exp_f32 v255, v159
    v_mfma_f32_16x16x32_bf16 v[168:171], v[228:231], v[136:139], v[168:171]
    ds_read_b64_tr_b16 v[214:215], v246 offset:10240
    v_cvt_pk_bf16_f32 v182, v252, v253
    v_mfma_f32_16x16x32_bf16 v[164:167], v[232:235], v[112:115], v[164:167]
    ds_read_b64_tr_b16 v[216:217], v247 offset:8192
    v_cvt_pk_bf16_f32 v183, v254, v255
    v_mfma_f32_16x16x32_bf16 v[172:175], v[232:235], v[136:139], v[172:175]
    ds_read_b64_tr_b16 v[218:219], v247 offset:10240
    v_or3_b32 v251, v176, v177, v178
    s_waitcnt lgkmcnt(4)
    v_mfma_f32_16x16x32_bf16 v[160:163], v[236:239], v[116:119], v[160:163]
    ds_read_b64_tr_b16 v[220:221], v248 offset:8192
    v_or3_b32 v251, v251, v179, v180
    v_mfma_f32_16x16x32_bf16 v[168:171], v[236:239], v[140:143], v[168:171]
    ds_read_b64_tr_b16 v[222:223], v248 offset:10240
    v_or3_b32 v251, v251, v181, v182
    v_mfma_f32_16x16x32_bf16 v[164:167], v[240:243], v[116:119], v[164:167]
    ds_read_b64_tr_b16 v[224:225], v249 offset:8192
    v_bitop3_b32 v251, v251, v183, s68 bitop3:0xa8
    v_mfma_f32_16x16x32_bf16 v[172:175], v[240:243], v[140:143], v[172:175]
    ds_read_b64_tr_b16 v[226:227], v249 offset:10240
    v_cmp_ne_u32 vcc, 0, v251
    s_cbranch_vccz t0_okq10_h
    s_call_b64 s[30:31], t0_rare0_h
t0_okq10_h:
    s_waitcnt lgkmcnt(4)
    v_mfma_f32_16x16x32_bf16 v[0:3], v[212:215], v[176:179], v[0:3]
    ds_read_b64_tr_b16 v[228:229], v246 offset:12288
    v_mfma_f32_16x16x32_bf16 v[48:51], v[212:215], v[180:183], v[48:51]
    ds_read_b64_tr_b16 v[230:231], v246 offset:14336
    v_mfma_f32_16x16x32_bf16 v[4:7], v[216:219], v[176:179], v[4:7]
    ds_read_b64_tr_b16 v[232:233], v247 offset:12288
    v_mfma_f32_16x16x32_bf16 v[52:55], v[216:219], v[180:183], v[52:55]
    ds_read_b64_tr_b16 v[234:235], v247 offset:14336
    v_exp_f32 v252, v160
    s_waitcnt lgkmcnt(4)
    v_mfma_f32_16x16x32_bf16 v[8:11], v[220:223], v[176:179], v[8:11]
    ds_read_b64_tr_b16 v[236:237], v248 offset:12288
    v_mfma_f32_16x16x32_bf16 v[56:59], v[220:223], v[180:183], v[56:59]
    ds_read_b64_tr_b16 v[238:239], v248 offset:14336
    v_exp_f32 v253, v161
    v_mfma_f32_16x16x32_bf16 v[12:15], v[224:227], v[176:179], v[12:15]
    ds_read_b64_tr_b16 v[240:241], v249 offset:12288
    v_mfma_f32_16x16x32_bf16 v[60:63], v[224:227], v[180:183], v[60:63]
    ds_read_b64_tr_b16 v[242:243], v249 offset:14336
    v_exp_f32 v254, v162
    s_waitcnt lgkmcnt(4)
    v_mfma_f32_16x16x32_bf16 v[16:19], v[228:231], v[176:179], v[16:19]
    ds_read_b64_tr_b16 v[212:213], v246 offset:16384
    v_mfma_f32_16x16x32_bf16 v[64:67], v[228:231], v[180:183], v[64:67]
    ds_read_b64_tr_b16 v[214:215], v246 offset:18432
    v_mfma_f32_16x16x32_bf16 v[200:203], v[208:211], v[176:179], v[200:203]
    ds_read_b64_tr_b16 v[216:217], v247 offset:16384
    v_exp_f32 v255, v163
    v_mfma_f32_16x16x32_bf16 v[204:207], v[208:211], v[180:183], v[204:207]
    ds_read_b64_tr_b16 v[218:219], v247 offset:18432
    v_mfma_f32_16x16x32_bf16 v[20:23], v[232:235], v[176:179], v[20:23]
    v_cvt_pk_bf16_f32 v184, v252, v253
    v_mfma_f32_16x16x32_bf16 v[68:71], v[232:235], v[180:183], v[68:71]
    v_exp_f32 v252, v164
    s_waitcnt lgkmcnt(4)
    v_mfma_f32_16x16x32_bf16 v[24:27], v[236:239], v[176:179], v[24:27]
    ds_read_b64_tr_b16 v[220:221], v248 offset:16384
    v_mfma_f32_16x16x32_bf16 v[72:75], v[236:239], v[180:183], v[72:75]
    ds_read_b64_tr_b16 v[222:223], v248 offset:18432
    v_mfma_f32_16x16x32_bf16 v[28:31], v[240:243], v[176:179], v[28:31]
    ds_read_b64_tr_b16 v[224:225], v249 offset:16384
    v_exp_f32 v253, v165
    v_mfma_f32_16x16x32_bf16 v[76:79], v[240:243], v[180:183], v[76:79]
    ds_read_b64_tr_b16 v[226:227], v249 offset:18432
    s_barrier
    s_waitcnt lgkmcnt(4)
    v_mfma_f32_16x16x32_bf16 v[32:35], v[212:215], v[176:179], v[32:35]
    ds_read_b128 v[228:231], v244 offset:20480
    v_cvt_pk_bf16_f32 v185, v254, v255
    v_mfma_f32_16x16x32_bf16 v[80:83], v[212:215], v[180:183], v[80:83]
    v_exp_f32 v254, v166
    v_mfma_f32_16x16x32_bf16 v[36:39], v[216:219], v[176:179], v[36:39]
    ds_read_b128 v[232:235], v244 offset:22528
    v_mfma_f32_16x16x32_bf16 v[84:87], v[216:219], v[180:183], v[84:87]
    s_waitcnt lgkmcnt(2)
    v_mfma_f32_16x16x32_bf16 v[40:43], v[220:223], v[176:179], v[40:43]
    ds_read_b128 v[236:239], v245 offset:20480
    v_exp_f32 v255, v167
    v_mfma_f32_16x16x32_bf16 v[88:91], v[220:223], v[180:183], v[88:91]
    v_mfma_f32_16x16x32_bf16 v[44:47], v[224:227], v[176:179], v[44:47]
    ds_read_b128 v[240:243], v245 offset:22528
    v_cvt_pk_bf16_f32 v186, v252, v253
    v_mfma_f32_16x16x32_bf16 v[92:95], v[224:227], v[180:183], v[92:95]
    v_cvt_pk_bf16_f32 v187, v254, v255
    s_waitcnt lgkmcnt(2)
    v_mfma_f32_16x16x32_bf16 v[144:147], v[228:231], v[96:99], v[192:195]
    ds_read_b128 v[212:215], v244 offset:24576
    v_exp_f32 v252, v168
    v_mfma_f32_16x16x32_bf16 v[152:155], v[228:231], v[120:123], v[196:199]
    v_mfma_f32_16x16x32_bf16 v[148:151], v[232:235], v[96:99], v[192:195]
    ds_read_b128 v[216:219], v244 offset:26624
    v_exp_f32 v253, v169
    v_mfma_f32_16x16x32_bf16 v[156:159], v[232:235], v[120:123], v[196:199]
    s_waitcnt lgkmcnt(2)
    v_mfma_f32_16x16x32_bf16 v[144:147], v[236:239], v[100:103], v[144:147]
    ds_read_b128 v[220:223], v245 offset:24576
    v_exp_f32 v254, v170
    v_mfma_f32_16x16x32_bf16 v[152:155], v[236:239], v[124:127], v[152:155]
    v_mfma_f32_16x16x32_bf16 v[148:151], v[240:243], v[100:103], v[148:151]
    ds_read_b128 v[224:227], v245 offset:26624
    v_exp_f32 v255, v171
    v_mfma_f32_16x16x32_bf16 v[156:159], v[240:243], v[124:127], v[156:159]
    s_waitcnt lgkmcnt(2)
    v_mfma_f32_16x16x32_bf16 v[144:147], v[212:215], v[104:107], v[144:147]
    ds_read_b128 v[228:231], v244 offset:28672
    v_cvt_pk_bf16_f32 v188, v252, v253
    v_mfma_f32_16x16x32_bf16 v[152:155], v[212:215], v[128:131], v[152:155]
    v_exp_f32 v252, v172
    v_mfma_f32_16x16x32_bf16 v[148:151], v[216:219], v[104:107], v[148:151]
    ds_read_b128 v[232:235], v244 offset:30720
    v_mfma_f32_16x16x32_bf16 v[156:159], v[216:219], v[128:131], v[156:159]
    v_exp_f32 v253, v173
    s_waitcnt lgkmcnt(2)
    v_mfma_f32_16x16x32_bf16 v[144:147], v[220:223], v[108:111], v[144:147]
    ds_read_b128 v[236:239], v245 offset:28672
    v_cvt_pk_bf16_f32 v189, v254, v255
    v_mfma_f32_16x16x32_bf16 v[152:155], v[220:223], v[132:135], v[152:155]
    v_mfma_f32_16x16x32_bf16 v[148:151], v[224:227], v[108:111], v[148:151]
    ds_read_b128 v[240:243], v245 offset:30720
    v_exp_f32 v254, v174
    v_mfma_f32_16x16x32_bf16 v[156:159], v[224:227], v[132:135], v[156:159]
    s_barrier
    s_waitcnt lgkmcnt(2)
    v_mfma_f32_16x16x32_bf16 v[144:147], v[228:231], v[112:115], v[144:147]
    ds_read_b64_tr_b16 v[212:213], v246 offset:32768
    v_exp_f32 v255, v175
    v_mfma_f32_16x16x32_bf16 v[152:155], v[228:231], v[136:139], v[152:155]
    ds_read_b64_tr_b16 v[214:215], v246 offset:34816
    v_cvt_pk_bf16_f32 v190, v252, v253
    v_mfma_f32_16x16x32_bf16 v[148:151], v[232:235], v[112:115], v[148:151]
    ds_read_b64_tr_b16 v[216:217], v247 offset:32768
    v_cvt_pk_bf16_f32 v191, v254, v255
    v_mfma_f32_16x16x32_bf16 v[156:159], v[232:235], v[136:139], v[156:159]
    ds_read_b64_tr_b16 v[218:219], v247 offset:34816
    v_or3_b32 v251, v184, v185, v186
    s_waitcnt lgkmcnt(4)
    v_mfma_f32_16x16x32_bf16 v[144:147], v[236:239], v[116:119], v[144:147]
    ds_read_b64_tr_b16 v[220:221], v248 offset:32768
    v_or3_b32 v251, v251, v187, v188
    v_mfma_f32_16x16x32_bf16 v[152:155], v[236:239], v[140:143], v[152:155]
    ds_read_b64_tr_b16 v[222:223], v248 offset:34816
    v_or3_b32 v251, v251, v189, v190
    v_mfma_f32_16x16x32_bf16 v[148:151], v[240:243], v[116:119], v[148:151]
    ds_read_b64_tr_b16 v[224:225], v249 offset:32768
    v_bitop3_b32 v251, v251, v191, s68 bitop3:0xa8
    v_mfma_f32_16x16x32_bf16 v[156:159], v[240:243], v[140:143], v[156:159]
    ds_read_b64_tr_b16 v[226:227], v249 offset:34816
    v_cmp_ne_u32 vcc, 0, v251
    s_cbranch_vccz t0_okq11_h
    s_call_b64 s[30:31], t0_rare1_h
t0_okq11_h:
    s_waitcnt lgkmcnt(4)
    v_mfma_f32_16x16x32_bf16 v[0:3], v[212:215], v[184:187], v[0:3]
    ds_read_b64_tr_b16 v[228:229], v246 offset:36864
    v_mfma_f32_16x16x32_bf16 v[48:51], v[212:215], v[188:191], v[48:51]
    ds_read_b64_tr_b16 v[230:231], v246 offset:38912
    v_mfma_f32_16x16x32_bf16 v[4:7], v[216:219], v[184:187], v[4:7]
    ds_read_b64_tr_b16 v[232:233], v247 offset:36864
    v_mfma_f32_16x16x32_bf16 v[52:55], v[216:219], v[188:191], v[52:55]
    ds_read_b64_tr_b16 v[234:235], v247 offset:38912
    v_exp_f32 v252, v144
    s_waitcnt lgkmcnt(4)
    v_mfma_f32_16x16x32_bf16 v[8:11], v[220:223], v[184:187], v[8:11]
    ds_read_b64_tr_b16 v[236:237], v248 offset:36864
    v_mfma_f32_16x16x32_bf16 v[56:59], v[220:223], v[188:191], v[56:59]
    ds_read_b64_tr_b16 v[238:239], v248 offset:38912
    v_exp_f32 v253, v145
    v_mfma_f32_16x16x32_bf16 v[12:15], v[224:227], v[184:187], v[12:15]
    ds_read_b64_tr_b16 v[240:241], v249 offset:36864
    v_mfma_f32_16x16x32_bf16 v[60:63], v[224:227], v[188:191], v[60:63]
    ds_read_b64_tr_b16 v[242:243], v249 offset:38912
    v_exp_f32 v254, v146
    s_waitcnt lgkmcnt(4)
    v_mfma_f32_16x16x32_bf16 v[16:19], v[228:231], v[184:187], v[16:19]
    ds_read_b64_tr_b16 v[212:213], v246 offset:40960
    v_mfma_f32_16x16x32_bf16 v[64:67], v[228:231], v[188:191], v[64:67]
    ds_read_b64_tr_b16 v[214:215], v246 offset:43008
    v_mfma_f32_16x16x32_bf16 v[200:203], v[208:211], v[184:187], v[200:203]
    ds_read_b64_tr_b16 v[216:217], v247 offset:40960
    v_exp_f32 v255, v147
    v_mfma_f32_16x16x32_bf16 v[204:207], v[208:211], v[188:191], v[204:207]
    ds_read_b64_tr_b16 v[218:219], v247 offset:43008
    v_mfma_f32_16x16x32_bf16 v[20:23], v[232:235], v[184:187], v[20:23]
    v_cvt_pk_bf16_f32 v176, v252, v253
    v_mfma_f32_16x16x32_bf16 v[68:71], v[232:235], v[188:191], v[68:71]
    v_exp_f32 v252, v148
    s_waitcnt lgkmcnt(4)
    v_mfma_f32_16x16x32_bf16 v[24:27], v[236:239], v[184:187], v[24:27]
    ds_read_b64_tr_b16 v[220:221], v248 offset:40960
    v_mfma_f32_16x16x32_bf16 v[72:75], v[236:239], v[188:191], v[72:75]
    ds_read_b64_tr_b16 v[222:223], v248 offset:43008
    v_mfma_f32_16x16x32_bf16 v[28:31], v[240:243], v[184:187], v[28:31]
    ds_read_b64_tr_b16 v[224:225], v249 offset:40960
    v_exp_f32 v253, v149
    v_mfma_f32_16x16x32_bf16 v[76:79], v[240:243], v[188:191], v[76:79]
    ds_read_b64_tr_b16 v[226:227], v249 offset:43008
    s_barrier
    s_waitcnt lgkmcnt(4)
    v_mfma_f32_16x16x32_bf16 v[32:35], v[212:215], v[184:187], v[32:35]
    ds_read_b128 v[228:231], v244 offset:45056
    v_cvt_pk_bf16_f32 v177, v254, v255
    v_mfma_f32_16x16x32_bf16 v[80:83], v[212:215], v[188:191], v[80:83]
    v_exp_f32 v254, v150
    v_mfma_f32_16x16x32_bf16 v[36:39], v[216:219], v[184:187], v[36:39]
    ds_read_b128 v[232:235], v244 offset:47104
    v_mfma_f32_16x16x32_bf16 v[84:87], v[216:219], v[188:191], v[84:87]
    s_waitcnt lgkmcnt(2)
    v_mfma_f32_16x16x32_bf16 v[40:43], v[220:223], v[184:187], v[40:43]
    ds_read_b128 v[236:239], v245 offset:45056
    v_exp_f32 v255, v151
    v_mfma_f32_16x16x32_bf16 v[88:91], v[220:223], v[188:191], v[88:91]
    v_mfma_f32_16x16x32_bf16 v[44:47], v[224:227], v[184:187], v[44:47]
    ds_read_b128 v[240:243], v245 offset:47104
    v_cvt_pk_bf16_f32 v178, v252, v253
    v_mfma_f32_16x16x32_bf16 v[92:95], v[224:227], v[188:191], v[92:95]
    v_cvt_pk_bf16_f32 v179, v254, v255
    s_waitcnt lgkmcnt(2)
    v_mfma_f32_16x16x32_bf16 v[160:163], v[228:231], v[96:99], v[192:195]
    ds_read_b128 v[212:215], v244 offset:49152
    v_exp_f32 v252, v152
    v_mfma_f32_16x16x32_bf16 v[168:171], v[228:231], v[120:123], v[196:199]
    v_mfma_f32_16x16x32_bf16 v[164:167], v[232:235], v[96:99], v[192:195]
    ds_read_b128 v[216:219], v244 offset:51200
    v_exp_f32 v253, v153
    v_mfma_f32_16x16x32_bf16 v[172:175], v[232:235], v[120:123], v[196:199]
    s_waitcnt lgkmcnt(2)
    v_mfma_f32_16x16x32_bf16 v[160:163], v[236:239], v[100:103], v[160:163]
    ds_read_b128 v[220:223], v245 offset:49152
    v_exp_f32 v254, v154
    v_mfma_f32_16x16x32_bf16 v[168:171], v[236:239], v[124:127], v[168:171]
    v_mfma_f32_16x16x32_bf16 v[164:167], v[240:243], v[100:103], v[164:167]
    ds_read_b128 v[224:227], v245 offset:51200
    v_exp_f32 v255, v155
    v_mfma_f32_16x16x32_bf16 v[172:175], v[240:243], v[124:127], v[172:175]
    s_waitcnt lgkmcnt(2)
    v_mfma_f32_16x16x32_bf16 v[160:163], v[212:215], v[104:107], v[160:163]
    ds_read_b128 v[228:231], v244 offset:53248
    v_cvt_pk_bf16_f32 v180, v252, v253
    v_mfma_f32_16x16x32_bf16 v[168:171], v[212:215], v[128:131], v[168:171]
    v_exp_f32 v252, v156
    v_mfma_f32_16x16x32_bf16 v[164:167], v[216:219], v[104:107], v[164:167]
    ds_read_b128 v[232:235], v244 offset:55296
    v_mfma_f32_16x16x32_bf16 v[172:175], v[216:219], v[128:131], v[172:175]
    v_exp_f32 v253, v157
    s_waitcnt lgkmcnt(2)
    v_mfma_f32_16x16x32_bf16 v[160:163], v[220:223], v[108:111], v[160:163]
    ds_read_b128 v[236:239], v245 offset:53248
    v_cvt_pk_bf16_f32 v181, v254, v255
    v_mfma_f32_16x16x32_bf16 v[168:171], v[220:223], v[132:135], v[168:171]
    v_mfma_f32_16x16x32_bf16 v[164:167], v[224:227], v[108:111], v[164:167]
    ds_read_b128 v[240:243], v245 offset:55296
    v_exp_f32 v254, v158
    v_mfma_f32_16x16x32_bf16 v[172:175], v[224:227], v[132:135], v[172:175]
    s_barrier
    s_waitcnt lgkmcnt(2)
    v_mfma_f32_16x16x32_bf16 v[160:163], v[228:231], v[112:115], v[160:163]
    ds_read_b64_tr_b16 v[212:213], v246 offset:57344
    v_exp_f32 v255, v159
    v_mfma_f32_16x16x32_bf16 v[168:171], v[228:231], v[136:139], v[168:171]
    ds_read_b64_tr_b16 v[214:215], v246 offset:59392
    v_cvt_pk_bf16_f32 v182, v252, v253
    v_mfma_f32_16x16x32_bf16 v[164:167], v[232:235], v[112:115], v[164:167]
    ds_read_b64_tr_b16 v[216:217], v247 offset:57344
    v_cvt_pk_bf16_f32 v183, v254, v255
    v_mfma_f32_16x16x32_bf16 v[172:175], v[232:235], v[136:139], v[172:175]
    ds_read_b64_tr_b16 v[218:219], v247 offset:59392
    v_or3_b32 v251, v176, v177, v178
    s_waitcnt lgkmcnt(4)
    v_mfma_f32_16x16x32_bf16 v[160:163], v[236:239], v[116:119], v[160:163]
    ds_read_b64_tr_b16 v[220:221], v248 offset:57344
    v_or3_b32 v251, v251, v179, v180
    v_mfma_f32_16x16x32_bf16 v[168:171], v[236:239], v[140:143], v[168:171]
    ds_read_b64_tr_b16 v[222:223], v248 offset:59392
    v_or3_b32 v251, v251, v181, v182
    v_mfma_f32_16x16x32_bf16 v[164:167], v[240:243], v[116:119], v[164:167]
    ds_read_b64_tr_b16 v[224:225], v249 offset:57344
    v_bitop3_b32 v251, v251, v183, s68 bitop3:0xa8
    v_mfma_f32_16x16x32_bf16 v[172:175], v[240:243], v[140:143], v[172:175]
    ds_read_b64_tr_b16 v[226:227], v249 offset:59392
    v_cmp_ne_u32 vcc, 0, v251
    s_cbranch_vccz t0_okq12_h
    s_call_b64 s[30:31], t0_rare0_h
t0_okq12_h:
    s_waitcnt lgkmcnt(4)
    v_mfma_f32_16x16x32_bf16 v[0:3], v[212:215], v[176:179], v[0:3]
    ds_read_b64_tr_b16 v[228:229], v246 offset:61440
    v_mfma_f32_16x16x32_bf16 v[48:51], v[212:215], v[180:183], v[48:51]
    ds_read_b64_tr_b16 v[230:231], v246 offset:63488
    v_mfma_f32_16x16x32_bf16 v[4:7], v[216:219], v[176:179], v[4:7]
    ds_read_b64_tr_b16 v[232:233], v247 offset:61440
    v_mfma_f32_16x16x32_bf16 v[52:55], v[216:219], v[180:183], v[52:55]
    ds_read_b64_tr_b16 v[234:235], v247 offset:63488
    v_exp_f32 v252, v160
    s_waitcnt lgkmcnt(4)
    v_mfma_f32_16x16x32_bf16 v[8:11], v[220:223], v[176:179], v[8:11]
    ds_read_b64_tr_b16 v[236:237], v248 offset:61440
    v_mfma_f32_16x16x32_bf16 v[56:59], v[220:223], v[180:183], v[56:59]
    ds_read_b64_tr_b16 v[238:239], v248 offset:63488
    v_exp_f32 v253, v161
    v_mfma_f32_16x16x32_bf16 v[12:15], v[224:227], v[176:179], v[12:15]
    ds_read_b64_tr_b16 v[240:241], v249 offset:61440
    v_mfma_f32_16x16x32_bf16 v[60:63], v[224:227], v[180:183], v[60:63]
    ds_read_b64_tr_b16 v[242:243], v249 offset:63488
    v_exp_f32 v254, v162
    s_waitcnt lgkmcnt(4)
    v_mfma_f32_16x16x32_bf16 v[16:19], v[228:231], v[176:179], v[16:19]
    ds_read_b64_tr_b16 v[212:213], v246 offset:0
    v_mfma_f32_16x16x32_bf16 v[64:67], v[228:231], v[180:183], v[64:67]
    ds_read_b64_tr_b16 v[214:215], v246 offset:2048
    v_mfma_f32_16x16x32_bf16 v[200:203], v[208:211], v[176:179], v[200:203]
    ds_read_b64_tr_b16 v[216:217], v247 offset:0
    v_exp_f32 v255, v163
    v_mfma_f32_16x16x32_bf16 v[204:207], v[208:211], v[180:183], v[204:207]
    ds_read_b64_tr_b16 v[218:219], v247 offset:2048
    v_mfma_f32_16x16x32_bf16 v[20:23], v[232:235], v[176:179], v[20:23]
    v_cvt_pk_bf16_f32 v184, v252, v253
    v_mfma_f32_16x16x32_bf16 v[68:71], v[232:235], v[180:183], v[68:71]
    v_exp_f32 v252, v164
    s_waitcnt lgkmcnt(4)
    v_mfma_f32_16x16x32_bf16 v[24:27], v[236:239], v[176:179], v[24:27]
    ds_read_b64_tr_b16 v[220:221], v248 offset:0
    v_mfma_f32_16x16x32_bf16 v[72:75], v[236:239], v[180:183], v[72:75]
    ds_read_b64_tr_b16 v[222:223], v248 offset:2048
    v_mfma_f32_16x16x32_bf16 v[28:31], v[240:243], v[176:179], v[28:31]
    ds_read_b64_tr_b16 v[224:225], v249 offset:0
    v_exp_f32 v253, v165
    v_mfma_f32_16x16x32_bf16 v[76:79], v[240:243], v[180:183], v[76:79]
    ds_read_b64_tr_b16 v[226:227], v249 offset:2048
    s_waitcnt lgkmcnt(4)
    v_mfma_f32_16x16x32_bf16 v[32:35], v[212:215], v[176:179], v[32:35]
    ds_read_b128 v[228:231], v244 offset:4096
    v_cvt_pk_bf16_f32 v185, v254, v255
    v_mfma_f32_16x16x32_bf16 v[80:83], v[212:215], v[180:183], v[80:83]
    v_exp_f32 v254, v166
    v_mfma_f32_16x16x32_bf16 v[36:39], v[216:219], v[176:179], v[36:39]
    ds_read_b128 v[232:235], v244 offset:6144
    v_mfma_f32_16x16x32_bf16 v[84:87], v[216:219], v[180:183], v[84:87]
    s_waitcnt lgkmcnt(2)
    v_mfma_f32_16x16x32_bf16 v[40:43], v[220:223], v[176:179], v[40:43]
    ds_read_b128 v[236:239], v245 offset:4096
    v_exp_f32 v255, v167
    v_mfma_f32_16x16x32_bf16 v[88:91], v[220:223], v[180:183], v[88:91]
    v_mfma_f32_16x16x32_bf16 v[44:47], v[224:227], v[176:179], v[44:47]
    ds_read_b128 v[240:243], v245 offset:6144
    v_cvt_pk_bf16_f32 v186, v252, v253
    v_mfma_f32_16x16x32_bf16 v[92:95], v[224:227], v[180:183], v[92:95]
    v_cvt_pk_bf16_f32 v187, v254, v255
    s_barrier
    s_waitcnt lgkmcnt(2)
    v_mfma_f32_16x16x32_bf16 v[144:147], v[228:231], v[96:99], v[192:195]
    ds_read_b128 v[212:215], v244 offset:8192
    v_exp_f32 v252, v168
    v_mfma_f32_16x16x32_bf16 v[152:155], v[228:231], v[120:123], v[196:199]
    v_mfma_f32_16x16x32_bf16 v[148:151], v[232:235], v[96:99], v[192:195]
    ds_read_b128 v[216:219], v244 offset:10240
    v_exp_f32 v253, v169
    v_mfma_f32_16x16x32_bf16 v[156:159], v[232:235], v[120:123], v[196:199]
    s_waitcnt lgkmcnt(2)
    v_mfma_f32_16x16x32_bf16 v[144:147], v[236:239], v[100:103], v[144:147]
    ds_read_b128 v[220:223], v245 offset:8192
    v_exp_f32 v254, v170
    v_mfma_f32_16x16x32_bf16 v[152:155], v[236:239], v[124:127], v[152:155]
    v_mfma_f32_16x16x32_bf16 v[148:151], v[240:243], v[100:103], v[148:151]
    ds_read_b128 v[224:227], v245 offset:10240
    v_exp_f32 v255, v171
    v_mfma_f32_16x16x32_bf16 v[156:159], v[240:243], v[124:127], v[156:159]
    s_waitcnt lgkmcnt(2)
    v_mfma_f32_16x16x32_bf16 v[144:147], v[212:215], v[104:107], v[144:147]
    ds_read_b128 v[228:231], v244 offset:12288
    v_cvt_pk_bf16_f32 v188, v252, v253
    v_mfma_f32_16x16x32_bf16 v[152:155], v[212:215], v[128:131], v[152:155]
    v_exp_f32 v252, v172
    v_mfma_f32_16x16x32_bf16 v[148:151], v[216:219], v[104:107], v[148:151]
    ds_read_b128 v[232:235], v244 offset:14336
    v_mfma_f32_16x16x32_bf16 v[156:159], v[216:219], v[128:131], v[156:159]
    v_exp_f32 v253, v173
    s_waitcnt lgkmcnt(2)
    v_mfma_f32_16x16x32_bf16 v[144:147], v[220:223], v[108:111], v[144:147]
    ds_read_b128 v[236:239], v245 offset:12288
    v_cvt_pk_bf16_f32 v189, v254, v255
    v_mfma_f32_16x16x32_bf16 v[152:155], v[220:223], v[132:135], v[152:155]
    v_mfma_f32_16x16x32_bf16 v[148:151], v[224:227], v[108:111], v[148:151]
    ds_read_b128 v[240:243], v245 offset:14336
    v_exp_f32 v254, v174
    v_mfma_f32_16x16x32_bf16 v[156:159], v[224:227], v[132:135], v[156:159]
    s_waitcnt lgkmcnt(2)
    v_mfma_f32_16x16x32_bf16 v[144:147], v[228:231], v[112:115], v[144:147]
    ds_read_b64_tr_b16 v[212:213], v246 offset:16384
    v_exp_f32 v255, v175
    v_mfma_f32_16x16x32_bf16 v[152:155], v[228:231], v[136:139], v[152:155]
    ds_read_b64_tr_b16 v[214:215], v246 offset:18432
    v_cvt_pk_bf16_f32 v190, v252, v253
    v_mfma_f32_16x16x32_bf16 v[148:151], v[232:235], v[112:115], v[148:151]
    ds_read_b64_tr_b16 v[216:217], v247 offset:16384
    v_cvt_pk_bf16_f32 v191, v254, v255
    v_mfma_f32_16x16x32_bf16 v[156:159], v[232:235], v[136:139], v[156:159]
    ds_read_b64_tr_b16 v[218:219], v247 offset:18432
    v_or3_b32 v251, v184, v185, v186
    s_waitcnt lgkmcnt(4)
    v_mfma_f32_16x16x32_bf16 v[144:147], v[236:239], v[116:119], v[144:147]
    ds_read_b64_tr_b16 v[220:221], v248 offset:16384
    v_or3_b32 v251, v251, v187, v188
    v_mfma_f32_16x16x32_bf16 v[152:155], v[236:239], v[140:143], v[152:155]
    ds_read_b64_tr_b16 v[222:223], v248 offset:18432
    v_or3_b32 v251, v251, v189, v190
    v_mfma_f32_16x16x32_bf16 v[148:151], v[240:243], v[116:119], v[148:151]
    ds_read_b64_tr_b16 v[224:225], v249 offset:16384
    v_bitop3_b32 v251, v251, v191, s68 bitop3:0xa8
    v_mfma_f32_16x16x32_bf16 v[156:159], v[240:243], v[140:143], v[156:159]
    ds_read_b64_tr_b16 v[226:227], v249 offset:18432
    v_cmp_ne_u32 vcc, 0, v251
    s_cbranch_vccz t0_okq13_h
    s_call_b64 s[30:31], t0_rare1_h
t0_okq13_h:
    s_barrier
    s_waitcnt lgkmcnt(4)
    v_mfma_f32_16x16x32_bf16 v[0:3], v[212:215], v[184:187], v[0:3]
    ds_read_b64_tr_b16 v[228:229], v246 offset:20480
    v_mfma_f32_16x16x32_bf16 v[48:51], v[212:215], v[188:191], v[48:51]
    ds_read_b64_tr_b16 v[230:231], v246 offset:22528
    v_mfma_f32_16x16x32_bf16 v[4:7], v[216:219], v[184:187], v[4:7]
    ds_read_b64_tr_b16 v[232:233], v247 offset:20480
    v_mfma_f32_16x16x32_bf16 v[52:55], v[216:219], v[188:191], v[52:55]
    ds_read_b64_tr_b16 v[234:235], v247 offset:22528
    v_exp_f32 v252, v144
    s_waitcnt lgkmcnt(4)
    v_mfma_f32_16x16x32_bf16 v[8:11], v[220:223], v[184:187], v[8:11]
    ds_read_b64_tr_b16 v[236:237], v248 offset:20480
    v_mfma_f32_16x16x32_bf16 v[56:59], v[220:223], v[188:191], v[56:59]
    ds_read_b64_tr_b16 v[238:239], v248 offset:22528
    v_exp_f32 v253, v145
    v_mfma_f32_16x16x32_bf16 v[12:15], v[224:227], v[184:187], v[12:15]
    ds_read_b64_tr_b16 v[240:241], v249 offset:20480
    v_mfma_f32_16x16x32_bf16 v[60:63], v[224:227], v[188:191], v[60:63]
    ds_read_b64_tr_b16 v[242:243], v249 offset:22528
    v_exp_f32 v254, v146
    s_waitcnt lgkmcnt(4)
    v_mfma_f32_16x16x32_bf16 v[16:19], v[228:231], v[184:187], v[16:19]
    ds_read_b64_tr_b16 v[212:213], v246 offset:24576
    v_mfma_f32_16x16x32_bf16 v[64:67], v[228:231], v[188:191], v[64:67]
    ds_read_b64_tr_b16 v[214:215], v246 offset:26624
    v_mfma_f32_16x16x32_bf16 v[200:203], v[208:211], v[184:187], v[200:203]
    ds_read_b64_tr_b16 v[216:217], v247 offset:24576
    v_exp_f32 v255, v147
    v_mfma_f32_16x16x32_bf16 v[204:207], v[208:211], v[188:191], v[204:207]
    ds_read_b64_tr_b16 v[218:219], v247 offset:26624
    v_mfma_f32_16x16x32_bf16 v[20:23], v[232:235], v[184:187], v[20:23]
    v_cvt_pk_bf16_f32 v176, v252, v253
    v_mfma_f32_16x16x32_bf16 v[68:71], v[232:235], v[188:191], v[68:71]
    v_exp_f32 v252, v148
    s_waitcnt lgkmcnt(4)
    v_mfma_f32_16x16x32_bf16 v[24:27], v[236:239], v[184:187], v[24:27]
    ds_read_b64_tr_b16 v[220:221], v248 offset:24576
    v_mfma_f32_16x16x32_bf16 v[72:75], v[236:239], v[188:191], v[72:75]
    ds_read_b64_tr_b16 v[222:223], v248 offset:26624
    v_mfma_f32_16x16x32_bf16 v[28:31], v[240:243], v[184:187], v[28:31]
    ds_read_b64_tr_b16 v[224:225], v249 offset:24576
    v_exp_f32 v253, v149
    v_mfma_f32_16x16x32_bf16 v[76:79], v[240:243], v[188:191], v[76:79]
    ds_read_b64_tr_b16 v[226:227], v249 offset:26624
    s_waitcnt lgkmcnt(4)
    v_mfma_f32_16x16x32_bf16 v[32:35], v[212:215], v[184:187], v[32:35]
    ds_read_b128 v[228:231], v244 offset:28672
    v_cvt_pk_bf16_f32 v177, v254, v255
    v_mfma_f32_16x16x32_bf16 v[80:83], v[212:215], v[188:191], v[80:83]
    v_exp_f32 v254, v150
    v_mfma_f32_16x16x32_bf16 v[36:39], v[216:219], v[184:187], v[36:39]
    ds_read_b128 v[232:235], v244 offset:30720
    v_mfma_f32_16x16x32_bf16 v[84:87], v[216:219], v[188:191], v[84:87]
    s_waitcnt lgkmcnt(2)
    v_mfma_f32_16x16x32_bf16 v[40:43], v[220:223], v[184:187], v[40:43]
    ds_read_b128 v[236:239], v245 offset:28672
    v_exp_f32 v255, v151
    v_mfma_f32_16x16x32_bf16 v[88:91], v[220:223], v[188:191], v[88:91]
    v_mfma_f32_16x16x32_bf16 v[44:47], v[224:227], v[184:187], v[44:47]
    ds_read_b128 v[240:243], v245 offset:30720
    v_cvt_pk_bf16_f32 v178, v252, v253
    v_mfma_f32_16x16x32_bf16 v[92:95], v[224:227], v[188:191], v[92:95]
    v_cvt_pk_bf16_f32 v179, v254, v255
    s_barrier
    s_waitcnt lgkmcnt(2)
    v_mfma_f32_16x16x32_bf16 v[160:163], v[228:231], v[96:99], v[192:195]
    ds_read_b128 v[212:215], v244 offset:32768
    v_exp_f32 v252, v152
    v_mfma_f32_16x16x32_bf16 v[168:171], v[228:231], v[120:123], v[196:199]
    v_mfma_f32_16x16x32_bf16 v[164:167], v[232:235], v[96:99], v[192:195]
    ds_read_b128 v[216:219], v244 offset:34816
    v_exp_f32 v253, v153
    v_mfma_f32_16x16x32_bf16 v[172:175], v[232:235], v[120:123], v[196:199]
    s_waitcnt lgkmcnt(2)
    v_mfma_f32_16x16x32_bf16 v[160:163], v[236:239], v[100:103], v[160:163]
    ds_read_b128 v[220:223], v245 offset:32768
    v_exp_f32 v254, v154
    v_mfma_f32_16x16x32_bf16 v[168:171], v[236:239], v[124:127], v[168:171]
    v_mfma_f32_16x16x32_bf16 v[164:167], v[240:243], v[100:103], v[164:167]
    ds_read_b128 v[224:227], v245 offset:34816
    v_exp_f32 v255, v155
    v_mfma_f32_16x16x32_bf16 v[172:175], v[240:243], v[124:127], v[172:175]
    s_waitcnt lgkmcnt(2)
    v_mfma_f32_16x16x32_bf16 v[160:163], v[212:215], v[104:107], v[160:163]
    ds_read_b128 v[228:231], v244 offset:36864
    v_cvt_pk_bf16_f32 v180, v252, v253
    v_mfma_f32_16x16x32_bf16 v[168:171], v[212:215], v[128:131], v[168:171]
    v_exp_f32 v252, v156
    v_mfma_f32_16x16x32_bf16 v[164:167], v[216:219], v[104:107], v[164:167]
    ds_read_b128 v[232:235], v244 offset:38912
    v_mfma_f32_16x16x32_bf16 v[172:175], v[216:219], v[128:131], v[172:175]
    v_exp_f32 v253, v157
    s_waitcnt lgkmcnt(2)
    v_mfma_f32_16x16x32_bf16 v[160:163], v[220:223], v[108:111], v[160:163]
    ds_read_b128 v[236:239], v245 offset:36864
    v_cvt_pk_bf16_f32 v181, v254, v255
    v_mfma_f32_16x16x32_bf16 v[168:171], v[220:223], v[132:135], v[168:171]
    v_mfma_f32_16x16x32_bf16 v[164:167], v[224:227], v[108:111], v[164:167]
    ds_read_b128 v[240:243], v245 offset:38912
    v_exp_f32 v254, v158
    v_mfma_f32_16x16x32_bf16 v[172:175], v[224:227], v[132:135], v[172:175]
    s_waitcnt lgkmcnt(2)
    v_mfma_f32_16x16x32_bf16 v[160:163], v[228:231], v[112:115], v[160:163]
    ds_read_b64_tr_b16 v[212:213], v246 offset:40960
    v_exp_f32 v255, v159
    v_mfma_f32_16x16x32_bf16 v[168:171], v[228:231], v[136:139], v[168:171]
    ds_read_b64_tr_b16 v[214:215], v246 offset:43008
    v_cvt_pk_bf16_f32 v182, v252, v253
    v_mfma_f32_16x16x32_bf16 v[164:167], v[232:235], v[112:115], v[164:167]
    ds_read_b64_tr_b16 v[216:217], v247 offset:40960
    v_cvt_pk_bf16_f32 v183, v254, v255
    v_mfma_f32_16x16x32_bf16 v[172:175], v[232:235], v[136:139], v[172:175]
    ds_read_b64_tr_b16 v[218:219], v247 offset:43008
    v_or3_b32 v251, v176, v177, v178
    s_waitcnt lgkmcnt(4)
    v_mfma_f32_16x16x32_bf16 v[160:163], v[236:239], v[116:119], v[160:163]
    ds_read_b64_tr_b16 v[220:221], v248 offset:40960
    v_or3_b32 v251, v251, v179, v180
    v_mfma_f32_16x16x32_bf16 v[168:171], v[236:239], v[140:143], v[168:171]
    ds_read_b64_tr_b16 v[222:223], v248 offset:43008
    v_or3_b32 v251, v251, v181, v182
    v_mfma_f32_16x16x32_bf16 v[164:167], v[240:243], v[116:119], v[164:167]
    ds_read_b64_tr_b16 v[224:225], v249 offset:40960
    v_bitop3_b32 v251, v251, v183, s68 bitop3:0xa8
    v_mfma_f32_16x16x32_bf16 v[172:175], v[240:243], v[140:143], v[172:175]
    ds_read_b64_tr_b16 v[226:227], v249 offset:43008
    v_cmp_ne_u32 vcc, 0, v251
    s_cbranch_vccz t0_okq14_h
    s_call_b64 s[30:31], t0_rare0_h
t0_okq14_h:
    s_barrier
    s_waitcnt lgkmcnt(4)
    v_mfma_f32_16x16x32_bf16 v[0:3], v[212:215], v[176:179], v[0:3]
    ds_read_b64_tr_b16 v[228:229], v246 offset:45056
    v_mfma_f32_16x16x32_bf16 v[48:51], v[212:215], v[180:183], v[48:51]
    ds_read_b64_tr_b16 v[230:231], v246 offset:47104
    v_mfma_f32_16x16x32_bf16 v[4:7], v[216:219], v[176:179], v[4:7]
    ds_read_b64_tr_b16 v[232:233], v247 offset:45056
    v_exp_f32 v252, v160
    v_mfma_f32_16x16x32_bf16 v[52:55], v[216:219], v[180:183], v[52:55]
    ds_read_b64_tr_b16 v[234:235], v247 offset:47104
    v_exp_f32 v253, v161
    s_waitcnt lgkmcnt(4)
    v_mfma_f32_16x16x32_bf16 v[8:11], v[220:223], v[176:179], v[8:11]
    ds_read_b64_tr_b16 v[236:237], v248 offset:45056
    v_exp_f32 v254, v162
    v_mfma_f32_16x16x32_bf16 v[56:59], v[220:223], v[180:183], v[56:59]
    ds_read_b64_tr_b16 v[238:239], v248 offset:47104
    v_exp_f32 v255, v163
    v_mfma_f32_16x16x32_bf16 v[12:15], v[224:227], v[176:179], v[12:15]
    ds_read_b64_tr_b16 v[240:241], v249 offset:45056
    v_cvt_pk_bf16_f32 v184, v252, v253
    v_mfma_f32_16x16x32_bf16 v[60:63], v[224:227], v[180:183], v[60:63]
    ds_read_b64_tr_b16 v[242:243], v249 offset:47104
    v_exp_f32 v252, v164
    s_waitcnt lgkmcnt(4)
    v_mfma_f32_16x16x32_bf16 v[16:19], v[228:231], v[176:179], v[16:19]
    ds_read_b64_tr_b16 v[212:213], v246 offset:49152
    v_exp_f32 v253, v165
    v_mfma_f32_16x16x32_bf16 v[64:67], v[228:231], v[180:183], v[64:67]
    ds_read_b64_tr_b16 v[214:215], v246 offset:51200
    v_cvt_pk_bf16_f32 v185, v254, v255
    v_exp_f32 v254, v166
    v_mfma_f32_16x16x32_bf16 v[200:203], v[208:211], v[176:179], v[200:203]
    ds_read_b64_tr_b16 v[216:217], v247 offset:49152
    v_mfma_f32_16x16x32_bf16 v[204:207], v[208:211], v[180:183], v[204:207]
    ds_read_b64_tr_b16 v[218:219], v247 offset:51200
    v_exp_f32 v255, v167
    v_cvt_pk_bf16_f32 v186, v252, v253
    v_mfma_f32_16x16x32_bf16 v[20:23], v[232:235], v[176:179], v[20:23]
    v_exp_f32 v252, v168
    v_mfma_f32_16x16x32_bf16 v[68:71], v[232:235], v[180:183], v[68:71]
    v_exp_f32 v253, v169
    s_waitcnt lgkmcnt(4)
    v_mfma_f32_16x16x32_bf16 v[24:27], v[236:239], v[176:179], v[24:27]
    ds_read_b64_tr_b16 v[220:221], v248 offset:49152
    v_cvt_pk_bf16_f32 v187, v254, v255
    v_mfma_f32_16x16x32_bf16 v[72:75], v[236:239], v[180:183], v[72:75]
    ds_read_b64_tr_b16 v[222:223], v248 offset:51200
    v_exp_f32 v254, v170
    v_mfma_f32_16x16x32_bf16 v[28:31], v[240:243], v[176:179], v[28:31]
    ds_read_b64_tr_b16 v[224:225], v249 offset:49152
    v_exp_f32 v255, v171
    v_mfma_f32_16x16x32_bf16 v[76:79], v[240:243], v[180:183], v[76:79]
    ds_read_b64_tr_b16 v[226:227], v249 offset:51200
    v_cvt_pk_bf16_f32 v188, v252, v253
    v_exp_f32 v252, v172
    s_waitcnt lgkmcnt(4)
    v_mfma_f32_16x16x32_bf16 v[32:35], v[212:215], v[176:179], v[32:35]
    ds_read_b64_tr_b16 v[228:229], v246 offset:53248
    v_mfma_f32_16x16x32_bf16 v[80:83], v[212:215], v[180:183], v[80:83]
    ds_read_b64_tr_b16 v[230:231], v246 offset:55296
    v_exp_f32 v253, v173
    v_cvt_pk_bf16_f32 v189, v254, v255
    v_mfma_f32_16x16x32_bf16 v[36:39], v[216:219], v[176:179], v[36:39]
    ds_read_b64_tr_b16 v[232:233], v247 offset:53248
    v_exp_f32 v254, v174
    v_mfma_f32_16x16x32_bf16 v[84:87], v[216:219], v[180:183], v[84:87]
    ds_read_b64_tr_b16 v[234:235], v247 offset:55296
    v_exp_f32 v255, v175
    s_waitcnt lgkmcnt(4)
    v_mfma_f32_16x16x32_bf16 v[40:43], v[220:223], v[176:179], v[40:43]
    ds_read_b64_tr_b16 v[236:237], v248 offset:53248
    v_cvt_pk_bf16_f32 v190, v252, v253
    v_mfma_f32_16x16x32_bf16 v[88:91], v[220:223], v[180:183], v[88:91]
    ds_read_b64_tr_b16 v[238:239], v248 offset:55296
    v_cvt_pk_bf16_f32 v191, v254, v255
    v_or3_b32 v251, v184, v185, v186
    v_mfma_f32_16x16x32_bf16 v[44:47], v[224:227], v[176:179], v[44:47]
    ds_read_b64_tr_b16 v[240:241], v249 offset:53248
    v_or3_b32 v251, v251, v187, v188
    v_or3_b32 v251, v251, v189, v190
    v_mfma_f32_16x16x32_bf16 v[92:95], v[224:227], v[180:183], v[92:95]
    ds_read_b64_tr_b16 v[242:243], v249 offset:55296
    v_bitop3_b32 v251, v251, v191, s68 bitop3:0xa8
    v_cmp_ne_u32 vcc, 0, v251
    s_cbranch_vccz t0_okq15_h
    s_call_b64 s[30:31], t0_rare1_h
t0_okq15_h:
    s_barrier
    s_waitcnt lgkmcnt(4)
    v_mfma_f32_16x16x32_bf16 v[200:203], v[208:211], v[184:187], v[200:203]
    ds_read_b64_tr_b16 v[212:213], v246 offset:57344
    v_mfma_f32_16x16x32_bf16 v[204:207], v[208:211], v[188:191], v[204:207]
    ds_read_b64_tr_b16 v[214:215], v246 offset:59392
    v_mfma_f32_16x16x32_bf16 v[0:3], v[228:231], v[184:187], v[0:3]
    v_mfma_f32_16x16x32_bf16 v[48:51], v[228:231], v[188:191], v[48:51]
    v_mfma_f32_16x16x32_bf16 v[4:7], v[232:235], v[184:187], v[4:7]
    ds_read_b64_tr_b16 v[216:217], v247 offset:57344
    v_mfma_f32_16x16x32_bf16 v[52:55], v[232:235], v[188:191], v[52:55]
    ds_read_b64_tr_b16 v[218:219], v247 offset:59392
    s_waitcnt lgkmcnt(4)
    v_mfma_f32_16x16x32_bf16 v[8:11], v[236:239], v[184:187], v[8:11]
    ds_read_b64_tr_b16 v[220:221], v248 offset:57344
    v_mfma_f32_16x16x32_bf16 v[56:59], v[236:239], v[188:191], v[56:59]
    ds_read_b64_tr_b16 v[222:223], v248 offset:59392
    v_rcp_f32 v252, v200
    v_rcp_f32 v253, v200
    v_rcp_f32 v254, v204
    v_rcp_f32 v255, v204
    v_mfma_f32_16x16x32_bf16 v[12:15], v[240:243], v[184:187], v[12:15]
    ds_read_b64_tr_b16 v[224:225], v249 offset:57344
    v_mfma_f32_16x16x32_bf16 v[60:63], v[240:243], v[188:191], v[60:63]
    ds_read_b64_tr_b16 v[226:227], v249 offset:59392
    v_pk_mul_f32 v[0:1], v[0:1], v[252:253]
    v_pk_mul_f32 v[2:3], v[2:3], v[252:253]
    v_pk_mul_f32 v[4:5], v[4:5], v[252:253]
    v_pk_mul_f32 v[6:7], v[6:7], v[252:253]
    v_cvt_pk_bf16_f32 v144, v0, v1
    v_cvt_pk_bf16_f32 v145, v2, v3
    v_cvt_pk_bf16_f32 v146, v4, v5
    v_cvt_pk_bf16_f32 v147, v6, v7
    v_pk_mul_f32 v[48:49], v[48:49], v[254:255]
    v_pk_mul_f32 v[50:51], v[50:51], v[254:255]
    v_pk_mul_f32 v[52:53], v[52:53], v[254:255]
    v_pk_mul_f32 v[54:55], v[54:55], v[254:255]
    v_cvt_pk_bf16_f32 v148, v48, v49
    v_cvt_pk_bf16_f32 v149, v50, v51
    v_cvt_pk_bf16_f32 v150, v52, v53
    v_cvt_pk_bf16_f32 v151, v54, v55
    s_waitcnt lgkmcnt(4)
    v_mfma_f32_16x16x32_bf16 v[16:19], v[212:215], v[184:187], v[16:19]
    ds_read_b64_tr_b16 v[228:229], v246 offset:61440
    v_mfma_f32_16x16x32_bf16 v[64:67], v[212:215], v[188:191], v[64:67]
    ds_read_b64_tr_b16 v[230:231], v246 offset:63488
    v_mfma_f32_16x16x32_bf16 v[20:23], v[216:219], v[184:187], v[20:23]
    ds_read_b64_tr_b16 v[232:233], v247 offset:61440
    v_mfma_f32_16x16x32_bf16 v[68:71], v[216:219], v[188:191], v[68:71]
    ds_read_b64_tr_b16 v[234:235], v247 offset:63488
    v_pk_mul_f32 v[8:9], v[8:9], v[252:253]
    v_pk_mul_f32 v[10:11], v[10:11], v[252:253]
    v_pk_mul_f32 v[12:13], v[12:13], v[252:253]
    v_pk_mul_f32 v[14:15], v[14:15], v[252:253]
    v_cvt_pk_bf16_f32 v152, v8, v9
    v_cvt_pk_bf16_f32 v153, v10, v11
    v_cvt_pk_bf16_f32 v154, v12, v13
    v_cvt_pk_bf16_f32 v155, v14, v15
    v_pk_mul_f32 v[56:57], v[56:57], v[254:255]
    v_pk_mul_f32 v[58:59], v[58:59], v[254:255]
    v_pk_mul_f32 v[60:61], v[60:61], v[254:255]
    v_pk_mul_f32 v[62:63], v[62:63], v[254:255]
    v_cvt_pk_bf16_f32 v156, v56, v57
    v_cvt_pk_bf16_f32 v157, v58, v59
    v_cvt_pk_bf16_f32 v158, v60, v61
    v_cvt_pk_bf16_f32 v159, v62, v63
    s_waitcnt lgkmcnt(4)
    v_mfma_f32_16x16x32_bf16 v[24:27], v[220:223], v[184:187], v[24:27]
    ds_read_b64_tr_b16 v[236:237], v248 offset:61440
    v_mfma_f32_16x16x32_bf16 v[72:75], v[220:223], v[188:191], v[72:75]
    ds_read_b64_tr_b16 v[238:239], v248 offset:63488
    v_mfma_f32_16x16x32_bf16 v[28:31], v[224:227], v[184:187], v[28:31]
    ds_read_b64_tr_b16 v[240:241], v249 offset:61440
    v_mfma_f32_16x16x32_bf16 v[76:79], v[224:227], v[188:191], v[76:79]
    ds_read_b64_tr_b16 v[242:243], v249 offset:63488
    v_pk_mul_f32 v[16:17], v[16:17], v[252:253]
    v_pk_mul_f32 v[18:19], v[18:19], v[252:253]
    v_pk_mul_f32 v[20:21], v[20:21], v[252:253]
    v_pk_mul_f32 v[22:23], v[22:23], v[252:253]
    v_cvt_pk_bf16_f32 v160, v16, v17
    v_cvt_pk_bf16_f32 v161, v18, v19
    v_cvt_pk_bf16_f32 v162, v20, v21
    v_cvt_pk_bf16_f32 v163, v22, v23
    v_pk_mul_f32 v[64:65], v[64:65], v[254:255]
    v_pk_mul_f32 v[66:67], v[66:67], v[254:255]
    v_pk_mul_f32 v[68:69], v[68:69], v[254:255]
    v_pk_mul_f32 v[70:71], v[70:71], v[254:255]
    v_cvt_pk_bf16_f32 v164, v64, v65
    v_cvt_pk_bf16_f32 v165, v66, v67
    v_cvt_pk_bf16_f32 v166, v68, v69
    v_cvt_pk_bf16_f32 v167, v70, v71
    s_waitcnt lgkmcnt(4)
    v_mfma_f32_16x16x32_bf16 v[32:35], v[228:231], v[184:187], v[32:35]
    v_mfma_f32_16x16x32_bf16 v[80:83], v[228:231], v[188:191], v[80:83]
    v_mfma_f32_16x16x32_bf16 v[36:39], v[232:235], v[184:187], v[36:39]
    v_mfma_f32_16x16x32_bf16 v[84:87], v[232:235], v[188:191], v[84:87]
    v_pk_mul_f32 v[24:25], v[24:25], v[252:253]
    v_pk_mul_f32 v[26:27], v[26:27], v[252:253]
    v_pk_mul_f32 v[28:29], v[28:29], v[252:253]
    v_pk_mul_f32 v[30:31], v[30:31], v[252:253]
    v_cvt_pk_bf16_f32 v168, v24, v25
    v_cvt_pk_bf16_f32 v169, v26, v27
    v_cvt_pk_bf16_f32 v170, v28, v29
    v_cvt_pk_bf16_f32 v171, v30, v31
    v_pk_mul_f32 v[72:73], v[72:73], v[254:255]
    v_pk_mul_f32 v[74:75], v[74:75], v[254:255]
    v_pk_mul_f32 v[76:77], v[76:77], v[254:255]
    v_pk_mul_f32 v[78:79], v[78:79], v[254:255]
    v_cvt_pk_bf16_f32 v172, v72, v73
    v_cvt_pk_bf16_f32 v173, v74, v75
    v_cvt_pk_bf16_f32 v174, v76, v77
    v_cvt_pk_bf16_f32 v175, v78, v79
    s_waitcnt lgkmcnt(0)
    v_mfma_f32_16x16x32_bf16 v[40:43], v[236:239], v[184:187], v[40:43]
    v_mfma_f32_16x16x32_bf16 v[88:91], v[236:239], v[188:191], v[88:91]
    v_mfma_f32_16x16x32_bf16 v[44:47], v[240:243], v[184:187], v[44:47]
    v_mfma_f32_16x16x32_bf16 v[92:95], v[240:243], v[188:191], v[92:95]
    v_pk_mul_f32 v[32:33], v[32:33], v[252:253]
    v_pk_mul_f32 v[34:35], v[34:35], v[252:253]
    v_pk_mul_f32 v[36:37], v[36:37], v[252:253]
    v_pk_mul_f32 v[38:39], v[38:39], v[252:253]
    v_cvt_pk_bf16_f32 v176, v32, v33
    v_cvt_pk_bf16_f32 v177, v34, v35
    v_cvt_pk_bf16_f32 v178, v36, v37
    v_cvt_pk_bf16_f32 v179, v38, v39
    v_pk_mul_f32 v[80:81], v[80:81], v[254:255]
    v_pk_mul_f32 v[82:83], v[82:83], v[254:255]
    v_pk_mul_f32 v[84:85], v[84:85], v[254:255]
    v_pk_mul_f32 v[86:87], v[86:87], v[254:255]
    v_cvt_pk_bf16_f32 v180, v80, v81
    v_cvt_pk_bf16_f32 v181, v82, v83
    v_cvt_pk_bf16_f32 v182, v84, v85
    v_cvt_pk_bf16_f32 v183, v86, v87
    v_pk_mul_f32 v[40:41], v[40:41], v[252:253]
    v_pk_mul_f32 v[42:43], v[42:43], v[252:253]
    v_pk_mul_f32 v[44:45], v[44:45], v[252:253]
    v_pk_mul_f32 v[46:47], v[46:47], v[252:253]
    v_cvt_pk_bf16_f32 v192, v40, v41
    v_cvt_pk_bf16_f32 v193, v42, v43
    v_cvt_pk_bf16_f32 v194, v44, v45
    v_cvt_pk_bf16_f32 v195, v46, v47
    v_pk_mul_f32 v[88:89], v[88:89], v[254:255]
    v_pk_mul_f32 v[90:91], v[90:91], v[254:255]
    v_pk_mul_f32 v[92:93], v[92:93], v[254:255]
    v_pk_mul_f32 v[94:95], v[94:95], v[254:255]
    v_cvt_pk_bf16_f32 v196, v88, v89
    v_cvt_pk_bf16_f32 v197, v90, v91
    v_cvt_pk_bf16_f32 v198, v92, v93
    v_cvt_pk_bf16_f32 v199, v94, v95
    s_add_u32 s55, s55, 1
    s_branch t0_unit_h
t0_exit_h:
    s_branch t0_final
t0_rare0_h:
    v_max3_f32 v251, v144, v145, v146
    v_max3_f32 v251, v251, v147, v148
    v_max3_f32 v251, v251, v149, v150
    v_max_f32 v251, v251, v151
    v_mov_b32 v252, v251
    s_nop 1
    v_permlane32_swap_b32 v252, v251
    v_max_f32 v251, v251, v252
    v_mov_b32 v252, v251
    s_nop 1
    v_permlane16_swap_b32 v252, v251
    v_max_f32 v251, v251, v252
    v_add_f32 v251, 0x40e00000, v251
    v_max_f32 v251, 0, v251
    v_sub_f32 v192, v192, v251
    v_sub_f32 v193, v193, v251
    v_sub_f32 v194, v194, v251
    v_sub_f32 v195, v195, v251
    v_sub_f32 v144, v144, v251
    v_sub_f32 v145, v145, v251
    v_sub_f32 v146, v146, v251
    v_sub_f32 v147, v147, v251
    v_sub_f32 v148, v148, v251
    v_sub_f32 v149, v149, v251
    v_sub_f32 v150, v150, v251
    v_sub_f32 v151, v151, v251
    v_sub_f32 v160, v160, v251
    v_sub_f32 v161, v161, v251
    v_sub_f32 v162, v162, v251
    v_sub_f32 v163, v163, v251
    v_sub_f32 v164, v164, v251
    v_sub_f32 v165, v165, v251
    v_sub_f32 v166, v166, v251
    v_sub_f32 v167, v167, v251
    v_exp_f32 v251, -v251
    s_nop 0
    v_mul_f32 v200, v200, v251
    v_mul_f32 v201, v201, v251
    v_mul_f32 v202, v202, v251
    v_mul_f32 v203, v203, v251
    v_mul_f32 v0, v0, v251
    v_mul_f32 v1, v1, v251
    v_mul_f32 v2, v2, v251
    v_mul_f32 v3, v3, v251
    v_mul_f32 v4, v4, v251
    v_mul_f32 v5, v5, v251
    v_mul_f32 v6, v6, v251
    v_mul_f32 v7, v7, v251
    v_mul_f32 v8, v8, v251
    v_mul_f32 v9, v9, v251
    v_mul_f32 v10, v10, v251
    v_mul_f32 v11, v11, v251
    v_mul_f32 v12, v12, v251
    v_mul_f32 v13, v13, v251
    v_mul_f32 v14, v14, v251
    v_mul_f32 v15, v15, v251
    v_mul_f32 v16, v16, v251
    v_mul_f32 v17, v17, v251
    v_mul_f32 v18, v18, v251
    v_mul_f32 v19, v19, v251
    v_mul_f32 v20, v20, v251
    v_mul_f32 v21, v21, v251
    v_mul_f32 v22, v22, v251
    v_mul_f32 v23, v23, v251
    v_mul_f32 v24, v24, v251
    v_mul_f32 v25, v25, v251
    v_mul_f32 v26, v26, v251
    v_mul_f32 v27, v27, v251
    v_mul_f32 v28, v28, v251
    v_mul_f32 v29, v29, v251
    v_mul_f32 v30, v30, v251
    v_mul_f32 v31, v31, v251
    v_mul_f32 v32, v32, v251
    v_mul_f32 v33, v33, v251
    v_mul_f32 v34, v34, v251
    v_mul_f32 v35, v35, v251
    v_mul_f32 v36, v36, v251
    v_mul_f32 v37, v37, v251
    v_mul_f32 v38, v38, v251
    v_mul_f32 v39, v39, v251
    v_mul_f32 v40, v40, v251
    v_mul_f32 v41, v41, v251
    v_mul_f32 v42, v42, v251
    v_mul_f32 v43, v43, v251
    v_mul_f32 v44, v44, v251
    v_mul_f32 v45, v45, v251
    v_mul_f32 v46, v46, v251
    v_mul_f32 v47, v47, v251
    v_max3_f32 v251, v152, v153, v154
    v_max3_f32 v251, v251, v155, v156
    v_max3_f32 v251, v251, v157, v158
    v_max_f32 v251, v251, v159
    v_mov_b32 v252, v251
    s_nop 1
    v_permlane32_swap_b32 v252, v251
    v_max_f32 v251, v251, v252
    v_mov_b32 v252, v251
    s_nop 1
    v_permlane16_swap_b32 v252, v251
    v_max_f32 v251, v251, v252
    v_add_f32 v251, 0x40e00000, v251
    v_max_f32 v251, 0, v251
    v_sub_f32 v196, v196, v251
    v_sub_f32 v197, v197, v251
    v_sub_f32 v198, v198, v251
    v_sub_f32 v199, v199, v251
    v_sub_f32 v152, v152, v251
    v_sub_f32 v153, v153, v251
    v_sub_f32 v154, v154, v251
    v_sub_f32 v155, v155, v251
    v_sub_f32 v156, v156, v251
    v_sub_f32 v157, v157, v251
    v_sub_f32 v158, v158, v251
    v_sub_f32 v159, v159, v251
    v_sub_f32 v168, v168, v251
    v_sub_f32 v169, v169, v251
    v_sub_f32 v170, v170, v251
    v_sub_f32 v171, v171, v251
    v_sub_f32 v172, v172, v251
    v_sub_f32 v173, v173, v251
    v_sub_f32 v174, v174, v251
    v_sub_f32 v175, v175, v251
    v_exp_f32 v251, -v251
    s_nop 0
    v_mul_f32 v204, v204, v251
    v_mul_f32 v205, v205, v251
    v_mul_f32 v206, v206, v251
    v_mul_f32 v207, v207, v251
    v_mul_f32 v48, v48, v251
    v_mul_f32 v49, v49, v251
    v_mul_f32 v50, v50, v251
    v_mul_f32 v51, v51, v251
    v_mul_f32 v52, v52, v251
    v_mul_f32 v53, v53, v251
    v_mul_f32 v54, v54, v251
    v_mul_f32 v55, v55, v251
    v_mul_f32 v56, v56, v251
    v_mul_f32 v57, v57, v251
    v_mul_f32 v58, v58, v251
    v_mul_f32 v59, v59, v251
    v_mul_f32 v60, v60, v251
    v_mul_f32 v61, v61, v251
    v_mul_f32 v62, v62, v251
    v_mul_f32 v63, v63, v251
    v_mul_f32 v64, v64, v251
    v_mul_f32 v65, v65, v251
    v_mul_f32 v66, v66, v251
    v_mul_f32 v67, v67, v251
    v_mul_f32 v68, v68, v251
    v_mul_f32 v69, v69, v251
    v_mul_f32 v70, v70, v251
    v_mul_f32 v71, v71, v251
    v_mul_f32 v72, v72, v251
    v_mul_f32 v73, v73, v251
    v_mul_f32 v74, v74, v251
    v_mul_f32 v75, v75, v251
    v_mul_f32 v76, v76, v251
    v_mul_f32 v77, v77, v251
    v_mul_f32 v78, v78, v251
    v_mul_f32 v79, v79, v251
    v_mul_f32 v80, v80, v251
    v_mul_f32 v81, v81, v251
    v_mul_f32 v82, v82, v251
    v_mul_f32 v83, v83, v251
    v_mul_f32 v84, v84, v251
    v_mul_f32 v85, v85, v251
    v_mul_f32 v86, v86, v251
    v_mul_f32 v87, v87, v251
    v_mul_f32 v88, v88, v251
    v_mul_f32 v89, v89, v251
    v_mul_f32 v90, v90, v251
    v_mul_f32 v91, v91, v251
    v_mul_f32 v92, v92, v251
    v_mul_f32 v93, v93, v251
    v_mul_f32 v94, v94, v251
    v_mul_f32 v95, v95, v251
    v_exp_f32 v252, v144
    v_exp_f32 v253, v145
    v_exp_f32 v254, v146
    v_exp_f32 v255, v147
    v_cvt_pk_bf16_f32 v176, v252, v253
    v_exp_f32 v252, v148
    v_exp_f32 v253, v149
    v_cvt_pk_bf16_f32 v177, v254, v255
    v_exp_f32 v254, v150
    v_exp_f32 v255, v151
    v_cvt_pk_bf16_f32 v178, v252, v253
    v_exp_f32 v252, v152
    v_exp_f32 v253, v153
    v_cvt_pk_bf16_f32 v179, v254, v255
    v_exp_f32 v254, v154
    v_exp_f32 v255, v155
    v_cvt_pk_bf16_f32 v180, v252, v253
    v_exp_f32 v252, v156
    v_exp_f32 v253, v157
    v_cvt_pk_bf16_f32 v181, v254, v255
    v_exp_f32 v254, v158
    v_exp_f32 v255, v159
    v_cvt_pk_bf16_f32 v182, v252, v253
    v_cvt_pk_bf16_f32 v183, v254, v255
    s_setpc_b64 s[30:31]
t0_rare1_h:
    v_max3_f32 v251, v160, v161, v162
    v_max3_f32 v251, v251, v163, v164
    v_max3_f32 v251, v251, v165, v166
    v_max_f32 v251, v251, v167
    v_mov_b32 v252, v251
    s_nop 1
    v_permlane32_swap_b32 v252, v251
    v_max_f32 v251, v251, v252
    v_mov_b32 v252, v251
    s_nop 1
    v_permlane16_swap_b32 v252, v251
    v_max_f32 v251, v251, v252
    v_add_f32 v251, 0x40e00000, v251
    v_max_f32 v251, 0, v251
    v_sub_f32 v192, v192, v251
    v_sub_f32 v193, v193, v251
    v_sub_f32 v194, v194, v251
    v_sub_f32 v195, v195, v251
    v_sub_f32 v144, v144, v251
    v_sub_f32 v145, v145, v251
    v_sub_f32 v146, v146, v251
    v_sub_f32 v147, v147, v251
    v_sub_f32 v148, v148, v251
    v_sub_f32 v149, v149, v251
    v_sub_f32 v150, v150, v251
    v_sub_f32 v151, v151, v251
    v_sub_f32 v160, v160, v251
    v_sub_f32 v161, v161, v251
    v_sub_f32 v162, v162, v251
    v_sub_f32 v163, v163, v251
    v_sub_f32 v164, v164, v251
    v_sub_f32 v165, v165, v251
    v_sub_f32 v166, v166, v251
    v_sub_f32 v167, v167, v251
    v_exp_f32 v251, -v251
    s_nop 0
    v_mul_f32 v200, v200, v251
    v_mul_f32 v201, v201, v251
    v_mul_f32 v202, v202, v251
    v_mul_f32 v203, v203, v251
    v_mul_f32 v0, v0, v251
    v_mul_f32 v1, v1, v251
    v_mul_f32 v2, v2, v251
    v_mul_f32 v3, v3, v251
    v_mul_f32 v4, v4, v251
    v_mul_f32 v5, v5, v251
    v_mul_f32 v6, v6, v251
    v_mul_f32 v7, v7, v251
    v_mul_f32 v8, v8, v251
    v_mul_f32 v9, v9, v251
    v_mul_f32 v10, v10, v251
    v_mul_f32 v11, v11, v251
    v_mul_f32 v12, v12, v251
    v_mul_f32 v13, v13, v251
    v_mul_f32 v14, v14, v251
    v_mul_f32 v15, v15, v251
    v_mul_f32 v16, v16, v251
    v_mul_f32 v17, v17, v251
    v_mul_f32 v18, v18, v251
    v_mul_f32 v19, v19, v251
    v_mul_f32 v20, v20, v251
    v_mul_f32 v21, v21, v251
    v_mul_f32 v22, v22, v251
    v_mul_f32 v23, v23, v251
    v_mul_f32 v24, v24, v251
    v_mul_f32 v25, v25, v251
    v_mul_f32 v26, v26, v251
    v_mul_f32 v27, v27, v251
    v_mul_f32 v28, v28, v251
    v_mul_f32 v29, v29, v251
    v_mul_f32 v30, v30, v251
    v_mul_f32 v31, v31, v251
    v_mul_f32 v32, v32, v251
    v_mul_f32 v33, v33, v251
    v_mul_f32 v34, v34, v251
    v_mul_f32 v35, v35, v251
    v_mul_f32 v36, v36, v251
    v_mul_f32 v37, v37, v251
    v_mul_f32 v38, v38, v251
    v_mul_f32 v39, v39, v251
    v_mul_f32 v40, v40, v251
    v_mul_f32 v41, v41, v251
    v_mul_f32 v42, v42, v251
    v_mul_f32 v43, v43, v251
    v_mul_f32 v44, v44, v251
    v_mul_f32 v45, v45, v251
    v_mul_f32 v46, v46, v251
    v_mul_f32 v47, v47, v251
    v_max3_f32 v251, v168, v169, v170
    v_max3_f32 v251, v251, v171, v172
    v_max3_f32 v251, v251, v173, v174
    v_max_f32 v251, v251, v175
    v_mov_b32 v252, v251
    s_nop 1
    v_permlane32_swap_b32 v252, v251
    v_max_f32 v251, v251, v252
    v_mov_b32 v252, v251
    s_nop 1
    v_permlane16_swap_b32 v252, v251
    v_max_f32 v251, v251, v252
    v_add_f32 v251, 0x40e00000, v251
    v_max_f32 v251, 0, v251
    v_sub_f32 v196, v196, v251
    v_sub_f32 v197, v197, v251
    v_sub_f32 v198, v198, v251
    v_sub_f32 v199, v199, v251
    v_sub_f32 v152, v152, v251
    v_sub_f32 v153, v153, v251
    v_sub_f32 v154, v154, v251
    v_sub_f32 v155, v155, v251
    v_sub_f32 v156, v156, v251
    v_sub_f32 v157, v157, v251
    v_sub_f32 v158, v158, v251
    v_sub_f32 v159, v159, v251
    v_sub_f32 v168, v168, v251
    v_sub_f32 v169, v169, v251
    v_sub_f32 v170, v170, v251
    v_sub_f32 v171, v171, v251
    v_sub_f32 v172, v172, v251
    v_sub_f32 v173, v173, v251
    v_sub_f32 v174, v174, v251
    v_sub_f32 v175, v175, v251
    v_exp_f32 v251, -v251
    s_nop 0
    v_mul_f32 v204, v204, v251
    v_mul_f32 v205, v205, v251
    v_mul_f32 v206, v206, v251
    v_mul_f32 v207, v207, v251
    v_mul_f32 v48, v48, v251
    v_mul_f32 v49, v49, v251
    v_mul_f32 v50, v50, v251
    v_mul_f32 v51, v51, v251
    v_mul_f32 v52, v52, v251
    v_mul_f32 v53, v53, v251
    v_mul_f32 v54, v54, v251
    v_mul_f32 v55, v55, v251
    v_mul_f32 v56, v56, v251
    v_mul_f32 v57, v57, v251
    v_mul_f32 v58, v58, v251
    v_mul_f32 v59, v59, v251
    v_mul_f32 v60, v60, v251
    v_mul_f32 v61, v61, v251
    v_mul_f32 v62, v62, v251
    v_mul_f32 v63, v63, v251
    v_mul_f32 v64, v64, v251
    v_mul_f32 v65, v65, v251
    v_mul_f32 v66, v66, v251
    v_mul_f32 v67, v67, v251
    v_mul_f32 v68, v68, v251
    v_mul_f32 v69, v69, v251
    v_mul_f32 v70, v70, v251
    v_mul_f32 v71, v71, v251
    v_mul_f32 v72, v72, v251
    v_mul_f32 v73, v73, v251
    v_mul_f32 v74, v74, v251
    v_mul_f32 v75, v75, v251
    v_mul_f32 v76, v76, v251
    v_mul_f32 v77, v77, v251
    v_mul_f32 v78, v78, v251
    v_mul_f32 v79, v79, v251
    v_mul_f32 v80, v80, v251
    v_mul_f32 v81, v81, v251
    v_mul_f32 v82, v82, v251
    v_mul_f32 v83, v83, v251
    v_mul_f32 v84, v84, v251
    v_mul_f32 v85, v85, v251
    v_mul_f32 v86, v86, v251
    v_mul_f32 v87, v87, v251
    v_mul_f32 v88, v88, v251
    v_mul_f32 v89, v89, v251
    v_mul_f32 v90, v90, v251
    v_mul_f32 v91, v91, v251
    v_mul_f32 v92, v92, v251
    v_mul_f32 v93, v93, v251
    v_mul_f32 v94, v94, v251
    v_mul_f32 v95, v95, v251
    v_exp_f32 v252, v160
    v_exp_f32 v253, v161
    v_exp_f32 v254, v162
    v_exp_f32 v255, v163
    v_cvt_pk_bf16_f32 v184, v252, v253
    v_exp_f32 v252, v164
    v_exp_f32 v253, v165
    v_cvt_pk_bf16_f32 v185, v254, v255
    v_exp_f32 v254, v166
    v_exp_f32 v255, v167
    v_cvt_pk_bf16_f32 v186, v252, v253
    v_exp_f32 v252, v168
    v_exp_f32 v253, v169
    v_cvt_pk_bf16_f32 v187, v254, v255
    v_exp_f32 v254, v170
    v_exp_f32 v255, v171
    v_cvt_pk_bf16_f32 v188, v252, v253
    v_exp_f32 v252, v172
    v_exp_f32 v253, v173
    v_cvt_pk_bf16_f32 v189, v254, v255
    v_exp_f32 v254, v174
    v_exp_f32 v255, v175
    v_cvt_pk_bf16_f32 v190, v252, v253
    v_cvt_pk_bf16_f32 v191, v254, v255
    s_setpc_b64 s[30:31]
k1_light:
    v_mbcnt_lo_u32_b32 v216, -1, 0
    v_mbcnt_hi_u32_b32 v216, -1, v216
    v_and_b32 v217, 15, v216
    v_lshrrev_b32 v218, 4, v216
    v_lshrrev_b32 v219, 2, v216
    v_and_b32 v220, 3, v219
    v_and_b32 v221, 3, v216
    v_lshrrev_b32 v222, 3, v216
    v_and_b32 v223, 7, v216
    s_waitcnt lgkmcnt(0)
    s_lshl_b32 s62, s52, 11
    s_add_u32 s62, s62, 0
    v_lshl_add_u32 v250, v216, 4, s62
    v_lshrrev_b32 v222, 1, v217
    v_and_b32 v222, 3, v222
    v_lshlrev_b32 v222, 1, v222
    v_xor_b32 v222, v218, v222
    v_lshlrev_b32 v222, 4, v222
    v_lshl_add_u32 v222, v217, 7, v222
    v_add_u32 v244, 94208, v222
    v_xor_b32 v245, 64, v244
    v_lshrrev_b32 v222, 1, v219
    v_and_b32 v222, 3, v222
    v_lshlrev_b32 v222, 5, v222
    v_lshl_add_u32 v222, v219, 7, v222
    v_lshl_add_u32 v222, v221, 3, v222
    v_add_u32 v246, 94208, v222
    v_xor_b32 v247, 32, v246
    v_xor_b32 v248, 64, v246
    v_xor_b32 v249, 96, v246
    s_mov_b32 s68, 0x40004000
    s_mov_b32 s55, 1
    v_mov_b32 v208, 0x3f803f80
    v_mov_b32 v209, 0x3f803f80
    v_mov_b32 v210, 0x3f803f80
    v_mov_b32 v211, 0x3f803f80
t0_unit_l:
    s_barrier
    s_cmp_gt_u32 s55, 3
    s_cbranch_scc1 t0_q3_l
    ds_read_b128 v[96:99], v250 offset:0
    ds_read_b128 v[100:103], v250 offset:7168
    ds_read_b128 v[104:107], v250 offset:14336
    ds_read_b128 v[108:111], v250 offset:21504
    ds_read_b128 v[112:115], v250 offset:28672
    ds_read_b128 v[116:119], v250 offset:35840
    s_cmp_lg_u32 s55, 1
    s_cbranch_scc1 t0_w_l
    s_branch t0_noo_l
t0_q3_l:
    s_cmp_eq_u32 s55, 5
    s_cbranch_scc1 t0_w_l
    v_mov_b32 v96, v120
    v_mov_b32 v97, v121
    v_mov_b32 v98, v122
    v_mov_b32 v99, v123
    v_mov_b32 v100, v124
    v_mov_b32 v101, v125
    v_mov_b32 v102, v126
    v_mov_b32 v103, v127
    v_mov_b32 v104, v128
    v_mov_b32 v105, v129
    v_mov_b32 v106, v130
    v_mov_b32 v107, v131
    v_mov_b32 v108, v132
    v_mov_b32 v109, v133
    v_mov_b32 v110, v134
    v_mov_b32 v111, v135
    v_mov_b32 v112, v136
    v_mov_b32 v113, v137
    v_mov_b32 v114, v138
    v_mov_b32 v115, v139
    v_mov_b32 v116, v140
    v_mov_b32 v117, v141
    v_mov_b32 v118, v142
    v_mov_b32 v119, v143
t0_w_l:
    s_waitcnt lgkmcnt(0)
    ds_write_b128 v250, v[144:147] offset:0
    ds_write_b128 v250, v[152:155] offset:7168
    ds_write_b128 v250, v[160:163] offset:14336
    ds_write_b128 v250, v[168:171] offset:21504
    ds_write_b128 v250, v[176:179] offset:28672
    ds_write_b128 v250, v[192:195] offset:35840
    s_cmp_eq_u32 s55, 5
    s_cbranch_scc1 t0_exit_l
t0_noo_l:
    ds_read_b128 v[212:215], v244 offset:0
    ds_read_b128 v[216:219], v244 offset:2048
    ds_read_b128 v[220:223], v245 offset:0
    ds_read_b128 v[224:227], v245 offset:2048
    s_waitcnt lgkmcnt(2)
    v_mfma_f32_16x16x32_bf16 v[144:147], v[212:215], v[96:99], 0
    ds_read_b128 v[228:231], v244 offset:4096
    s_barrier
    v_mfma_f32_16x16x32_bf16 v[148:151], v[216:219], v[96:99], 0
    ds_read_b128 v[232:235], v244 offset:6144
    s_waitcnt lgkmcnt(2)
    v_mfma_f32_16x16x32_bf16 v[144:147], v[220:223], v[100:103], v[144:147]
    ds_read_b128 v[236:239], v245 offset:4096
    v_mfma_f32_16x16x32_bf16 v[148:151], v[224:227], v[100:103], v[148:151]
    ds_read_b128 v[240:243], v245 offset:6144
    s_barrier
    s_waitcnt lgkmcnt(2)
    v_mfma_f32_16x16x32_bf16 v[144:147], v[228:231], v[104:107], v[144:147]
    ds_read_b128 v[212:215], v244 offset:8192
    v_mfma_f32_16x16x32_bf16 v[148:151], v[232:235], v[104:107], v[148:151]
    ds_read_b128 v[216:219], v244 offset:10240
    s_waitcnt lgkmcnt(2)
    v_mfma_f32_16x16x32_bf16 v[144:147], v[236:239], v[108:111], v[144:147]
    ds_read_b128 v[220:223], v245 offset:8192
    v_mfma_f32_16x16x32_bf16 v[148:151], v[240:243], v[108:111], v[148:151]
    ds_read_b128 v[224:227], v245 offset:10240
    s_waitcnt lgkmcnt(2)
    v_mfma_f32_16x16x32_bf16 v[144:147], v[212:215], v[112:115], v[144:147]
    ds_read_b128 v[228:231], v244 offset:12288
    v_mfma_f32_16x16x32_bf16 v[148:151], v[216:219], v[112:115], v[148:151]
    ds_read_b128 v[232:235], v244 offset:14336
    s_waitcnt lgkmcnt(2)
    v_mfma_f32_16x16x32_bf16 v[144:147], v[220:223], v[116:119], v[144:147]
    ds_read_b128 v[236:239], v245 offset:12288
    v_mfma_f32_16x16x32_bf16 v[148:151], v[224:227], v[116:119], v[148:151]
    ds_read_b128 v[240:243], v245 offset:14336
    s_nop 4
    v_max3_f32 v252, v144, v145, v146
    s_nop 0
    v_max3_f32 v252, v252, v147, v148
    v_max3_f32 v252, v252, v149, v150
    v_max_f32 v252, v252, v151
    v_mov_b32 v253, v252
    s_nop 1
    v_permlane32_swap_b32 v253, v252
    v_max_f32 v252, v252, v253
    v_mov_b32 v253, v252
    s_nop 1
    v_permlane16_swap_b32 v253, v252
    v_max_f32 v252, v252, v253
    v_add_f32 v252, 0x40e00000, v252
    v_sub_f32 v192, 0, v252
    v_sub_f32 v193, 0, v252
    v_sub_f32 v194, 0, v252
    v_sub_f32 v195, 0, v252
    v_sub_f32 v144, v144, v252
    v_sub_f32 v145, v145, v252
    v_sub_f32 v146, v146, v252
    v_sub_f32 v147, v147, v252
    v_sub_f32 v148, v148, v252
    v_sub_f32 v149, v149, v252
    v_sub_f32 v150, v150, v252
    v_sub_f32 v151, v151, v252
    s_waitcnt lgkmcnt(2)
    v_mfma_f32_16x16x32_bf16 v[160:163], v[228:231], v[96:99], v[192:195]
    ds_read_b128 v[212:215], v244 offset:16384
    v_exp_f32 v252, v144
    v_mfma_f32_16x16x32_bf16 v[164:167], v[232:235], v[96:99], v[192:195]
    ds_read_b128 v[216:219], v244 offset:18432
    v_exp_f32 v253, v145
    s_waitcnt lgkmcnt(2)
    v_mfma_f32_16x16x32_bf16 v[160:163], v[236:239], v[100:103], v[160:163]
    ds_read_b128 v[220:223], v245 offset:16384
    v_exp_f32 v254, v146
    v_mfma_f32_16x16x32_bf16 v[164:167], v[240:243], v[100:103], v[164:167]
    ds_read_b128 v[224:227], v245 offset:18432
    v_exp_f32 v255, v147
    s_barrier
    s_waitcnt lgkmcnt(2)
    v_mfma_f32_16x16x32_bf16 v[160:163], v[212:215], v[104:107], v[160:163]
    ds_read_b128 v[228:231], v244 offset:20480
    v_cvt_pk_bf16_f32 v176, v252, v253
    v_mfma_f32_16x16x32_bf16 v[164:167], v[216:219], v[104:107], v[164:167]
    ds_read_b128 v[232:235], v244 offset:22528
    v_exp_f32 v252, v148
    s_waitcnt lgkmcnt(2)
    v_mfma_f32_16x16x32_bf16 v[160:163], v[220:223], v[108:111], v[160:163]
    ds_read_b128 v[236:239], v245 offset:20480
    v_exp_f32 v253, v149
    v_mfma_f32_16x16x32_bf16 v[164:167], v[224:227], v[108:111], v[164:167]
    ds_read_b128 v[240:243], v245 offset:22528
    v_cvt_pk_bf16_f32 v177, v254, v255
    v_exp_f32 v254, v150
    s_waitcnt lgkmcnt(2)
    v_mfma_f32_16x16x32_bf16 v[160:163], v[228:231], v[112:115], v[160:163]
    ds_read_b64_tr_b16 v[212:213], v246 offset:24576
    ds_read_b64_tr_b16 v[214:215], v246 offset:26624
    v_exp_f32 v255, v151
    v_mfma_f32_16x16x32_bf16 v[164:167], v[232:235], v[112:115], v[164:167]
    ds_read_b64_tr_b16 v[216:217], v247 offset:24576
    ds_read_b64_tr_b16 v[218:219], v247 offset:26624
    v_cvt_pk_bf16_f32 v178, v252, v253
    s_waitcnt lgkmcnt(4)
    v_mfma_f32_16x16x32_bf16 v[160:163], v[236:239], v[116:119], v[160:163]
    ds_read_b64_tr_b16 v[220:221], v248 offset:24576
    ds_read_b64_tr_b16 v[222:223], v248 offset:26624
    v_cvt_pk_bf16_f32 v179, v254, v255
    v_or3_b32 v251, v176, v177, v178
    v_mfma_f32_16x16x32_bf16 v[164:167], v[240:243], v[116:119], v[164:167]
    ds_read_b64_tr_b16 v[224:225], v249 offset:24576
    ds_read_b64_tr_b16 v[226:227], v249 offset:26624
    v_bitop3_b32 v251, v251, v179, s68 bitop3:0xa8
    v_cmp_ne_u32 vcc, 0, v251
    s_cbranch_vccz t0_okq0_l
    s_call_b64 s[30:31], t0_rare0_l
t0_okq0_l:
    s_waitcnt lgkmcnt(4)
    v_mfma_f32_16x16x32_bf16 v[0:3], v[212:215], v[176:179], 0
    ds_read_b64_tr_b16 v[228:229], v246 offset:28672
    ds_read_b64_tr_b16 v[230:231], v246 offset:30720
    v_mfma_f32_16x16x32_bf16 v[4:7], v[216:219], v[176:179], 0
    ds_read_b64_tr_b16 v[232:233], v247 offset:28672
    ds_read_b64_tr_b16 v[234:235], v247 offset:30720
    s_waitcnt lgkmcnt(4)
    v_mfma_f32_16x16x32_bf16 v[8:11], v[220:223], v[176:179], 0
    ds_read_b64_tr_b16 v[236:237], v248 offset:28672
    ds_read_b64_tr_b16 v[238:239], v248 offset:30720
    v_exp_f32 v252, v160
    v_mfma_f32_16x16x32_bf16 v[12:15], v[224:227], v[176:179], 0
    ds_read_b64_tr_b16 v[240:241], v249 offset:28672
    ds_read_b64_tr_b16 v[242:243], v249 offset:30720
    s_barrier
    s_waitcnt lgkmcnt(4)
    v_mfma_f32_16x16x32_bf16 v[16:19], v[228:231], v[176:179], 0
    ds_read_b64_tr_b16 v[212:213], v246 offset:32768
    ds_read_b64_tr_b16 v[214:215], v246 offset:34816
    v_exp_f32 v253, v161
    v_mfma_f32_16x16x32_bf16 v[200:203], v[208:211], v[176:179], 0
    ds_read_b64_tr_b16 v[216:217], v247 offset:32768
    v_mfma_f32_16x16x32_bf16 v[20:23], v[232:235], v[176:179], 0
    ds_read_b64_tr_b16 v[218:219], v247 offset:34816
    v_exp_f32 v254, v162
    s_waitcnt lgkmcnt(4)
    v_mfma_f32_16x16x32_bf16 v[24:27], v[236:239], v[176:179], 0
    ds_read_b64_tr_b16 v[220:221], v248 offset:32768
    ds_read_b64_tr_b16 v[222:223], v248 offset:34816
    v_mfma_f32_16x16x32_bf16 v[28:31], v[240:243], v[176:179], 0
    ds_read_b64_tr_b16 v[224:225], v249 offset:32768
    ds_read_b64_tr_b16 v[226:227], v249 offset:34816
    s_waitcnt lgkmcnt(4)
    v_mfma_f32_16x16x32_bf16 v[32:35], v[212:215], v[176:179], 0
    ds_read_b128 v[228:231], v244 offset:36864
    v_exp_f32 v255, v163
    v_mfma_f32_16x16x32_bf16 v[36:39], v[216:219], v[176:179], 0
    ds_read_b128 v[232:235], v244 offset:38912
    s_waitcnt lgkmcnt(2)
    v_mfma_f32_16x16x32_bf16 v[40:43], v[220:223], v[176:179], 0
    ds_read_b128 v[236:239], v245 offset:36864
    v_cvt_pk_bf16_f32 v184, v252, v253
    v_mfma_f32_16x16x32_bf16 v[44:47], v[224:227], v[176:179], 0
    ds_read_b128 v[240:243], v245 offset:38912
    v_cvt_pk_bf16_f32 v185, v254, v255
    s_waitcnt lgkmcnt(2)
    v_mfma_f32_16x16x32_bf16 v[144:147], v[228:231], v[96:99], v[192:195]
    ds_read_b128 v[212:215], v244 offset:40960
    v_exp_f32 v252, v164
    v_mfma_f32_16x16x32_bf16 v[148:151], v[232:235], v[96:99], v[192:195]
    ds_read_b128 v[216:219], v244 offset:43008
    s_waitcnt lgkmcnt(2)
    v_mfma_f32_16x16x32_bf16 v[144:147], v[236:239], v[100:103], v[144:147]
    ds_read_b128 v[220:223], v245 offset:40960
    v_exp_f32 v253, v165
    v_mfma_f32_16x16x32_bf16 v[148:151], v[240:243], v[100:103], v[148:151]
    ds_read_b128 v[224:227], v245 offset:43008
    s_barrier
    s_waitcnt lgkmcnt(2)
    v_mfma_f32_16x16x32_bf16 v[144:147], v[212:215], v[104:107], v[144:147]
    ds_read_b128 v[228:231], v244 offset:45056
    v_exp_f32 v254, v166
    v_mfma_f32_16x16x32_bf16 v[148:151], v[216:219], v[104:107], v[148:151]
    ds_read_b128 v[232:235], v244 offset:47104
    s_waitcnt lgkmcnt(2)
    v_mfma_f32_16x16x32_bf16 v[144:147], v[220:223], v[108:111], v[144:147]
    ds_read_b128 v[236:239], v245 offset:45056
    v_exp_f32 v255, v167
    v_mfma_f32_16x16x32_bf16 v[148:151], v[224:227], v[108:111], v[148:151]
    ds_read_b128 v[240:243], v245 offset:47104
    v_cvt_pk_bf16_f32 v186, v252, v253
    s_waitcnt lgkmcnt(2)
    v_mfma_f32_16x16x32_bf16 v[144:147], v[228:231], v[112:115], v[144:147]
    ds_read_b64_tr_b16 v[212:213], v246 offset:49152
    ds_read_b64_tr_b16 v[214:215], v246 offset:51200
    v_cvt_pk_bf16_f32 v187, v254, v255
    v_mfma_f32_16x16x32_bf16 v[148:151], v[232:235], v[112:115], v[148:151]
    ds_read_b64_tr_b16 v[216:217], v247 offset:49152
    ds_read_b64_tr_b16 v[218:219], v247 offset:51200
    v_or3_b32 v251, v184, v185, v186
    s_waitcnt lgkmcnt(4)
    v_mfma_f32_16x16x32_bf16 v[144:147], v[236:239], v[116:119], v[144:147]
    ds_read_b64_tr_b16 v[220:221], v248 offset:49152
    ds_read_b64_tr_b16 v[222:223], v248 offset:51200
    v_bitop3_b32 v251, v251, v187, s68 bitop3:0xa8
    v_mfma_f32_16x16x32_bf16 v[148:151], v[240:243], v[116:119], v[148:151]
    ds_read_b64_tr_b16 v[224:225], v249 offset:49152
    ds_read_b64_tr_b16 v[226:227], v249 offset:51200
    v_cmp_ne_u32 vcc, 0, v251
    s_cbranch_vccz t0_okq1_l
    s_call_b64 s[30:31], t0_rare1_l
t0_okq1_l:
    s_waitcnt lgkmcnt(4)
    v_mfma_f32_16x16x32_bf16 v[0:3], v[212:215], v[184:187], v[0:3]
    ds_read_b64_tr_b16 v[228:229], v246 offset:53248
    ds_read_b64_tr_b16 v[230:231], v246 offset:55296
    v_mfma_f32_16x16x32_bf16 v[4:7], v[216:219], v[184:187], v[4:7]
    ds_read_b64_tr_b16 v[232:233], v247 offset:53248
    ds_read_b64_tr_b16 v[234:235], v247 offset:55296
    s_waitcnt lgkmcnt(4)
    v_mfma_f32_16x16x32_bf16 v[8:11], v[220:223], v[184:187], v[8:11]
    ds_read_b64_tr_b16 v[236:237], v248 offset:53248
    ds_read_b64_tr_b16 v[238:239], v248 offset:55296
    v_exp_f32 v252, v144
    v_mfma_f32_16x16x32_bf16 v[12:15], v[224:227], v[184:187], v[12:15]
    ds_read_b64_tr_b16 v[240:241], v249 offset:53248
    ds_read_b64_tr_b16 v[242:243], v249 offset:55296
    s_barrier
    s_waitcnt lgkmcnt(4)
    v_mfma_f32_16x16x32_bf16 v[16:19], v[228:231], v[184:187], v[16:19]
    ds_read_b64_tr_b16 v[212:213], v246 offset:57344
    ds_read_b64_tr_b16 v[214:215], v246 offset:59392
    v_exp_f32 v253, v145
    v_mfma_f32_16x16x32_bf16 v[200:203], v[208:211], v[184:187], v[200:203]
    ds_read_b64_tr_b16 v[216:217], v247 offset:57344
    v_mfma_f32_16x16x32_bf16 v[20:23], v[232:235], v[184:187], v[20:23]
    ds_read_b64_tr_b16 v[218:219], v247 offset:59392
    v_exp_f32 v254, v146
    s_waitcnt lgkmcnt(4)
    v_mfma_f32_16x16x32_bf16 v[24:27], v[236:239], v[184:187], v[24:27]
    ds_read_b64_tr_b16 v[220:221], v248 offset:57344
    ds_read_b64_tr_b16 v[222:223], v248 offset:59392
    v_mfma_f32_16x16x32_bf16 v[28:31], v[240:243], v[184:187], v[28:31]
    ds_read_b64_tr_b16 v[224:225], v249 offset:57344
    ds_read_b64_tr_b16 v[226:227], v249 offset:59392
    s_waitcnt lgkmcnt(4)
    v_mfma_f32_16x16x32_bf16 v[32:35], v[212:215], v[184:187], v[32:35]
    ds_read_b128 v[228:231], v244 offset:61440
    v_exp_f32 v255, v147
    v_mfma_f32_16x16x32_bf16 v[36:39], v[216:219], v[184:187], v[36:39]
    ds_read_b128 v[232:235], v244 offset:63488
    s_waitcnt lgkmcnt(2)
    v_mfma_f32_16x16x32_bf16 v[40:43], v[220:223], v[184:187], v[40:43]
    ds_read_b128 v[236:239], v245 offset:61440
    v_cvt_pk_bf16_f32 v176, v252, v253
    v_mfma_f32_16x16x32_bf16 v[44:47], v[224:227], v[184:187], v[44:47]
    ds_read_b128 v[240:243], v245 offset:63488
    v_cvt_pk_bf16_f32 v177, v254, v255
    s_waitcnt lgkmcnt(2)
    v_mfma_f32_16x16x32_bf16 v[160:163], v[228:231], v[96:99], v[192:195]
    ds_read_b128 v[212:215], v244 offset:0
    v_exp_f32 v252, v148
    v_mfma_f32_16x16x32_bf16 v[164:167], v[232:235], v[96:99], v[192:195]
    ds_read_b128 v[216:219], v244 offset:2048
    s_waitcnt lgkmcnt(2)
    v_mfma_f32_16x16x32_bf16 v[160:163], v[236:239], v[100:103], v[160:163]
    ds_read_b128 v[220:223], v245 offset:0
    v_exp_f32 v253, v149
    v_mfma_f32_16x16x32_bf16 v[164:167], v[240:243], v[100:103], v[164:167]
    ds_read_b128 v[224:227], v245 offset:2048
    s_waitcnt lgkmcnt(2)
    v_mfma_f32_16x16x32_bf16 v[160:163], v[212:215], v[104:107], v[160:163]
    ds_read_b128 v[228:231], v244 offset:4096
    v_exp_f32 v254, v150
    v_mfma_f32_16x16x32_bf16 v[164:167], v[216:219], v[104:107], v[164:167]
    ds_read_b128 v[232:235], v244 offset:6144
    s_waitcnt lgkmcnt(2)
    v_mfma_f32_16x16x32_bf16 v[160:163], v[220:223], v[108:111], v[160:163]
    ds_read_b128 v[236:239], v245 offset:4096
    v_exp_f32 v255, v151
    v_mfma_f32_16x16x32_bf16 v[164:167], v[224:227], v[108:111], v[164:167]
    ds_read_b128 v[240:243], v245 offset:6144
    v_cvt_pk_bf16_f32 v178, v252, v253
    s_barrier
    s_waitcnt lgkmcnt(2)
    v_mfma_f32_16x16x32_bf16 v[160:163], v[228:231], v[112:115], v[160:163]
    ds_read_b64_tr_b16 v[212:213], v246 offset:8192
    ds_read_b64_tr_b16 v[214:215], v246 offset:10240
    v_cvt_pk_bf16_f32 v179, v254, v255
    v_mfma_f32_16x16x32_bf16 v[164:167], v[232:235], v[112:115], v[164:167]
    ds_read_b64_tr_b16 v[216:217], v247 offset:8192
    ds_read_b64_tr_b16 v[218:219], v247 offset:10240
    v_or3_b32 v251, v176, v177, v178
    s_waitcnt lgkmcnt(4)
    v_mfma_f32_16x16x32_bf16 v[160:163], v[236:239], v[116:119], v[160:163]
    ds_read_b64_tr_b16 v[220:221], v248 offset:8192
    ds_read_b64_tr_b16 v[222:223], v248 offset:10240
    v_bitop3_b32 v251, v251, v179, s68 bitop3:0xa8
    v_mfma_f32_16x16x32_bf16 v[164:167], v[240:243], v[116:119], v[164:167]
    ds_read_b64_tr_b16 v[224:225], v249 offset:8192
    ds_read_b64_tr_b16 v[226:227], v249 offset:10240
    v_cmp_ne_u32 vcc, 0, v251
    s_cbranch_vccz t0_okq2_l
    s_call_b64 s[30:31], t0_rare0_l
t0_okq2_l:
    s_waitcnt lgkmcnt(4)
    v_mfma_f32_16x16x32_bf16 v[0:3], v[212:215], v[176:179], v[0:3]
    ds_read_b64_tr_b16 v[228:229], v246 offset:12288
    ds_read_b64_tr_b16 v[230:231], v246 offset:14336
    v_mfma_f32_16x16x32_bf16 v[4:7], v[216:219], v[176:179], v[4:7]
    ds_read_b64_tr_b16 v[232:233], v247 offset:12288
    ds_read_b64_tr_b16 v[234:235], v247 offset:14336
    s_waitcnt lgkmcnt(4)
    v_mfma_f32_16x16x32_bf16 v[8:11], v[220:223], v[176:179], v[8:11]
    ds_read_b64_tr_b16 v[236:237], v248 offset:12288
    ds_read_b64_tr_b16 v[238:239], v248 offset:14336
    v_exp_f32 v252, v160
    v_mfma_f32_16x16x32_bf16 v[12:15], v[224:227], v[176:179], v[12:15]
    ds_read_b64_tr_b16 v[240:241], v249 offset:12288
    ds_read_b64_tr_b16 v[242:243], v249 offset:14336
    s_waitcnt lgkmcnt(4)
    v_mfma_f32_16x16x32_bf16 v[16:19], v[228:231], v[176:179], v[16:19]
    ds_read_b64_tr_b16 v[212:213], v246 offset:16384
    ds_read_b64_tr_b16 v[214:215], v246 offset:18432
    v_exp_f32 v253, v161
    v_mfma_f32_16x16x32_bf16 v[200:203], v[208:211], v[176:179], v[200:203]
    ds_read_b64_tr_b16 v[216:217], v247 offset:16384
    v_mfma_f32_16x16x32_bf16 v[20:23], v[232:235], v[176:179], v[20:23]
    ds_read_b64_tr_b16 v[218:219], v247 offset:18432
    v_exp_f32 v254, v162
    s_waitcnt lgkmcnt(4)
    v_mfma_f32_16x16x32_bf16 v[24:27], v[236:239], v[176:179], v[24:27]
    ds_read_b64_tr_b16 v[220:221], v248 offset:16384
    ds_read_b64_tr_b16 v[222:223], v248 offset:18432
    v_mfma_f32_16x16x32_bf16 v[28:31], v[240:243], v[176:179], v[28:31]
    ds_read_b64_tr_b16 v[224:225], v249 offset:16384
    ds_read_b64_tr_b16 v[226:227], v249 offset:18432
    s_barrier
    s_waitcnt lgkmcnt(4)
    v_mfma_f32_16x16x32_bf16 v[32:35], v[212:215], v[176:179], v[32:35]
    ds_read_b128 v[228:231], v244 offset:20480
    v_exp_f32 v255, v163
    v_mfma_f32_16x16x32_bf16 v[36:39], v[216:219], v[176:179], v[36:39]
    ds_read_b128 v[232:235], v244 offset:22528
    s_waitcnt lgkmcnt(2)
    v_mfma_f32_16x16x32_bf16 v[40:43], v[220:223], v[176:179], v[40:43]
    ds_read_b128 v[236:239], v245 offset:20480
    v_cvt_pk_bf16_f32 v184, v252, v253
    v_mfma_f32_16x16x32_bf16 v[44:47], v[224:227], v[176:179], v[44:47]
    ds_read_b128 v[240:243], v245 offset:22528
    v_cvt_pk_bf16_f32 v185, v254, v255
    s_waitcnt lgkmcnt(2)
    v_mfma_f32_16x16x32_bf16 v[144:147], v[228:231], v[96:99], v[192:195]
    ds_read_b128 v[212:215], v244 offset:24576
    v_exp_f32 v252, v164
    v_mfma_f32_16x16x32_bf16 v[148:151], v[232:235], v[96:99], v[192:195]
    ds_read_b128 v[216:219], v244 offset:26624
    s_waitcnt lgkmcnt(2)
    v_mfma_f32_16x16x32_bf16 v[144:147], v[236:239], v[100:103], v[144:147]
    ds_read_b128 v[220:223], v245 offset:24576
    v_exp_f32 v253, v165
    v_mfma_f32_16x16x32_bf16 v[148:151], v[240:243], v[100:103], v[148:151]
    ds_read_b128 v[224:227], v245 offset:26624
    s_waitcnt lgkmcnt(2)
    v_mfma_f32_16x16x32_bf16 v[144:147], v[212:215], v[104:107], v[144:147]
    ds_read_b128 v[228:231], v244 offset:28672
    v_exp_f32 v254, v166
    v_mfma_f32_16x16x32_bf16 v[148:151], v[216:219], v[104:107], v[148:151]
    ds_read_b128 v[232:235], v244 offset:30720
    s_waitcnt lgkmcnt(2)
    v_mfma_f32_16x16x32_bf16 v[144:147], v[220:223], v[108:111], v[144:147]
    ds_read_b128 v[236:239], v245 offset:28672
    v_exp_f32 v255, v167
    v_mfma_f32_16x16x32_bf16 v[148:151], v[224:227], v[108:111], v[148:151]
    ds_read_b128 v[240:243], v245 offset:30720
    v_cvt_pk_bf16_f32 v186, v252, v253
    s_barrier
    s_waitcnt lgkmcnt(2)
    v_mfma_f32_16x16x32_bf16 v[144:147], v[228:231], v[112:115], v[144:147]
    ds_read_b64_tr_b16 v[212:213], v246 offset:32768
    ds_read_b64_tr_b16 v[214:215], v246 offset:34816
    v_cvt_pk_bf16_f32 v187, v254, v255
    v_mfma_f32_16x16x32_bf16 v[148:151], v[232:235], v[112:115], v[148:151]
    ds_read_b64_tr_b16 v[216:217], v247 offset:32768
    ds_read_b64_tr_b16 v[218:219], v247 offset:34816
    v_or3_b32 v251, v184, v185, v186
    s_waitcnt lgkmcnt(4)
    v_mfma_f32_16x16x32_bf16 v[144:147], v[236:239], v[116:119], v[144:147]
    ds_read_b64_tr_b16 v[220:221], v248 offset:32768
    ds_read_b64_tr_b16 v[222:223], v248 offset:34816
    v_bitop3_b32 v251, v251, v187, s68 bitop3:0xa8
    v_mfma_f32_16x16x32_bf16 v[148:151], v[240:243], v[116:119], v[148:151]
    ds_read_b64_tr_b16 v[224:225], v249 offset:32768
    ds_read_b64_tr_b16 v[226:227], v249 offset:34816
    v_cmp_ne_u32 vcc, 0, v251
    s_cbranch_vccz t0_okq3_l
    s_call_b64 s[30:31], t0_rare1_l
t0_okq3_l:
    s_waitcnt lgkmcnt(4)
    v_mfma_f32_16x16x32_bf16 v[0:3], v[212:215], v[184:187], v[0:3]
    ds_read_b64_tr_b16 v[228:229], v246 offset:36864
    ds_read_b64_tr_b16 v[230:231], v246 offset:38912
    v_mfma_f32_16x16x32_bf16 v[4:7], v[216:219], v[184:187], v[4:7]
    ds_read_b64_tr_b16 v[232:233], v247 offset:36864
    ds_read_b64_tr_b16 v[234:235], v247 offset:38912
    s_waitcnt lgkmcnt(4)
    v_mfma_f32_16x16x32_bf16 v[8:11], v[220:223], v[184:187], v[8:11]
    ds_read_b64_tr_b16 v[236:237], v248 offset:36864
    ds_read_b64_tr_b16 v[238:239], v248 offset:38912
    v_exp_f32 v252, v144
    v_mfma_f32_16x16x32_bf16 v[12:15], v[224:227], v[184:187], v[12:15]
    ds_read_b64_tr_b16 v[240:241], v249 offset:36864
    ds_read_b64_tr_b16 v[242:243], v249 offset:38912
    s_waitcnt lgkmcnt(4)
    v_mfma_f32_16x16x32_bf16 v[16:19], v[228:231], v[184:187], v[16:19]
    ds_read_b64_tr_b16 v[212:213], v246 offset:40960
    ds_read_b64_tr_b16 v[214:215], v246 offset:43008
    v_exp_f32 v253, v145
    v_mfma_f32_16x16x32_bf16 v[200:203], v[208:211], v[184:187], v[200:203]
    ds_read_b64_tr_b16 v[216:217], v247 offset:40960
    v_mfma_f32_16x16x32_bf16 v[20:23], v[232:235], v[184:187], v[20:23]
    ds_read_b64_tr_b16 v[218:219], v247 offset:43008
    v_exp_f32 v254, v146
    s_waitcnt lgkmcnt(4)
    v_mfma_f32_16x16x32_bf16 v[24:27], v[236:239], v[184:187], v[24:27]
    ds_read_b64_tr_b16 v[220:221], v248 offset:40960
    ds_read_b64_tr_b16 v[222:223], v248 offset:43008
    v_mfma_f32_16x16x32_bf16 v[28:31], v[240:243], v[184:187], v[28:31]
    ds_read_b64_tr_b16 v[224:225], v249 offset:40960
    ds_read_b64_tr_b16 v[226:227], v249 offset:43008
    s_barrier
    s_waitcnt lgkmcnt(4)
    v_mfma_f32_16x16x32_bf16 v[32:35], v[212:215], v[184:187], v[32:35]
    ds_read_b128 v[228:231], v244 offset:45056
    v_exp_f32 v255, v147
    v_mfma_f32_16x16x32_bf16 v[36:39], v[216:219], v[184:187], v[36:39]
    ds_read_b128 v[232:235], v244 offset:47104
    s_waitcnt lgkmcnt(2)
    v_mfma_f32_16x16x32_bf16 v[40:43], v[220:223], v[184:187], v[40:43]
    ds_read_b128 v[236:239], v245 offset:45056
    v_cvt_pk_bf16_f32 v176, v252, v253
    v_mfma_f32_16x16x32_bf16 v[44:47], v[224:227], v[184:187], v[44:47]
    ds_read_b128 v[240:243], v245 offset:47104
    v_cvt_pk_bf16_f32 v177, v254, v255
    s_waitcnt lgkmcnt(2)
    v_mfma_f32_16x16x32_bf16 v[160:163], v[228:231], v[96:99], v[192:195]
    ds_read_b128 v[212:215], v244 offset:49152
    v_exp_f32 v252, v148
    v_mfma_f32_16x16x32_bf16 v[164:167], v[232:235], v[96:99], v[192:195]
    ds_read_b128 v[216:219], v244 offset:51200
    s_waitcnt lgkmcnt(2)
    v_mfma_f32_16x16x32_bf16 v[160:163], v[236:239], v[100:103], v[160:163]
    ds_read_b128 v[220:223], v245 offset:49152
    v_exp_f32 v253, v149
    v_mfma_f32_16x16x32_bf16 v[164:167], v[240:243], v[100:103], v[164:167]
    ds_read_b128 v[224:227], v245 offset:51200
    s_waitcnt lgkmcnt(2)
    v_mfma_f32_16x16x32_bf16 v[160:163], v[212:215], v[104:107], v[160:163]
    ds_read_b128 v[228:231], v244 offset:53248
    v_exp_f32 v254, v150
    v_mfma_f32_16x16x32_bf16 v[164:167], v[216:219], v[104:107], v[164:167]
    ds_read_b128 v[232:235], v244 offset:55296
    s_waitcnt lgkmcnt(2)
    v_mfma_f32_16x16x32_bf16 v[160:163], v[220:223], v[108:111], v[160:163]
    ds_read_b128 v[236:239], v245 offset:53248
    v_exp_f32 v255, v151
    v_mfma_f32_16x16x32_bf16 v[164:167], v[224:227], v[108:111], v[164:167]
    ds_read_b128 v[240:243], v245 offset:55296
    v_cvt_pk_bf16_f32 v178, v252, v253
    s_barrier
    s_waitcnt lgkmcnt(2)
    v_mfma_f32_16x16x32_bf16 v[160:163], v[228:231], v[112:115], v[160:163]
    ds_read_b64_tr_b16 v[212:213], v246 offset:57344
    ds_read_b64_tr_b16 v[214:215], v246 offset:59392
    v_cvt_pk_bf16_f32 v179, v254, v255
    v_mfma_f32_16x16x32_bf16 v[164:167], v[232:235], v[112:115], v[164:167]
    ds_read_b64_tr_b16 v[216:217], v247 offset:57344
    ds_read_b64_tr_b16 v[218:219], v247 offset:59392
    v_or3_b32 v251, v176, v177, v178
    s_waitcnt lgkmcnt(4)
    v_mfma_f32_16x16x32_bf16 v[160:163], v[236:239], v[116:119], v[160:163]
    ds_read_b64_tr_b16 v[220:221], v248 offset:57344
    ds_read_b64_tr_b16 v[222:223], v248 offset:59392
    v_bitop3_b32 v251, v251, v179, s68 bitop3:0xa8
    v_mfma_f32_16x16x32_bf16 v[164:167], v[240:243], v[116:119], v[164:167]
    ds_read_b64_tr_b16 v[224:225], v249 offset:57344
    ds_read_b64_tr_b16 v[226:227], v249 offset:59392
    v_cmp_ne_u32 vcc, 0, v251
    s_cbranch_vccz t0_okq4_l
    s_call_b64 s[30:31], t0_rare0_l
t0_okq4_l:
    s_waitcnt lgkmcnt(4)
    v_mfma_f32_16x16x32_bf16 v[0:3], v[212:215], v[176:179], v[0:3]
    ds_read_b64_tr_b16 v[228:229], v246 offset:61440
    ds_read_b64_tr_b16 v[230:231], v246 offset:63488
    v_mfma_f32_16x16x32_bf16 v[4:7], v[216:219], v[176:179], v[4:7]
    ds_read_b64_tr_b16 v[232:233], v247 offset:61440
    ds_read_b64_tr_b16 v[234:235], v247 offset:63488
    s_waitcnt lgkmcnt(4)
    v_mfma_f32_16x16x32_bf16 v[8:11], v[220:223], v[176:179], v[8:11]
    ds_read_b64_tr_b16 v[236:237], v248 offset:61440
    ds_read_b64_tr_b16 v[238:239], v248 offset:63488
    v_exp_f32 v252, v160
    v_mfma_f32_16x16x32_bf16 v[12:15], v[224:227], v[176:179], v[12:15]
    ds_read_b64_tr_b16 v[240:241], v249 offset:61440
    ds_read_b64_tr_b16 v[242:243], v249 offset:63488
    s_waitcnt lgkmcnt(4)
    v_mfma_f32_16x16x32_bf16 v[16:19], v[228:231], v[176:179], v[16:19]
    ds_read_b64_tr_b16 v[212:213], v246 offset:0
    ds_read_b64_tr_b16 v[214:215], v246 offset:2048
    v_exp_f32 v253, v161
    v_mfma_f32_16x16x32_bf16 v[200:203], v[208:211], v[176:179], v[200:203]
    ds_read_b64_tr_b16 v[216:217], v247 offset:0
    v_mfma_f32_16x16x32_bf16 v[20:23], v[232:235], v[176:179], v[20:23]
    ds_read_b64_tr_b16 v[218:219], v247 offset:2048
    v_exp_f32 v254, v162
    s_waitcnt lgkmcnt(4)
    v_mfma_f32_16x16x32_bf16 v[24:27], v[236:239], v[176:179], v[24:27]
    ds_read_b64_tr_b16 v[220:221], v248 offset:0
    ds_read_b64_tr_b16 v[222:223], v248 offset:2048
    v_mfma_f32_16x16x32_bf16 v[28:31], v[240:243], v[176:179], v[28:31]
    ds_read_b64_tr_b16 v[224:225], v249 offset:0
    ds_read_b64_tr_b16 v[226:227], v249 offset:2048
    s_waitcnt lgkmcnt(4)
    v_mfma_f32_16x16x32_bf16 v[32:35], v[212:215], v[176:179], v[32:35]
    ds_read_b128 v[228:231], v244 offset:4096
    v_exp_f32 v255, v163
    v_mfma_f32_16x16x32_bf16 v[36:39], v[216:219], v[176:179], v[36:39]
    ds_read_b128 v[232:235], v244 offset:6144
    s_waitcnt lgkmcnt(2)
    v_mfma_f32_16x16x32_bf16 v[40:43], v[220:223], v[176:179], v[40:43]
    ds_read_b128 v[236:239], v245 offset:4096
    v_cvt_pk_bf16_f32 v184, v252, v253
    v_mfma_f32_16x16x32_bf16 v[44:47], v[224:227], v[176:179], v[44:47]
    ds_read_b128 v[240:243], v245 offset:6144
    v_cvt_pk_bf16_f32 v185, v254, v255
    s_barrier
    s_waitcnt lgkmcnt(2)
    v_mfma_f32_16x16x32_bf16 v[144:147], v[228:231], v[96:99], v[192:195]
    ds_read_b128 v[212:215], v244 offset:8192
    v_exp_f32 v252, v164
    v_mfma_f32_16x16x32_bf16 v[148:151], v[232:235], v[96:99], v[192:195]
    ds_read_b128 v[216:219], v244 offset:10240
    s_waitcnt lgkmcnt(2)
    v_mfma_f32_16x16x32_bf16 v[144:147], v[236:239], v[100:103], v[144:147]
    ds_read_b128 v[220:223], v245 offset:8192
    v_exp_f32 v253, v165
    v_mfma_f32_16x16x32_bf16 v[148:151], v[240:243], v[100:103], v[148:151]
    ds_read_b128 v[224:227], v245 offset:10240
    s_waitcnt lgkmcnt(2)
    v_mfma_f32_16x16x32_bf16 v[144:147], v[212:215], v[104:107], v[144:147]
    ds_read_b128 v[228:231], v244 offset:12288
    v_exp_f32 v254, v166
    v_mfma_f32_16x16x32_bf16 v[148:151], v[216:219], v[104:107], v[148:151]
    ds_read_b128 v[232:235], v244 offset:14336
    s_waitcnt lgkmcnt(2)
    v_mfma_f32_16x16x32_bf16 v[144:147], v[220:223], v[108:111], v[144:147]
    ds_read_b128 v[236:239], v245 offset:12288
    v_exp_f32 v255, v167
    v_mfma_f32_16x16x32_bf16 v[148:151], v[224:227], v[108:111], v[148:151]
    ds_read_b128 v[240:243], v245 offset:14336
    v_cvt_pk_bf16_f32 v186, v252, v253
    s_waitcnt lgkmcnt(2)
    v_mfma_f32_16x16x32_bf16 v[144:147], v[228:231], v[112:115], v[144:147]
    ds_read_b64_tr_b16 v[212:213], v246 offset:16384
    ds_read_b64_tr_b16 v[214:215], v246 offset:18432
    v_cvt_pk_bf16_f32 v187, v254, v255
    v_mfma_f32_16x16x32_bf16 v[148:151], v[232:235], v[112:115], v[148:151]
    ds_read_b64_tr_b16 v[216:217], v247 offset:16384
    ds_read_b64_tr_b16 v[218:219], v247 offset:18432
    v_or3_b32 v251, v184, v185, v186
    s_waitcnt lgkmcnt(4)
    v_mfma_f32_16x16x32_bf16 v[144:147], v[236:239], v[116:119], v[144:147]
    ds_read_b64_tr_b16 v[220:221], v248 offset:16384
    ds_read_b64_tr_b16 v[222:223], v248 offset:18432
    v_bitop3_b32 v251, v251, v187, s68 bitop3:0xa8
    v_mfma_f32_16x16x32_bf16 v[148:151], v[240:243], v[116:119], v[148:151]
    ds_read_b64_tr_b16 v[224:225], v249 offset:16384
    ds_read_b64_tr_b16 v[226:227], v249 offset:18432
    v_cmp_ne_u32 vcc, 0, v251
    s_cbranch_vccz t0_okq5_l
    s_call_b64 s[30:31], t0_rare1_l
t0_okq5_l:
    s_barrier
    s_waitcnt lgkmcnt(4)
    v_mfma_f32_16x16x32_bf16 v[0:3], v[212:215], v[184:187], v[0:3]
    ds_read_b64_tr_b16 v[228:229], v246 offset:20480
    ds_read_b64_tr_b16 v[230:231], v246 offset:22528
    v_mfma_f32_16x16x32_bf16 v[4:7], v[216:219], v[184:187], v[4:7]
    ds_read_b64_tr_b16 v[232:233], v247 offset:20480
    ds_read_b64_tr_b16 v[234:235], v247 offset:22528
    s_waitcnt lgkmcnt(4)
    v_mfma_f32_16x16x32_bf16 v[8:11], v[220:223], v[184:187], v[8:11]
    ds_read_b64_tr_b16 v[236:237], v248 offset:20480
    ds_read_b64_tr_b16 v[238:239], v248 offset:22528
    v_exp_f32 v252, v144
    v_mfma_f32_16x16x32_bf16 v[12:15], v[224:227], v[184:187], v[12:15]
    ds_read_b64_tr_b16 v[240:241], v249 offset:20480
    ds_read_b64_tr_b16 v[242:243], v249 offset:22528
    s_waitcnt lgkmcnt(4)
    v_mfma_f32_16x16x32_bf16 v[16:19], v[228:231], v[184:187], v[16:19]
    ds_read_b64_tr_b16 v[212:213], v246 offset:24576
    ds_read_b64_tr_b16 v[214:215], v246 offset:26624
    v_exp_f32 v253, v145
    v_mfma_f32_16x16x32_bf16 v[200:203], v[208:211], v[184:187], v[200:203]
    ds_read_b64_tr_b16 v[216:217], v247 offset:24576
    v_mfma_f32_16x16x32_bf16 v[20:23], v[232:235], v[184:187], v[20:23]
    ds_read_b64_tr_b16 v[218:219], v247 offset:26624
    v_exp_f32 v254, v146
    s_waitcnt lgkmcnt(4)
    v_mfma_f32_16x16x32_bf16 v[24:27], v[236:239], v[184:187], v[24:27]
    ds_read_b64_tr_b16 v[220:221], v248 offset:24576
    ds_read_b64_tr_b16 v[222:223], v248 offset:26624
    v_mfma_f32_16x16x32_bf16 v[28:31], v[240:243], v[184:187], v[28:31]
    ds_read_b64_tr_b16 v[224:225], v249 offset:24576
    ds_read_b64_tr_b16 v[226:227], v249 offset:26624
    s_waitcnt lgkmcnt(4)
    v_mfma_f32_16x16x32_bf16 v[32:35], v[212:215], v[184:187], v[32:35]
    ds_read_b128 v[228:231], v244 offset:28672
    v_exp_f32 v255, v147
    v_mfma_f32_16x16x32_bf16 v[36:39], v[216:219], v[184:187], v[36:39]
    ds_read_b128 v[232:235], v244 offset:30720
    s_waitcnt lgkmcnt(2)
    v_mfma_f32_16x16x32_bf16 v[40:43], v[220:223], v[184:187], v[40:43]
    ds_read_b128 v[236:239], v245 offset:28672
    v_cvt_pk_bf16_f32 v176, v252, v253
    v_mfma_f32_16x16x32_bf16 v[44:47], v[224:227], v[184:187], v[44:47]
    ds_read_b128 v[240:243], v245 offset:30720
    v_cvt_pk_bf16_f32 v177, v254, v255
    s_barrier
    s_waitcnt lgkmcnt(2)
    v_mfma_f32_16x16x32_bf16 v[160:163], v[228:231], v[96:99], v[192:195]
    ds_read_b128 v[212:215], v244 offset:32768
    v_exp_f32 v252, v148
    v_mfma_f32_16x16x32_bf16 v[164:167], v[232:235], v[96:99], v[192:195]
    ds_read_b128 v[216:219], v244 offset:34816
    s_waitcnt lgkmcnt(2)
    v_mfma_f32_16x16x32_bf16 v[160:163], v[236:239], v[100:103], v[160:163]
    ds_read_b128 v[220:223], v245 offset:32768
    v_exp_f32 v253, v149
    v_mfma_f32_16x16x32_bf16 v[164:167], v[240:243], v[100:103], v[164:167]
    ds_read_b128 v[224:227], v245 offset:34816
    s_waitcnt lgkmcnt(2)
    v_mfma_f32_16x16x32_bf16 v[160:163], v[212:215], v[104:107], v[160:163]
    ds_read_b128 v[228:231], v244 offset:36864
    v_exp_f32 v254, v150
    v_mfma_f32_16x16x32_bf16 v[164:167], v[216:219], v[104:107], v[164:167]
    ds_read_b128 v[232:235], v244 offset:38912
    s_waitcnt lgkmcnt(2)
    v_mfma_f32_16x16x32_bf16 v[160:163], v[220:223], v[108:111], v[160:163]
    ds_read_b128 v[236:239], v245 offset:36864
    v_exp_f32 v255, v151
    v_mfma_f32_16x16x32_bf16 v[164:167], v[224:227], v[108:111], v[164:167]
    ds_read_b128 v[240:243], v245 offset:38912
    v_cvt_pk_bf16_f32 v178, v252, v253
    s_waitcnt lgkmcnt(2)
    v_mfma_f32_16x16x32_bf16 v[160:163], v[228:231], v[112:115], v[160:163]
    ds_read_b64_tr_b16 v[212:213], v246 offset:40960
    ds_read_b64_tr_b16 v[214:215], v246 offset:43008
    v_cvt_pk_bf16_f32 v179, v254, v255
    v_mfma_f32_16x16x32_bf16 v[164:167], v[232:235], v[112:115], v[164:167]
    ds_read_b64_tr_b16 v[216:217], v247 offset:40960
    ds_read_b64_tr_b16 v[218:219], v247 offset:43008
    v_or3_b32 v251, v176, v177, v178
    s_waitcnt lgkmcnt(4)
    v_mfma_f32_16x16x32_bf16 v[160:163], v[236:239], v[116:119], v[160:163]
    ds_read_b64_tr_b16 v[220:221], v248 offset:40960
    ds_read_b64_tr_b16 v[222:223], v248 offset:43008
    v_bitop3_b32 v251, v251, v179, s68 bitop3:0xa8
    v_mfma_f32_16x16x32_bf16 v[164:167], v[240:243], v[116:119], v[164:167]
    ds_read_b64_tr_b16 v[224:225], v249 offset:40960
    ds_read_b64_tr_b16 v[226:227], v249 offset:43008
    v_cmp_ne_u32 vcc, 0, v251
    s_cbranch_vccz t0_okq6_l
    s_call_b64 s[30:31], t0_rare0_l
t0_okq6_l:
    s_barrier
    s_waitcnt lgkmcnt(4)
    v_mfma_f32_16x16x32_bf16 v[0:3], v[212:215], v[176:179], v[0:3]
    ds_read_b64_tr_b16 v[228:229], v246 offset:45056
    ds_read_b64_tr_b16 v[230:231], v246 offset:47104
    v_mfma_f32_16x16x32_bf16 v[4:7], v[216:219], v[176:179], v[4:7]
    ds_read_b64_tr_b16 v[232:233], v247 offset:45056
    ds_read_b64_tr_b16 v[234:235], v247 offset:47104
    s_waitcnt lgkmcnt(4)
    v_mfma_f32_16x16x32_bf16 v[8:11], v[220:223], v[176:179], v[8:11]
    ds_read_b64_tr_b16 v[236:237], v248 offset:45056
    ds_read_b64_tr_b16 v[238:239], v248 offset:47104
    v_exp_f32 v252, v160
    v_mfma_f32_16x16x32_bf16 v[12:15], v[224:227], v[176:179], v[12:15]
    ds_read_b64_tr_b16 v[240:241], v249 offset:45056
    ds_read_b64_tr_b16 v[242:243], v249 offset:47104
    s_waitcnt lgkmcnt(4)
    v_mfma_f32_16x16x32_bf16 v[16:19], v[228:231], v[176:179], v[16:19]
    ds_read_b64_tr_b16 v[212:213], v246 offset:49152
    ds_read_b64_tr_b16 v[214:215], v246 offset:51200
    v_exp_f32 v253, v161
    v_mfma_f32_16x16x32_bf16 v[200:203], v[208:211], v[176:179], v[200:203]
    ds_read_b64_tr_b16 v[216:217], v247 offset:49152
    v_mfma_f32_16x16x32_bf16 v[20:23], v[232:235], v[176:179], v[20:23]
    ds_read_b64_tr_b16 v[218:219], v247 offset:51200
    v_exp_f32 v254, v162
    s_waitcnt lgkmcnt(4)
    v_mfma_f32_16x16x32_bf16 v[24:27], v[236:239], v[176:179], v[24:27]
    ds_read_b64_tr_b16 v[220:221], v248 offset:49152
    ds_read_b64_tr_b16 v[222:223], v248 offset:51200
    v_mfma_f32_16x16x32_bf16 v[28:31], v[240:243], v[176:179], v[28:31]
    ds_read_b64_tr_b16 v[224:225], v249 offset:49152
    ds_read_b64_tr_b16 v[226:227], v249 offset:51200
    s_waitcnt lgkmcnt(4)
    v_mfma_f32_16x16x32_bf16 v[32:35], v[212:215], v[176:179], v[32:35]
    ds_read_b128 v[228:231], v244 offset:53248
    v_exp_f32 v255, v163
    v_mfma_f32_16x16x32_bf16 v[36:39], v[216:219], v[176:179], v[36:39]
    ds_read_b128 v[232:235], v244 offset:55296
    s_waitcnt lgkmcnt(2)
    v_mfma_f32_16x16x32_bf16 v[40:43], v[220:223], v[176:179], v[40:43]
    ds_read_b128 v[236:239], v245 offset:53248
    v_cvt_pk_bf16_f32 v184, v252, v253
    v_mfma_f32_16x16x32_bf16 v[44:47], v[224:227], v[176:179], v[44:47]
    ds_read_b128 v[240:243], v245 offset:55296
    v_cvt_pk_bf16_f32 v185, v254, v255
    s_barrier
    s_waitcnt lgkmcnt(2)
    v_mfma_f32_16x16x32_bf16 v[144:147], v[228:231], v[96:99], v[192:195]
    ds_read_b128 v[212:215], v244 offset:57344
    v_exp_f32 v252, v164
    v_mfma_f32_16x16x32_bf16 v[148:151], v[232:235], v[96:99], v[192:195]
    ds_read_b128 v[216:219], v244 offset:59392
    s_waitcnt lgkmcnt(2)
    v_mfma_f32_16x16x32_bf16 v[144:147], v[236:239], v[100:103], v[144:147]
    ds_read_b128 v[220:223], v245 offset:57344
    v_exp_f32 v253, v165
    v_mfma_f32_16x16x32_bf16 v[148:151], v[240:243], v[100:103], v[148:151]
    ds_read_b128 v[224:227], v245 offset:59392
    s_waitcnt lgkmcnt(2)
    v_mfma_f32_16x16x32_bf16 v[144:147], v[212:215], v[104:107], v[144:147]
    ds_read_b128 v[228:231], v244 offset:61440
    v_exp_f32 v254, v166
    v_mfma_f32_16x16x32_bf16 v[148:151], v[216:219], v[104:107], v[148:151]
    ds_read_b128 v[232:235], v244 offset:63488
    s_waitcnt lgkmcnt(2)
    v_mfma_f32_16x16x32_bf16 v[144:147], v[220:223], v[108:111], v[144:147]
    ds_read_b128 v[236:239], v245 offset:61440
    v_exp_f32 v255, v167
    v_mfma_f32_16x16x32_bf16 v[148:151], v[224:227], v[108:111], v[148:151]
    ds_read_b128 v[240:243], v245 offset:63488
    v_cvt_pk_bf16_f32 v186, v252, v253
    s_waitcnt lgkmcnt(2)
    v_mfma_f32_16x16x32_bf16 v[144:147], v[228:231], v[112:115], v[144:147]
    ds_read_b64_tr_b16 v[212:213], v246 offset:0
    ds_read_b64_tr_b16 v[214:215], v246 offset:2048
    v_cvt_pk_bf16_f32 v187, v254, v255
    v_mfma_f32_16x16x32_bf16 v[148:151], v[232:235], v[112:115], v[148:151]
    ds_read_b64_tr_b16 v[216:217], v247 offset:0
    ds_read_b64_tr_b16 v[218:219], v247 offset:2048
    v_or3_b32 v251, v184, v185, v186
    s_waitcnt lgkmcnt(4)
    v_mfma_f32_16x16x32_bf16 v[144:147], v[236:239], v[116:119], v[144:147]
    ds_read_b64_tr_b16 v[220:221], v248 offset:0
    ds_read_b64_tr_b16 v[222:223], v248 offset:2048
    v_bitop3_b32 v251, v251, v187, s68 bitop3:0xa8
    v_mfma_f32_16x16x32_bf16 v[148:151], v[240:243], v[116:119], v[148:151]
    ds_read_b64_tr_b16 v[224:225], v249 offset:0
    ds_read_b64_tr_b16 v[226:227], v249 offset:2048
    v_cmp_ne_u32 vcc, 0, v251
    s_cbranch_vccz t0_okq7_l
    s_call_b64 s[30:31], t0_rare1_l
t0_okq7_l:
    s_waitcnt lgkmcnt(4)
    v_mfma_f32_16x16x32_bf16 v[0:3], v[212:215], v[184:187], v[0:3]
    ds_read_b64_tr_b16 v[228:229], v246 offset:4096
    ds_read_b64_tr_b16 v[230:231], v246 offset:6144
    v_mfma_f32_16x16x32_bf16 v[4:7], v[216:219], v[184:187], v[4:7]
    ds_read_b64_tr_b16 v[232:233], v247 offset:4096
    ds_read_b64_tr_b16 v[234:235], v247 offset:6144
    s_waitcnt lgkmcnt(4)
    v_mfma_f32_16x16x32_bf16 v[8:11], v[220:223], v[184:187], v[8:11]
    ds_read_b64_tr_b16 v[236:237], v248 offset:4096
    ds_read_b64_tr_b16 v[238:239], v248 offset:6144
    v_exp_f32 v252, v144
    v_mfma_f32_16x16x32_bf16 v[12:15], v[224:227], v[184:187], v[12:15]
    ds_read_b64_tr_b16 v[240:241], v249 offset:4096
    ds_read_b64_tr_b16 v[242:243], v249 offset:6144
    s_barrier
    s_waitcnt lgkmcnt(4)
    v_mfma_f32_16x16x32_bf16 v[16:19], v[228:231], v[184:187], v[16:19]
    ds_read_b64_tr_b16 v[212:213], v246 offset:8192
    ds_read_b64_tr_b16 v[214:215], v246 offset:10240
    v_exp_f32 v253, v145
    v_mfma_f32_16x16x32_bf16 v[200:203], v[208:211], v[184:187], v[200:203]
    ds_read_b64_tr_b16 v[216:217], v247 offset:8192
    v_mfma_f32_16x16x32_bf16 v[20:23], v[232:235], v[184:187], v[20:23]
    ds_read_b64_tr_b16 v[218:219], v247 offset:10240
    v_exp_f32 v254, v146
    s_waitcnt lgkmcnt(4)
    v_mfma_f32_16x16x32_bf16 v[24:27], v[236:239], v[184:187], v[24:27]
    ds_read_b64_tr_b16 v[220:221], v248 offset:8192
    ds_read_b64_tr_b16 v[222:223], v248 offset:10240
    v_mfma_f32_16x16x32_bf16 v[28:31], v[240:243], v[184:187], v[28:31]
    ds_read_b64_tr_b16 v[224:225], v249 offset:8192
    ds_read_b64_tr_b16 v[226:227], v249 offset:10240
    s_waitcnt lgkmcnt(4)
    v_mfma_f32_16x16x32_bf16 v[32:35], v[212:215], v[184:187], v[32:35]
    ds_read_b128 v[228:231], v244 offset:12288
    v_exp_f32 v255, v147
    v_mfma_f32_16x16x32_bf16 v[36:39], v[216:219], v[184:187], v[36:39]
    ds_read_b128 v[232:235], v244 offset:14336
    s_waitcnt lgkmcnt(2)
    v_mfma_f32_16x16x32_bf16 v[40:43], v[220:223], v[184:187], v[40:43]
    ds_read_b128 v[236:239], v245 offset:12288
    v_cvt_pk_bf16_f32 v176, v252, v253
    v_mfma_f32_16x16x32_bf16 v[44:47], v[224:227], v[184:187], v[44:47]
    ds_read_b128 v[240:243], v245 offset:14336
    v_cvt_pk_bf16_f32 v177, v254, v255
    s_waitcnt lgkmcnt(2)
    v_mfma_f32_16x16x32_bf16 v[160:163], v[228:231], v[96:99], v[192:195]
    ds_read_b128 v[212:215], v244 offset:16384
    v_exp_f32 v252, v148
    v_mfma_f32_16x16x32_bf16 v[164:167], v[232:235], v[96:99], v[192:195]
    ds_read_b128 v[216:219], v244 offset:18432
    s_waitcnt lgkmcnt(2)
    v_mfma_f32_16x16x32_bf16 v[160:163], v[236:239], v[100:103], v[160:163]
    ds_read_b128 v[220:223], v245 offset:16384
    v_exp_f32 v253, v149
    v_mfma_f32_16x16x32_bf16 v[164:167], v[240:243], v[100:103], v[164:167]
    ds_read_b128 v[224:227], v245 offset:18432
    s_barrier
    s_waitcnt lgkmcnt(2)
    v_mfma_f32_16x16x32_bf16 v[160:163], v[212:215], v[104:107], v[160:163]
    ds_read_b128 v[228:231], v244 offset:20480
    v_exp_f32 v254, v150
    v_mfma_f32_16x16x32_bf16 v[164:167], v[216:219], v[104:107], v[164:167]
    ds_read_b128 v[232:235], v244 offset:22528
    s_waitcnt lgkmcnt(2)
    v_mfma_f32_16x16x32_bf16 v[160:163], v[220:223], v[108:111], v[160:163]
    ds_read_b128 v[236:239], v245 offset:20480
    v_exp_f32 v255, v151
    v_mfma_f32_16x16x32_bf16 v[164:167], v[224:227], v[108:111], v[164:167]
    ds_read_b128 v[240:243], v245 offset:22528
    v_cvt_pk_bf16_f32 v178, v252, v253
    s_waitcnt lgkmcnt(2)
    v_mfma_f32_16x16x32_bf16 v[160:163], v[228:231], v[112:115], v[160:163]
    ds_read_b64_tr_b16 v[212:213], v246 offset:24576
    ds_read_b64_tr_b16 v[214:215], v246 offset:26624
    v_cvt_pk_bf16_f32 v179, v254, v255
    v_mfma_f32_16x16x32_bf16 v[164:167], v[232:235], v[112:115], v[164:167]
    ds_read_b64_tr_b16 v[216:217], v247 offset:24576
    ds_read_b64_tr_b16 v[218:219], v247 offset:26624
    v_or3_b32 v251, v176, v177, v178
    s_waitcnt lgkmcnt(4)
    v_mfma_f32_16x16x32_bf16 v[160:163], v[236:239], v[116:119], v[160:163]
    ds_read_b64_tr_b16 v[220:221], v248 offset:24576
    ds_read_b64_tr_b16 v[222:223], v248 offset:26624
    v_bitop3_b32 v251, v251, v179, s68 bitop3:0xa8
    v_mfma_f32_16x16x32_bf16 v[164:167], v[240:243], v[116:119], v[164:167]
    ds_read_b64_tr_b16 v[224:225], v249 offset:24576
    ds_read_b64_tr_b16 v[226:227], v249 offset:26624
    v_cmp_ne_u32 vcc, 0, v251
    s_cbranch_vccz t0_okq8_l
    s_call_b64 s[30:31], t0_rare0_l
t0_okq8_l:
    s_waitcnt lgkmcnt(4)
    v_mfma_f32_16x16x32_bf16 v[0:3], v[212:215], v[176:179], v[0:3]
    ds_read_b64_tr_b16 v[228:229], v246 offset:28672
    ds_read_b64_tr_b16 v[230:231], v246 offset:30720
    v_mfma_f32_16x16x32_bf16 v[4:7], v[216:219], v[176:179], v[4:7]
    ds_read_b64_tr_b16 v[232:233], v247 offset:28672
    ds_read_b64_tr_b16 v[234:235], v247 offset:30720
    s_waitcnt lgkmcnt(4)
    v_mfma_f32_16x16x32_bf16 v[8:11], v[220:223], v[176:179], v[8:11]
    ds_read_b64_tr_b16 v[236:237], v248 offset:28672
    ds_read_b64_tr_b16 v[238:239], v248 offset:30720
    v_exp_f32 v252, v160
    v_mfma_f32_16x16x32_bf16 v[12:15], v[224:227], v[176:179], v[12:15]
    ds_read_b64_tr_b16 v[240:241], v249 offset:28672
    ds_read_b64_tr_b16 v[242:243], v249 offset:30720
    s_barrier
    s_waitcnt lgkmcnt(4)
    v_mfma_f32_16x16x32_bf16 v[16:19], v[228:231], v[176:179], v[16:19]
    ds_read_b64_tr_b16 v[212:213], v246 offset:32768
    ds_read_b64_tr_b16 v[214:215], v246 offset:34816
    v_exp_f32 v253, v161
    v_mfma_f32_16x16x32_bf16 v[200:203], v[208:211], v[176:179], v[200:203]
    ds_read_b64_tr_b16 v[216:217], v247 offset:32768
    v_mfma_f32_16x16x32_bf16 v[20:23], v[232:235], v[176:179], v[20:23]
    ds_read_b64_tr_b16 v[218:219], v247 offset:34816
    v_exp_f32 v254, v162
    s_waitcnt lgkmcnt(4)
    v_mfma_f32_16x16x32_bf16 v[24:27], v[236:239], v[176:179], v[24:27]
    ds_read_b64_tr_b16 v[220:221], v248 offset:32768
    ds_read_b64_tr_b16 v[222:223], v248 offset:34816
    v_mfma_f32_16x16x32_bf16 v[28:31], v[240:243], v[176:179], v[28:31]
    ds_read_b64_tr_b16 v[224:225], v249 offset:32768
    ds_read_b64_tr_b16 v[226:227], v249 offset:34816
    s_waitcnt lgkmcnt(4)
    v_mfma_f32_16x16x32_bf16 v[32:35], v[212:215], v[176:179], v[32:35]
    ds_read_b128 v[228:231], v244 offset:36864
    v_exp_f32 v255, v163
    v_mfma_f32_16x16x32_bf16 v[36:39], v[216:219], v[176:179], v[36:39]
    ds_read_b128 v[232:235], v244 offset:38912
    s_waitcnt lgkmcnt(2)
    v_mfma_f32_16x16x32_bf16 v[40:43], v[220:223], v[176:179], v[40:43]
    ds_read_b128 v[236:239], v245 offset:36864
    v_cvt_pk_bf16_f32 v184, v252, v253
    v_mfma_f32_16x16x32_bf16 v[44:47], v[224:227], v[176:179], v[44:47]
    ds_read_b128 v[240:243], v245 offset:38912
    v_cvt_pk_bf16_f32 v185, v254, v255
    s_waitcnt lgkmcnt(2)
    v_mfma_f32_16x16x32_bf16 v[144:147], v[228:231], v[96:99], v[192:195]
    ds_read_b128 v[212:215], v244 offset:40960
    v_exp_f32 v252, v164
    v_mfma_f32_16x16x32_bf16 v[148:151], v[232:235], v[96:99], v[192:195]
    ds_read_b128 v[216:219], v244 offset:43008
    s_waitcnt lgkmcnt(2)
    v_mfma_f32_16x16x32_bf16 v[144:147], v[236:239], v[100:103], v[144:147]
    ds_read_b128 v[220:223], v245 offset:40960
    v_exp_f32 v253, v165
    v_mfma_f32_16x16x32_bf16 v[148:151], v[240:243], v[100:103], v[148:151]
    ds_read_b128 v[224:227], v245 offset:43008
    s_barrier
    s_waitcnt lgkmcnt(2)
    v_mfma_f32_16x16x32_bf16 v[144:147], v[212:215], v[104:107], v[144:147]
    ds_read_b128 v[228:231], v244 offset:45056
    v_exp_f32 v254, v166
    v_mfma_f32_16x16x32_bf16 v[148:151], v[216:219], v[104:107], v[148:151]
    ds_read_b128 v[232:235], v244 offset:47104
    s_waitcnt lgkmcnt(2)
    v_mfma_f32_16x16x32_bf16 v[144:147], v[220:223], v[108:111], v[144:147]
    ds_read_b128 v[236:239], v245 offset:45056
    v_exp_f32 v255, v167
    v_mfma_f32_16x16x32_bf16 v[148:151], v[224:227], v[108:111], v[148:151]
    ds_read_b128 v[240:243], v245 offset:47104
    v_cvt_pk_bf16_f32 v186, v252, v253
    s_waitcnt lgkmcnt(2)
    v_mfma_f32_16x16x32_bf16 v[144:147], v[228:231], v[112:115], v[144:147]
    ds_read_b64_tr_b16 v[212:213], v246 offset:49152
    ds_read_b64_tr_b16 v[214:215], v246 offset:51200
    v_cvt_pk_bf16_f32 v187, v254, v255
    v_mfma_f32_16x16x32_bf16 v[148:151], v[232:235], v[112:115], v[148:151]
    ds_read_b64_tr_b16 v[216:217], v247 offset:49152
    ds_read_b64_tr_b16 v[218:219], v247 offset:51200
    v_or3_b32 v251, v184, v185, v186
    s_waitcnt lgkmcnt(4)
    v_mfma_f32_16x16x32_bf16 v[144:147], v[236:239], v[116:119], v[144:147]
    ds_read_b64_tr_b16 v[220:221], v248 offset:49152
    ds_read_b64_tr_b16 v[222:223], v248 offset:51200
    v_bitop3_b32 v251, v251, v187, s68 bitop3:0xa8
    v_mfma_f32_16x16x32_bf16 v[148:151], v[240:243], v[116:119], v[148:151]
    ds_read_b64_tr_b16 v[224:225], v249 offset:49152
    ds_read_b64_tr_b16 v[226:227], v249 offset:51200
    v_cmp_ne_u32 vcc, 0, v251
    s_cbranch_vccz t0_okq9_l
    s_call_b64 s[30:31], t0_rare1_l
t0_okq9_l:
    s_waitcnt lgkmcnt(4)
    v_mfma_f32_16x16x32_bf16 v[0:3], v[212:215], v[184:187], v[0:3]
    ds_read_b64_tr_b16 v[228:229], v246 offset:53248
    ds_read_b64_tr_b16 v[230:231], v246 offset:55296
    v_mfma_f32_16x16x32_bf16 v[4:7], v[216:219], v[184:187], v[4:7]
    ds_read_b64_tr_b16 v[232:233], v247 offset:53248
    ds_read_b64_tr_b16 v[234:235], v247 offset:55296
    s_waitcnt lgkmcnt(4)
    v_mfma_f32_16x16x32_bf16 v[8:11], v[220:223], v[184:187], v[8:11]
    ds_read_b64_tr_b16 v[236:237], v248 offset:53248
    ds_read_b64_tr_b16 v[238:239], v248 offset:55296
    v_exp_f32 v252, v144
    v_mfma_f32_16x16x32_bf16 v[12:15], v[224:227], v[184:187], v[12:15]
    ds_read_b64_tr_b16 v[240:241], v249 offset:53248
    ds_read_b64_tr_b16 v[242:243], v249 offset:55296
    s_barrier
    s_waitcnt lgkmcnt(4)
    v_mfma_f32_16x16x32_bf16 v[16:19], v[228:231], v[184:187], v[16:19]
    ds_read_b64_tr_b16 v[212:213], v246 offset:57344
    ds_read_b64_tr_b16 v[214:215], v246 offset:59392
    v_exp_f32 v253, v145
    v_mfma_f32_16x16x32_bf16 v[200:203], v[208:211], v[184:187], v[200:203]
    ds_read_b64_tr_b16 v[216:217], v247 offset:57344
    v_mfma_f32_16x16x32_bf16 v[20:23], v[232:235], v[184:187], v[20:23]
    ds_read_b64_tr_b16 v[218:219], v247 offset:59392
    v_exp_f32 v254, v146
    s_waitcnt lgkmcnt(4)
    v_mfma_f32_16x16x32_bf16 v[24:27], v[236:239], v[184:187], v[24:27]
    ds_read_b64_tr_b16 v[220:221], v248 offset:57344
    ds_read_b64_tr_b16 v[222:223], v248 offset:59392
    v_mfma_f32_16x16x32_bf16 v[28:31], v[240:243], v[184:187], v[28:31]
    ds_read_b64_tr_b16 v[224:225], v249 offset:57344
    ds_read_b64_tr_b16 v[226:227], v249 offset:59392
    s_waitcnt lgkmcnt(4)
    v_mfma_f32_16x16x32_bf16 v[32:35], v[212:215], v[184:187], v[32:35]
    ds_read_b128 v[228:231], v244 offset:61440
    v_exp_f32 v255, v147
    v_mfma_f32_16x16x32_bf16 v[36:39], v[216:219], v[184:187], v[36:39]
    ds_read_b128 v[232:235], v244 offset:63488
    s_waitcnt lgkmcnt(2)
    v_mfma_f32_16x16x32_bf16 v[40:43], v[220:223], v[184:187], v[40:43]
    ds_read_b128 v[236:239], v245 offset:61440
    v_cvt_pk_bf16_f32 v176, v252, v253
    v_mfma_f32_16x16x32_bf16 v[44:47], v[224:227], v[184:187], v[44:47]
    ds_read_b128 v[240:243], v245 offset:63488
    v_cvt_pk_bf16_f32 v177, v254, v255
    s_waitcnt lgkmcnt(2)
    v_mfma_f32_16x16x32_bf16 v[160:163], v[228:231], v[96:99], v[192:195]
    ds_read_b128 v[212:215], v244 offset:0
    v_exp_f32 v252, v148
    v_mfma_f32_16x16x32_bf16 v[164:167], v[232:235], v[96:99], v[192:195]
    ds_read_b128 v[216:219], v244 offset:2048
    s_waitcnt lgkmcnt(2)
    v_mfma_f32_16x16x32_bf16 v[160:163], v[236:239], v[100:103], v[160:163]
    ds_read_b128 v[220:223], v245 offset:0
    v_exp_f32 v253, v149
    v_mfma_f32_16x16x32_bf16 v[164:167], v[240:243], v[100:103], v[164:167]
    ds_read_b128 v[224:227], v245 offset:2048
    s_waitcnt lgkmcnt(2)
    v_mfma_f32_16x16x32_bf16 v[160:163], v[212:215], v[104:107], v[160:163]
    ds_read_b128 v[228:231], v244 offset:4096
    v_exp_f32 v254, v150
    v_mfma_f32_16x16x32_bf16 v[164:167], v[216:219], v[104:107], v[164:167]
    ds_read_b128 v[232:235], v244 offset:6144
    s_waitcnt lgkmcnt(2)
    v_mfma_f32_16x16x32_bf16 v[160:163], v[220:223], v[108:111], v[160:163]
    ds_read_b128 v[236:239], v245 offset:4096
    v_exp_f32 v255, v151
    v_mfma_f32_16x16x32_bf16 v[164:167], v[224:227], v[108:111], v[164:167]
    ds_read_b128 v[240:243], v245 offset:6144
    v_cvt_pk_bf16_f32 v178, v252, v253
    s_barrier
    s_waitcnt lgkmcnt(2)
    v_mfma_f32_16x16x32_bf16 v[160:163], v[228:231], v[112:115], v[160:163]
    ds_read_b64_tr_b16 v[212:213], v246 offset:8192
    ds_read_b64_tr_b16 v[214:215], v246 offset:10240
    v_cvt_pk_bf16_f32 v179, v254, v255
    v_mfma_f32_16x16x32_bf16 v[164:167], v[232:235], v[112:115], v[164:167]
    ds_read_b64_tr_b16 v[216:217], v247 offset:8192
    ds_read_b64_tr_b16 v[218:219], v247 offset:10240
    v_or3_b32 v251, v176, v177, v178
    s_waitcnt lgkmcnt(4)
    v_mfma_f32_16x16x32_bf16 v[160:163], v[236:239], v[116:119], v[160:163]
    ds_read_b64_tr_b16 v[220:221], v248 offset:8192
    ds_read_b64_tr_b16 v[222:223], v248 offset:10240
    v_bitop3_b32 v251, v251, v179, s68 bitop3:0xa8
    v_mfma_f32_16x16x32_bf16 v[164:167], v[240:243], v[116:119], v[164:167]
    ds_read_b64_tr_b16 v[224:225], v249 offset:8192
    ds_read_b64_tr_b16 v[226:227], v249 offset:10240
    v_cmp_ne_u32 vcc, 0, v251
    s_cbranch_vccz t0_okq10_l
    s_call_b64 s[30:31], t0_rare0_l
t0_okq10_l:
    s_waitcnt lgkmcnt(4)
    v_mfma_f32_16x16x32_bf16 v[0:3], v[212:215], v[176:179], v[0:3]
    ds_read_b64_tr_b16 v[228:229], v246 offset:12288
    ds_read_b64_tr_b16 v[230:231], v246 offset:14336
    v_mfma_f32_16x16x32_bf16 v[4:7], v[216:219], v[176:179], v[4:7]
    ds_read_b64_tr_b16 v[232:233], v247 offset:12288
    ds_read_b64_tr_b16 v[234:235], v247 offset:14336
    s_waitcnt lgkmcnt(4)
    v_mfma_f32_16x16x32_bf16 v[8:11], v[220:223], v[176:179], v[8:11]
    ds_read_b64_tr_b16 v[236:237], v248 offset:12288
    ds_read_b64_tr_b16 v[238:239], v248 offset:14336
    v_exp_f32 v252, v160
    v_mfma_f32_16x16x32_bf16 v[12:15], v[224:227], v[176:179], v[12:15]
    ds_read_b64_tr_b16 v[240:241], v249 offset:12288
    ds_read_b64_tr_b16 v[242:243], v249 offset:14336
    s_waitcnt lgkmcnt(4)
    v_mfma_f32_16x16x32_bf16 v[16:19], v[228:231], v[176:179], v[16:19]
    ds_read_b64_tr_b16 v[212:213], v246 offset:16384
    ds_read_b64_tr_b16 v[214:215], v246 offset:18432
    v_exp_f32 v253, v161
    v_mfma_f32_16x16x32_bf16 v[200:203], v[208:211], v[176:179], v[200:203]
    ds_read_b64_tr_b16 v[216:217], v247 offset:16384
    v_mfma_f32_16x16x32_bf16 v[20:23], v[232:235], v[176:179], v[20:23]
    ds_read_b64_tr_b16 v[218:219], v247 offset:18432
    v_exp_f32 v254, v162
    s_waitcnt lgkmcnt(4)
    v_mfma_f32_16x16x32_bf16 v[24:27], v[236:239], v[176:179], v[24:27]
    ds_read_b64_tr_b16 v[220:221], v248 offset:16384
    ds_read_b64_tr_b16 v[222:223], v248 offset:18432
    v_mfma_f32_16x16x32_bf16 v[28:31], v[240:243], v[176:179], v[28:31]
    ds_read_b64_tr_b16 v[224:225], v249 offset:16384
    ds_read_b64_tr_b16 v[226:227], v249 offset:18432
    s_barrier
    s_waitcnt lgkmcnt(4)
    v_mfma_f32_16x16x32_bf16 v[32:35], v[212:215], v[176:179], v[32:35]
    ds_read_b128 v[228:231], v244 offset:20480
    v_exp_f32 v255, v163
    v_mfma_f32_16x16x32_bf16 v[36:39], v[216:219], v[176:179], v[36:39]
    ds_read_b128 v[232:235], v244 offset:22528
    s_waitcnt lgkmcnt(2)
    v_mfma_f32_16x16x32_bf16 v[40:43], v[220:223], v[176:179], v[40:43]
    ds_read_b128 v[236:239], v245 offset:20480
    v_cvt_pk_bf16_f32 v184, v252, v253
    v_mfma_f32_16x16x32_bf16 v[44:47], v[224:227], v[176:179], v[44:47]
    ds_read_b128 v[240:243], v245 offset:22528
    v_cvt_pk_bf16_f32 v185, v254, v255
    s_waitcnt lgkmcnt(2)
    v_mfma_f32_16x16x32_bf16 v[144:147], v[228:231], v[96:99], v[192:195]
    ds_read_b128 v[212:215], v244 offset:24576
    v_exp_f32 v252, v164
    v_mfma_f32_16x16x32_bf16 v[148:151], v[232:235], v[96:99], v[192:195]
    ds_read_b128 v[216:219], v244 offset:26624
    s_waitcnt lgkmcnt(2)
    v_mfma_f32_16x16x32_bf16 v[144:147], v[236:239], v[100:103], v[144:147]
    ds_read_b128 v[220:223], v245 offset:24576
    v_exp_f32 v253, v165
    v_mfma_f32_16x16x32_bf16 v[148:151], v[240:243], v[100:103], v[148:151]
    ds_read_b128 v[224:227], v245 offset:26624
    s_waitcnt lgkmcnt(2)
    v_mfma_f32_16x16x32_bf16 v[144:147], v[212:215], v[104:107], v[144:147]
    ds_read_b128 v[228:231], v244 offset:28672
    v_exp_f32 v254, v166
    v_mfma_f32_16x16x32_bf16 v[148:151], v[216:219], v[104:107], v[148:151]
    ds_read_b128 v[232:235], v244 offset:30720
    s_waitcnt lgkmcnt(2)
    v_mfma_f32_16x16x32_bf16 v[144:147], v[220:223], v[108:111], v[144:147]
    ds_read_b128 v[236:239], v245 offset:28672
    v_exp_f32 v255, v167
    v_mfma_f32_16x16x32_bf16 v[148:151], v[224:227], v[108:111], v[148:151]
    ds_read_b128 v[240:243], v245 offset:30720
    v_cvt_pk_bf16_f32 v186, v252, v253
    s_barrier
    s_waitcnt lgkmcnt(2)
    v_mfma_f32_16x16x32_bf16 v[144:147], v[228:231], v[112:115], v[144:147]
    ds_read_b64_tr_b16 v[212:213], v246 offset:32768
    ds_read_b64_tr_b16 v[214:215], v246 offset:34816
    v_cvt_pk_bf16_f32 v187, v254, v255
    v_mfma_f32_16x16x32_bf16 v[148:151], v[232:235], v[112:115], v[148:151]
    ds_read_b64_tr_b16 v[216:217], v247 offset:32768
    ds_read_b64_tr_b16 v[218:219], v247 offset:34816
    v_or3_b32 v251, v184, v185, v186
    s_waitcnt lgkmcnt(4)
    v_mfma_f32_16x16x32_bf16 v[144:147], v[236:239], v[116:119], v[144:147]
    ds_read_b64_tr_b16 v[220:221], v248 offset:32768
    ds_read_b64_tr_b16 v[222:223], v248 offset:34816
    v_bitop3_b32 v251, v251, v187, s68 bitop3:0xa8
    v_mfma_f32_16x16x32_bf16 v[148:151], v[240:243], v[116:119], v[148:151]
    ds_read_b64_tr_b16 v[224:225], v249 offset:32768
    ds_read_b64_tr_b16 v[226:227], v249 offset:34816
    v_cmp_ne_u32 vcc, 0, v251
    s_cbranch_vccz t0_okq11_l
    s_call_b64 s[30:31], t0_rare1_l
t0_okq11_l:
    s_waitcnt lgkmcnt(4)
    v_mfma_f32_16x16x32_bf16 v[0:3], v[212:215], v[184:187], v[0:3]
    ds_read_b64_tr_b16 v[228:229], v246 offset:36864
    ds_read_b64_tr_b16 v[230:231], v246 offset:38912
    v_mfma_f32_16x16x32_bf16 v[4:7], v[216:219], v[184:187], v[4:7]
    ds_read_b64_tr_b16 v[232:233], v247 offset:36864
    ds_read_b64_tr_b16 v[234:235], v247 offset:38912
    s_waitcnt lgkmcnt(4)
    v_mfma_f32_16x16x32_bf16 v[8:11], v[220:223], v[184:187], v[8:11]
    ds_read_b64_tr_b16 v[236:237], v248 offset:36864
    ds_read_b64_tr_b16 v[238:239], v248 offset:38912
    v_exp_f32 v252, v144
    v_mfma_f32_16x16x32_bf16 v[12:15], v[224:227], v[184:187], v[12:15]
    ds_read_b64_tr_b16 v[240:241], v249 offset:36864
    ds_read_b64_tr_b16 v[242:243], v249 offset:38912
    s_waitcnt lgkmcnt(4)
    v_mfma_f32_16x16x32_bf16 v[16:19], v[228:231], v[184:187], v[16:19]
    ds_read_b64_tr_b16 v[212:213], v246 offset:40960
    ds_read_b64_tr_b16 v[214:215], v246 offset:43008
    v_exp_f32 v253, v145
    v_mfma_f32_16x16x32_bf16 v[200:203], v[208:211], v[184:187], v[200:203]
    ds_read_b64_tr_b16 v[216:217], v247 offset:40960
    v_mfma_f32_16x16x32_bf16 v[20:23], v[232:235], v[184:187], v[20:23]
    ds_read_b64_tr_b16 v[218:219], v247 offset:43008
    v_exp_f32 v254, v146
    s_waitcnt lgkmcnt(4)
    v_mfma_f32_16x16x32_bf16 v[24:27], v[236:239], v[184:187], v[24:27]
    ds_read_b64_tr_b16 v[220:221], v248 offset:40960
    ds_read_b64_tr_b16 v[222:223], v248 offset:43008
    v_mfma_f32_16x16x32_bf16 v[28:31], v[240:243], v[184:187], v[28:31]
    ds_read_b64_tr_b16 v[224:225], v249 offset:40960
    ds_read_b64_tr_b16 v[226:227], v249 offset:43008
    s_barrier
    s_cmp_lg_u32 s55, 1
    s_cbranch_scc1 t0_nopick
    v_subrev_u32 v251, 6144, v250
    ds_read_b128 v[120:123], v251 offset:0
    ds_read_b128 v[124:127], v251 offset:1024
    ds_read_b128 v[128:131], v251 offset:2048
    ds_read_b128 v[132:135], v251 offset:3072
    ds_read_b128 v[136:139], v251 offset:4096
    ds_read_b128 v[140:143], v251 offset:5120
    ds_read_b128 v[48:51], v251 offset:6144
    ds_read_b128 v[52:55], v251 offset:7168
    ds_read_b128 v[56:59], v251 offset:8192
    ds_read_b128 v[60:63], v251 offset:9216
    ds_read_b128 v[64:67], v251 offset:10240
    ds_read_b128 v[68:71], v251 offset:11264
    ds_read_b128 v[72:75], v251 offset:12288
    ds_read_b128 v[76:79], v251 offset:13312
    ds_read_b128 v[80:83], v251 offset:14336
    ds_read_b128 v[84:87], v251 offset:15360
    ds_read_b128 v[88:91], v251 offset:16384
    ds_read_b128 v[92:95], v251 offset:17408
    ds_read_b128 v[156:159], v251 offset:18432
    ds_read_b128 v[172:175], v251 offset:19456
    ds_read_b128 v[180:183], v251 offset:20480
    ds_read_b128 v[188:191], v251 offset:21504
    ds_read_b128 v[196:199], v251 offset:22528
    ds_read_b128 v[204:207], v251 offset:23552
    s_waitcnt lgkmcnt(0)
t0_nopick:
    s_waitcnt lgkmcnt(4)
    v_mfma_f32_16x16x32_bf16 v[32:35], v[212:215], v[184:187], v[32:35]
    ds_read_b128 v[228:231], v244 offset:45056
    v_exp_f32 v255, v147
    v_mfma_f32_16x16x32_bf16 v[36:39], v[216:219], v[184:187], v[36:39]
    ds_read_b128 v[232:235], v244 offset:47104
    s_waitcnt lgkmcnt(2)
    v_mfma_f32_16x16x32_bf16 v[40:43], v[220:223], v[184:187], v[40:43]
    ds_read_b128 v[236:239], v245 offset:45056
    v_cvt_pk_bf16_f32 v176, v252, v253
    v_mfma_f32_16x16x32_bf16 v[44:47], v[224:227], v[184:187], v[44:47]
    ds_read_b128 v[240:243], v245 offset:47104
    v_cvt_pk_bf16_f32 v177, v254, v255
    s_waitcnt lgkmcnt(2)
    v_mfma_f32_16x16x32_bf16 v[160:163], v[228:231], v[96:99], v[192:195]
    ds_read_b128 v[212:215], v244 offset:49152
    v_exp_f32 v252, v148
    v_mfma_f32_16x16x32_bf16 v[164:167], v[232:235], v[96:99], v[192:195]
    ds_read_b128 v[216:219], v244 offset:51200
    s_waitcnt lgkmcnt(2)
    v_mfma_f32_16x16x32_bf16 v[160:163], v[236:239], v[100:103], v[160:163]
    ds_read_b128 v[220:223], v245 offset:49152
    v_exp_f32 v253, v149
    v_mfma_f32_16x16x32_bf16 v[164:167], v[240:243], v[100:103], v[164:167]
    ds_read_b128 v[224:227], v245 offset:51200
    s_waitcnt lgkmcnt(2)
    v_mfma_f32_16x16x32_bf16 v[160:163], v[212:215], v[104:107], v[160:163]
    ds_read_b128 v[228:231], v244 offset:53248
    v_exp_f32 v254, v150
    v_mfma_f32_16x16x32_bf16 v[164:167], v[216:219], v[104:107], v[164:167]
    ds_read_b128 v[232:235], v244 offset:55296
    s_waitcnt lgkmcnt(2)
    v_mfma_f32_16x16x32_bf16 v[160:163], v[220:223], v[108:111], v[160:163]
    ds_read_b128 v[236:239], v245 offset:53248
    v_exp_f32 v255, v151
    v_mfma_f32_16x16x32_bf16 v[164:167], v[224:227], v[108:111], v[164:167]
    ds_read_b128 v[240:243], v245 offset:55296
    v_cvt_pk_bf16_f32 v178, v252, v253
    s_barrier
    s_waitcnt lgkmcnt(2)
    v_mfma_f32_16x16x32_bf16 v[160:163], v[228:231], v[112:115], v[160:163]
    ds_read_b64_tr_b16 v[212:213], v246 offset:57344
    ds_read_b64_tr_b16 v[214:215], v246 offset:59392
    v_cvt_pk_bf16_f32 v179, v254, v255
    v_mfma_f32_16x16x32_bf16 v[164:167], v[232:235], v[112:115], v[164:167]
    ds_read_b64_tr_b16 v[216:217], v247 offset:57344
    ds_read_b64_tr_b16 v[218:219], v247 offset:59392
    v_or3_b32 v251, v176, v177, v178
    s_waitcnt lgkmcnt(4)
    v_mfma_f32_16x16x32_bf16 v[160:163], v[236:239], v[116:119], v[160:163]
    ds_read_b64_tr_b16 v[220:221], v248 offset:57344
    ds_read_b64_tr_b16 v[222:223], v248 offset:59392
    v_bitop3_b32 v251, v251, v179, s68 bitop3:0xa8
    v_mfma_f32_16x16x32_bf16 v[164:167], v[240:243], v[116:119], v[164:167]
    ds_read_b64_tr_b16 v[224:225], v249 offset:57344
    ds_read_b64_tr_b16 v[226:227], v249 offset:59392
    v_cmp_ne_u32 vcc, 0, v251
    s_cbranch_vccz t0_okq12_l
    s_call_b64 s[30:31], t0_rare0_l
t0_okq12_l:
    s_waitcnt lgkmcnt(4)
    v_mfma_f32_16x16x32_bf16 v[0:3], v[212:215], v[176:179], v[0:3]
    ds_read_b64_tr_b16 v[228:229], v246 offset:61440
    ds_read_b64_tr_b16 v[230:231], v246 offset:63488
    v_mfma_f32_16x16x32_bf16 v[4:7], v[216:219], v[176:179], v[4:7]
    ds_read_b64_tr_b16 v[232:233], v247 offset:61440
    ds_read_b64_tr_b16 v[234:235], v247 offset:63488
    s_waitcnt lgkmcnt(4)
    v_mfma_f32_16x16x32_bf16 v[8:11], v[220:223], v[176:179], v[8:11]
    ds_read_b64_tr_b16 v[236:237], v248 offset:61440
    ds_read_b64_tr_b16 v[238:239], v248 offset:63488
    v_exp_f32 v252, v160
    v_mfma_f32_16x16x32_bf16 v[12:15], v[224:227], v[176:179], v[12:15]
    ds_read_b64_tr_b16 v[240:241], v249 offset:61440
    ds_read_b64_tr_b16 v[242:243], v249 offset:63488
    s_waitcnt lgkmcnt(4)
    v_mfma_f32_16x16x32_bf16 v[16:19], v[228:231], v[176:179], v[16:19]
    ds_read_b64_tr_b16 v[212:213], v246 offset:0
    ds_read_b64_tr_b16 v[214:215], v246 offset:2048
    v_exp_f32 v253, v161
    v_mfma_f32_16x16x32_bf16 v[200:203], v[208:211], v[176:179], v[200:203]
    ds_read_b64_tr_b16 v[216:217], v247 offset:0
    v_mfma_f32_16x16x32_bf16 v[20:23], v[232:235], v[176:179], v[20:23]
    ds_read_b64_tr_b16 v[218:219], v247 offset:2048
    v_exp_f32 v254, v162
    s_waitcnt lgkmcnt(4)
    v_mfma_f32_16x16x32_bf16 v[24:27], v[236:239], v[176:179], v[24:27]
    ds_read_b64_tr_b16 v[220:221], v248 offset:0
    ds_read_b64_tr_b16 v[222:223], v248 offset:2048
    v_mfma_f32_16x16x32_bf16 v[28:31], v[240:243], v[176:179], v[28:31]
    ds_read_b64_tr_b16 v[224:225], v249 offset:0
    ds_read_b64_tr_b16 v[226:227], v249 offset:2048
    s_waitcnt lgkmcnt(4)
    v_mfma_f32_16x16x32_bf16 v[32:35], v[212:215], v[176:179], v[32:35]
    ds_read_b128 v[228:231], v244 offset:4096
    v_exp_f32 v255, v163
    v_mfma_f32_16x16x32_bf16 v[36:39], v[216:219], v[176:179], v[36:39]
    ds_read_b128 v[232:235], v244 offset:6144
    s_waitcnt lgkmcnt(2)
    v_mfma_f32_16x16x32_bf16 v[40:43], v[220:223], v[176:179], v[40:43]
    ds_read_b128 v[236:239], v245 offset:4096
    v_cvt_pk_bf16_f32 v184, v252, v253
    v_mfma_f32_16x16x32_bf16 v[44:47], v[224:227], v[176:179], v[44:47]
    ds_read_b128 v[240:243], v245 offset:6144
    v_cvt_pk_bf16_f32 v185, v254, v255
    s_barrier
    s_waitcnt lgkmcnt(2)
    v_mfma_f32_16x16x32_bf16 v[144:147], v[228:231], v[96:99], v[192:195]
    ds_read_b128 v[212:215], v244 offset:8192
    v_exp_f32 v252, v164
    v_mfma_f32_16x16x32_bf16 v[148:151], v[232:235], v[96:99], v[192:195]
    ds_read_b128 v[216:219], v244 offset:10240
    s_waitcnt lgkmcnt(2)
    v_mfma_f32_16x16x32_bf16 v[144:147], v[236:239], v[100:103], v[144:147]
    ds_read_b128 v[220:223], v245 offset:8192
    v_exp_f32 v253, v165
    v_mfma_f32_16x16x32_bf16 v[148:151], v[240:243], v[100:103], v[148:151]
    ds_read_b128 v[224:227], v245 offset:10240
    s_waitcnt lgkmcnt(2)
    v_mfma_f32_16x16x32_bf16 v[144:147], v[212:215], v[104:107], v[144:147]
    ds_read_b128 v[228:231], v244 offset:12288
    v_exp_f32 v254, v166
    v_mfma_f32_16x16x32_bf16 v[148:151], v[216:219], v[104:107], v[148:151]
    ds_read_b128 v[232:235], v244 offset:14336
    s_waitcnt lgkmcnt(2)
    v_mfma_f32_16x16x32_bf16 v[144:147], v[220:223], v[108:111], v[144:147]
    ds_read_b128 v[236:239], v245 offset:12288
    v_exp_f32 v255, v167
    v_mfma_f32_16x16x32_bf16 v[148:151], v[224:227], v[108:111], v[148:151]
    ds_read_b128 v[240:243], v245 offset:14336
    v_cvt_pk_bf16_f32 v186, v252, v253
    s_waitcnt lgkmcnt(2)
    v_mfma_f32_16x16x32_bf16 v[144:147], v[228:231], v[112:115], v[144:147]
    ds_read_b64_tr_b16 v[212:213], v246 offset:16384
    ds_read_b64_tr_b16 v[214:215], v246 offset:18432
    v_cvt_pk_bf16_f32 v187, v254, v255
    v_mfma_f32_16x16x32_bf16 v[148:151], v[232:235], v[112:115], v[148:151]
    ds_read_b64_tr_b16 v[216:217], v247 offset:16384
    ds_read_b64_tr_b16 v[218:219], v247 offset:18432
    v_or3_b32 v251, v184, v185, v186
    s_waitcnt lgkmcnt(4)
    v_mfma_f32_16x16x32_bf16 v[144:147], v[236:239], v[116:119], v[144:147]
    ds_read_b64_tr_b16 v[220:221], v248 offset:16384
    ds_read_b64_tr_b16 v[222:223], v248 offset:18432
    v_bitop3_b32 v251, v251, v187, s68 bitop3:0xa8
    v_mfma_f32_16x16x32_bf16 v[148:151], v[240:243], v[116:119], v[148:151]
    ds_read_b64_tr_b16 v[224:225], v249 offset:16384
    ds_read_b64_tr_b16 v[226:227], v249 offset:18432
    v_cmp_ne_u32 vcc, 0, v251
    s_cbranch_vccz t0_okq13_l
    s_call_b64 s[30:31], t0_rare1_l
t0_okq13_l:
    s_barrier
    s_waitcnt lgkmcnt(4)
    v_mfma_f32_16x16x32_bf16 v[0:3], v[212:215], v[184:187], v[0:3]
    ds_read_b64_tr_b16 v[228:229], v246 offset:20480
    ds_read_b64_tr_b16 v[230:231], v246 offset:22528
    v_mfma_f32_16x16x32_bf16 v[4:7], v[216:219], v[184:187], v[4:7]
    ds_read_b64_tr_b16 v[232:233], v247 offset:20480
    ds_read_b64_tr_b16 v[234:235], v247 offset:22528
    s_waitcnt lgkmcnt(4)
    v_mfma_f32_16x16x32_bf16 v[8:11], v[220:223], v[184:187], v[8:11]
    ds_read_b64_tr_b16 v[236:237], v248 offset:20480
    ds_read_b64_tr_b16 v[238:239], v248 offset:22528
    v_exp_f32 v252, v144
    v_mfma_f32_16x16x32_bf16 v[12:15], v[224:227], v[184:187], v[12:15]
    ds_read_b64_tr_b16 v[240:241], v249 offset:20480
    ds_read_b64_tr_b16 v[242:243], v249 offset:22528
    s_waitcnt lgkmcnt(4)
    v_mfma_f32_16x16x32_bf16 v[16:19], v[228:231], v[184:187], v[16:19]
    ds_read_b64_tr_b16 v[212:213], v246 offset:24576
    ds_read_b64_tr_b16 v[214:215], v246 offset:26624
    v_exp_f32 v253, v145
    v_mfma_f32_16x16x32_bf16 v[200:203], v[208:211], v[184:187], v[200:203]
    ds_read_b64_tr_b16 v[216:217], v247 offset:24576
    v_mfma_f32_16x16x32_bf16 v[20:23], v[232:235], v[184:187], v[20:23]
    ds_read_b64_tr_b16 v[218:219], v247 offset:26624
    v_exp_f32 v254, v146
    s_waitcnt lgkmcnt(4)
    v_mfma_f32_16x16x32_bf16 v[24:27], v[236:239], v[184:187], v[24:27]
    ds_read_b64_tr_b16 v[220:221], v248 offset:24576
    ds_read_b64_tr_b16 v[222:223], v248 offset:26624
    v_mfma_f32_16x16x32_bf16 v[28:31], v[240:243], v[184:187], v[28:31]
    ds_read_b64_tr_b16 v[224:225], v249 offset:24576
    ds_read_b64_tr_b16 v[226:227], v249 offset:26624
    s_waitcnt lgkmcnt(4)
    v_mfma_f32_16x16x32_bf16 v[32:35], v[212:215], v[184:187], v[32:35]
    ds_read_b128 v[228:231], v244 offset:28672
    v_exp_f32 v255, v147
    v_mfma_f32_16x16x32_bf16 v[36:39], v[216:219], v[184:187], v[36:39]
    ds_read_b128 v[232:235], v244 offset:30720
    s_waitcnt lgkmcnt(2)
    v_mfma_f32_16x16x32_bf16 v[40:43], v[220:223], v[184:187], v[40:43]
    ds_read_b128 v[236:239], v245 offset:28672
    v_cvt_pk_bf16_f32 v176, v252, v253
    v_mfma_f32_16x16x32_bf16 v[44:47], v[224:227], v[184:187], v[44:47]
    ds_read_b128 v[240:243], v245 offset:30720
    v_cvt_pk_bf16_f32 v177, v254, v255
    s_barrier
    s_waitcnt lgkmcnt(2)
    v_mfma_f32_16x16x32_bf16 v[160:163], v[228:231], v[96:99], v[192:195]
    ds_read_b128 v[212:215], v244 offset:32768
    v_exp_f32 v252, v148
    v_mfma_f32_16x16x32_bf16 v[164:167], v[232:235], v[96:99], v[192:195]
    ds_read_b128 v[216:219], v244 offset:34816
    s_waitcnt lgkmcnt(2)
    v_mfma_f32_16x16x32_bf16 v[160:163], v[236:239], v[100:103], v[160:163]
    ds_read_b128 v[220:223], v245 offset:32768
    v_exp_f32 v253, v149
    v_mfma_f32_16x16x32_bf16 v[164:167], v[240:243], v[100:103], v[164:167]
    ds_read_b128 v[224:227], v245 offset:34816
    s_waitcnt lgkmcnt(2)
    v_mfma_f32_16x16x32_bf16 v[160:163], v[212:215], v[104:107], v[160:163]
    ds_read_b128 v[228:231], v244 offset:36864
    v_exp_f32 v254, v150
    v_mfma_f32_16x16x32_bf16 v[164:167], v[216:219], v[104:107], v[164:167]
    ds_read_b128 v[232:235], v244 offset:38912
    s_waitcnt lgkmcnt(2)
    v_mfma_f32_16x16x32_bf16 v[160:163], v[220:223], v[108:111], v[160:163]
    ds_read_b128 v[236:239], v245 offset:36864
    v_exp_f32 v255, v151
    v_mfma_f32_16x16x32_bf16 v[164:167], v[224:227], v[108:111], v[164:167]
    ds_read_b128 v[240:243], v245 offset:38912
    v_cvt_pk_bf16_f32 v178, v252, v253
    s_waitcnt lgkmcnt(2)
    v_mfma_f32_16x16x32_bf16 v[160:163], v[228:231], v[112:115], v[160:163]
    ds_read_b64_tr_b16 v[212:213], v246 offset:40960
    ds_read_b64_tr_b16 v[214:215], v246 offset:43008
    v_cvt_pk_bf16_f32 v179, v254, v255
    v_mfma_f32_16x16x32_bf16 v[164:167], v[232:235], v[112:115], v[164:167]
    ds_read_b64_tr_b16 v[216:217], v247 offset:40960
    ds_read_b64_tr_b16 v[218:219], v247 offset:43008
    v_or3_b32 v251, v176, v177, v178
    s_waitcnt lgkmcnt(4)
    v_mfma_f32_16x16x32_bf16 v[160:163], v[236:239], v[116:119], v[160:163]
    ds_read_b64_tr_b16 v[220:221], v248 offset:40960
    ds_read_b64_tr_b16 v[222:223], v248 offset:43008
    v_bitop3_b32 v251, v251, v179, s68 bitop3:0xa8
    v_mfma_f32_16x16x32_bf16 v[164:167], v[240:243], v[116:119], v[164:167]
    ds_read_b64_tr_b16 v[224:225], v249 offset:40960
    ds_read_b64_tr_b16 v[226:227], v249 offset:43008
    v_cmp_ne_u32 vcc, 0, v251
    s_cbranch_vccz t0_okq14_l
    s_call_b64 s[30:31], t0_rare0_l
t0_okq14_l:
    s_barrier
    s_waitcnt lgkmcnt(4)
    v_mfma_f32_16x16x32_bf16 v[0:3], v[212:215], v[176:179], v[0:3]
    ds_read_b64_tr_b16 v[228:229], v246 offset:45056
    ds_read_b64_tr_b16 v[230:231], v246 offset:47104
    v_mfma_f32_16x16x32_bf16 v[4:7], v[216:219], v[176:179], v[4:7]
    ds_read_b64_tr_b16 v[232:233], v247 offset:45056
    ds_read_b64_tr_b16 v[234:235], v247 offset:47104
    v_exp_f32 v252, v160
    s_waitcnt lgkmcnt(4)
    v_mfma_f32_16x16x32_bf16 v[8:11], v[220:223], v[176:179], v[8:11]
    ds_read_b64_tr_b16 v[236:237], v248 offset:45056
    ds_read_b64_tr_b16 v[238:239], v248 offset:47104
    v_exp_f32 v253, v161
    v_mfma_f32_16x16x32_bf16 v[12:15], v[224:227], v[176:179], v[12:15]
    ds_read_b64_tr_b16 v[240:241], v249 offset:45056
    ds_read_b64_tr_b16 v[242:243], v249 offset:47104
    v_exp_f32 v254, v162
    s_waitcnt lgkmcnt(4)
    v_mfma_f32_16x16x32_bf16 v[16:19], v[228:231], v[176:179], v[16:19]
    ds_read_b64_tr_b16 v[212:213], v246 offset:49152
    ds_read_b64_tr_b16 v[214:215], v246 offset:51200
    v_exp_f32 v255, v163
    v_mfma_f32_16x16x32_bf16 v[200:203], v[208:211], v[176:179], v[200:203]
    ds_read_b64_tr_b16 v[216:217], v247 offset:49152
    v_cvt_pk_bf16_f32 v184, v252, v253
    v_mfma_f32_16x16x32_bf16 v[20:23], v[232:235], v[176:179], v[20:23]
    ds_read_b64_tr_b16 v[218:219], v247 offset:51200
    v_exp_f32 v252, v164
    s_waitcnt lgkmcnt(4)
    v_mfma_f32_16x16x32_bf16 v[24:27], v[236:239], v[176:179], v[24:27]
    ds_read_b64_tr_b16 v[220:221], v248 offset:49152
    ds_read_b64_tr_b16 v[222:223], v248 offset:51200
    v_exp_f32 v253, v165
    v_mfma_f32_16x16x32_bf16 v[28:31], v[240:243], v[176:179], v[28:31]
    ds_read_b64_tr_b16 v[224:225], v249 offset:49152
    ds_read_b64_tr_b16 v[226:227], v249 offset:51200
    v_cvt_pk_bf16_f32 v185, v254, v255
    v_exp_f32 v254, v166
    s_waitcnt lgkmcnt(4)
    v_mfma_f32_16x16x32_bf16 v[32:35], v[212:215], v[176:179], v[32:35]
    ds_read_b64_tr_b16 v[228:229], v246 offset:53248
    ds_read_b64_tr_b16 v[230:231], v246 offset:55296
    v_exp_f32 v255, v167
    v_mfma_f32_16x16x32_bf16 v[36:39], v[216:219], v[176:179], v[36:39]
    ds_read_b64_tr_b16 v[232:233], v247 offset:53248
    ds_read_b64_tr_b16 v[234:235], v247 offset:55296
    v_cvt_pk_bf16_f32 v186, v252, v253
    s_waitcnt lgkmcnt(4)
    v_mfma_f32_16x16x32_bf16 v[40:43], v[220:223], v[176:179], v[40:43]
    ds_read_b64_tr_b16 v[236:237], v248 offset:53248
    ds_read_b64_tr_b16 v[238:239], v248 offset:55296
    v_cvt_pk_bf16_f32 v187, v254, v255
    v_or3_b32 v251, v184, v185, v186
    v_mfma_f32_16x16x32_bf16 v[44:47], v[224:227], v[176:179], v[44:47]
    ds_read_b64_tr_b16 v[240:241], v249 offset:53248
    ds_read_b64_tr_b16 v[242:243], v249 offset:55296
    v_bitop3_b32 v251, v251, v187, s68 bitop3:0xa8
    v_cmp_ne_u32 vcc, 0, v251
    s_cbranch_vccz t0_okq15_l
    s_call_b64 s[30:31], t0_rare1_l
t0_okq15_l:
    s_barrier
    s_waitcnt lgkmcnt(4)
    v_mfma_f32_16x16x32_bf16 v[200:203], v[208:211], v[184:187], v[200:203]
    ds_read_b64_tr_b16 v[212:213], v246 offset:57344
    v_mfma_f32_16x16x32_bf16 v[0:3], v[228:231], v[184:187], v[0:3]
    ds_read_b64_tr_b16 v[214:215], v246 offset:59392
    v_mfma_f32_16x16x32_bf16 v[4:7], v[232:235], v[184:187], v[4:7]
    ds_read_b64_tr_b16 v[216:217], v247 offset:57344
    ds_read_b64_tr_b16 v[218:219], v247 offset:59392
    s_waitcnt lgkmcnt(4)
    v_mfma_f32_16x16x32_bf16 v[8:11], v[236:239], v[184:187], v[8:11]
    ds_read_b64_tr_b16 v[220:221], v248 offset:57344
    ds_read_b64_tr_b16 v[222:223], v248 offset:59392
    v_rcp_f32 v252, v200
    v_rcp_f32 v253, v200
    v_mfma_f32_16x16x32_bf16 v[12:15], v[240:243], v[184:187], v[12:15]
    ds_read_b64_tr_b16 v[224:225], v249 offset:57344
    ds_read_b64_tr_b16 v[226:227], v249 offset:59392
    v_pk_mul_f32 v[0:1], v[0:1], v[252:253]
    v_pk_mul_f32 v[2:3], v[2:3], v[252:253]
    v_pk_mul_f32 v[4:5], v[4:5], v[252:253]
    v_pk_mul_f32 v[6:7], v[6:7], v[252:253]
    v_cvt_pk_bf16_f32 v144, v0, v1
    v_cvt_pk_bf16_f32 v145, v2, v3
    v_cvt_pk_bf16_f32 v146, v4, v5
    v_cvt_pk_bf16_f32 v147, v6, v7
    s_waitcnt lgkmcnt(4)
    v_mfma_f32_16x16x32_bf16 v[16:19], v[212:215], v[184:187], v[16:19]
    ds_read_b64_tr_b16 v[228:229], v246 offset:61440
    ds_read_b64_tr_b16 v[230:231], v246 offset:63488
    v_mfma_f32_16x16x32_bf16 v[20:23], v[216:219], v[184:187], v[20:23]
    ds_read_b64_tr_b16 v[232:233], v247 offset:61440
    ds_read_b64_tr_b16 v[234:235], v247 offset:63488
    v_pk_mul_f32 v[8:9], v[8:9], v[252:253]
    v_pk_mul_f32 v[10:11], v[10:11], v[252:253]
    v_pk_mul_f32 v[12:13], v[12:13], v[252:253]
    v_pk_mul_f32 v[14:15], v[14:15], v[252:253]
    v_cvt_pk_bf16_f32 v152, v8, v9
    v_cvt_pk_bf16_f32 v153, v10, v11
    v_cvt_pk_bf16_f32 v154, v12, v13
    v_cvt_pk_bf16_f32 v155, v14, v15
    s_waitcnt lgkmcnt(4)
    v_mfma_f32_16x16x32_bf16 v[24:27], v[220:223], v[184:187], v[24:27]
    ds_read_b64_tr_b16 v[236:237], v248 offset:61440
    ds_read_b64_tr_b16 v[238:239], v248 offset:63488
    v_mfma_f32_16x16x32_bf16 v[28:31], v[224:227], v[184:187], v[28:31]
    ds_read_b64_tr_b16 v[240:241], v249 offset:61440
    ds_read_b64_tr_b16 v[242:243], v249 offset:63488
    v_pk_mul_f32 v[16:17], v[16:17], v[252:253]
    v_pk_mul_f32 v[18:19], v[18:19], v[252:253]
    v_pk_mul_f32 v[20:21], v[20:21], v[252:253]
    v_pk_mul_f32 v[22:23], v[22:23], v[252:253]
    v_cvt_pk_bf16_f32 v160, v16, v17
    v_cvt_pk_bf16_f32 v161, v18, v19
    v_cvt_pk_bf16_f32 v162, v20, v21
    v_cvt_pk_bf16_f32 v163, v22, v23
    s_waitcnt lgkmcnt(4)
    v_mfma_f32_16x16x32_bf16 v[32:35], v[228:231], v[184:187], v[32:35]
    v_mfma_f32_16x16x32_bf16 v[36:39], v[232:235], v[184:187], v[36:39]
    v_pk_mul_f32 v[24:25], v[24:25], v[252:253]
    v_pk_mul_f32 v[26:27], v[26:27], v[252:253]
    v_pk_mul_f32 v[28:29], v[28:29], v[252:253]
    v_pk_mul_f32 v[30:31], v[30:31], v[252:253]
    v_cvt_pk_bf16_f32 v168, v24, v25
    v_cvt_pk_bf16_f32 v169, v26, v27
    v_cvt_pk_bf16_f32 v170, v28, v29
    v_cvt_pk_bf16_f32 v171, v30, v31
    s_waitcnt lgkmcnt(0)
    v_mfma_f32_16x16x32_bf16 v[40:43], v[236:239], v[184:187], v[40:43]
    v_mfma_f32_16x16x32_bf16 v[44:47], v[240:243], v[184:187], v[44:47]
    v_pk_mul_f32 v[32:33], v[32:33], v[252:253]
    v_pk_mul_f32 v[34:35], v[34:35], v[252:253]
    v_pk_mul_f32 v[36:37], v[36:37], v[252:253]
    v_pk_mul_f32 v[38:39], v[38:39], v[252:253]
    v_cvt_pk_bf16_f32 v176, v32, v33
    v_cvt_pk_bf16_f32 v177, v34, v35
    v_cvt_pk_bf16_f32 v178, v36, v37
    v_cvt_pk_bf16_f32 v179, v38, v39
    v_pk_mul_f32 v[40:41], v[40:41], v[252:253]
    v_pk_mul_f32 v[42:43], v[42:43], v[252:253]
    v_pk_mul_f32 v[44:45], v[44:45], v[252:253]
    v_pk_mul_f32 v[46:47], v[46:47], v[252:253]
    v_cvt_pk_bf16_f32 v192, v40, v41
    v_cvt_pk_bf16_f32 v193, v42, v43
    v_cvt_pk_bf16_f32 v194, v44, v45
    v_cvt_pk_bf16_f32 v195, v46, v47
    s_cmp_lg_u32 s55, 3
    s_cbranch_scc1 t0_nohold
    v_subrev_u32 v251, 6144, v250
    ds_write_b128 v251, v[48:51] offset:21504
    ds_write_b128 v251, v[52:55] offset:22528
    ds_write_b128 v251, v[56:59] offset:23552
    ds_write_b128 v251, v[60:63] offset:24576
    ds_write_b128 v251, v[64:67] offset:25600
    ds_write_b128 v251, v[68:71] offset:26624
    ds_write_b128 v251, v[72:75] offset:28672
    ds_write_b128 v251, v[76:79] offset:29696
    ds_write_b128 v251, v[80:83] offset:30720
    ds_write_b128 v251, v[84:87] offset:31744
    ds_write_b128 v251, v[88:91] offset:32768
    ds_write_b128 v251, v[92:95] offset:33792
    ds_write_b128 v251, v[156:159] offset:35840
    ds_write_b128 v251, v[172:175] offset:36864
    ds_write_b128 v251, v[180:183] offset:37888
    ds_write_b128 v251, v[188:191] offset:38912
    ds_write_b128 v251, v[196:199] offset:39936
    ds_write_b128 v251, v[204:207] offset:40960
    s_waitcnt lgkmcnt(0)
t0_nohold:
    s_add_u32 s55, s55, 1
    s_branch t0_unit_l
t0_exit_l:
    s_branch t0_final
t0_rare0_l:
    v_max3_f32 v251, v144, v145, v146
    v_max3_f32 v251, v251, v147, v148
    v_max3_f32 v251, v251, v149, v150
    v_max_f32 v251, v251, v151
    v_mov_b32 v252, v251
    s_nop 1
    v_permlane32_swap_b32 v252, v251
    v_max_f32 v251, v251, v252
    v_mov_b32 v252, v251
    s_nop 1
    v_permlane16_swap_b32 v252, v251
    v_max_f32 v251, v251, v252
    v_add_f32 v251, 0x40e00000, v251
    v_max_f32 v251, 0, v251
    v_sub_f32 v192, v192, v251
    v_sub_f32 v193, v193, v251
    v_sub_f32 v194, v194, v251
    v_sub_f32 v195, v195, v251
    v_sub_f32 v144, v144, v251
    v_sub_f32 v145, v145, v251
    v_sub_f32 v146, v146, v251
    v_sub_f32 v147, v147, v251
    v_sub_f32 v148, v148, v251
    v_sub_f32 v149, v149, v251
    v_sub_f32 v150, v150, v251
    v_sub_f32 v151, v151, v251
    v_sub_f32 v160, v160, v251
    v_sub_f32 v161, v161, v251
    v_sub_f32 v162, v162, v251
    v_sub_f32 v163, v163, v251
    v_sub_f32 v164, v164, v251
    v_sub_f32 v165, v165, v251
    v_sub_f32 v166, v166, v251
    v_sub_f32 v167, v167, v251
    v_exp_f32 v251, -v251
    s_nop 0
    v_mul_f32 v200, v200, v251
    v_mul_f32 v201, v201, v251
    v_mul_f32 v202, v202, v251
    v_mul_f32 v203, v203, v251
    v_mul_f32 v0, v0, v251
    v_mul_f32 v1, v1, v251
    v_mul_f32 v2, v2, v251
    v_mul_f32 v3, v3, v251
    v_mul_f32 v4, v4, v251
    v_mul_f32 v5, v5, v251
    v_mul_f32 v6, v6, v251
    v_mul_f32 v7, v7, v251
    v_mul_f32 v8, v8, v251
    v_mul_f32 v9, v9, v251
    v_mul_f32 v10, v10, v251
    v_mul_f32 v11, v11, v251
    v_mul_f32 v12, v12, v251
    v_mul_f32 v13, v13, v251
    v_mul_f32 v14, v14, v251
    v_mul_f32 v15, v15, v251
    v_mul_f32 v16, v16, v251
    v_mul_f32 v17, v17, v251
    v_mul_f32 v18, v18, v251
    v_mul_f32 v19, v19, v251
    v_mul_f32 v20, v20, v251
    v_mul_f32 v21, v21, v251
    v_mul_f32 v22, v22, v251
    v_mul_f32 v23, v23, v251
    v_mul_f32 v24, v24, v251
    v_mul_f32 v25, v25, v251
    v_mul_f32 v26, v26, v251
    v_mul_f32 v27, v27, v251
    v_mul_f32 v28, v28, v251
    v_mul_f32 v29, v29, v251
    v_mul_f32 v30, v30, v251
    v_mul_f32 v31, v31, v251
    v_mul_f32 v32, v32, v251
    v_mul_f32 v33, v33, v251
    v_mul_f32 v34, v34, v251
    v_mul_f32 v35, v35, v251
    v_mul_f32 v36, v36, v251
    v_mul_f32 v37, v37, v251
    v_mul_f32 v38, v38, v251
    v_mul_f32 v39, v39, v251
    v_mul_f32 v40, v40, v251
    v_mul_f32 v41, v41, v251
    v_mul_f32 v42, v42, v251
    v_mul_f32 v43, v43, v251
    v_mul_f32 v44, v44, v251
    v_mul_f32 v45, v45, v251
    v_mul_f32 v46, v46, v251
    v_mul_f32 v47, v47, v251
    v_exp_f32 v252, v144
    v_exp_f32 v253, v145
    v_exp_f32 v254, v146
    v_exp_f32 v255, v147
    v_cvt_pk_bf16_f32 v176, v252, v253
    v_exp_f32 v252, v148
    v_exp_f32 v253, v149
    v_cvt_pk_bf16_f32 v177, v254, v255
    v_exp_f32 v254, v150
    v_exp_f32 v255, v151
    v_cvt_pk_bf16_f32 v178, v252, v253
    v_cvt_pk_bf16_f32 v179, v254, v255
    s_setpc_b64 s[30:31]
t0_rare1_l:
    v_max3_f32 v251, v160, v161, v162
    v_max3_f32 v251, v251, v163, v164
    v_max3_f32 v251, v251, v165, v166
    v_max_f32 v251, v251, v167
    v_mov_b32 v252, v251
    s_nop 1
    v_permlane32_swap_b32 v252, v251
    v_max_f32 v251, v251, v252
    v_mov_b32 v252, v251
    s_nop 1
    v_permlane16_swap_b32 v252, v251
    v_max_f32 v251, v251, v252
    v_add_f32 v251, 0x40e00000, v251
    v_max_f32 v251, 0, v251
    v_sub_f32 v192, v192, v251
    v_sub_f32 v193, v193, v251
    v_sub_f32 v194, v194, v251
    v_sub_f32 v195, v195, v251
    v_sub_f32 v144, v144, v251
    v_sub_f32 v145, v145, v251
    v_sub_f32 v146, v146, v251
    v_sub_f32 v147, v147, v251
    v_sub_f32 v148, v148, v251
    v_sub_f32 v149, v149, v251
    v_sub_f32 v150, v150, v251
    v_sub_f32 v151, v151, v251
    v_sub_f32 v160, v160, v251
    v_sub_f32 v161, v161, v251
    v_sub_f32 v162, v162, v251
    v_sub_f32 v163, v163, v251
    v_sub_f32 v164, v164, v251
    v_sub_f32 v165, v165, v251
    v_sub_f32 v166, v166, v251
    v_sub_f32 v167, v167, v251
    v_exp_f32 v251, -v251
    s_nop 0
    v_mul_f32 v200, v200, v251
    v_mul_f32 v201, v201, v251
    v_mul_f32 v202, v202, v251
    v_mul_f32 v203, v203, v251
    v_mul_f32 v0, v0, v251
    v_mul_f32 v1, v1, v251
    v_mul_f32 v2, v2, v251
    v_mul_f32 v3, v3, v251
    v_mul_f32 v4, v4, v251
    v_mul_f32 v5, v5, v251
    v_mul_f32 v6, v6, v251
    v_mul_f32 v7, v7, v251
    v_mul_f32 v8, v8, v251
    v_mul_f32 v9, v9, v251
    v_mul_f32 v10, v10, v251
    v_mul_f32 v11, v11, v251
    v_mul_f32 v12, v12, v251
    v_mul_f32 v13, v13, v251
    v_mul_f32 v14, v14, v251
    v_mul_f32 v15, v15, v251
    v_mul_f32 v16, v16, v251
    v_mul_f32 v17, v17, v251
    v_mul_f32 v18, v18, v251
    v_mul_f32 v19, v19, v251
    v_mul_f32 v20, v20, v251
    v_mul_f32 v21, v21, v251
    v_mul_f32 v22, v22, v251
    v_mul_f32 v23, v23, v251
    v_mul_f32 v24, v24, v251
    v_mul_f32 v25, v25, v251
    v_mul_f32 v26, v26, v251
    v_mul_f32 v27, v27, v251
    v_mul_f32 v28, v28, v251
    v_mul_f32 v29, v29, v251
    v_mul_f32 v30, v30, v251
    v_mul_f32 v31, v31, v251
    v_mul_f32 v32, v32, v251
    v_mul_f32 v33, v33, v251
    v_mul_f32 v34, v34, v251
    v_mul_f32 v35, v35, v251
    v_mul_f32 v36, v36, v251
    v_mul_f32 v37, v37, v251
    v_mul_f32 v38, v38, v251
    v_mul_f32 v39, v39, v251
    v_mul_f32 v40, v40, v251
    v_mul_f32 v41, v41, v251
    v_mul_f32 v42, v42, v251
    v_mul_f32 v43, v43, v251
    v_mul_f32 v44, v44, v251
    v_mul_f32 v45, v45, v251
    v_mul_f32 v46, v46, v251
    v_mul_f32 v47, v47, v251
    v_exp_f32 v252, v160
    v_exp_f32 v253, v161
    v_exp_f32 v254, v162
    v_exp_f32 v255, v163
    v_cvt_pk_bf16_f32 v184, v252, v253
    v_exp_f32 v252, v164
    v_exp_f32 v253, v165
    v_cvt_pk_bf16_f32 v185, v254, v255
    v_exp_f32 v254, v166
    v_exp_f32 v255, v167
    v_cvt_pk_bf16_f32 v186, v252, v253
    v_cvt_pk_bf16_f32 v187, v254, v255
    s_setpc_b64 s[30:31]
t0_final:
    v_mbcnt_lo_u32_b32 v232, -1, 0
    v_mbcnt_hi_u32_b32 v232, -1, v232
    v_and_b32 v233, 15, v232
    v_lshrrev_b32 v234, 4, v232
    v_lshrrev_b32 v235, 2, v232
    v_and_b32 v236, 3, v235
    v_and_b32 v237, 3, v232
    v_lshrrev_b32 v238, 3, v232
    v_and_b32 v239, 7, v232
    v_lshlrev_b32 v246, 4, v232
    v_lshlrev_b32 v240, 1, v234
    v_xor_b32 v240, v233, v240
    v_lshlrev_b32 v240, 4, v240
    v_mul_u32_u24 v241, 1280, v234
    v_add_u32 v247, v240, v241
    v_xor_b32 v240, 128, v240
    v_add_u32 v240, v240, v241
    v_add_u32 v248, 4096, v240
    s_lshl_b32 s62, s56, 1
    v_and_b32 v240, 7, v235
    v_xor_b32 v240, s62, v240
    v_lshlrev_b32 v240, 5, v240
    v_lshl_add_u32 v240, v235, 8, v240
    v_lshl_add_u32 v240, v237, 3, v240
    v_add_u32 v244, 94208, v240
    v_xor_b32 v245, 32, v244
    s_mul_i32 s59, s56, 10240
    s_add_u32 s59, s59, 737280
    s_lshl_b32 s60, s56, 11
    s_mov_b32 s69, 0x01000c0c
    s_mov_b32 s72, 0x03020c0c
    s_lshl_b32 s62, s56, 10
    s_add_u32 s62, s62, 126976
    v_add_u32 v249, s62, v246
    s_add_u32 m0, s60, 94208
    s_add_u32 s63, s59, 768
    buffer_load_dwordx4 v247, s[44:47], s63 offen  lds
    buffer_load_dwordx4 v248, s[44:47], s63 offen offset:1024  lds
    s_add_u32 m0, s60, 102400
    s_add_u32 s63, s59, 41728
    buffer_load_dwordx4 v247, s[44:47], s63 offen  lds
    buffer_load_dwordx4 v248, s[44:47], s63 offen offset:1024  lds
    s_add_u32 m0, s60, 110592
    s_add_u32 s63, s59, 82688
    buffer_load_dwordx4 v247, s[44:47], s63 offen  lds
    buffer_load_dwordx4 v248, s[44:47], s63 offen offset:1024  lds
    s_add_u32 m0, s60, 118784
    s_add_u32 s63, s59, 123648
    buffer_load_dwordx4 v247, s[44:47], s63 offen  lds
    buffer_load_dwordx4 v248, s[44:47], s63 offen offset:1024  lds
    s_waitcnt lgkmcnt(0)
    s_barrier
    ds_read_b128 v[0:3], v249 offset:0
    ds_read_b128 v[4:7], v249 offset:4096
    ds_read_b128 v[8:11], v249 offset:8192
    ds_read_b128 v[12:15], v249 offset:12288
    ds_read_b128 v[16:19], v249 offset:16384
    ds_read_b128 v[20:23], v249 offset:20480
    ds_read_b128 v[24:27], v249 offset:24576
    s_waitcnt lgkmcnt(0)
    v_perm_b32 v56, v0, v0, s69
    v_perm_b32 v57, v0, v0, s72
    v_perm_b32 v58, v1, v1, s69
    v_perm_b32 v59, v1, v1, s72
    v_perm_b32 v60, v2, v2, s69
    v_perm_b32 v61, v2, v2, s72
    v_perm_b32 v62, v3, v3, s69
    v_perm_b32 v63, v3, v3, s72
    v_perm_b32 v64, v4, v4, s69
    v_perm_b32 v65, v4, v4, s72
    v_perm_b32 v66, v5, v5, s69
    v_perm_b32 v67, v5, v5, s72
    v_perm_b32 v68, v6, v6, s69
    v_perm_b32 v69, v6, v6, s72
    v_perm_b32 v70, v7, v7, s69
    v_perm_b32 v71, v7, v7, s72
    v_perm_b32 v72, v8, v8, s69
    v_perm_b32 v73, v8, v8, s72
    v_perm_b32 v74, v9, v9, s69
    v_perm_b32 v75, v9, v9, s72
    v_perm_b32 v76, v10, v10, s69
    v_perm_b32 v77, v10, v10, s72
    v_perm_b32 v78, v11, v11, s69
    v_perm_b32 v79, v11, v11, s72
    v_perm_b32 v80, v12, v12, s69
    v_perm_b32 v81, v12, v12, s72
    v_perm_b32 v82, v13, v13, s69
    v_perm_b32 v83, v13, v13, s72
    v_perm_b32 v84, v14, v14, s69
    v_perm_b32 v85, v14, v14, s72
    v_perm_b32 v86, v15, v15, s69
    v_perm_b32 v87, v15, v15, s72
    v_perm_b32 v88, v16, v16, s69
    v_perm_b32 v89, v16, v16, s72
    v_perm_b32 v90, v17, v17, s69
    v_perm_b32 v91, v17, v17, s72
    v_perm_b32 v92, v18, v18, s69
    v_perm_b32 v93, v18, v18, s72
    v_perm_b32 v94, v19, v19, s69
    v_perm_b32 v95, v19, v19, s72
    v_perm_b32 v96, v20, v20, s69
    v_perm_b32 v97, v20, v20, s72
    v_perm_b32 v98, v21, v21, s69
    v_perm_b32 v99, v21, v21, s72
    v_perm_b32 v100, v22, v22, s69
    v_perm_b32 v101, v22, v22, s72
    v_perm_b32 v102, v23, v23, s69
    v_perm_b32 v103, v23, v23, s72
    v_perm_b32 v104, v24, v24, s69
    v_perm_b32 v105, v24, v24, s72
    v_perm_b32 v106, v25, v25, s69
    v_perm_b32 v107, v25, v25, s72
    v_perm_b32 v108, v26, v26, s69
    v_perm_b32 v109, v26, v26, s72
    v_perm_b32 v110, v27, v27, s69
    v_perm_b32 v111, v27, v27, s72
    s_waitcnt vmcnt(6)
    s_barrier
    ds_read_b64_tr_b16 v[112:113], v244 offset:0
    ds_read_b64_tr_b16 v[114:115], v244 offset:4096
    ds_read_b128 v[128:131], v246 offset:0
    ds_read_b64_tr_b16 v[116:117], v245 offset:0
    ds_read_b64_tr_b16 v[118:119], v245 offset:4096
    ds_read_b128 v[132:135], v246 offset:1024
    ds_read_b128 v[136:139], v246 offset:2048
    ds_read_b128 v[140:143], v246 offset:3072
    ds_read_b128 v[144:147], v246 offset:4096
    ds_read_b128 v[148:151], v246 offset:5120
    s_waitcnt lgkmcnt(7)
    v_mfma_f32_16x16x32_bf16 v[56:59], v[112:115], v[128:131], v[56:59]
    s_waitcnt lgkmcnt(5)
    v_mfma_f32_16x16x32_bf16 v[60:63], v[116:119], v[128:131], v[60:63]
    ds_read_b128 v[128:131], v246 offset:6144
    s_waitcnt lgkmcnt(5)
    v_mfma_f32_16x16x32_bf16 v[64:67], v[112:115], v[132:135], v[64:67]
    s_waitcnt vmcnt(4)
    s_barrier
    s_add_u32 m0, s60, 94208
    s_add_u32 s63, s59, 164608
    buffer_load_dwordx4 v247, s[44:47], s63 offen  lds
    buffer_load_dwordx4 v248, s[44:47], s63 offen offset:1024  lds
    v_mfma_f32_16x16x32_bf16 v[68:71], v[116:119], v[132:135], v[68:71]
    ds_read_b128 v[132:135], v246 offset:7168
    s_waitcnt lgkmcnt(5)
    v_mfma_f32_16x16x32_bf16 v[72:75], v[112:115], v[136:139], v[72:75]
    ds_read_b64_tr_b16 v[120:121], v244 offset:8192
    v_mfma_f32_16x16x32_bf16 v[76:79], v[116:119], v[136:139], v[76:79]
    ds_read_b128 v[136:139], v246 offset:8192
    s_waitcnt lgkmcnt(6)
    v_mfma_f32_16x16x32_bf16 v[80:83], v[112:115], v[140:143], v[80:83]
    ds_read_b64_tr_b16 v[122:123], v244 offset:12288
    v_mfma_f32_16x16x32_bf16 v[84:87], v[116:119], v[140:143], v[84:87]
    ds_read_b128 v[140:143], v246 offset:9216
    s_waitcnt lgkmcnt(7)
    v_mfma_f32_16x16x32_bf16 v[88:91], v[112:115], v[144:147], v[88:91]
    ds_read_b64_tr_b16 v[124:125], v245 offset:8192
    v_mfma_f32_16x16x32_bf16 v[92:95], v[116:119], v[144:147], v[92:95]
    ds_read_b128 v[144:147], v246 offset:10240
    s_waitcnt lgkmcnt(8)
    v_mfma_f32_16x16x32_bf16 v[96:99], v[112:115], v[148:151], v[96:99]
    ds_read_b64_tr_b16 v[126:127], v245 offset:12288
    v_mfma_f32_16x16x32_bf16 v[100:103], v[116:119], v[148:151], v[100:103]
    ds_read_b128 v[148:151], v246 offset:11264
    s_waitcnt lgkmcnt(9)
    v_mfma_f32_16x16x32_bf16 v[104:107], v[112:115], v[128:131], v[104:107]
    v_mfma_f32_16x16x32_bf16 v[108:111], v[116:119], v[128:131], v[108:111]
    ds_read_b128 v[128:131], v246 offset:12288
    s_waitcnt lgkmcnt(6)
    v_mfma_f32_16x16x32_bf16 v[56:59], v[120:123], v[132:135], v[56:59]
    s_waitcnt lgkmcnt(2)
    v_mfma_f32_16x16x32_bf16 v[60:63], v[124:127], v[132:135], v[60:63]
    ds_read_b128 v[132:135], v246 offset:13312
    v_mfma_f32_16x16x32_bf16 v[64:67], v[120:123], v[136:139], v[64:67]
    s_waitcnt vmcnt(4)
    s_barrier
    s_add_u32 m0, s60, 102400
    s_add_u32 s63, s59, 205568
    buffer_load_dwordx4 v247, s[44:47], s63 offen  lds
    buffer_load_dwordx4 v248, s[44:47], s63 offen offset:1024  lds
    v_mfma_f32_16x16x32_bf16 v[68:71], v[124:127], v[136:139], v[68:71]
    ds_read_b128 v[136:139], v246 offset:14336
    v_mfma_f32_16x16x32_bf16 v[72:75], v[120:123], v[140:143], v[72:75]
    ds_read_b64_tr_b16 v[112:113], v244 offset:16384
    v_mfma_f32_16x16x32_bf16 v[76:79], v[124:127], v[140:143], v[76:79]
    ds_read_b128 v[140:143], v246 offset:15360
    v_mfma_f32_16x16x32_bf16 v[80:83], v[120:123], v[144:147], v[80:83]
    ds_read_b64_tr_b16 v[114:115], v244 offset:20480
    v_mfma_f32_16x16x32_bf16 v[84:87], v[124:127], v[144:147], v[84:87]
    ds_read_b128 v[144:147], v246 offset:16384
    s_waitcnt lgkmcnt(7)
    v_mfma_f32_16x16x32_bf16 v[88:91], v[120:123], v[148:151], v[88:91]
    ds_read_b64_tr_b16 v[116:117], v245 offset:16384
    v_mfma_f32_16x16x32_bf16 v[92:95], v[124:127], v[148:151], v[92:95]
    ds_read_b128 v[148:151], v246 offset:17408
    s_waitcnt lgkmcnt(8)
    v_mfma_f32_16x16x32_bf16 v[96:99], v[120:123], v[128:131], v[96:99]
    ds_read_b64_tr_b16 v[118:119], v245 offset:20480
    v_mfma_f32_16x16x32_bf16 v[100:103], v[124:127], v[128:131], v[100:103]
    ds_read_b128 v[128:131], v246 offset:18432
    s_waitcnt lgkmcnt(9)
    v_mfma_f32_16x16x32_bf16 v[104:107], v[120:123], v[132:135], v[104:107]
    v_mfma_f32_16x16x32_bf16 v[108:111], v[124:127], v[132:135], v[108:111]
    ds_read_b128 v[132:135], v246 offset:19456
    s_waitcnt lgkmcnt(6)
    v_mfma_f32_16x16x32_bf16 v[56:59], v[112:115], v[136:139], v[56:59]
    s_waitcnt lgkmcnt(2)
    v_mfma_f32_16x16x32_bf16 v[60:63], v[116:119], v[136:139], v[60:63]
    ds_read_b128 v[136:139], v246 offset:20480
    v_mfma_f32_16x16x32_bf16 v[64:67], v[112:115], v[140:143], v[64:67]
    s_waitcnt vmcnt(4)
    s_barrier
    s_add_u32 m0, s60, 110592
    s_add_u32 s63, s59, 1024
    buffer_load_dwordx4 v247, s[44:47], s63 offen  lds
    buffer_load_dwordx4 v248, s[44:47], s63 offen offset:1024  lds
    v_mfma_f32_16x16x32_bf16 v[68:71], v[116:119], v[140:143], v[68:71]
    ds_read_b128 v[140:143], v246 offset:21504
    v_mfma_f32_16x16x32_bf16 v[72:75], v[112:115], v[144:147], v[72:75]
    ds_read_b64_tr_b16 v[120:121], v244 offset:24576
    ds_read_b128 v[28:31], v249 offset:0
    ds_read_b128 v[32:35], v249 offset:4096
    ds_read_b128 v[36:39], v249 offset:8192
    ds_read_b128 v[40:43], v249 offset:12288
    ds_read_b128 v[44:47], v249 offset:16384
    ds_read_b128 v[48:51], v249 offset:20480
    ds_read_b128 v[52:55], v249 offset:24576
    v_mfma_f32_16x16x32_bf16 v[76:79], v[116:119], v[144:147], v[76:79]
    ds_read_b128 v[144:147], v246 offset:22528
    v_mfma_f32_16x16x32_bf16 v[80:83], v[112:115], v[148:151], v[80:83]
    ds_read_b64_tr_b16 v[122:123], v244 offset:28672
    v_mfma_f32_16x16x32_bf16 v[84:87], v[116:119], v[148:151], v[84:87]
    ds_read_b128 v[148:151], v246 offset:23552
    s_waitcnt lgkmcnt(14)
    v_mfma_f32_16x16x32_bf16 v[88:91], v[112:115], v[128:131], v[88:91]
    ds_read_b64_tr_b16 v[124:125], v245 offset:24576
    v_mfma_f32_16x16x32_bf16 v[92:95], v[116:119], v[128:131], v[92:95]
    ds_read_b128 v[128:131], v246 offset:24576
    s_waitcnt lgkmcnt(15)
    v_mfma_f32_16x16x32_bf16 v[96:99], v[112:115], v[132:135], v[96:99]
    ds_read_b64_tr_b16 v[126:127], v245 offset:28672
    v_mfma_f32_16x16x32_bf16 v[100:103], v[116:119], v[132:135], v[100:103]
    ds_read_b128 v[132:135], v246 offset:25600
    s_waitcnt lgkmcnt(15)
    v_mfma_f32_16x16x32_bf16 v[104:107], v[112:115], v[136:139], v[104:107]
    v_mfma_f32_16x16x32_bf16 v[108:111], v[116:119], v[136:139], v[108:111]
    ds_read_b128 v[136:139], v246 offset:26624
    s_waitcnt lgkmcnt(6)
    v_mfma_f32_16x16x32_bf16 v[56:59], v[120:123], v[140:143], v[56:59]
    s_waitcnt lgkmcnt(2)
    v_mfma_f32_16x16x32_bf16 v[60:63], v[124:127], v[140:143], v[60:63]
    ds_read_b128 v[140:143], v246 offset:27648
    v_mfma_f32_16x16x32_bf16 v[64:67], v[120:123], v[144:147], v[64:67]
    s_waitcnt vmcnt(4)
    s_barrier
    s_add_u32 m0, s60, 118784
    s_add_u32 s63, s59, 41984
    buffer_load_dwordx4 v247, s[44:47], s63 offen  lds
    buffer_load_dwordx4 v248, s[44:47], s63 offen offset:1024  lds
    v_mfma_f32_16x16x32_bf16 v[68:71], v[124:127], v[144:147], v[68:71]
    ds_read_b128 v[144:147], v246 offset:28672
    v_mfma_f32_16x16x32_bf16 v[72:75], v[120:123], v[148:151], v[72:75]
    ds_read_b64_tr_b16 v[112:113], v244 offset:0
    v_mfma_f32_16x16x32_bf16 v[76:79], v[124:127], v[148:151], v[76:79]
    ds_read_b128 v[148:151], v246 offset:29696
    v_mfma_f32_16x16x32_bf16 v[80:83], v[120:123], v[128:131], v[80:83]
    ds_read_b64_tr_b16 v[114:115], v244 offset:4096
    v_mfma_f32_16x16x32_bf16 v[84:87], v[124:127], v[128:131], v[84:87]
    ds_read_b128 v[128:131], v246 offset:30720
    s_waitcnt lgkmcnt(7)
    v_mfma_f32_16x16x32_bf16 v[88:91], v[120:123], v[132:135], v[88:91]
    ds_read_b64_tr_b16 v[116:117], v245 offset:0
    v_mfma_f32_16x16x32_bf16 v[92:95], v[124:127], v[132:135], v[92:95]
    ds_read_b128 v[132:135], v246 offset:31744
    s_waitcnt lgkmcnt(8)
    v_mfma_f32_16x16x32_bf16 v[96:99], v[120:123], v[136:139], v[96:99]
    ds_read_b64_tr_b16 v[118:119], v245 offset:4096
    v_mfma_f32_16x16x32_bf16 v[100:103], v[124:127], v[136:139], v[100:103]
    ds_read_b128 v[136:139], v246 offset:32768
    s_waitcnt lgkmcnt(9)
    v_mfma_f32_16x16x32_bf16 v[104:107], v[120:123], v[140:143], v[104:107]
    v_mfma_f32_16x16x32_bf16 v[108:111], v[124:127], v[140:143], v[108:111]
    ds_read_b128 v[140:143], v246 offset:33792
    s_waitcnt lgkmcnt(6)
    v_mfma_f32_16x16x32_bf16 v[56:59], v[112:115], v[144:147], v[56:59]
    s_waitcnt lgkmcnt(2)
    v_mfma_f32_16x16x32_bf16 v[60:63], v[116:119], v[144:147], v[60:63]
    ds_read_b128 v[144:147], v246 offset:34816
    v_mfma_f32_16x16x32_bf16 v[64:67], v[112:115], v[148:151], v[64:67]
    s_waitcnt vmcnt(4)
    s_barrier
    s_add_u32 m0, s60, 94208
    s_add_u32 s63, s59, 82944
    buffer_load_dwordx4 v247, s[44:47], s63 offen  lds
    buffer_load_dwordx4 v248, s[44:47], s63 offen offset:1024  lds
    v_mfma_f32_16x16x32_bf16 v[68:71], v[116:119], v[148:151], v[68:71]
    ds_read_b128 v[148:151], v246 offset:35840
    v_mfma_f32_16x16x32_bf16 v[72:75], v[112:115], v[128:131], v[72:75]
    ds_read_b64_tr_b16 v[120:121], v244 offset:8192
    v_mfma_f32_16x16x32_bf16 v[76:79], v[116:119], v[128:131], v[76:79]
    ds_read_b128 v[128:131], v246 offset:36864
    v_mfma_f32_16x16x32_bf16 v[80:83], v[112:115], v[132:135], v[80:83]
    ds_read_b64_tr_b16 v[122:123], v244 offset:12288
    v_mfma_f32_16x16x32_bf16 v[84:87], v[116:119], v[132:135], v[84:87]
    ds_read_b128 v[132:135], v246 offset:37888
    s_waitcnt lgkmcnt(7)
    v_mfma_f32_16x16x32_bf16 v[88:91], v[112:115], v[136:139], v[88:91]
    ds_read_b64_tr_b16 v[124:125], v245 offset:8192
    v_mfma_f32_16x16x32_bf16 v[92:95], v[116:119], v[136:139], v[92:95]
    ds_read_b128 v[136:139], v246 offset:38912
    s_waitcnt lgkmcnt(8)
    v_mfma_f32_16x16x32_bf16 v[96:99], v[112:115], v[140:143], v[96:99]
    ds_read_b64_tr_b16 v[126:127], v245 offset:12288
    v_mfma_f32_16x16x32_bf16 v[100:103], v[116:119], v[140:143], v[100:103]
    ds_read_b128 v[140:143], v246 offset:39936
    s_waitcnt lgkmcnt(9)
    v_mfma_f32_16x16x32_bf16 v[104:107], v[112:115], v[144:147], v[104:107]
    v_mfma_f32_16x16x32_bf16 v[108:111], v[116:119], v[144:147], v[108:111]
    ds_read_b128 v[144:147], v246 offset:40960
    s_waitcnt lgkmcnt(6)
    v_mfma_f32_16x16x32_bf16 v[56:59], v[120:123], v[148:151], v[56:59]
    s_waitcnt lgkmcnt(2)
    v_mfma_f32_16x16x32_bf16 v[60:63], v[124:127], v[148:151], v[60:63]
    ds_read_b128 v[148:151], v246 offset:41984
    v_mfma_f32_16x16x32_bf16 v[64:67], v[120:123], v[128:131], v[64:67]
    s_waitcnt vmcnt(4)
    s_barrier
    s_add_u32 m0, s60, 102400
    s_add_u32 s63, s59, 123904
    buffer_load_dwordx4 v247, s[44:47], s63 offen  lds
    buffer_load_dwordx4 v248, s[44:47], s63 offen offset:1024  lds
    v_mfma_f32_16x16x32_bf16 v[68:71], v[124:127], v[128:131], v[68:71]
    ds_read_b128 v[128:131], v246 offset:0
    v_cvt_pk_bf16_f32 v0, v56, v57
    v_cvt_pk_bf16_f32 v1, v58, v59
    v_perm_b32 v56, v28, v28, s69
    v_perm_b32 v57, v28, v28, s72
    v_perm_b32 v58, v29, v29, s69
    v_perm_b32 v59, v29, v29, s72
    v_mfma_f32_16x16x32_bf16 v[72:75], v[120:123], v[132:135], v[72:75]
    ds_read_b64_tr_b16 v[112:113], v244 offset:16384
    v_cvt_pk_bf16_f32 v2, v60, v61
    v_cvt_pk_bf16_f32 v3, v62, v63
    v_perm_b32 v60, v30, v30, s69
    v_perm_b32 v61, v30, v30, s72
    v_perm_b32 v62, v31, v31, s69
    v_perm_b32 v63, v31, v31, s72
    s_mov_b32 s61, 20480
    s_cmp_lg_u32 s54, 5
    s_cbranch_scc1 op_k21
    s_mov_b32 s61, 0x100000
    ds_write_b128 v249, v[0:3] offset:8192
op_k21:
    buffer_store_dwordx4 v[0:3], v246, s[76:79], s61 offen offset:1024 sc1
    v_mfma_f32_16x16x32_bf16 v[76:79], v[124:127], v[132:135], v[76:79]
    ds_read_b128 v[132:135], v246 offset:1024
    v_cvt_pk_bf16_f32 v4, v64, v65
    v_cvt_pk_bf16_f32 v5, v66, v67
    v_perm_b32 v64, v32, v32, s69
    v_perm_b32 v65, v32, v32, s72
    v_perm_b32 v66, v33, v33, s69
    v_perm_b32 v67, v33, v33, s72
    v_mfma_f32_16x16x32_bf16 v[80:83], v[120:123], v[136:139], v[80:83]
    ds_read_b64_tr_b16 v[114:115], v244 offset:20480
    v_cvt_pk_bf16_f32 v6, v68, v69
    v_cvt_pk_bf16_f32 v7, v70, v71
    v_perm_b32 v68, v34, v34, s69
    v_perm_b32 v69, v34, v34, s72
    v_perm_b32 v70, v35, v35, s69
    v_perm_b32 v71, v35, v35, s72
    s_mov_b32 s61, 20480
    s_cmp_lg_u32 s54, 6
    s_cbranch_scc1 op_k22
    s_mov_b32 s61, 0x100000
    ds_write_b128 v249, v[4:7] offset:8192
op_k22:
    buffer_store_dwordx4 v[4:7], v246, s[76:79], s61 offen offset:2048 sc1
    v_mfma_f32_16x16x32_bf16 v[84:87], v[124:127], v[136:139], v[84:87]
    ds_read_b128 v[136:139], v246 offset:2048
    v_cvt_pk_bf16_f32 v8, v72, v73
    v_cvt_pk_bf16_f32 v9, v74, v75
    v_perm_b32 v72, v36, v36, s69
    v_perm_b32 v73, v36, v36, s72
    v_perm_b32 v74, v37, v37, s69
    v_perm_b32 v75, v37, v37, s72
    s_waitcnt lgkmcnt(7)
    v_mfma_f32_16x16x32_bf16 v[88:91], v[120:123], v[140:143], v[88:91]
    ds_read_b64_tr_b16 v[116:117], v245 offset:16384
    v_cvt_pk_bf16_f32 v10, v76, v77
    v_cvt_pk_bf16_f32 v11, v78, v79
    v_perm_b32 v76, v38, v38, s69
    v_perm_b32 v77, v38, v38, s72
    v_perm_b32 v78, v39, v39, s69
    v_perm_b32 v79, v39, v39, s72
    s_mov_b32 s61, 20480
    s_cmp_lg_u32 s54, 7
    s_cbranch_scc1 op_k23
    s_mov_b32 s61, 0x100000
    ds_write_b128 v249, v[8:11] offset:8192
op_k23:
    buffer_store_dwordx4 v[8:11], v246, s[76:79], s61 offen offset:3072 sc1
    v_mfma_f32_16x16x32_bf16 v[92:95], v[124:127], v[140:143], v[92:95]
    ds_read_b128 v[140:143], v246 offset:3072
    v_cvt_pk_bf16_f32 v12, v80, v81
    v_cvt_pk_bf16_f32 v13, v82, v83
    v_perm_b32 v80, v40, v40, s69
    v_perm_b32 v81, v40, v40, s72
    v_perm_b32 v82, v41, v41, s69
    v_perm_b32 v83, v41, v41, s72
    s_waitcnt lgkmcnt(8)
    v_mfma_f32_16x16x32_bf16 v[96:99], v[120:123], v[144:147], v[96:99]
    ds_read_b64_tr_b16 v[118:119], v245 offset:20480
    v_cvt_pk_bf16_f32 v14, v84, v85
    v_cvt_pk_bf16_f32 v15, v86, v87
    v_perm_b32 v84, v42, v42, s69
    v_perm_b32 v85, v42, v42, s72
    v_perm_b32 v86, v43, v43, s69
    v_perm_b32 v87, v43, v43, s72
    s_mov_b32 s61, 24576
    s_cmp_lg_u32 s54, 0
    s_cbranch_scc1 op_k24
    s_mov_b32 s61, 0x100000
    ds_write_b128 v249, v[12:15] offset:12288
op_k24:
    buffer_store_dwordx4 v[12:15], v246, s[76:79], s61 offen offset:0 sc1
    v_mfma_f32_16x16x32_bf16 v[100:103], v[124:127], v[144:147], v[100:103]
    ds_read_b128 v[144:147], v246 offset:4096
    v_cvt_pk_bf16_f32 v16, v88, v89
    v_cvt_pk_bf16_f32 v17, v90, v91
    v_perm_b32 v88, v44, v44, s69
    v_perm_b32 v89, v44, v44, s72
    v_perm_b32 v90, v45, v45, s69
    v_perm_b32 v91, v45, v45, s72
    s_waitcnt lgkmcnt(9)
    v_mfma_f32_16x16x32_bf16 v[104:107], v[120:123], v[148:151], v[104:107]
    v_cvt_pk_bf16_f32 v18, v92, v93
    v_cvt_pk_bf16_f32 v19, v94, v95
    v_perm_b32 v92, v46, v46, s69
    v_perm_b32 v93, v46, v46, s72
    v_perm_b32 v94, v47, v47, s69
    v_perm_b32 v95, v47, v47, s72
    s_mov_b32 s61, 24576
    s_cmp_lg_u32 s54, 1
    s_cbranch_scc1 op_k25
    s_mov_b32 s61, 0x100000
    ds_write_b128 v249, v[16:19] offset:12288
op_k25:
    buffer_store_dwordx4 v[16:19], v246, s[76:79], s61 offen offset:1024 sc1
    v_mfma_f32_16x16x32_bf16 v[108:111], v[124:127], v[148:151], v[108:111]
    ds_read_b128 v[148:151], v246 offset:5120
    v_cvt_pk_bf16_f32 v20, v96, v97
    v_cvt_pk_bf16_f32 v21, v98, v99
    v_perm_b32 v96, v48, v48, s69
    v_perm_b32 v97, v48, v48, s72
    v_perm_b32 v98, v49, v49, s69
    v_perm_b32 v99, v49, v49, s72
    s_waitcnt lgkmcnt(6)
    v_mfma_f32_16x16x32_bf16 v[56:59], v[112:115], v[128:131], v[56:59]
    v_cvt_pk_bf16_f32 v22, v100, v101
    v_cvt_pk_bf16_f32 v23, v102, v103
    v_perm_b32 v100, v50, v50, s69
    v_perm_b32 v101, v50, v50, s72
    v_perm_b32 v102, v51, v51, s69
    v_perm_b32 v103, v51, v51, s72
    s_mov_b32 s61, 24576
    s_cmp_lg_u32 s54, 2
    s_cbranch_scc1 op_k26
    s_mov_b32 s61, 0x100000
    ds_write_b128 v249, v[20:23] offset:12288
op_k26:
    buffer_store_dwordx4 v[20:23], v246, s[76:79], s61 offen offset:2048 sc1
    s_waitcnt lgkmcnt(2)
    v_mfma_f32_16x16x32_bf16 v[60:63], v[116:119], v[128:131], v[60:63]
    ds_read_b128 v[128:131], v246 offset:6144
    v_cvt_pk_bf16_f32 v24, v104, v105
    v_cvt_pk_bf16_f32 v25, v106, v107
    v_perm_b32 v104, v52, v52, s69
    v_perm_b32 v105, v52, v52, s72
    v_perm_b32 v106, v53, v53, s69
    v_perm_b32 v107, v53, v53, s72
    v_mfma_f32_16x16x32_bf16 v[64:67], v[112:115], v[132:135], v[64:67]
    v_cvt_pk_bf16_f32 v26, v108, v109
    v_cvt_pk_bf16_f32 v27, v110, v111
    v_perm_b32 v108, v54, v54, s69
    v_perm_b32 v109, v54, v54, s72
    v_perm_b32 v110, v55, v55, s69
    v_perm_b32 v111, v55, v55, s72
    s_mov_b32 s61, 24576
    s_cmp_lg_u32 s54, 3
    s_cbranch_scc1 op_k27
    s_mov_b32 s61, 0x100000
    ds_write_b128 v249, v[24:27] offset:12288
op_k27:
    buffer_store_dwordx4 v[24:27], v246, s[76:79], s61 offen offset:3072 sc1
    s_waitcnt vmcnt(11)
    s_barrier
    s_add_u32 m0, s60, 110592
    s_add_u32 s63, s59, 164864
    buffer_load_dwordx4 v247, s[44:47], s63 offen  lds
    buffer_load_dwordx4 v248, s[44:47], s63 offen offset:1024  lds
    v_mfma_f32_16x16x32_bf16 v[68:71], v[116:119], v[132:135], v[68:71]
    ds_read_b128 v[132:135], v246 offset:7168
    v_mfma_f32_16x16x32_bf16 v[72:75], v[112:115], v[136:139], v[72:75]
    ds_read_b64_tr_b16 v[120:121], v244 offset:24576
    v_mfma_f32_16x16x32_bf16 v[76:79], v[116:119], v[136:139], v[76:79]
    ds_read_b128 v[136:139], v246 offset:8192
    v_mfma_f32_16x16x32_bf16 v[80:83], v[112:115], v[140:143], v[80:83]
    ds_read_b64_tr_b16 v[122:123], v244 offset:28672
    v_mfma_f32_16x16x32_bf16 v[84:87], v[116:119], v[140:143], v[84:87]
    ds_read_b128 v[140:143], v246 offset:9216
    s_waitcnt lgkmcnt(7)
    v_mfma_f32_16x16x32_bf16 v[88:91], v[112:115], v[144:147], v[88:91]
    ds_read_b64_tr_b16 v[124:125], v245 offset:24576
    v_mfma_f32_16x16x32_bf16 v[92:95], v[116:119], v[144:147], v[92:95]
    ds_read_b128 v[144:147], v246 offset:10240
    s_waitcnt lgkmcnt(8)
    v_mfma_f32_16x16x32_bf16 v[96:99], v[112:115], v[148:151], v[96:99]
    ds_read_b64_tr_b16 v[126:127], v245 offset:28672
    v_mfma_f32_16x16x32_bf16 v[100:103], v[116:119], v[148:151], v[100:103]
    ds_read_b128 v[148:151], v246 offset:11264
    s_waitcnt lgkmcnt(9)
    v_mfma_f32_16x16x32_bf16 v[104:107], v[112:115], v[128:131], v[104:107]
    v_mfma_f32_16x16x32_bf16 v[108:111], v[116:119], v[128:131], v[108:111]
    ds_read_b128 v[128:131], v246 offset:12288
    s_waitcnt lgkmcnt(6)
    v_mfma_f32_16x16x32_bf16 v[56:59], v[120:123], v[132:135], v[56:59]
    s_waitcnt lgkmcnt(2)
    v_mfma_f32_16x16x32_bf16 v[60:63], v[124:127], v[132:135], v[60:63]
    ds_read_b128 v[132:135], v246 offset:13312
    v_mfma_f32_16x16x32_bf16 v[64:67], v[120:123], v[136:139], v[64:67]
    s_waitcnt vmcnt(11)
    s_barrier
    s_add_u32 m0, s60, 118784
    s_add_u32 s63, s59, 205824
    buffer_load_dwordx4 v247, s[44:47], s63 offen  lds
    buffer_load_dwordx4 v248, s[44:47], s63 offen offset:1024  lds
    v_mfma_f32_16x16x32_bf16 v[68:71], v[124:127], v[136:139], v[68:71]
    ds_read_b128 v[136:139], v246 offset:14336
    v_mfma_f32_16x16x32_bf16 v[72:75], v[120:123], v[140:143], v[72:75]
    ds_read_b64_tr_b16 v[112:113], v244 offset:0
    v_mfma_f32_16x16x32_bf16 v[76:79], v[124:127], v[140:143], v[76:79]
    ds_read_b128 v[140:143], v246 offset:15360
    v_mfma_f32_16x16x32_bf16 v[80:83], v[120:123], v[144:147], v[80:83]
    ds_read_b64_tr_b16 v[114:115], v244 offset:4096
    v_mfma_f32_16x16x32_bf16 v[84:87], v[124:127], v[144:147], v[84:87]
    ds_read_b128 v[144:147], v246 offset:16384
    s_waitcnt lgkmcnt(7)
    v_mfma_f32_16x16x32_bf16 v[88:91], v[120:123], v[148:151], v[88:91]
    ds_read_b64_tr_b16 v[116:117], v245 offset:0
    v_mfma_f32_16x16x32_bf16 v[92:95], v[124:127], v[148:151], v[92:95]
    ds_read_b128 v[148:151], v246 offset:17408
    s_waitcnt lgkmcnt(8)
    v_mfma_f32_16x16x32_bf16 v[96:99], v[120:123], v[128:131], v[96:99]
    ds_read_b64_tr_b16 v[118:119], v245 offset:4096
    v_mfma_f32_16x16x32_bf16 v[100:103], v[124:127], v[128:131], v[100:103]
    ds_read_b128 v[128:131], v246 offset:18432
    s_waitcnt lgkmcnt(9)
    v_mfma_f32_16x16x32_bf16 v[104:107], v[120:123], v[132:135], v[104:107]
    v_mfma_f32_16x16x32_bf16 v[108:111], v[124:127], v[132:135], v[108:111]
    ds_read_b128 v[132:135], v246 offset:19456
    s_waitcnt lgkmcnt(6)
    v_mfma_f32_16x16x32_bf16 v[56:59], v[112:115], v[136:139], v[56:59]
    s_waitcnt lgkmcnt(2)
    v_mfma_f32_16x16x32_bf16 v[60:63], v[116:119], v[136:139], v[60:63]
    ds_read_b128 v[136:139], v246 offset:20480
    v_mfma_f32_16x16x32_bf16 v[64:67], v[112:115], v[140:143], v[64:67]
    s_waitcnt vmcnt(11)
    s_barrier
    v_mfma_f32_16x16x32_bf16 v[68:71], v[116:119], v[140:143], v[68:71]
    ds_read_b128 v[140:143], v246 offset:21504
    v_mfma_f32_16x16x32_bf16 v[72:75], v[112:115], v[144:147], v[72:75]
    ds_read_b64_tr_b16 v[120:121], v244 offset:8192
    v_mfma_f32_16x16x32_bf16 v[76:79], v[116:119], v[144:147], v[76:79]
    ds_read_b128 v[144:147], v246 offset:22528
    v_mfma_f32_16x16x32_bf16 v[80:83], v[112:115], v[148:151], v[80:83]
    ds_read_b64_tr_b16 v[122:123], v244 offset:12288
    v_mfma_f32_16x16x32_bf16 v[84:87], v[116:119], v[148:151], v[84:87]
    ds_read_b128 v[148:151], v246 offset:23552
    s_waitcnt lgkmcnt(7)
    v_mfma_f32_16x16x32_bf16 v[88:91], v[112:115], v[128:131], v[88:91]
    ds_read_b64_tr_b16 v[124:125], v245 offset:8192
    v_mfma_f32_16x16x32_bf16 v[92:95], v[116:119], v[128:131], v[92:95]
    ds_read_b128 v[128:131], v246 offset:24576
    s_waitcnt lgkmcnt(8)
    v_mfma_f32_16x16x32_bf16 v[96:99], v[112:115], v[132:135], v[96:99]
    ds_read_b64_tr_b16 v[126:127], v245 offset:12288
    v_mfma_f32_16x16x32_bf16 v[100:103], v[116:119], v[132:135], v[100:103]
    ds_read_b128 v[132:135], v246 offset:25600
    s_waitcnt lgkmcnt(9)
    v_mfma_f32_16x16x32_bf16 v[104:107], v[112:115], v[136:139], v[104:107]
    v_mfma_f32_16x16x32_bf16 v[108:111], v[116:119], v[136:139], v[108:111]
    ds_read_b128 v[136:139], v246 offset:26624
    s_waitcnt lgkmcnt(6)
    v_mfma_f32_16x16x32_bf16 v[56:59], v[120:123], v[140:143], v[56:59]
    s_waitcnt lgkmcnt(2)
    v_mfma_f32_16x16x32_bf16 v[60:63], v[124:127], v[140:143], v[60:63]
    ds_read_b128 v[140:143], v246 offset:27648
    v_mfma_f32_16x16x32_bf16 v[64:67], v[120:123], v[144:147], v[64:67]
    s_waitcnt vmcnt(2)
    s_barrier
    v_mfma_f32_16x16x32_bf16 v[68:71], v[124:127], v[144:147], v[68:71]
    ds_read_b128 v[144:147], v246 offset:28672
    v_mfma_f32_16x16x32_bf16 v[72:75], v[120:123], v[148:151], v[72:75]
    ds_read_b64_tr_b16 v[112:113], v244 offset:16384
    v_mfma_f32_16x16x32_bf16 v[76:79], v[124:127], v[148:151], v[76:79]
    ds_read_b128 v[148:151], v246 offset:29696
    v_mfma_f32_16x16x32_bf16 v[80:83], v[120:123], v[128:131], v[80:83]
    ds_read_b64_tr_b16 v[114:115], v244 offset:20480
    v_mfma_f32_16x16x32_bf16 v[84:87], v[124:127], v[128:131], v[84:87]
    ds_read_b128 v[128:131], v246 offset:30720
    s_waitcnt lgkmcnt(7)
    v_mfma_f32_16x16x32_bf16 v[88:91], v[120:123], v[132:135], v[88:91]
    ds_read_b64_tr_b16 v[116:117], v245 offset:16384
    v_mfma_f32_16x16x32_bf16 v[92:95], v[124:127], v[132:135], v[92:95]
    ds_read_b128 v[132:135], v246 offset:31744
    s_waitcnt lgkmcnt(8)
    v_mfma_f32_16x16x32_bf16 v[96:99], v[120:123], v[136:139], v[96:99]
    ds_read_b64_tr_b16 v[118:119], v245 offset:20480
    v_mfma_f32_16x16x32_bf16 v[100:103], v[124:127], v[136:139], v[100:103]
    ds_read_b128 v[136:139], v246 offset:32768
    s_waitcnt lgkmcnt(9)
    v_mfma_f32_16x16x32_bf16 v[104:107], v[120:123], v[140:143], v[104:107]
    v_mfma_f32_16x16x32_bf16 v[108:111], v[124:127], v[140:143], v[108:111]
    ds_read_b128 v[140:143], v246 offset:33792
    s_waitcnt lgkmcnt(6)
    v_mfma_f32_16x16x32_bf16 v[56:59], v[112:115], v[144:147], v[56:59]
    s_waitcnt lgkmcnt(2)
    v_mfma_f32_16x16x32_bf16 v[60:63], v[116:119], v[144:147], v[60:63]
    ds_read_b128 v[144:147], v246 offset:34816
    v_mfma_f32_16x16x32_bf16 v[64:67], v[112:115], v[148:151], v[64:67]
    s_waitcnt vmcnt(0)
    s_barrier
    v_mfma_f32_16x16x32_bf16 v[68:71], v[116:119], v[148:151], v[68:71]
    ds_read_b128 v[148:151], v246 offset:35840
    v_mfma_f32_16x16x32_bf16 v[72:75], v[112:115], v[128:131], v[72:75]
    ds_read_b64_tr_b16 v[120:121], v244 offset:24576
    v_mfma_f32_16x16x32_bf16 v[76:79], v[116:119], v[128:131], v[76:79]
    ds_read_b128 v[128:131], v246 offset:36864
    v_mfma_f32_16x16x32_bf16 v[80:83], v[112:115], v[132:135], v[80:83]
    ds_read_b64_tr_b16 v[122:123], v244 offset:28672
    v_mfma_f32_16x16x32_bf16 v[84:87], v[116:119], v[132:135], v[84:87]
    ds_read_b128 v[132:135], v246 offset:37888
    s_waitcnt lgkmcnt(7)
    v_mfma_f32_16x16x32_bf16 v[88:91], v[112:115], v[136:139], v[88:91]
    ds_read_b64_tr_b16 v[124:125], v245 offset:24576
    v_mfma_f32_16x16x32_bf16 v[92:95], v[116:119], v[136:139], v[92:95]
    ds_read_b128 v[136:139], v246 offset:38912
    s_waitcnt lgkmcnt(8)
    v_mfma_f32_16x16x32_bf16 v[96:99], v[112:115], v[140:143], v[96:99]
    ds_read_b64_tr_b16 v[126:127], v245 offset:28672
    v_mfma_f32_16x16x32_bf16 v[100:103], v[116:119], v[140:143], v[100:103]
    ds_read_b128 v[140:143], v246 offset:39936
    s_waitcnt lgkmcnt(9)
    v_mfma_f32_16x16x32_bf16 v[104:107], v[112:115], v[144:147], v[104:107]
    v_mfma_f32_16x16x32_bf16 v[108:111], v[116:119], v[144:147], v[108:111]
    ds_read_b128 v[144:147], v246 offset:40960
    s_waitcnt lgkmcnt(6)
    v_mfma_f32_16x16x32_bf16 v[56:59], v[120:123], v[148:151], v[56:59]
    s_waitcnt lgkmcnt(2)
    v_mfma_f32_16x16x32_bf16 v[60:63], v[124:127], v[148:151], v[60:63]
    ds_read_b128 v[148:151], v246 offset:41984
    v_mfma_f32_16x16x32_bf16 v[64:67], v[120:123], v[128:131], v[64:67]
    v_mfma_f32_16x16x32_bf16 v[68:71], v[124:127], v[128:131], v[68:71]
    s_nop 2
    v_cvt_pk_bf16_f32 v28, v56, v57
    v_cvt_pk_bf16_f32 v29, v58, v59
    v_mfma_f32_16x16x32_bf16 v[72:75], v[120:123], v[132:135], v[72:75]
    v_cvt_pk_bf16_f32 v30, v60, v61
    v_cvt_pk_bf16_f32 v31, v62, v63
    s_mov_b32 s61, 28672
    s_cmp_lg_u32 s54, 4
    s_cbranch_scc1 op_k28
    s_mov_b32 s61, 0x100000
    ds_write_b128 v249, v[28:31] offset:12288
op_k28:
    buffer_store_dwordx4 v[28:31], v246, s[76:79], s61 offen offset:0 sc1
    v_mfma_f32_16x16x32_bf16 v[76:79], v[124:127], v[132:135], v[76:79]
    v_cvt_pk_bf16_f32 v32, v64, v65
    v_cvt_pk_bf16_f32 v33, v66, v67
    v_mfma_f32_16x16x32_bf16 v[80:83], v[120:123], v[136:139], v[80:83]
    v_cvt_pk_bf16_f32 v34, v68, v69
    v_cvt_pk_bf16_f32 v35, v70, v71
    s_mov_b32 s61, 28672
    s_cmp_lg_u32 s54, 5
    s_cbranch_scc1 op_k29
    s_mov_b32 s61, 0x100000
    ds_write_b128 v249, v[32:35] offset:12288
op_k29:
    buffer_store_dwordx4 v[32:35], v246, s[76:79], s61 offen offset:1024 sc1
    v_mfma_f32_16x16x32_bf16 v[84:87], v[124:127], v[136:139], v[84:87]
    v_cvt_pk_bf16_f32 v36, v72, v73
    v_cvt_pk_bf16_f32 v37, v74, v75
    s_waitcnt lgkmcnt(2)
    v_mfma_f32_16x16x32_bf16 v[88:91], v[120:123], v[140:143], v[88:91]
    v_cvt_pk_bf16_f32 v38, v76, v77
    v_cvt_pk_bf16_f32 v39, v78, v79
    s_mov_b32 s61, 28672
    s_cmp_lg_u32 s54, 6
    s_cbranch_scc1 op_k30
    s_mov_b32 s61, 0x100000
    ds_write_b128 v249, v[36:39] offset:12288
op_k30:
    buffer_store_dwordx4 v[36:39], v246, s[76:79], s61 offen offset:2048 sc1
    v_mfma_f32_16x16x32_bf16 v[92:95], v[124:127], v[140:143], v[92:95]
    v_cvt_pk_bf16_f32 v40, v80, v81
    v_cvt_pk_bf16_f32 v41, v82, v83
    s_waitcnt lgkmcnt(1)
    v_mfma_f32_16x16x32_bf16 v[96:99], v[120:123], v[144:147], v[96:99]
    v_cvt_pk_bf16_f32 v42, v84, v85
    v_cvt_pk_bf16_f32 v43, v86, v87
    s_mov_b32 s61, 28672
    s_cmp_lg_u32 s54, 7
    s_cbranch_scc1 op_k31
    s_mov_b32 s61, 0x100000
    ds_write_b128 v249, v[40:43] offset:12288
op_k31:
    buffer_store_dwordx4 v[40:43], v246, s[76:79], s61 offen offset:3072 sc1
    v_mfma_f32_16x16x32_bf16 v[100:103], v[124:127], v[144:147], v[100:103]
    v_cvt_pk_bf16_f32 v44, v88, v89
    v_cvt_pk_bf16_f32 v45, v90, v91
    s_waitcnt lgkmcnt(0)
    v_mfma_f32_16x16x32_bf16 v[104:107], v[120:123], v[148:151], v[104:107]
    v_cvt_pk_bf16_f32 v46, v92, v93
    v_cvt_pk_bf16_f32 v47, v94, v95
    s_mov_b32 s61, 32768
    s_cmp_lg_u32 s54, 0
    s_cbranch_scc1 op_k32
    s_mov_b32 s61, 0x100000
    ds_write_b128 v249, v[44:47] offset:16384
op_k32:
    buffer_store_dwordx4 v[44:47], v246, s[76:79], s61 offen offset:0 sc1
    v_mfma_f32_16x16x32_bf16 v[108:111], v[124:127], v[148:151], v[108:111]
    v_cvt_pk_bf16_f32 v48, v96, v97
    v_cvt_pk_bf16_f32 v49, v98, v99
    v_cvt_pk_bf16_f32 v50, v100, v101
    v_cvt_pk_bf16_f32 v51, v102, v103
    s_mov_b32 s61, 32768
    s_cmp_lg_u32 s54, 1
    s_cbranch_scc1 op_k33
    s_mov_b32 s61, 0x100000
    ds_write_b128 v249, v[48:51] offset:16384
op_k33:
    buffer_store_dwordx4 v[48:51], v246, s[76:79], s61 offen offset:1024 sc1
    v_cvt_pk_bf16_f32 v52, v104, v105
    v_cvt_pk_bf16_f32 v53, v106, v107
    v_cvt_pk_bf16_f32 v54, v108, v109
    v_cvt_pk_bf16_f32 v55, v110, v111
    s_mov_b32 s61, 32768
    s_cmp_lg_u32 s54, 2
    s_cbranch_scc1 op_k34
    s_mov_b32 s61, 0x100000
    ds_write_b128 v249, v[52:55] offset:16384
op_k34:
    buffer_store_dwordx4 v[52:55], v246, s[76:79], s61 offen offset:2048 sc1
    s_barrier
    s_barrier
    s_barrier
    s_barrier
    s_barrier
    s_branch k1_final
k1_q1:
    v_mbcnt_lo_u32_b32 v2, -1, 0
    v_mbcnt_hi_u32_b32 v2, -1, v2
    v_and_b32 v3, 15, v2
    v_lshrrev_b32 v4, 4, v2
    v_lshrrev_b32 v5, 2, v2
    v_and_b32 v6, 3, v5
    v_and_b32 v7, 3, v2
    v_lshrrev_b32 v8, 3, v2
    v_and_b32 v9, 7, v2
    v_lshrrev_b32 v13, 1, v8
    v_and_b32 v13, 3, v13
    v_lshlrev_b32 v13, 1, v13
    v_xor_b32 v13, v9, v13
    v_lshlrev_b32 v13, 4, v13
    v_mul_u32_u24 v14, 1280, v8
    v_add_u32 v246, v13, v14
    v_mul_u32_u24 v14, 384, v8
    v_add_u32 v255, v13, v14
    s_mul_i32 s70, s56, 10240
    s_lshl_b32 s71, s56, 10
    s_sub_u32 s73, s71, 2048
    s_add_u32 s73, s73, 159744
    s_and_b32 s62, s56, 1
    s_lshl_b32 s62, s62, 2
    v_xor_b32 v16, s62, v9
    s_mul_i32 s58, s56, 98304
    v_add_u32 v10, 0, v8
    v_mul_u32_u24 v11, 43, v10
    v_lshrrev_b32 v11, 7, v11
    v_mul_u32_u24 v12, 3, v11
    v_sub_u32 v12, v10, v12
    v_lshrrev_b32 v13, 1, v11
    v_and_b32 v14, 1, v13
    v_xor_b32 v14, v16, v14
    v_lshlrev_b32 v14, 4, v14
    v_lshl_add_u32 v14, v12, 7, v14
    v_mul_u32_u24 v15, 12288, v11
    v_add_u32 v14, v14, v15
    v_subrev_u32 v243, 0, v14
    v_add_u32 v10, 8, v8
    v_mul_u32_u24 v11, 43, v10
    v_lshrrev_b32 v11, 7, v11
    v_mul_u32_u24 v12, 3, v11
    v_sub_u32 v12, v10, v12
    v_lshrrev_b32 v13, 1, v11
    v_and_b32 v14, 1, v13
    v_xor_b32 v14, v16, v14
    v_lshlrev_b32 v14, 4, v14
    v_lshl_add_u32 v14, v12, 7, v14
    v_mul_u32_u24 v15, 12288, v11
    v_add_u32 v14, v14, v15
    v_subrev_u32 v244, 1024, v14
    v_add_u32 v10, 16, v8
    v_mul_u32_u24 v11, 43, v10
    v_lshrrev_b32 v11, 7, v11
    v_mul_u32_u24 v12, 3, v11
    v_sub_u32 v12, v10, v12
    v_lshrrev_b32 v13, 1, v11
    v_and_b32 v14, 1, v13
    v_xor_b32 v14, v16, v14
    v_lshlrev_b32 v14, 4, v14
    v_lshl_add_u32 v14, v12, 7, v14
    v_mul_u32_u24 v15, 12288, v11
    v_add_u32 v14, v14, v15
    v_subrev_u32 v245, 2048, v14
    s_waitcnt lgkmcnt(0)
    s_and_b32 s62, s2, 7
    s_cmp_lt_u32 s62, 4
    s_cselect_b64 s[4:5], s[4:5], s[14:15]
    s_cselect_b64 s[10:11], s[10:11], s[20:21]
    s_mul_i32 s63, s53, 143360
    s_add_u32 s48, s4, s63
    s_addc_u32 s49, s5, 0
    s_mul_i32 s63, s54, 1536
    s_add_u32 s40, s10, s63
    s_addc_u32 s41, s11, 0
    s_sub_u32 s42, 7864320, s63
    s_and_b32 s62, s2, 7
    s_cmp_lt_u32 s62, 4
    s_cselect_b64 s[6:7], s[6:7], s[16:17]
    s_cselect_b64 s[8:9], s[8:9], s[18:19]
    s_cselect_b64 s[12:13], s[12:13], s[22:23]
    s_cselect_b32 s3, 0, 16
    s_add_u32 s3, s3, s53
    s_lshl_b32 s62, s53, 3
    s_add_u32 s62, s62, s54
    s_mul_i32 s63, s62, 786432
    s_add_u32 s32, s6, s63
    s_addc_u32 s33, s7, 0
    s_add_u32 s36, s8, s63
    s_addc_u32 s37, s9, 0
    s_mul_i32 s63, s54, 983040
    s_add_u32 s44, s12, s63
    s_addc_u32 s45, s13, 0
    s_lshl_b32 s62, s3, 3
    s_add_u32 s62, s62, s54
    s_mul_i32 s61, s62, 143360
    s_mul_i32 s63, s56, 35840
    s_add_u32 s61, s61, s63
    s_add_u32 s61, s61, 1048576
    s_add_u32 s76, s28, s61
    s_addc_u32 s77, s29, 0
    s_cmp_lg_u32 s52, 4
    s_cbranch_scc1 k1_noclr
    s_lshl_b32 s62, s62, 7
    s_add_u32 s62, s62, 0
    s_add_u32 s4, s28, s62
    s_addc_u32 s5, s29, 0
    s_mov_b32 s6, 128
    s_mov_b32 s7, 0x20000
    v_mov_b32 v204, 0
    v_mov_b32 v205, 0
    s_mov_b64 exec, 1
    buffer_store_dwordx2 v[204:205], v204, s[4:7], 0 offen sc1
    s_mov_b64 exec, -1
k1_noclr:
    s_cmp_lg_u32 s52, 7
    s_cbranch_scc1 k1_nocpf
    s_getpc_b64 s[4:5]
k1_pc:
    s_sub_u32 s4, s4, k1_pc-k1_q0
    s_subb_u32 s5, s5, 0
    s_lshr_b32 s62, s2, 3
    s_and_b32 s62, s62, 31
    s_lshl_b32 s62, s62, 7
    v_lshlrev_b32 v10, 12, v2
    v_add_u32 v10, s62, v10
    v_min_u32 v10, k1_end-k1_q0, v10
    v_mov_b32 v11, s5
    v_add_co_u32 v10, vcc, s4, v10
    s_nop 1
    v_addc_co_u32 v11, vcc, 0, v11, vcc
    global_load_dword v247, v[10:11], off
k1_nocpf:
    v_lshrrev_b32 v8, 1, v3
    v_and_b32 v8, 3, v8
    v_lshlrev_b32 v8, 1, v8
    v_xor_b32 v8, v4, v8
    v_lshlrev_b32 v8, 4, v8
    v_lshl_add_u32 v9, v3, 7, v8
    v_add_u32 v238, 0, v9
    v_xor_b32 v239, 64, v238
    v_lshl_add_u32 v8, v4, 3, v6
    v_mul_u32_u24 v9, 384, v8
    v_lshrrev_b32 v8, 1, v6
    v_and_b32 v11, 1, v4
    v_lshl_add_u32 v8, v11, 2, v8
    v_xor_b32 v8, v7, v8
    v_lshl_add_u32 v9, v8, 4, v9
    v_lshlrev_b32 v12, 3, v11
    v_lshl_add_u32 v12, v2, 4, v12
    v_and_b32 v11, 1, v7
    v_lshl_add_u32 v11, v11, 3, v9
    s_mov_b32 s66, 0x3dd53b95
    s_mov_b32 s67, s66
    s_mul_i32 s62, s56, 3
    s_add_u32 s62, s62, 0
    s_and_b32 s61, s62, 2
    s_lshl_b32 s61, s61, 5
    s_and_b32 s63, s62, 1
    s_lshl_b32 s63, s63, 3
    v_xor_b32 v248, s63, v12
    s_or_b32 s61, s61, s63
    v_xor_b32 v13, s61, v11
    s_lshr_b32 s63, s62, 2
    s_lshl_b32 s63, s63, 7
    v_add_u32 v13, s63, v13
    v_add_u32 v235, 43008, v13
    v_add_u32 v232, 94208, v13
    s_lshr_b32 s62, s62, 1
    s_mul_i32 s63, s62, 7168
    v_add_u32 v248, s63, v248
    s_cmp_lt_u32 s62, 3
    s_cselect_b32 s61, 88064, 0
    s_sub_u32 s61, s61, 12288
    s_lshl_b32 s63, s62, 10
    s_sub_u32 s63, s61, s63
    v_add_u32 v240, s63, v248
    s_mul_i32 s63, s62, 6144
    v_subrev_u32 v251, s63, v248
    s_mul_i32 s62, s56, 3
    s_add_u32 s62, s62, 1
    s_and_b32 s61, s62, 2
    s_lshl_b32 s61, s61, 5
    s_and_b32 s63, s62, 1
    s_lshl_b32 s63, s63, 3
    v_xor_b32 v249, s63, v12
    s_or_b32 s61, s61, s63
    v_xor_b32 v13, s61, v11
    s_lshr_b32 s63, s62, 2
    s_lshl_b32 s63, s63, 7
    v_add_u32 v13, s63, v13
    v_add_u32 v236, 43008, v13
    v_add_u32 v233, 94208, v13
    s_lshr_b32 s62, s62, 1
    s_mul_i32 s63, s62, 7168
    v_add_u32 v249, s63, v249
    s_cmp_lt_u32 s62, 3
    s_cselect_b32 s61, 88064, 0
    s_sub_u32 s61, s61, 12288
    s_lshl_b32 s63, s62, 10
    s_sub_u32 s63, s61, s63
    v_add_u32 v241, s63, v249
    s_mul_i32 s63, s62, 6144
    v_subrev_u32 v252, s63, v249
    s_mul_i32 s62, s56, 3
    s_add_u32 s62, s62, 2
    s_and_b32 s61, s62, 2
    s_lshl_b32 s61, s61, 5
    s_and_b32 s63, s62, 1
    s_lshl_b32 s63, s63, 3
    v_xor_b32 v250, s63, v12
    s_or_b32 s61, s61, s63
    v_xor_b32 v13, s61, v11
    s_lshr_b32 s63, s62, 2
    s_lshl_b32 s63, s63, 7
    v_add_u32 v13, s63, v13
    v_add_u32 v237, 43008, v13
    v_add_u32 v234, 94208, v13
    s_lshr_b32 s62, s62, 1
    s_mul_i32 s63, s62, 7168
    v_add_u32 v250, s63, v250
    s_cmp_lt_u32 s62, 3
    s_cselect_b32 s61, 88064, 0
    s_sub_u32 s61, s61, 12288
    s_lshl_b32 s63, s62, 10
    s_sub_u32 s63, s61, s63
    v_add_u32 v242, s63, v250
    s_mul_i32 s63, s62, 6144
    v_subrev_u32 v253, s63, v250
    s_cmp_lg_u32 s52, 4
    s_cbranch_scc1 k1_nocnt
    s_mov_b32 s4, s26
    s_mov_b32 s5, s27
    s_mov_b32 s6, 256
    s_mov_b32 s7, 0x20000
    s_lshl_b32 s62, s3, 2
    v_mov_b32 v204, 0
    v_mov_b32 v206, 1
    s_mov_b64 exec, 1
    s_waitcnt vmcnt(0)
    buffer_atomic_add v206, v204, s[4:7], s62 offen sc1
    s_mov_b64 exec, -1
k1_nocnt:
    s_barrier
    ds_read_b64_tr_b16 v[168:169], v232 offset:12288
    ds_read_b64_tr_b16 v[170:171], v232 offset:13824
    ds_read_b128 v[216:219], v238 offset:0
    ds_read_b128 v[220:223], v238 offset:2048
    ds_read_b64_tr_b16 v[172:173], v233 offset:12288
    ds_read_b64_tr_b16 v[174:175], v233 offset:13824
    ds_read_b64_tr_b16 v[176:177], v234 offset:12288
    ds_read_b64_tr_b16 v[178:179], v234 offset:13824
    ds_read_b64_tr_b16 v[180:181], v232 offset:24576
    ds_read_b64_tr_b16 v[182:183], v232 offset:26112
    ds_read_b64_tr_b16 v[184:185], v233 offset:24576
    ds_read_b64_tr_b16 v[186:187], v233 offset:26112
    ds_read_b64_tr_b16 v[188:189], v234 offset:24576
    ds_read_b64_tr_b16 v[190:191], v234 offset:26112
    ds_read_b128 v[224:227], v238 offset:4096
    ds_read_b128 v[228:231], v238 offset:6144
    s_waitcnt lgkmcnt(13)
    v_mfma_f32_16x16x32_bf16 v[0:3], v[168:171], v[216:219], 0
    s_waitcnt lgkmcnt(10)
    v_mfma_f32_16x16x32_bf16 v[4:7], v[172:175], v[216:219], 0
    s_waitcnt lgkmcnt(8)
    v_mfma_f32_16x16x32_bf16 v[8:11], v[176:179], v[216:219], 0
    v_mfma_f32_16x16x32_bf16 v[12:15], v[168:171], v[220:223], 0
    v_mfma_f32_16x16x32_bf16 v[16:19], v[172:175], v[220:223], 0
    v_mfma_f32_16x16x32_bf16 v[20:23], v[176:179], v[220:223], 0
    s_waitcnt lgkmcnt(6)
    v_mfma_f32_16x16x32_bf16 v[84:87], v[180:183], v[216:219], 0
    s_waitcnt lgkmcnt(4)
    v_mfma_f32_16x16x32_bf16 v[88:91], v[184:187], v[216:219], 0
    s_waitcnt lgkmcnt(2)
    s_barrier
    v_mfma_f32_16x16x32_bf16 v[92:95], v[188:191], v[216:219], 0
    ds_read_b128 v[216:219], v238 offset:8192
    v_mfma_f32_16x16x32_bf16 v[96:99], v[180:183], v[220:223], 0
    v_mfma_f32_16x16x32_bf16 v[100:103], v[184:187], v[220:223], 0
    ds_read_b64_tr_b16 v[192:193], v235 offset:12288
    v_mfma_f32_16x16x32_bf16 v[104:107], v[188:191], v[220:223], 0
    ds_read_b128 v[220:223], v238 offset:10240
    s_waitcnt lgkmcnt(4)
    v_mfma_f32_16x16x32_bf16 v[24:27], v[168:171], v[224:227], 0
    v_mfma_f32_16x16x32_bf16 v[28:31], v[172:175], v[224:227], 0
    ds_read_b64_tr_b16 v[194:195], v235 offset:13824
    v_mfma_f32_16x16x32_bf16 v[32:35], v[176:179], v[224:227], 0
    v_mfma_f32_16x16x32_bf16 v[108:111], v[180:183], v[224:227], 0
    v_mfma_f32_16x16x32_bf16 v[112:115], v[184:187], v[224:227], 0
    ds_read_b64_tr_b16 v[196:197], v236 offset:12288
    v_mfma_f32_16x16x32_bf16 v[116:119], v[188:191], v[224:227], 0
    ds_read_b128 v[224:227], v238 offset:12288
    s_waitcnt lgkmcnt(6)
    v_mfma_f32_16x16x32_bf16 v[36:39], v[168:171], v[228:231], 0
    v_mfma_f32_16x16x32_bf16 v[40:43], v[172:175], v[228:231], 0
    ds_read_b64_tr_b16 v[198:199], v236 offset:13824
    v_mfma_f32_16x16x32_bf16 v[44:47], v[176:179], v[228:231], 0
    v_mfma_f32_16x16x32_bf16 v[120:123], v[180:183], v[228:231], 0
    v_mfma_f32_16x16x32_bf16 v[124:127], v[184:187], v[228:231], 0
    ds_read_b64_tr_b16 v[200:201], v237 offset:12288
    v_mfma_f32_16x16x32_bf16 v[128:131], v[188:191], v[228:231], 0
    ds_read_b128 v[228:231], v239 offset:0
    s_waitcnt lgkmcnt(8)
    v_mfma_f32_16x16x32_bf16 v[48:51], v[168:171], v[216:219], 0
    v_mfma_f32_16x16x32_bf16 v[52:55], v[172:175], v[216:219], 0
    ds_read_b64_tr_b16 v[202:203], v237 offset:13824
    v_mfma_f32_16x16x32_bf16 v[56:59], v[176:179], v[216:219], 0
    v_mfma_f32_16x16x32_bf16 v[132:135], v[180:183], v[216:219], 0
    v_mfma_f32_16x16x32_bf16 v[136:139], v[184:187], v[216:219], 0
    s_waitcnt lgkmcnt(0)
    s_barrier
    v_mfma_f32_16x16x32_bf16 v[140:143], v[188:191], v[216:219], 0
    ds_read_b128 v[216:219], v239 offset:2048
    v_mfma_f32_16x16x32_bf16 v[60:63], v[168:171], v[220:223], 0
    ds_read_b64_tr_b16 v[204:205], v235 offset:24576
    v_mfma_f32_16x16x32_bf16 v[64:67], v[172:175], v[220:223], 0
    v_mfma_f32_16x16x32_bf16 v[68:71], v[176:179], v[220:223], 0
    ds_read_b64_tr_b16 v[206:207], v235 offset:26112
    v_mfma_f32_16x16x32_bf16 v[144:147], v[180:183], v[220:223], 0
    v_mfma_f32_16x16x32_bf16 v[148:151], v[184:187], v[220:223], 0
    ds_read_b64_tr_b16 v[208:209], v236 offset:24576
    v_mfma_f32_16x16x32_bf16 v[152:155], v[188:191], v[220:223], 0
    ds_read_b128 v[220:223], v239 offset:4096
    v_mfma_f32_16x16x32_bf16 v[72:75], v[168:171], v[224:227], 0
    ds_read_b64_tr_b16 v[210:211], v236 offset:26112
    v_mfma_f32_16x16x32_bf16 v[76:79], v[172:175], v[224:227], 0
    v_mfma_f32_16x16x32_bf16 v[80:83], v[176:179], v[224:227], 0
    ds_read_b64_tr_b16 v[212:213], v237 offset:24576
    v_mfma_f32_16x16x32_bf16 v[156:159], v[180:183], v[224:227], 0
    v_mfma_f32_16x16x32_bf16 v[160:163], v[184:187], v[224:227], 0
    ds_read_b64_tr_b16 v[214:215], v237 offset:26112
    v_mfma_f32_16x16x32_bf16 v[164:167], v[188:191], v[224:227], 0
    ds_read_b128 v[224:227], v239 offset:6144
    v_mfma_f32_16x16x32_bf16 v[0:3], v[192:195], v[228:231], v[0:3]
    v_mfma_f32_16x16x32_bf16 v[4:7], v[196:199], v[228:231], v[4:7]
    v_mfma_f32_16x16x32_bf16 v[8:11], v[200:203], v[228:231], v[8:11]
    s_waitcnt lgkmcnt(8)
    v_mfma_f32_16x16x32_bf16 v[12:15], v[192:195], v[216:219], v[12:15]
    v_mfma_f32_16x16x32_bf16 v[16:19], v[196:199], v[216:219], v[16:19]
    v_mfma_f32_16x16x32_bf16 v[20:23], v[200:203], v[216:219], v[20:23]
    s_waitcnt lgkmcnt(6)
    v_mfma_f32_16x16x32_bf16 v[84:87], v[204:207], v[228:231], v[84:87]
    s_waitcnt lgkmcnt(3)
    v_mfma_f32_16x16x32_bf16 v[88:91], v[208:211], v[228:231], v[88:91]
    s_waitcnt lgkmcnt(1)
    s_barrier
    v_mfma_f32_16x16x32_bf16 v[92:95], v[212:215], v[228:231], v[92:95]
    ds_read_b128 v[228:231], v239 offset:8192
    v_mfma_f32_16x16x32_bf16 v[96:99], v[204:207], v[216:219], v[96:99]
    v_mfma_f32_16x16x32_bf16 v[100:103], v[208:211], v[216:219], v[100:103]
    ds_read_b64_tr_b16 v[168:169], v232 offset:12288
    v_mfma_f32_16x16x32_bf16 v[104:107], v[212:215], v[216:219], v[104:107]
    ds_read_b128 v[216:219], v239 offset:10240
    v_mfma_f32_16x16x32_bf16 v[24:27], v[192:195], v[220:223], v[24:27]
    v_mfma_f32_16x16x32_bf16 v[28:31], v[196:199], v[220:223], v[28:31]
    ds_read_b64_tr_b16 v[170:171], v232 offset:13824
    v_mfma_f32_16x16x32_bf16 v[32:35], v[200:203], v[220:223], v[32:35]
    v_mfma_f32_16x16x32_bf16 v[108:111], v[204:207], v[220:223], v[108:111]
    v_mfma_f32_16x16x32_bf16 v[112:115], v[208:211], v[220:223], v[112:115]
    ds_read_b64_tr_b16 v[172:173], v233 offset:12288
    v_mfma_f32_16x16x32_bf16 v[116:119], v[212:215], v[220:223], v[116:119]
    ds_read_b128 v[220:223], v239 offset:12288
    s_waitcnt lgkmcnt(6)
    v_mfma_f32_16x16x32_bf16 v[36:39], v[192:195], v[224:227], v[36:39]
    v_mfma_f32_16x16x32_bf16 v[40:43], v[196:199], v[224:227], v[40:43]
    ds_read_b64_tr_b16 v[174:175], v233 offset:13824
    v_mfma_f32_16x16x32_bf16 v[44:47], v[200:203], v[224:227], v[44:47]
    v_mfma_f32_16x16x32_bf16 v[120:123], v[204:207], v[224:227], v[120:123]
    v_mfma_f32_16x16x32_bf16 v[124:127], v[208:211], v[224:227], v[124:127]
    ds_read_b64_tr_b16 v[176:177], v234 offset:12288
    v_mfma_f32_16x16x32_bf16 v[128:131], v[212:215], v[224:227], v[128:131]
    ds_read_b128 v[224:227], v238 offset:14336
    s_waitcnt lgkmcnt(8)
    v_mfma_f32_16x16x32_bf16 v[48:51], v[192:195], v[228:231], v[48:51]
    v_mfma_f32_16x16x32_bf16 v[52:55], v[196:199], v[228:231], v[52:55]
    ds_read_b64_tr_b16 v[178:179], v234 offset:13824
    v_mfma_f32_16x16x32_bf16 v[56:59], v[200:203], v[228:231], v[56:59]
    v_mfma_f32_16x16x32_bf16 v[132:135], v[204:207], v[228:231], v[132:135]
    v_mfma_f32_16x16x32_bf16 v[136:139], v[208:211], v[228:231], v[136:139]
    s_waitcnt lgkmcnt(0)
    s_barrier
    v_mfma_f32_16x16x32_bf16 v[140:143], v[212:215], v[228:231], v[140:143]
    ds_read_b128 v[228:231], v238 offset:16384
    v_mfma_f32_16x16x32_bf16 v[60:63], v[192:195], v[216:219], v[60:63]
    ds_read_b64_tr_b16 v[180:181], v232 offset:24576
    v_mfma_f32_16x16x32_bf16 v[64:67], v[196:199], v[216:219], v[64:67]
    v_mfma_f32_16x16x32_bf16 v[68:71], v[200:203], v[216:219], v[68:71]
    ds_read_b64_tr_b16 v[182:183], v232 offset:26112
    v_mfma_f32_16x16x32_bf16 v[144:147], v[204:207], v[216:219], v[144:147]
    v_mfma_f32_16x16x32_bf16 v[148:151], v[208:211], v[216:219], v[148:151]
    ds_read_b64_tr_b16 v[184:185], v233 offset:24576
    v_mfma_f32_16x16x32_bf16 v[152:155], v[212:215], v[216:219], v[152:155]
    ds_read_b128 v[216:219], v238 offset:18432
    v_mfma_f32_16x16x32_bf16 v[72:75], v[192:195], v[220:223], v[72:75]
    ds_read_b64_tr_b16 v[186:187], v233 offset:26112
    v_mfma_f32_16x16x32_bf16 v[76:79], v[196:199], v[220:223], v[76:79]
    v_mfma_f32_16x16x32_bf16 v[80:83], v[200:203], v[220:223], v[80:83]
    ds_read_b64_tr_b16 v[188:189], v234 offset:24576
    v_mfma_f32_16x16x32_bf16 v[156:159], v[204:207], v[220:223], v[156:159]
    v_mfma_f32_16x16x32_bf16 v[160:163], v[208:211], v[220:223], v[160:163]
    ds_read_b64_tr_b16 v[190:191], v234 offset:26112
    v_mfma_f32_16x16x32_bf16 v[164:167], v[212:215], v[220:223], v[164:167]
    ds_read_b128 v[220:223], v238 offset:20480
    v_mfma_f32_16x16x32_bf16 v[0:3], v[168:171], v[224:227], v[0:3]
    v_mfma_f32_16x16x32_bf16 v[4:7], v[172:175], v[224:227], v[4:7]
    v_mfma_f32_16x16x32_bf16 v[8:11], v[176:179], v[224:227], v[8:11]
    s_waitcnt lgkmcnt(8)
    v_mfma_f32_16x16x32_bf16 v[12:15], v[168:171], v[228:231], v[12:15]
    v_mfma_f32_16x16x32_bf16 v[16:19], v[172:175], v[228:231], v[16:19]
    v_mfma_f32_16x16x32_bf16 v[20:23], v[176:179], v[228:231], v[20:23]
    s_waitcnt lgkmcnt(6)
    v_mfma_f32_16x16x32_bf16 v[84:87], v[180:183], v[224:227], v[84:87]
    s_waitcnt lgkmcnt(3)
    v_mfma_f32_16x16x32_bf16 v[88:91], v[184:187], v[224:227], v[88:91]
    s_waitcnt lgkmcnt(1)
    s_barrier
    v_mfma_f32_16x16x32_bf16 v[92:95], v[188:191], v[224:227], v[92:95]
    ds_read_b128 v[224:227], v238 offset:22528
    v_mfma_f32_16x16x32_bf16 v[96:99], v[180:183], v[228:231], v[96:99]
    v_mfma_f32_16x16x32_bf16 v[100:103], v[184:187], v[228:231], v[100:103]
    ds_read_b64_tr_b16 v[192:193], v235 offset:12288
    v_mfma_f32_16x16x32_bf16 v[104:107], v[188:191], v[228:231], v[104:107]
    ds_read_b128 v[228:231], v238 offset:24576
    v_mfma_f32_16x16x32_bf16 v[24:27], v[168:171], v[216:219], v[24:27]
    v_mfma_f32_16x16x32_bf16 v[28:31], v[172:175], v[216:219], v[28:31]
    ds_read_b64_tr_b16 v[194:195], v235 offset:13824
    v_mfma_f32_16x16x32_bf16 v[32:35], v[176:179], v[216:219], v[32:35]
    v_mfma_f32_16x16x32_bf16 v[108:111], v[180:183], v[216:219], v[108:111]
    v_mfma_f32_16x16x32_bf16 v[112:115], v[184:187], v[216:219], v[112:115]
    ds_read_b64_tr_b16 v[196:197], v236 offset:12288
    v_mfma_f32_16x16x32_bf16 v[116:119], v[188:191], v[216:219], v[116:119]
    ds_read_b128 v[216:219], v238 offset:26624
    s_waitcnt lgkmcnt(6)
    v_mfma_f32_16x16x32_bf16 v[36:39], v[168:171], v[220:223], v[36:39]
    v_mfma_f32_16x16x32_bf16 v[40:43], v[172:175], v[220:223], v[40:43]
    ds_read_b64_tr_b16 v[198:199], v236 offset:13824
    v_mfma_f32_16x16x32_bf16 v[44:47], v[176:179], v[220:223], v[44:47]
    v_mfma_f32_16x16x32_bf16 v[120:123], v[180:183], v[220:223], v[120:123]
    v_mfma_f32_16x16x32_bf16 v[124:127], v[184:187], v[220:223], v[124:127]
    ds_read_b64_tr_b16 v[200:201], v237 offset:12288
    v_mfma_f32_16x16x32_bf16 v[128:131], v[188:191], v[220:223], v[128:131]
    ds_read_b128 v[220:223], v239 offset:14336
    s_waitcnt lgkmcnt(8)
    v_mfma_f32_16x16x32_bf16 v[48:51], v[168:171], v[224:227], v[48:51]
    v_mfma_f32_16x16x32_bf16 v[52:55], v[172:175], v[224:227], v[52:55]
    ds_read_b64_tr_b16 v[202:203], v237 offset:13824
    v_mfma_f32_16x16x32_bf16 v[56:59], v[176:179], v[224:227], v[56:59]
    v_mfma_f32_16x16x32_bf16 v[132:135], v[180:183], v[224:227], v[132:135]
    v_mfma_f32_16x16x32_bf16 v[136:139], v[184:187], v[224:227], v[136:139]
    s_waitcnt lgkmcnt(0)
    s_barrier
    v_mfma_f32_16x16x32_bf16 v[140:143], v[188:191], v[224:227], v[140:143]
    ds_read_b128 v[224:227], v239 offset:16384
    v_mfma_f32_16x16x32_bf16 v[60:63], v[168:171], v[228:231], v[60:63]
    ds_read_b64_tr_b16 v[204:205], v235 offset:24576
    v_mfma_f32_16x16x32_bf16 v[64:67], v[172:175], v[228:231], v[64:67]
    v_mfma_f32_16x16x32_bf16 v[68:71], v[176:179], v[228:231], v[68:71]
    ds_read_b64_tr_b16 v[206:207], v235 offset:26112
    v_mfma_f32_16x16x32_bf16 v[144:147], v[180:183], v[228:231], v[144:147]
    v_mfma_f32_16x16x32_bf16 v[148:151], v[184:187], v[228:231], v[148:151]
    ds_read_b64_tr_b16 v[208:209], v236 offset:24576
    v_mfma_f32_16x16x32_bf16 v[152:155], v[188:191], v[228:231], v[152:155]
    ds_read_b128 v[228:231], v239 offset:18432
    v_mfma_f32_16x16x32_bf16 v[72:75], v[168:171], v[216:219], v[72:75]
    ds_read_b64_tr_b16 v[210:211], v236 offset:26112
    v_mfma_f32_16x16x32_bf16 v[76:79], v[172:175], v[216:219], v[76:79]
    v_mfma_f32_16x16x32_bf16 v[80:83], v[176:179], v[216:219], v[80:83]
    ds_read_b64_tr_b16 v[212:213], v237 offset:24576
    v_mfma_f32_16x16x32_bf16 v[156:159], v[180:183], v[216:219], v[156:159]
    v_mfma_f32_16x16x32_bf16 v[160:163], v[184:187], v[216:219], v[160:163]
    ds_read_b64_tr_b16 v[214:215], v237 offset:26112
    v_mfma_f32_16x16x32_bf16 v[164:167], v[188:191], v[216:219], v[164:167]
    ds_read_b128 v[216:219], v239 offset:20480
    v_mfma_f32_16x16x32_bf16 v[0:3], v[192:195], v[220:223], v[0:3]
    v_mfma_f32_16x16x32_bf16 v[4:7], v[196:199], v[220:223], v[4:7]
    v_mfma_f32_16x16x32_bf16 v[8:11], v[200:203], v[220:223], v[8:11]
    s_waitcnt lgkmcnt(8)
    v_mfma_f32_16x16x32_bf16 v[12:15], v[192:195], v[224:227], v[12:15]
    v_mfma_f32_16x16x32_bf16 v[16:19], v[196:199], v[224:227], v[16:19]
    v_mfma_f32_16x16x32_bf16 v[20:23], v[200:203], v[224:227], v[20:23]
    s_waitcnt lgkmcnt(6)
    v_mfma_f32_16x16x32_bf16 v[84:87], v[204:207], v[220:223], v[84:87]
    s_waitcnt lgkmcnt(3)
    v_mfma_f32_16x16x32_bf16 v[88:91], v[208:211], v[220:223], v[88:91]
    s_waitcnt lgkmcnt(1)
    s_barrier
    v_mfma_f32_16x16x32_bf16 v[92:95], v[212:215], v[220:223], v[92:95]
    ds_read_b128 v[220:223], v239 offset:22528
    v_mfma_f32_16x16x32_bf16 v[96:99], v[204:207], v[224:227], v[96:99]
    v_mfma_f32_16x16x32_bf16 v[100:103], v[208:211], v[224:227], v[100:103]
    ds_read_b64_tr_b16 v[168:169], v232 offset:12288
    v_mfma_f32_16x16x32_bf16 v[104:107], v[212:215], v[224:227], v[104:107]
    ds_read_b128 v[224:227], v239 offset:24576
    v_mfma_f32_16x16x32_bf16 v[24:27], v[192:195], v[228:231], v[24:27]
    v_mfma_f32_16x16x32_bf16 v[28:31], v[196:199], v[228:231], v[28:31]
    ds_read_b64_tr_b16 v[170:171], v232 offset:13824
    v_mfma_f32_16x16x32_bf16 v[32:35], v[200:203], v[228:231], v[32:35]
    v_mfma_f32_16x16x32_bf16 v[108:111], v[204:207], v[228:231], v[108:111]
    v_mfma_f32_16x16x32_bf16 v[112:115], v[208:211], v[228:231], v[112:115]
    ds_read_b64_tr_b16 v[172:173], v233 offset:12288
    v_mfma_f32_16x16x32_bf16 v[116:119], v[212:215], v[228:231], v[116:119]
    ds_read_b128 v[228:231], v239 offset:26624
    s_waitcnt lgkmcnt(6)
    v_mfma_f32_16x16x32_bf16 v[36:39], v[192:195], v[216:219], v[36:39]
    v_mfma_f32_16x16x32_bf16 v[40:43], v[196:199], v[216:219], v[40:43]
    ds_read_b64_tr_b16 v[174:175], v233 offset:13824
    v_mfma_f32_16x16x32_bf16 v[44:47], v[200:203], v[216:219], v[44:47]
    v_mfma_f32_16x16x32_bf16 v[120:123], v[204:207], v[216:219], v[120:123]
    v_mfma_f32_16x16x32_bf16 v[124:127], v[208:211], v[216:219], v[124:127]
    ds_read_b64_tr_b16 v[176:177], v234 offset:12288
    v_mfma_f32_16x16x32_bf16 v[128:131], v[212:215], v[216:219], v[128:131]
    ds_read_b128 v[216:219], v238 offset:28672
    s_waitcnt lgkmcnt(8)
    v_mfma_f32_16x16x32_bf16 v[48:51], v[192:195], v[220:223], v[48:51]
    v_mfma_f32_16x16x32_bf16 v[52:55], v[196:199], v[220:223], v[52:55]
    ds_read_b64_tr_b16 v[178:179], v234 offset:13824
    v_mfma_f32_16x16x32_bf16 v[56:59], v[200:203], v[220:223], v[56:59]
    v_mfma_f32_16x16x32_bf16 v[132:135], v[204:207], v[220:223], v[132:135]
    v_mfma_f32_16x16x32_bf16 v[136:139], v[208:211], v[220:223], v[136:139]
    s_waitcnt lgkmcnt(0)
    s_barrier
    v_mfma_f32_16x16x32_bf16 v[140:143], v[212:215], v[220:223], v[140:143]
    ds_read_b128 v[220:223], v238 offset:30720
    v_mfma_f32_16x16x32_bf16 v[60:63], v[192:195], v[224:227], v[60:63]
    ds_read_b64_tr_b16 v[180:181], v232 offset:24576
    v_mfma_f32_16x16x32_bf16 v[64:67], v[196:199], v[224:227], v[64:67]
    v_mfma_f32_16x16x32_bf16 v[68:71], v[200:203], v[224:227], v[68:71]
    ds_read_b64_tr_b16 v[182:183], v232 offset:26112
    v_mfma_f32_16x16x32_bf16 v[144:147], v[204:207], v[224:227], v[144:147]
    v_mfma_f32_16x16x32_bf16 v[148:151], v[208:211], v[224:227], v[148:151]
    ds_read_b64_tr_b16 v[184:185], v233 offset:24576
    v_mfma_f32_16x16x32_bf16 v[152:155], v[212:215], v[224:227], v[152:155]
    ds_read_b128 v[224:227], v238 offset:32768
    v_mfma_f32_16x16x32_bf16 v[72:75], v[192:195], v[228:231], v[72:75]
    ds_read_b64_tr_b16 v[186:187], v233 offset:26112
    v_mfma_f32_16x16x32_bf16 v[76:79], v[196:199], v[228:231], v[76:79]
    v_mfma_f32_16x16x32_bf16 v[80:83], v[200:203], v[228:231], v[80:83]
    ds_read_b64_tr_b16 v[188:189], v234 offset:24576
    v_mfma_f32_16x16x32_bf16 v[156:159], v[204:207], v[228:231], v[156:159]
    v_mfma_f32_16x16x32_bf16 v[160:163], v[208:211], v[228:231], v[160:163]
    ds_read_b64_tr_b16 v[190:191], v234 offset:26112
    v_mfma_f32_16x16x32_bf16 v[164:167], v[212:215], v[228:231], v[164:167]
    ds_read_b128 v[228:231], v238 offset:34816
    v_mfma_f32_16x16x32_bf16 v[0:3], v[168:171], v[216:219], v[0:3]
    v_mfma_f32_16x16x32_bf16 v[4:7], v[172:175], v[216:219], v[4:7]
    v_mfma_f32_16x16x32_bf16 v[8:11], v[176:179], v[216:219], v[8:11]
    s_waitcnt lgkmcnt(8)
    v_mfma_f32_16x16x32_bf16 v[12:15], v[168:171], v[220:223], v[12:15]
    v_mfma_f32_16x16x32_bf16 v[16:19], v[172:175], v[220:223], v[16:19]
    v_mfma_f32_16x16x32_bf16 v[20:23], v[176:179], v[220:223], v[20:23]
    s_waitcnt lgkmcnt(6)
    v_mfma_f32_16x16x32_bf16 v[84:87], v[180:183], v[216:219], v[84:87]
    s_waitcnt lgkmcnt(3)
    v_mfma_f32_16x16x32_bf16 v[88:91], v[184:187], v[216:219], v[88:91]
    s_waitcnt lgkmcnt(1)
    s_barrier
    v_mfma_f32_16x16x32_bf16 v[92:95], v[188:191], v[216:219], v[92:95]
    ds_read_b128 v[216:219], v238 offset:36864
    v_mfma_f32_16x16x32_bf16 v[96:99], v[180:183], v[220:223], v[96:99]
    v_mfma_f32_16x16x32_bf16 v[100:103], v[184:187], v[220:223], v[100:103]
    ds_read_b64_tr_b16 v[192:193], v235 offset:12288
    v_mfma_f32_16x16x32_bf16 v[104:107], v[188:191], v[220:223], v[104:107]
    ds_read_b128 v[220:223], v238 offset:38912
    v_mfma_f32_16x16x32_bf16 v[24:27], v[168:171], v[224:227], v[24:27]
    v_mfma_f32_16x16x32_bf16 v[28:31], v[172:175], v[224:227], v[28:31]
    ds_read_b64_tr_b16 v[194:195], v235 offset:13824
    v_mfma_f32_16x16x32_bf16 v[32:35], v[176:179], v[224:227], v[32:35]
    v_mfma_f32_16x16x32_bf16 v[108:111], v[180:183], v[224:227], v[108:111]
    v_mfma_f32_16x16x32_bf16 v[112:115], v[184:187], v[224:227], v[112:115]
    ds_read_b64_tr_b16 v[196:197], v236 offset:12288
    v_mfma_f32_16x16x32_bf16 v[116:119], v[188:191], v[224:227], v[116:119]
    ds_read_b128 v[224:227], v238 offset:40960
    s_waitcnt lgkmcnt(6)
    v_mfma_f32_16x16x32_bf16 v[36:39], v[168:171], v[228:231], v[36:39]
    v_mfma_f32_16x16x32_bf16 v[40:43], v[172:175], v[228:231], v[40:43]
    ds_read_b64_tr_b16 v[198:199], v236 offset:13824
    v_mfma_f32_16x16x32_bf16 v[44:47], v[176:179], v[228:231], v[44:47]
    v_mfma_f32_16x16x32_bf16 v[120:123], v[180:183], v[228:231], v[120:123]
    v_mfma_f32_16x16x32_bf16 v[124:127], v[184:187], v[228:231], v[124:127]
    ds_read_b64_tr_b16 v[200:201], v237 offset:12288
    v_mfma_f32_16x16x32_bf16 v[128:131], v[188:191], v[228:231], v[128:131]
    ds_read_b128 v[228:231], v239 offset:28672
    s_waitcnt lgkmcnt(8)
    v_mfma_f32_16x16x32_bf16 v[48:51], v[168:171], v[216:219], v[48:51]
    v_mfma_f32_16x16x32_bf16 v[52:55], v[172:175], v[216:219], v[52:55]
    ds_read_b64_tr_b16 v[202:203], v237 offset:13824
    v_mfma_f32_16x16x32_bf16 v[56:59], v[176:179], v[216:219], v[56:59]
    v_mfma_f32_16x16x32_bf16 v[132:135], v[180:183], v[216:219], v[132:135]
    v_mfma_f32_16x16x32_bf16 v[136:139], v[184:187], v[216:219], v[136:139]
    s_waitcnt lgkmcnt(0)
    s_barrier
    v_mfma_f32_16x16x32_bf16 v[140:143], v[188:191], v[216:219], v[140:143]
    ds_read_b128 v[216:219], v239 offset:30720
    v_mfma_f32_16x16x32_bf16 v[60:63], v[168:171], v[220:223], v[60:63]
    ds_read_b64_tr_b16 v[204:205], v235 offset:24576
    v_mfma_f32_16x16x32_bf16 v[64:67], v[172:175], v[220:223], v[64:67]
    v_mfma_f32_16x16x32_bf16 v[68:71], v[176:179], v[220:223], v[68:71]
    ds_read_b64_tr_b16 v[206:207], v235 offset:26112
    v_mfma_f32_16x16x32_bf16 v[144:147], v[180:183], v[220:223], v[144:147]
    v_mfma_f32_16x16x32_bf16 v[148:151], v[184:187], v[220:223], v[148:151]
    ds_read_b64_tr_b16 v[208:209], v236 offset:24576
    v_mfma_f32_16x16x32_bf16 v[152:155], v[188:191], v[220:223], v[152:155]
    ds_read_b128 v[220:223], v239 offset:32768
    v_mfma_f32_16x16x32_bf16 v[72:75], v[168:171], v[224:227], v[72:75]
    ds_read_b64_tr_b16 v[210:211], v236 offset:26112
    v_mfma_f32_16x16x32_bf16 v[76:79], v[172:175], v[224:227], v[76:79]
    v_mfma_f32_16x16x32_bf16 v[80:83], v[176:179], v[224:227], v[80:83]
    ds_read_b64_tr_b16 v[212:213], v237 offset:24576
    v_mfma_f32_16x16x32_bf16 v[156:159], v[180:183], v[224:227], v[156:159]
    v_mfma_f32_16x16x32_bf16 v[160:163], v[184:187], v[224:227], v[160:163]
    ds_read_b64_tr_b16 v[214:215], v237 offset:26112
    v_mfma_f32_16x16x32_bf16 v[164:167], v[188:191], v[224:227], v[164:167]
    ds_read_b128 v[224:227], v239 offset:34816
    v_mfma_f32_16x16x32_bf16 v[0:3], v[192:195], v[228:231], v[0:3]
    v_mfma_f32_16x16x32_bf16 v[4:7], v[196:199], v[228:231], v[4:7]
    v_mfma_f32_16x16x32_bf16 v[8:11], v[200:203], v[228:231], v[8:11]
    s_waitcnt lgkmcnt(8)
    v_mfma_f32_16x16x32_bf16 v[12:15], v[192:195], v[216:219], v[12:15]
    v_mfma_f32_16x16x32_bf16 v[16:19], v[196:199], v[216:219], v[16:19]
    v_mfma_f32_16x16x32_bf16 v[20:23], v[200:203], v[216:219], v[20:23]
    s_waitcnt lgkmcnt(6)
    v_mfma_f32_16x16x32_bf16 v[84:87], v[204:207], v[228:231], v[84:87]
    s_waitcnt lgkmcnt(3)
    v_mfma_f32_16x16x32_bf16 v[88:91], v[208:211], v[228:231], v[88:91]
    s_waitcnt lgkmcnt(1)
    s_barrier
    v_mfma_f32_16x16x32_bf16 v[92:95], v[212:215], v[228:231], v[92:95]
    ds_read_b128 v[228:231], v239 offset:36864
    v_mfma_f32_16x16x32_bf16 v[96:99], v[204:207], v[216:219], v[96:99]
    v_mfma_f32_16x16x32_bf16 v[100:103], v[208:211], v[216:219], v[100:103]
    ds_read_b64_tr_b16 v[168:169], v232 offset:12288
    v_mfma_f32_16x16x32_bf16 v[104:107], v[212:215], v[216:219], v[104:107]
    ds_read_b128 v[216:219], v239 offset:38912
    v_mfma_f32_16x16x32_bf16 v[24:27], v[192:195], v[220:223], v[24:27]
    v_mfma_f32_16x16x32_bf16 v[28:31], v[196:199], v[220:223], v[28:31]
    ds_read_b64_tr_b16 v[170:171], v232 offset:13824
    v_mfma_f32_16x16x32_bf16 v[32:35], v[200:203], v[220:223], v[32:35]
    v_mfma_f32_16x16x32_bf16 v[108:111], v[204:207], v[220:223], v[108:111]
    v_mfma_f32_16x16x32_bf16 v[112:115], v[208:211], v[220:223], v[112:115]
    ds_read_b64_tr_b16 v[172:173], v233 offset:12288
    v_mfma_f32_16x16x32_bf16 v[116:119], v[212:215], v[220:223], v[116:119]
    ds_read_b128 v[220:223], v239 offset:40960
    s_waitcnt lgkmcnt(6)
    v_mfma_f32_16x16x32_bf16 v[36:39], v[192:195], v[224:227], v[36:39]
    v_mfma_f32_16x16x32_bf16 v[40:43], v[196:199], v[224:227], v[40:43]
    ds_read_b64_tr_b16 v[174:175], v233 offset:13824
    v_mfma_f32_16x16x32_bf16 v[44:47], v[200:203], v[224:227], v[44:47]
    v_mfma_f32_16x16x32_bf16 v[120:123], v[204:207], v[224:227], v[120:123]
    v_mfma_f32_16x16x32_bf16 v[124:127], v[208:211], v[224:227], v[124:127]
    ds_read_b64_tr_b16 v[176:177], v234 offset:12288
    v_mfma_f32_16x16x32_bf16 v[128:131], v[212:215], v[224:227], v[128:131]
    ds_read_b128 v[224:227], v238 offset:0
    s_waitcnt lgkmcnt(8)
    v_mfma_f32_16x16x32_bf16 v[48:51], v[192:195], v[228:231], v[48:51]
    v_mfma_f32_16x16x32_bf16 v[52:55], v[196:199], v[228:231], v[52:55]
    ds_read_b64_tr_b16 v[178:179], v234 offset:13824
    v_mfma_f32_16x16x32_bf16 v[56:59], v[200:203], v[228:231], v[56:59]
    v_mfma_f32_16x16x32_bf16 v[132:135], v[204:207], v[228:231], v[132:135]
    v_mfma_f32_16x16x32_bf16 v[136:139], v[208:211], v[228:231], v[136:139]
    s_waitcnt lgkmcnt(0)
    s_barrier
    v_mfma_f32_16x16x32_bf16 v[140:143], v[212:215], v[228:231], v[140:143]
    ds_read_b128 v[228:231], v238 offset:2048
    v_mfma_f32_16x16x32_bf16 v[60:63], v[192:195], v[216:219], v[60:63]
    ds_read_b64_tr_b16 v[180:181], v232 offset:24576
    v_mfma_f32_16x16x32_bf16 v[64:67], v[196:199], v[216:219], v[64:67]
    v_mfma_f32_16x16x32_bf16 v[68:71], v[200:203], v[216:219], v[68:71]
    ds_read_b64_tr_b16 v[182:183], v232 offset:26112
    v_mfma_f32_16x16x32_bf16 v[144:147], v[204:207], v[216:219], v[144:147]
    v_mfma_f32_16x16x32_bf16 v[148:151], v[208:211], v[216:219], v[148:151]
    ds_read_b64_tr_b16 v[184:185], v233 offset:24576
    v_mfma_f32_16x16x32_bf16 v[152:155], v[212:215], v[216:219], v[152:155]
    ds_read_b128 v[216:219], v238 offset:4096
    v_mfma_f32_16x16x32_bf16 v[72:75], v[192:195], v[220:223], v[72:75]
    ds_read_b64_tr_b16 v[186:187], v233 offset:26112
    v_mfma_f32_16x16x32_bf16 v[76:79], v[196:199], v[220:223], v[76:79]
    v_mfma_f32_16x16x32_bf16 v[80:83], v[200:203], v[220:223], v[80:83]
    ds_read_b64_tr_b16 v[188:189], v234 offset:24576
    v_mfma_f32_16x16x32_bf16 v[156:159], v[204:207], v[220:223], v[156:159]
    v_mfma_f32_16x16x32_bf16 v[160:163], v[208:211], v[220:223], v[160:163]
    ds_read_b64_tr_b16 v[190:191], v234 offset:26112
    v_mfma_f32_16x16x32_bf16 v[164:167], v[212:215], v[220:223], v[164:167]
    ds_read_b128 v[220:223], v238 offset:6144
    v_mfma_f32_16x16x32_bf16 v[0:3], v[168:171], v[224:227], v[0:3]
    v_mfma_f32_16x16x32_bf16 v[4:7], v[172:175], v[224:227], v[4:7]
    v_mfma_f32_16x16x32_bf16 v[8:11], v[176:179], v[224:227], v[8:11]
    s_waitcnt lgkmcnt(8)
    v_mfma_f32_16x16x32_bf16 v[12:15], v[168:171], v[228:231], v[12:15]
    v_mfma_f32_16x16x32_bf16 v[16:19], v[172:175], v[228:231], v[16:19]
    v_mfma_f32_16x16x32_bf16 v[20:23], v[176:179], v[228:231], v[20:23]
    s_waitcnt lgkmcnt(6)
    v_mfma_f32_16x16x32_bf16 v[84:87], v[180:183], v[224:227], v[84:87]
    s_waitcnt lgkmcnt(3)
    v_mfma_f32_16x16x32_bf16 v[88:91], v[184:187], v[224:227], v[88:91]
    s_waitcnt lgkmcnt(1)
    s_barrier
    v_mfma_f32_16x16x32_bf16 v[92:95], v[188:191], v[224:227], v[92:95]
    ds_read_b128 v[224:227], v238 offset:8192
    v_mfma_f32_16x16x32_bf16 v[96:99], v[180:183], v[228:231], v[96:99]
    v_mfma_f32_16x16x32_bf16 v[100:103], v[184:187], v[228:231], v[100:103]
    ds_read_b64_tr_b16 v[192:193], v235 offset:12288
    v_mfma_f32_16x16x32_bf16 v[104:107], v[188:191], v[228:231], v[104:107]
    ds_read_b128 v[228:231], v238 offset:10240
    v_mfma_f32_16x16x32_bf16 v[24:27], v[168:171], v[216:219], v[24:27]
    v_mfma_f32_16x16x32_bf16 v[28:31], v[172:175], v[216:219], v[28:31]
    ds_read_b64_tr_b16 v[194:195], v235 offset:13824
    v_mfma_f32_16x16x32_bf16 v[32:35], v[176:179], v[216:219], v[32:35]
    v_mfma_f32_16x16x32_bf16 v[108:111], v[180:183], v[216:219], v[108:111]
    v_mfma_f32_16x16x32_bf16 v[112:115], v[184:187], v[216:219], v[112:115]
    ds_read_b64_tr_b16 v[196:197], v236 offset:12288
    v_mfma_f32_16x16x32_bf16 v[116:119], v[188:191], v[216:219], v[116:119]
    ds_read_b128 v[216:219], v238 offset:12288
    s_waitcnt lgkmcnt(6)
    v_mfma_f32_16x16x32_bf16 v[36:39], v[168:171], v[220:223], v[36:39]
    v_mfma_f32_16x16x32_bf16 v[40:43], v[172:175], v[220:223], v[40:43]
    ds_read_b64_tr_b16 v[198:199], v236 offset:13824
    v_mfma_f32_16x16x32_bf16 v[44:47], v[176:179], v[220:223], v[44:47]
    v_mfma_f32_16x16x32_bf16 v[120:123], v[180:183], v[220:223], v[120:123]
    v_mfma_f32_16x16x32_bf16 v[124:127], v[184:187], v[220:223], v[124:127]
    ds_read_b64_tr_b16 v[200:201], v237 offset:12288
    v_mfma_f32_16x16x32_bf16 v[128:131], v[188:191], v[220:223], v[128:131]
    ds_read_b128 v[220:223], v239 offset:0
    s_waitcnt lgkmcnt(8)
    v_mfma_f32_16x16x32_bf16 v[48:51], v[168:171], v[224:227], v[48:51]
    v_mfma_f32_16x16x32_bf16 v[52:55], v[172:175], v[224:227], v[52:55]
    ds_read_b64_tr_b16 v[202:203], v237 offset:13824
    v_mfma_f32_16x16x32_bf16 v[56:59], v[176:179], v[224:227], v[56:59]
    v_mfma_f32_16x16x32_bf16 v[132:135], v[180:183], v[224:227], v[132:135]
    v_mfma_f32_16x16x32_bf16 v[136:139], v[184:187], v[224:227], v[136:139]
    s_waitcnt lgkmcnt(0)
    s_barrier
    v_mfma_f32_16x16x32_bf16 v[140:143], v[188:191], v[224:227], v[140:143]
    ds_read_b128 v[224:227], v239 offset:2048
    v_mfma_f32_16x16x32_bf16 v[60:63], v[168:171], v[228:231], v[60:63]
    ds_read_b64_tr_b16 v[204:205], v235 offset:24576
    v_mfma_f32_16x16x32_bf16 v[64:67], v[172:175], v[228:231], v[64:67]
    v_mfma_f32_16x16x32_bf16 v[68:71], v[176:179], v[228:231], v[68:71]
    ds_read_b64_tr_b16 v[206:207], v235 offset:26112
    v_mfma_f32_16x16x32_bf16 v[144:147], v[180:183], v[228:231], v[144:147]
    v_mfma_f32_16x16x32_bf16 v[148:151], v[184:187], v[228:231], v[148:151]
    ds_read_b64_tr_b16 v[208:209], v236 offset:24576
    v_mfma_f32_16x16x32_bf16 v[152:155], v[188:191], v[228:231], v[152:155]
    ds_read_b128 v[228:231], v239 offset:4096
    v_mfma_f32_16x16x32_bf16 v[72:75], v[168:171], v[216:219], v[72:75]
    ds_read_b64_tr_b16 v[210:211], v236 offset:26112
    v_mfma_f32_16x16x32_bf16 v[76:79], v[172:175], v[216:219], v[76:79]
    v_mfma_f32_16x16x32_bf16 v[80:83], v[176:179], v[216:219], v[80:83]
    ds_read_b64_tr_b16 v[212:213], v237 offset:24576
    v_mfma_f32_16x16x32_bf16 v[156:159], v[180:183], v[216:219], v[156:159]
    v_mfma_f32_16x16x32_bf16 v[160:163], v[184:187], v[216:219], v[160:163]
    ds_read_b64_tr_b16 v[214:215], v237 offset:26112
    v_mfma_f32_16x16x32_bf16 v[164:167], v[188:191], v[216:219], v[164:167]
    ds_read_b128 v[216:219], v239 offset:6144
    v_mfma_f32_16x16x32_bf16 v[0:3], v[192:195], v[220:223], v[0:3]
    v_mfma_f32_16x16x32_bf16 v[4:7], v[196:199], v[220:223], v[4:7]
    v_mfma_f32_16x16x32_bf16 v[8:11], v[200:203], v[220:223], v[8:11]
    s_waitcnt lgkmcnt(8)
    v_mfma_f32_16x16x32_bf16 v[12:15], v[192:195], v[224:227], v[12:15]
    v_mfma_f32_16x16x32_bf16 v[16:19], v[196:199], v[224:227], v[16:19]
    v_mfma_f32_16x16x32_bf16 v[20:23], v[200:203], v[224:227], v[20:23]
    s_waitcnt lgkmcnt(6)
    v_mfma_f32_16x16x32_bf16 v[84:87], v[204:207], v[220:223], v[84:87]
    s_waitcnt lgkmcnt(3)
    v_mfma_f32_16x16x32_bf16 v[88:91], v[208:211], v[220:223], v[88:91]
    s_waitcnt lgkmcnt(1)
    s_barrier
    v_mfma_f32_16x16x32_bf16 v[92:95], v[212:215], v[220:223], v[92:95]
    ds_read_b128 v[220:223], v239 offset:8192
    v_mfma_f32_16x16x32_bf16 v[96:99], v[204:207], v[224:227], v[96:99]
    v_mfma_f32_16x16x32_bf16 v[100:103], v[208:211], v[224:227], v[100:103]
    ds_read_b64_tr_b16 v[168:169], v232 offset:12288
    v_mfma_f32_16x16x32_bf16 v[104:107], v[212:215], v[224:227], v[104:107]
    ds_read_b128 v[224:227], v239 offset:10240
    v_mfma_f32_16x16x32_bf16 v[24:27], v[192:195], v[228:231], v[24:27]
    v_mfma_f32_16x16x32_bf16 v[28:31], v[196:199], v[228:231], v[28:31]
    ds_read_b64_tr_b16 v[170:171], v232 offset:13824
    v_mfma_f32_16x16x32_bf16 v[32:35], v[200:203], v[228:231], v[32:35]
    v_mfma_f32_16x16x32_bf16 v[108:111], v[204:207], v[228:231], v[108:111]
    v_mfma_f32_16x16x32_bf16 v[112:115], v[208:211], v[228:231], v[112:115]
    ds_read_b64_tr_b16 v[172:173], v233 offset:12288
    v_mfma_f32_16x16x32_bf16 v[116:119], v[212:215], v[228:231], v[116:119]
    ds_read_b128 v[228:231], v239 offset:12288
    s_waitcnt lgkmcnt(6)
    v_mfma_f32_16x16x32_bf16 v[36:39], v[192:195], v[216:219], v[36:39]
    v_mfma_f32_16x16x32_bf16 v[40:43], v[196:199], v[216:219], v[40:43]
    ds_read_b64_tr_b16 v[174:175], v233 offset:13824
    v_mfma_f32_16x16x32_bf16 v[44:47], v[200:203], v[216:219], v[44:47]
    v_mfma_f32_16x16x32_bf16 v[120:123], v[204:207], v[216:219], v[120:123]
    v_mfma_f32_16x16x32_bf16 v[124:127], v[208:211], v[216:219], v[124:127]
    ds_read_b64_tr_b16 v[176:177], v234 offset:12288
    v_mfma_f32_16x16x32_bf16 v[128:131], v[212:215], v[216:219], v[128:131]
    ds_read_b128 v[216:219], v238 offset:14336
    s_waitcnt lgkmcnt(8)
    v_mfma_f32_16x16x32_bf16 v[48:51], v[192:195], v[220:223], v[48:51]
    v_mfma_f32_16x16x32_bf16 v[52:55], v[196:199], v[220:223], v[52:55]
    ds_read_b64_tr_b16 v[178:179], v234 offset:13824
    v_mfma_f32_16x16x32_bf16 v[56:59], v[200:203], v[220:223], v[56:59]
    v_mfma_f32_16x16x32_bf16 v[132:135], v[204:207], v[220:223], v[132:135]
    v_mfma_f32_16x16x32_bf16 v[136:139], v[208:211], v[220:223], v[136:139]
    s_waitcnt lgkmcnt(0)
    s_barrier
    v_mfma_f32_16x16x32_bf16 v[140:143], v[212:215], v[220:223], v[140:143]
    ds_read_b128 v[220:223], v238 offset:16384
    v_mfma_f32_16x16x32_bf16 v[60:63], v[192:195], v[224:227], v[60:63]
    ds_read_b64_tr_b16 v[180:181], v232 offset:24576
    v_mfma_f32_16x16x32_bf16 v[64:67], v[196:199], v[224:227], v[64:67]
    v_mfma_f32_16x16x32_bf16 v[68:71], v[200:203], v[224:227], v[68:71]
    ds_read_b64_tr_b16 v[182:183], v232 offset:26112
    v_mfma_f32_16x16x32_bf16 v[144:147], v[204:207], v[224:227], v[144:147]
    v_mfma_f32_16x16x32_bf16 v[148:151], v[208:211], v[224:227], v[148:151]
    ds_read_b64_tr_b16 v[184:185], v233 offset:24576
    v_mfma_f32_16x16x32_bf16 v[152:155], v[212:215], v[224:227], v[152:155]
    ds_read_b128 v[224:227], v238 offset:18432
    v_mfma_f32_16x16x32_bf16 v[72:75], v[192:195], v[228:231], v[72:75]
    ds_read_b64_tr_b16 v[186:187], v233 offset:26112
    v_mfma_f32_16x16x32_bf16 v[76:79], v[196:199], v[228:231], v[76:79]
    v_mfma_f32_16x16x32_bf16 v[80:83], v[200:203], v[228:231], v[80:83]
    ds_read_b64_tr_b16 v[188:189], v234 offset:24576
    v_mfma_f32_16x16x32_bf16 v[156:159], v[204:207], v[228:231], v[156:159]
    v_mfma_f32_16x16x32_bf16 v[160:163], v[208:211], v[228:231], v[160:163]
    ds_read_b64_tr_b16 v[190:191], v234 offset:26112
    v_mfma_f32_16x16x32_bf16 v[164:167], v[212:215], v[228:231], v[164:167]
    ds_read_b128 v[228:231], v238 offset:20480
    v_mfma_f32_16x16x32_bf16 v[0:3], v[168:171], v[216:219], v[0:3]
    v_mfma_f32_16x16x32_bf16 v[4:7], v[172:175], v[216:219], v[4:7]
    v_mfma_f32_16x16x32_bf16 v[8:11], v[176:179], v[216:219], v[8:11]
    s_waitcnt lgkmcnt(8)
    v_mfma_f32_16x16x32_bf16 v[12:15], v[168:171], v[220:223], v[12:15]
    v_mfma_f32_16x16x32_bf16 v[16:19], v[172:175], v[220:223], v[16:19]
    v_mfma_f32_16x16x32_bf16 v[20:23], v[176:179], v[220:223], v[20:23]
    s_waitcnt lgkmcnt(6)
    v_mfma_f32_16x16x32_bf16 v[84:87], v[180:183], v[216:219], v[84:87]
    s_waitcnt lgkmcnt(3)
    v_mfma_f32_16x16x32_bf16 v[88:91], v[184:187], v[216:219], v[88:91]
    s_waitcnt lgkmcnt(1)
    s_barrier
    v_mfma_f32_16x16x32_bf16 v[92:95], v[188:191], v[216:219], v[92:95]
    ds_read_b128 v[216:219], v238 offset:22528
    v_mfma_f32_16x16x32_bf16 v[96:99], v[180:183], v[220:223], v[96:99]
    v_mfma_f32_16x16x32_bf16 v[100:103], v[184:187], v[220:223], v[100:103]
    ds_read_b64_tr_b16 v[192:193], v235 offset:12288
    v_mfma_f32_16x16x32_bf16 v[104:107], v[188:191], v[220:223], v[104:107]
    ds_read_b128 v[220:223], v238 offset:24576
    v_mfma_f32_16x16x32_bf16 v[24:27], v[168:171], v[224:227], v[24:27]
    v_mfma_f32_16x16x32_bf16 v[28:31], v[172:175], v[224:227], v[28:31]
    ds_read_b64_tr_b16 v[194:195], v235 offset:13824
    v_mfma_f32_16x16x32_bf16 v[32:35], v[176:179], v[224:227], v[32:35]
    v_mfma_f32_16x16x32_bf16 v[108:111], v[180:183], v[224:227], v[108:111]
    v_mfma_f32_16x16x32_bf16 v[112:115], v[184:187], v[224:227], v[112:115]
    ds_read_b64_tr_b16 v[196:197], v236 offset:12288
    v_mfma_f32_16x16x32_bf16 v[116:119], v[188:191], v[224:227], v[116:119]
    ds_read_b128 v[224:227], v238 offset:26624
    s_waitcnt lgkmcnt(6)
    v_mfma_f32_16x16x32_bf16 v[36:39], v[168:171], v[228:231], v[36:39]
    v_mfma_f32_16x16x32_bf16 v[40:43], v[172:175], v[228:231], v[40:43]
    ds_read_b64_tr_b16 v[198:199], v236 offset:13824
    v_mfma_f32_16x16x32_bf16 v[44:47], v[176:179], v[228:231], v[44:47]
    v_mfma_f32_16x16x32_bf16 v[120:123], v[180:183], v[228:231], v[120:123]
    v_mfma_f32_16x16x32_bf16 v[124:127], v[184:187], v[228:231], v[124:127]
    ds_read_b64_tr_b16 v[200:201], v237 offset:12288
    v_mfma_f32_16x16x32_bf16 v[128:131], v[188:191], v[228:231], v[128:131]
    ds_read_b128 v[228:231], v239 offset:14336
    s_waitcnt lgkmcnt(8)
    v_mfma_f32_16x16x32_bf16 v[48:51], v[168:171], v[216:219], v[48:51]
    v_mfma_f32_16x16x32_bf16 v[52:55], v[172:175], v[216:219], v[52:55]
    ds_read_b64_tr_b16 v[202:203], v237 offset:13824
    v_mfma_f32_16x16x32_bf16 v[56:59], v[176:179], v[216:219], v[56:59]
    v_mfma_f32_16x16x32_bf16 v[132:135], v[180:183], v[216:219], v[132:135]
    v_mfma_f32_16x16x32_bf16 v[136:139], v[184:187], v[216:219], v[136:139]
    s_waitcnt lgkmcnt(0)
    s_barrier
    v_mfma_f32_16x16x32_bf16 v[140:143], v[188:191], v[216:219], v[140:143]
    ds_read_b128 v[216:219], v239 offset:16384
    v_mfma_f32_16x16x32_bf16 v[60:63], v[168:171], v[220:223], v[60:63]
    ds_read_b64_tr_b16 v[204:205], v235 offset:24576
    v_mfma_f32_16x16x32_bf16 v[64:67], v[172:175], v[220:223], v[64:67]
    v_mfma_f32_16x16x32_bf16 v[68:71], v[176:179], v[220:223], v[68:71]
    ds_read_b64_tr_b16 v[206:207], v235 offset:26112
    v_mfma_f32_16x16x32_bf16 v[144:147], v[180:183], v[220:223], v[144:147]
    v_mfma_f32_16x16x32_bf16 v[148:151], v[184:187], v[220:223], v[148:151]
    ds_read_b64_tr_b16 v[208:209], v236 offset:24576
    v_mfma_f32_16x16x32_bf16 v[152:155], v[188:191], v[220:223], v[152:155]
    ds_read_b128 v[220:223], v239 offset:18432
    v_mfma_f32_16x16x32_bf16 v[72:75], v[168:171], v[224:227], v[72:75]
    ds_read_b64_tr_b16 v[210:211], v236 offset:26112
    v_mfma_f32_16x16x32_bf16 v[76:79], v[172:175], v[224:227], v[76:79]
    v_mfma_f32_16x16x32_bf16 v[80:83], v[176:179], v[224:227], v[80:83]
    ds_read_b64_tr_b16 v[212:213], v237 offset:24576
    v_mfma_f32_16x16x32_bf16 v[156:159], v[180:183], v[224:227], v[156:159]
    v_mfma_f32_16x16x32_bf16 v[160:163], v[184:187], v[224:227], v[160:163]
    ds_read_b64_tr_b16 v[214:215], v237 offset:26112
    v_mfma_f32_16x16x32_bf16 v[164:167], v[188:191], v[224:227], v[164:167]
    ds_read_b128 v[224:227], v239 offset:20480
    v_mfma_f32_16x16x32_bf16 v[0:3], v[192:195], v[228:231], v[0:3]
    v_mfma_f32_16x16x32_bf16 v[4:7], v[196:199], v[228:231], v[4:7]
    v_mfma_f32_16x16x32_bf16 v[8:11], v[200:203], v[228:231], v[8:11]
    s_waitcnt lgkmcnt(8)
    v_mfma_f32_16x16x32_bf16 v[12:15], v[192:195], v[216:219], v[12:15]
    v_mfma_f32_16x16x32_bf16 v[16:19], v[196:199], v[216:219], v[16:19]
    v_mfma_f32_16x16x32_bf16 v[20:23], v[200:203], v[216:219], v[20:23]
    s_waitcnt lgkmcnt(6)
    v_mfma_f32_16x16x32_bf16 v[84:87], v[204:207], v[228:231], v[84:87]
    s_waitcnt lgkmcnt(3)
    v_mfma_f32_16x16x32_bf16 v[88:91], v[208:211], v[228:231], v[88:91]
    s_waitcnt lgkmcnt(1)
    s_barrier
    v_mfma_f32_16x16x32_bf16 v[92:95], v[212:215], v[228:231], v[92:95]
    ds_read_b128 v[228:231], v239 offset:22528
    v_mfma_f32_16x16x32_bf16 v[96:99], v[204:207], v[216:219], v[96:99]
    v_mfma_f32_16x16x32_bf16 v[100:103], v[208:211], v[216:219], v[100:103]
    ds_read_b64_tr_b16 v[168:169], v232 offset:12288
    v_mfma_f32_16x16x32_bf16 v[104:107], v[212:215], v[216:219], v[104:107]
    ds_read_b128 v[216:219], v239 offset:24576
    v_mfma_f32_16x16x32_bf16 v[24:27], v[192:195], v[220:223], v[24:27]
    v_mfma_f32_16x16x32_bf16 v[28:31], v[196:199], v[220:223], v[28:31]
    ds_read_b64_tr_b16 v[170:171], v232 offset:13824
    v_mfma_f32_16x16x32_bf16 v[32:35], v[200:203], v[220:223], v[32:35]
    v_mfma_f32_16x16x32_bf16 v[108:111], v[204:207], v[220:223], v[108:111]
    v_mfma_f32_16x16x32_bf16 v[112:115], v[208:211], v[220:223], v[112:115]
    ds_read_b64_tr_b16 v[172:173], v233 offset:12288
    v_mfma_f32_16x16x32_bf16 v[116:119], v[212:215], v[220:223], v[116:119]
    ds_read_b128 v[220:223], v239 offset:26624
    s_waitcnt lgkmcnt(6)
    v_mfma_f32_16x16x32_bf16 v[36:39], v[192:195], v[224:227], v[36:39]
    v_mfma_f32_16x16x32_bf16 v[40:43], v[196:199], v[224:227], v[40:43]
    ds_read_b64_tr_b16 v[174:175], v233 offset:13824
    v_mfma_f32_16x16x32_bf16 v[44:47], v[200:203], v[224:227], v[44:47]
    v_mfma_f32_16x16x32_bf16 v[120:123], v[204:207], v[224:227], v[120:123]
    v_mfma_f32_16x16x32_bf16 v[124:127], v[208:211], v[224:227], v[124:127]
    ds_read_b64_tr_b16 v[176:177], v234 offset:12288
    v_mfma_f32_16x16x32_bf16 v[128:131], v[212:215], v[224:227], v[128:131]
    ds_read_b128 v[224:227], v238 offset:28672
    s_waitcnt lgkmcnt(8)
    v_mfma_f32_16x16x32_bf16 v[48:51], v[192:195], v[228:231], v[48:51]
    v_mfma_f32_16x16x32_bf16 v[52:55], v[196:199], v[228:231], v[52:55]
    ds_read_b64_tr_b16 v[178:179], v234 offset:13824
    v_mfma_f32_16x16x32_bf16 v[56:59], v[200:203], v[228:231], v[56:59]
    v_mfma_f32_16x16x32_bf16 v[132:135], v[204:207], v[228:231], v[132:135]
    v_mfma_f32_16x16x32_bf16 v[136:139], v[208:211], v[228:231], v[136:139]
    s_waitcnt lgkmcnt(0)
    s_barrier
    v_mfma_f32_16x16x32_bf16 v[140:143], v[212:215], v[228:231], v[140:143]
    ds_read_b128 v[228:231], v238 offset:30720
    v_mfma_f32_16x16x32_bf16 v[60:63], v[192:195], v[216:219], v[60:63]
    ds_read_b64_tr_b16 v[180:181], v232 offset:24576
    v_mfma_f32_16x16x32_bf16 v[64:67], v[196:199], v[216:219], v[64:67]
    v_mfma_f32_16x16x32_bf16 v[68:71], v[200:203], v[216:219], v[68:71]
    ds_read_b64_tr_b16 v[182:183], v232 offset:26112
    v_mfma_f32_16x16x32_bf16 v[144:147], v[204:207], v[216:219], v[144:147]
    v_mfma_f32_16x16x32_bf16 v[148:151], v[208:211], v[216:219], v[148:151]
    ds_read_b64_tr_b16 v[184:185], v233 offset:24576
    v_mfma_f32_16x16x32_bf16 v[152:155], v[212:215], v[216:219], v[152:155]
    ds_read_b128 v[216:219], v238 offset:32768
    v_mfma_f32_16x16x32_bf16 v[72:75], v[192:195], v[220:223], v[72:75]
    ds_read_b64_tr_b16 v[186:187], v233 offset:26112
    v_mfma_f32_16x16x32_bf16 v[76:79], v[196:199], v[220:223], v[76:79]
    v_mfma_f32_16x16x32_bf16 v[80:83], v[200:203], v[220:223], v[80:83]
    ds_read_b64_tr_b16 v[188:189], v234 offset:24576
    v_mfma_f32_16x16x32_bf16 v[156:159], v[204:207], v[220:223], v[156:159]
    v_mfma_f32_16x16x32_bf16 v[160:163], v[208:211], v[220:223], v[160:163]
    ds_read_b64_tr_b16 v[190:191], v234 offset:26112
    v_mfma_f32_16x16x32_bf16 v[164:167], v[212:215], v[220:223], v[164:167]
    ds_read_b128 v[220:223], v238 offset:34816
    v_mfma_f32_16x16x32_bf16 v[0:3], v[168:171], v[224:227], v[0:3]
    v_mfma_f32_16x16x32_bf16 v[4:7], v[172:175], v[224:227], v[4:7]
    v_mfma_f32_16x16x32_bf16 v[8:11], v[176:179], v[224:227], v[8:11]
    s_waitcnt lgkmcnt(8)
    v_mfma_f32_16x16x32_bf16 v[12:15], v[168:171], v[228:231], v[12:15]
    v_mfma_f32_16x16x32_bf16 v[16:19], v[172:175], v[228:231], v[16:19]
    v_mfma_f32_16x16x32_bf16 v[20:23], v[176:179], v[228:231], v[20:23]
    s_waitcnt lgkmcnt(6)
    v_mfma_f32_16x16x32_bf16 v[84:87], v[180:183], v[224:227], v[84:87]
    s_waitcnt lgkmcnt(3)
    v_mfma_f32_16x16x32_bf16 v[88:91], v[184:187], v[224:227], v[88:91]
    s_waitcnt lgkmcnt(1)
    s_barrier
    v_mfma_f32_16x16x32_bf16 v[92:95], v[188:191], v[224:227], v[92:95]
    ds_read_b128 v[224:227], v238 offset:36864
    v_mfma_f32_16x16x32_bf16 v[96:99], v[180:183], v[228:231], v[96:99]
    v_mfma_f32_16x16x32_bf16 v[100:103], v[184:187], v[228:231], v[100:103]
    ds_read_b64_tr_b16 v[192:193], v235 offset:12288
    v_mfma_f32_16x16x32_bf16 v[104:107], v[188:191], v[228:231], v[104:107]
    ds_read_b128 v[228:231], v238 offset:38912
    v_mfma_f32_16x16x32_bf16 v[24:27], v[168:171], v[216:219], v[24:27]
    v_mfma_f32_16x16x32_bf16 v[28:31], v[172:175], v[216:219], v[28:31]
    ds_read_b64_tr_b16 v[194:195], v235 offset:13824
    v_mfma_f32_16x16x32_bf16 v[32:35], v[176:179], v[216:219], v[32:35]
    v_mfma_f32_16x16x32_bf16 v[108:111], v[180:183], v[216:219], v[108:111]
    v_mfma_f32_16x16x32_bf16 v[112:115], v[184:187], v[216:219], v[112:115]
    ds_read_b64_tr_b16 v[196:197], v236 offset:12288
    v_mfma_f32_16x16x32_bf16 v[116:119], v[188:191], v[216:219], v[116:119]
    ds_read_b128 v[216:219], v238 offset:40960
    s_waitcnt lgkmcnt(6)
    v_mfma_f32_16x16x32_bf16 v[36:39], v[168:171], v[220:223], v[36:39]
    v_mfma_f32_16x16x32_bf16 v[40:43], v[172:175], v[220:223], v[40:43]
    ds_read_b64_tr_b16 v[198:199], v236 offset:13824
    v_mfma_f32_16x16x32_bf16 v[44:47], v[176:179], v[220:223], v[44:47]
    v_mfma_f32_16x16x32_bf16 v[120:123], v[180:183], v[220:223], v[120:123]
    v_mfma_f32_16x16x32_bf16 v[124:127], v[184:187], v[220:223], v[124:127]
    ds_read_b64_tr_b16 v[200:201], v237 offset:12288
    v_mfma_f32_16x16x32_bf16 v[128:131], v[188:191], v[220:223], v[128:131]
    ds_read_b128 v[220:223], v239 offset:28672
    s_waitcnt lgkmcnt(8)
    v_mfma_f32_16x16x32_bf16 v[48:51], v[168:171], v[224:227], v[48:51]
    v_mfma_f32_16x16x32_bf16 v[52:55], v[172:175], v[224:227], v[52:55]
    ds_read_b64_tr_b16 v[202:203], v237 offset:13824
    v_mfma_f32_16x16x32_bf16 v[56:59], v[176:179], v[224:227], v[56:59]
    v_mfma_f32_16x16x32_bf16 v[132:135], v[180:183], v[224:227], v[132:135]
    v_mfma_f32_16x16x32_bf16 v[136:139], v[184:187], v[224:227], v[136:139]
    s_waitcnt lgkmcnt(0)
    s_barrier
    v_mfma_f32_16x16x32_bf16 v[140:143], v[188:191], v[224:227], v[140:143]
    ds_read_b128 v[224:227], v239 offset:30720
    v_mfma_f32_16x16x32_bf16 v[60:63], v[168:171], v[228:231], v[60:63]
    ds_read_b64_tr_b16 v[204:205], v235 offset:24576
    v_mfma_f32_16x16x32_bf16 v[64:67], v[172:175], v[228:231], v[64:67]
    v_mfma_f32_16x16x32_bf16 v[68:71], v[176:179], v[228:231], v[68:71]
    ds_read_b64_tr_b16 v[206:207], v235 offset:26112
    v_mfma_f32_16x16x32_bf16 v[144:147], v[180:183], v[228:231], v[144:147]
    v_mfma_f32_16x16x32_bf16 v[148:151], v[184:187], v[228:231], v[148:151]
    ds_read_b64_tr_b16 v[208:209], v236 offset:24576
    v_mfma_f32_16x16x32_bf16 v[152:155], v[188:191], v[228:231], v[152:155]
    ds_read_b128 v[228:231], v239 offset:32768
    v_mfma_f32_16x16x32_bf16 v[72:75], v[168:171], v[216:219], v[72:75]
    ds_read_b64_tr_b16 v[210:211], v236 offset:26112
    v_mfma_f32_16x16x32_bf16 v[76:79], v[172:175], v[216:219], v[76:79]
    v_mfma_f32_16x16x32_bf16 v[80:83], v[176:179], v[216:219], v[80:83]
    ds_read_b64_tr_b16 v[212:213], v237 offset:24576
    v_mfma_f32_16x16x32_bf16 v[156:159], v[180:183], v[216:219], v[156:159]
    v_mfma_f32_16x16x32_bf16 v[160:163], v[184:187], v[216:219], v[160:163]
    ds_read_b64_tr_b16 v[214:215], v237 offset:26112
    v_mfma_f32_16x16x32_bf16 v[164:167], v[188:191], v[216:219], v[164:167]
    ds_read_b128 v[216:219], v239 offset:34816
    v_mfma_f32_16x16x32_bf16 v[0:3], v[192:195], v[220:223], v[0:3]
    v_mfma_f32_16x16x32_bf16 v[4:7], v[196:199], v[220:223], v[4:7]
    v_mfma_f32_16x16x32_bf16 v[8:11], v[200:203], v[220:223], v[8:11]
    s_waitcnt lgkmcnt(8)
    v_mfma_f32_16x16x32_bf16 v[12:15], v[192:195], v[224:227], v[12:15]
    v_mfma_f32_16x16x32_bf16 v[16:19], v[196:199], v[224:227], v[16:19]
    v_mfma_f32_16x16x32_bf16 v[20:23], v[200:203], v[224:227], v[20:23]
    s_waitcnt lgkmcnt(6)
    v_mfma_f32_16x16x32_bf16 v[84:87], v[204:207], v[220:223], v[84:87]
    s_waitcnt lgkmcnt(3)
    v_mfma_f32_16x16x32_bf16 v[88:91], v[208:211], v[220:223], v[88:91]
    s_waitcnt lgkmcnt(1)
    s_barrier
    v_mfma_f32_16x16x32_bf16 v[92:95], v[212:215], v[220:223], v[92:95]
    ds_read_b128 v[220:223], v239 offset:36864
    v_mfma_f32_16x16x32_bf16 v[96:99], v[204:207], v[224:227], v[96:99]
    v_mfma_f32_16x16x32_bf16 v[100:103], v[208:211], v[224:227], v[100:103]
    ds_read_b64_tr_b16 v[168:169], v232 offset:12288
    v_mfma_f32_16x16x32_bf16 v[104:107], v[212:215], v[224:227], v[104:107]
    ds_read_b128 v[224:227], v239 offset:38912
    v_mfma_f32_16x16x32_bf16 v[24:27], v[192:195], v[228:231], v[24:27]
    v_mfma_f32_16x16x32_bf16 v[28:31], v[196:199], v[228:231], v[28:31]
    ds_read_b64_tr_b16 v[170:171], v232 offset:13824
    v_mfma_f32_16x16x32_bf16 v[32:35], v[200:203], v[228:231], v[32:35]
    v_mfma_f32_16x16x32_bf16 v[108:111], v[204:207], v[228:231], v[108:111]
    v_mfma_f32_16x16x32_bf16 v[112:115], v[208:211], v[228:231], v[112:115]
    ds_read_b64_tr_b16 v[172:173], v233 offset:12288
    v_mfma_f32_16x16x32_bf16 v[116:119], v[212:215], v[228:231], v[116:119]
    ds_read_b128 v[228:231], v239 offset:40960
    s_waitcnt lgkmcnt(6)
    v_mfma_f32_16x16x32_bf16 v[36:39], v[192:195], v[216:219], v[36:39]
    v_mfma_f32_16x16x32_bf16 v[40:43], v[196:199], v[216:219], v[40:43]
    ds_read_b64_tr_b16 v[174:175], v233 offset:13824
    v_mfma_f32_16x16x32_bf16 v[44:47], v[200:203], v[216:219], v[44:47]
    v_mfma_f32_16x16x32_bf16 v[120:123], v[204:207], v[216:219], v[120:123]
    v_mfma_f32_16x16x32_bf16 v[124:127], v[208:211], v[216:219], v[124:127]
    ds_read_b64_tr_b16 v[176:177], v234 offset:12288
    v_mfma_f32_16x16x32_bf16 v[128:131], v[212:215], v[216:219], v[128:131]
    ds_read_b128 v[216:219], v238 offset:0
    s_waitcnt lgkmcnt(8)
    v_mfma_f32_16x16x32_bf16 v[48:51], v[192:195], v[220:223], v[48:51]
    v_mfma_f32_16x16x32_bf16 v[52:55], v[196:199], v[220:223], v[52:55]
    ds_read_b64_tr_b16 v[178:179], v234 offset:13824
    v_mfma_f32_16x16x32_bf16 v[56:59], v[200:203], v[220:223], v[56:59]
    v_mfma_f32_16x16x32_bf16 v[132:135], v[204:207], v[220:223], v[132:135]
    v_mfma_f32_16x16x32_bf16 v[136:139], v[208:211], v[220:223], v[136:139]
    s_waitcnt lgkmcnt(0)
    s_barrier
    v_mfma_f32_16x16x32_bf16 v[140:143], v[212:215], v[220:223], v[140:143]
    ds_read_b128 v[220:223], v238 offset:2048
    v_mfma_f32_16x16x32_bf16 v[60:63], v[192:195], v[224:227], v[60:63]
    ds_read_b64_tr_b16 v[180:181], v232 offset:24576
    v_mfma_f32_16x16x32_bf16 v[64:67], v[196:199], v[224:227], v[64:67]
    v_mfma_f32_16x16x32_bf16 v[68:71], v[200:203], v[224:227], v[68:71]
    ds_read_b64_tr_b16 v[182:183], v232 offset:26112
    v_mfma_f32_16x16x32_bf16 v[144:147], v[204:207], v[224:227], v[144:147]
    v_mfma_f32_16x16x32_bf16 v[148:151], v[208:211], v[224:227], v[148:151]
    ds_read_b64_tr_b16 v[184:185], v233 offset:24576
    v_mfma_f32_16x16x32_bf16 v[152:155], v[212:215], v[224:227], v[152:155]
    ds_read_b128 v[224:227], v238 offset:4096
    v_mfma_f32_16x16x32_bf16 v[72:75], v[192:195], v[228:231], v[72:75]
    ds_read_b64_tr_b16 v[186:187], v233 offset:26112
    v_mfma_f32_16x16x32_bf16 v[76:79], v[196:199], v[228:231], v[76:79]
    v_mfma_f32_16x16x32_bf16 v[80:83], v[200:203], v[228:231], v[80:83]
    ds_read_b64_tr_b16 v[188:189], v234 offset:24576
    v_mfma_f32_16x16x32_bf16 v[156:159], v[204:207], v[228:231], v[156:159]
    v_mfma_f32_16x16x32_bf16 v[160:163], v[208:211], v[228:231], v[160:163]
    ds_read_b64_tr_b16 v[190:191], v234 offset:26112
    v_mfma_f32_16x16x32_bf16 v[164:167], v[212:215], v[228:231], v[164:167]
    ds_read_b128 v[228:231], v238 offset:6144
    v_mfma_f32_16x16x32_bf16 v[0:3], v[168:171], v[216:219], v[0:3]
    v_mfma_f32_16x16x32_bf16 v[4:7], v[172:175], v[216:219], v[4:7]
    v_mfma_f32_16x16x32_bf16 v[8:11], v[176:179], v[216:219], v[8:11]
    s_waitcnt lgkmcnt(8)
    v_mfma_f32_16x16x32_bf16 v[12:15], v[168:171], v[220:223], v[12:15]
    v_mfma_f32_16x16x32_bf16 v[16:19], v[172:175], v[220:223], v[16:19]
    v_mfma_f32_16x16x32_bf16 v[20:23], v[176:179], v[220:223], v[20:23]
    s_waitcnt lgkmcnt(6)
    v_mfma_f32_16x16x32_bf16 v[84:87], v[180:183], v[216:219], v[84:87]
    s_waitcnt lgkmcnt(3)
    v_mfma_f32_16x16x32_bf16 v[88:91], v[184:187], v[216:219], v[88:91]
    s_waitcnt lgkmcnt(1)
    s_barrier
    v_mfma_f32_16x16x32_bf16 v[92:95], v[188:191], v[216:219], v[92:95]
    ds_read_b128 v[216:219], v238 offset:8192
    v_mfma_f32_16x16x32_bf16 v[96:99], v[180:183], v[220:223], v[96:99]
    v_mfma_f32_16x16x32_bf16 v[100:103], v[184:187], v[220:223], v[100:103]
    ds_read_b64_tr_b16 v[192:193], v235 offset:12288
    v_mfma_f32_16x16x32_bf16 v[104:107], v[188:191], v[220:223], v[104:107]
    ds_read_b128 v[220:223], v238 offset:10240
    v_mfma_f32_16x16x32_bf16 v[24:27], v[168:171], v[224:227], v[24:27]
    v_mfma_f32_16x16x32_bf16 v[28:31], v[172:175], v[224:227], v[28:31]
    ds_read_b64_tr_b16 v[194:195], v235 offset:13824
    v_mfma_f32_16x16x32_bf16 v[32:35], v[176:179], v[224:227], v[32:35]
    v_mfma_f32_16x16x32_bf16 v[108:111], v[180:183], v[224:227], v[108:111]
    v_mfma_f32_16x16x32_bf16 v[112:115], v[184:187], v[224:227], v[112:115]
    ds_read_b64_tr_b16 v[196:197], v236 offset:12288
    v_mfma_f32_16x16x32_bf16 v[116:119], v[188:191], v[224:227], v[116:119]
    ds_read_b128 v[224:227], v238 offset:12288
    s_waitcnt lgkmcnt(6)
    v_mfma_f32_16x16x32_bf16 v[36:39], v[168:171], v[228:231], v[36:39]
    v_mfma_f32_16x16x32_bf16 v[40:43], v[172:175], v[228:231], v[40:43]
    ds_read_b64_tr_b16 v[198:199], v236 offset:13824
    v_mfma_f32_16x16x32_bf16 v[44:47], v[176:179], v[228:231], v[44:47]
    v_mfma_f32_16x16x32_bf16 v[120:123], v[180:183], v[228:231], v[120:123]
    v_mfma_f32_16x16x32_bf16 v[124:127], v[184:187], v[228:231], v[124:127]
    ds_read_b64_tr_b16 v[200:201], v237 offset:12288
    v_mfma_f32_16x16x32_bf16 v[128:131], v[188:191], v[228:231], v[128:131]
    ds_read_b128 v[228:231], v239 offset:0
    s_waitcnt lgkmcnt(8)
    v_mfma_f32_16x16x32_bf16 v[48:51], v[168:171], v[216:219], v[48:51]
    v_mfma_f32_16x16x32_bf16 v[52:55], v[172:175], v[216:219], v[52:55]
    ds_read_b64_tr_b16 v[202:203], v237 offset:13824
    v_mfma_f32_16x16x32_bf16 v[56:59], v[176:179], v[216:219], v[56:59]
    v_mfma_f32_16x16x32_bf16 v[132:135], v[180:183], v[216:219], v[132:135]
    v_mfma_f32_16x16x32_bf16 v[136:139], v[184:187], v[216:219], v[136:139]
    s_waitcnt lgkmcnt(0)
    s_barrier
    v_mfma_f32_16x16x32_bf16 v[140:143], v[188:191], v[216:219], v[140:143]
    ds_read_b128 v[216:219], v239 offset:2048
    v_mfma_f32_16x16x32_bf16 v[60:63], v[168:171], v[220:223], v[60:63]
    ds_read_b64_tr_b16 v[204:205], v235 offset:24576
    v_mfma_f32_16x16x32_bf16 v[64:67], v[172:175], v[220:223], v[64:67]
    v_mfma_f32_16x16x32_bf16 v[68:71], v[176:179], v[220:223], v[68:71]
    ds_read_b64_tr_b16 v[206:207], v235 offset:26112
    v_mfma_f32_16x16x32_bf16 v[144:147], v[180:183], v[220:223], v[144:147]
    v_mfma_f32_16x16x32_bf16 v[148:151], v[184:187], v[220:223], v[148:151]
    ds_read_b64_tr_b16 v[208:209], v236 offset:24576
    v_mfma_f32_16x16x32_bf16 v[152:155], v[188:191], v[220:223], v[152:155]
    ds_read_b128 v[220:223], v239 offset:4096
    v_mfma_f32_16x16x32_bf16 v[72:75], v[168:171], v[224:227], v[72:75]
    ds_read_b64_tr_b16 v[210:211], v236 offset:26112
    v_mfma_f32_16x16x32_bf16 v[76:79], v[172:175], v[224:227], v[76:79]
    v_mfma_f32_16x16x32_bf16 v[80:83], v[176:179], v[224:227], v[80:83]
    ds_read_b64_tr_b16 v[212:213], v237 offset:24576
    v_mfma_f32_16x16x32_bf16 v[156:159], v[180:183], v[224:227], v[156:159]
    v_mfma_f32_16x16x32_bf16 v[160:163], v[184:187], v[224:227], v[160:163]
    ds_read_b64_tr_b16 v[214:215], v237 offset:26112
    v_mfma_f32_16x16x32_bf16 v[164:167], v[188:191], v[224:227], v[164:167]
    ds_read_b128 v[224:227], v239 offset:6144
    v_mfma_f32_16x16x32_bf16 v[0:3], v[192:195], v[228:231], v[0:3]
    v_mfma_f32_16x16x32_bf16 v[4:7], v[196:199], v[228:231], v[4:7]
    v_mfma_f32_16x16x32_bf16 v[8:11], v[200:203], v[228:231], v[8:11]
    s_waitcnt lgkmcnt(8)
    v_mfma_f32_16x16x32_bf16 v[12:15], v[192:195], v[216:219], v[12:15]
    v_mfma_f32_16x16x32_bf16 v[16:19], v[196:199], v[216:219], v[16:19]
    v_mfma_f32_16x16x32_bf16 v[20:23], v[200:203], v[216:219], v[20:23]
    s_waitcnt lgkmcnt(6)
    v_mfma_f32_16x16x32_bf16 v[84:87], v[204:207], v[228:231], v[84:87]
    s_waitcnt lgkmcnt(3)
    v_mfma_f32_16x16x32_bf16 v[88:91], v[208:211], v[228:231], v[88:91]
    s_waitcnt lgkmcnt(1)
    s_barrier
    v_mfma_f32_16x16x32_bf16 v[92:95], v[212:215], v[228:231], v[92:95]
    ds_read_b128 v[228:231], v239 offset:8192
    v_mfma_f32_16x16x32_bf16 v[96:99], v[204:207], v[216:219], v[96:99]
    v_mfma_f32_16x16x32_bf16 v[100:103], v[208:211], v[216:219], v[100:103]
    ds_read_b64_tr_b16 v[168:169], v232 offset:12288
    v_mfma_f32_16x16x32_bf16 v[104:107], v[212:215], v[216:219], v[104:107]
    ds_read_b128 v[216:219], v239 offset:10240
    v_mfma_f32_16x16x32_bf16 v[24:27], v[192:195], v[220:223], v[24:27]
    v_mfma_f32_16x16x32_bf16 v[28:31], v[196:199], v[220:223], v[28:31]
    ds_read_b64_tr_b16 v[170:171], v232 offset:13824
    v_mfma_f32_16x16x32_bf16 v[32:35], v[200:203], v[220:223], v[32:35]
    v_mfma_f32_16x16x32_bf16 v[108:111], v[204:207], v[220:223], v[108:111]
    v_mfma_f32_16x16x32_bf16 v[112:115], v[208:211], v[220:223], v[112:115]
    ds_read_b64_tr_b16 v[172:173], v233 offset:12288
    v_mfma_f32_16x16x32_bf16 v[116:119], v[212:215], v[220:223], v[116:119]
    ds_read_b128 v[220:223], v239 offset:12288
    s_waitcnt lgkmcnt(6)
    v_mfma_f32_16x16x32_bf16 v[36:39], v[192:195], v[224:227], v[36:39]
    v_mfma_f32_16x16x32_bf16 v[40:43], v[196:199], v[224:227], v[40:43]
    ds_read_b64_tr_b16 v[174:175], v233 offset:13824
    v_mfma_f32_16x16x32_bf16 v[44:47], v[200:203], v[224:227], v[44:47]
    v_mfma_f32_16x16x32_bf16 v[120:123], v[204:207], v[224:227], v[120:123]
    v_mfma_f32_16x16x32_bf16 v[124:127], v[208:211], v[224:227], v[124:127]
    ds_read_b64_tr_b16 v[176:177], v234 offset:12288
    v_mfma_f32_16x16x32_bf16 v[128:131], v[212:215], v[224:227], v[128:131]
    ds_read_b128 v[224:227], v238 offset:14336
    s_waitcnt lgkmcnt(8)
    v_mfma_f32_16x16x32_bf16 v[48:51], v[192:195], v[228:231], v[48:51]
    v_mfma_f32_16x16x32_bf16 v[52:55], v[196:199], v[228:231], v[52:55]
    ds_read_b64_tr_b16 v[178:179], v234 offset:13824
    v_mfma_f32_16x16x32_bf16 v[56:59], v[200:203], v[228:231], v[56:59]
    v_mfma_f32_16x16x32_bf16 v[132:135], v[204:207], v[228:231], v[132:135]
    v_mfma_f32_16x16x32_bf16 v[136:139], v[208:211], v[228:231], v[136:139]
    s_waitcnt lgkmcnt(0)
    s_barrier
    v_mfma_f32_16x16x32_bf16 v[140:143], v[212:215], v[228:231], v[140:143]
    ds_read_b128 v[228:231], v238 offset:16384
    v_mfma_f32_16x16x32_bf16 v[60:63], v[192:195], v[216:219], v[60:63]
    ds_read_b64_tr_b16 v[180:181], v232 offset:24576
    v_mfma_f32_16x16x32_bf16 v[64:67], v[196:199], v[216:219], v[64:67]
    v_mfma_f32_16x16x32_bf16 v[68:71], v[200:203], v[216:219], v[68:71]
    ds_read_b64_tr_b16 v[182:183], v232 offset:26112
    v_mfma_f32_16x16x32_bf16 v[144:147], v[204:207], v[216:219], v[144:147]
    v_mfma_f32_16x16x32_bf16 v[148:151], v[208:211], v[216:219], v[148:151]
    ds_read_b64_tr_b16 v[184:185], v233 offset:24576
    v_mfma_f32_16x16x32_bf16 v[152:155], v[212:215], v[216:219], v[152:155]
    ds_read_b128 v[216:219], v238 offset:18432
    v_mfma_f32_16x16x32_bf16 v[72:75], v[192:195], v[220:223], v[72:75]
    ds_read_b64_tr_b16 v[186:187], v233 offset:26112
    v_mfma_f32_16x16x32_bf16 v[76:79], v[196:199], v[220:223], v[76:79]
    v_mfma_f32_16x16x32_bf16 v[80:83], v[200:203], v[220:223], v[80:83]
    ds_read_b64_tr_b16 v[188:189], v234 offset:24576
    v_mfma_f32_16x16x32_bf16 v[156:159], v[204:207], v[220:223], v[156:159]
    v_mfma_f32_16x16x32_bf16 v[160:163], v[208:211], v[220:223], v[160:163]
    ds_read_b64_tr_b16 v[190:191], v234 offset:26112
    v_mfma_f32_16x16x32_bf16 v[164:167], v[212:215], v[220:223], v[164:167]
    ds_read_b128 v[220:223], v238 offset:20480
    v_mfma_f32_16x16x32_bf16 v[0:3], v[168:171], v[224:227], v[0:3]
    v_mfma_f32_16x16x32_bf16 v[4:7], v[172:175], v[224:227], v[4:7]
    v_mfma_f32_16x16x32_bf16 v[8:11], v[176:179], v[224:227], v[8:11]
    s_waitcnt lgkmcnt(8)
    v_mfma_f32_16x16x32_bf16 v[12:15], v[168:171], v[228:231], v[12:15]
    v_mfma_f32_16x16x32_bf16 v[16:19], v[172:175], v[228:231], v[16:19]
    v_mfma_f32_16x16x32_bf16 v[20:23], v[176:179], v[228:231], v[20:23]
    s_waitcnt lgkmcnt(6)
    v_mfma_f32_16x16x32_bf16 v[84:87], v[180:183], v[224:227], v[84:87]
    s_waitcnt lgkmcnt(3)
    v_mfma_f32_16x16x32_bf16 v[88:91], v[184:187], v[224:227], v[88:91]
    s_waitcnt lgkmcnt(1)
    s_barrier
    v_mfma_f32_16x16x32_bf16 v[92:95], v[188:191], v[224:227], v[92:95]
    ds_read_b128 v[224:227], v238 offset:22528
    v_mfma_f32_16x16x32_bf16 v[96:99], v[180:183], v[228:231], v[96:99]
    v_mfma_f32_16x16x32_bf16 v[100:103], v[184:187], v[228:231], v[100:103]
    ds_read_b64_tr_b16 v[192:193], v235 offset:12288
    v_mfma_f32_16x16x32_bf16 v[104:107], v[188:191], v[228:231], v[104:107]
    ds_read_b128 v[228:231], v238 offset:24576
    v_mfma_f32_16x16x32_bf16 v[24:27], v[168:171], v[216:219], v[24:27]
    v_mfma_f32_16x16x32_bf16 v[28:31], v[172:175], v[216:219], v[28:31]
    ds_read_b64_tr_b16 v[194:195], v235 offset:13824
    v_mfma_f32_16x16x32_bf16 v[32:35], v[176:179], v[216:219], v[32:35]
    v_mfma_f32_16x16x32_bf16 v[108:111], v[180:183], v[216:219], v[108:111]
    v_mfma_f32_16x16x32_bf16 v[112:115], v[184:187], v[216:219], v[112:115]
    ds_read_b64_tr_b16 v[196:197], v236 offset:12288
    v_mfma_f32_16x16x32_bf16 v[116:119], v[188:191], v[216:219], v[116:119]
    ds_read_b128 v[216:219], v238 offset:26624
    s_waitcnt lgkmcnt(6)
    v_mfma_f32_16x16x32_bf16 v[36:39], v[168:171], v[220:223], v[36:39]
    v_mfma_f32_16x16x32_bf16 v[40:43], v[172:175], v[220:223], v[40:43]
    ds_read_b64_tr_b16 v[198:199], v236 offset:13824
    v_mfma_f32_16x16x32_bf16 v[44:47], v[176:179], v[220:223], v[44:47]
    v_mfma_f32_16x16x32_bf16 v[120:123], v[180:183], v[220:223], v[120:123]
    v_mfma_f32_16x16x32_bf16 v[124:127], v[184:187], v[220:223], v[124:127]
    ds_read_b64_tr_b16 v[200:201], v237 offset:12288
    v_mfma_f32_16x16x32_bf16 v[128:131], v[188:191], v[220:223], v[128:131]
    ds_read_b128 v[220:223], v239 offset:14336
    s_waitcnt lgkmcnt(8)
    v_mfma_f32_16x16x32_bf16 v[48:51], v[168:171], v[224:227], v[48:51]
    v_mfma_f32_16x16x32_bf16 v[52:55], v[172:175], v[224:227], v[52:55]
    ds_read_b64_tr_b16 v[202:203], v237 offset:13824
    v_mfma_f32_16x16x32_bf16 v[56:59], v[176:179], v[224:227], v[56:59]
    v_mfma_f32_16x16x32_bf16 v[132:135], v[180:183], v[224:227], v[132:135]
    v_mfma_f32_16x16x32_bf16 v[136:139], v[184:187], v[224:227], v[136:139]
    s_waitcnt lgkmcnt(0)
    s_barrier
    v_mfma_f32_16x16x32_bf16 v[140:143], v[188:191], v[224:227], v[140:143]
    ds_read_b128 v[224:227], v239 offset:16384
    v_mfma_f32_16x16x32_bf16 v[60:63], v[168:171], v[228:231], v[60:63]
    ds_read_b64_tr_b16 v[204:205], v235 offset:24576
    v_mfma_f32_16x16x32_bf16 v[64:67], v[172:175], v[228:231], v[64:67]
    v_mfma_f32_16x16x32_bf16 v[68:71], v[176:179], v[228:231], v[68:71]
    ds_read_b64_tr_b16 v[206:207], v235 offset:26112
    v_mfma_f32_16x16x32_bf16 v[144:147], v[180:183], v[228:231], v[144:147]
    v_mfma_f32_16x16x32_bf16 v[148:151], v[184:187], v[228:231], v[148:151]
    ds_read_b64_tr_b16 v[208:209], v236 offset:24576
    v_mfma_f32_16x16x32_bf16 v[152:155], v[188:191], v[228:231], v[152:155]
    ds_read_b128 v[228:231], v239 offset:18432
    v_mfma_f32_16x16x32_bf16 v[72:75], v[168:171], v[216:219], v[72:75]
    ds_read_b64_tr_b16 v[210:211], v236 offset:26112
    v_mfma_f32_16x16x32_bf16 v[76:79], v[172:175], v[216:219], v[76:79]
    v_mfma_f32_16x16x32_bf16 v[80:83], v[176:179], v[216:219], v[80:83]
    ds_read_b64_tr_b16 v[212:213], v237 offset:24576
    v_mfma_f32_16x16x32_bf16 v[156:159], v[180:183], v[216:219], v[156:159]
    v_mfma_f32_16x16x32_bf16 v[160:163], v[184:187], v[216:219], v[160:163]
    ds_read_b64_tr_b16 v[214:215], v237 offset:26112
    v_mfma_f32_16x16x32_bf16 v[164:167], v[188:191], v[216:219], v[164:167]
    ds_read_b128 v[216:219], v239 offset:20480
    v_mfma_f32_16x16x32_bf16 v[0:3], v[192:195], v[220:223], v[0:3]
    v_mfma_f32_16x16x32_bf16 v[4:7], v[196:199], v[220:223], v[4:7]
    v_mfma_f32_16x16x32_bf16 v[8:11], v[200:203], v[220:223], v[8:11]
    s_waitcnt lgkmcnt(8)
    v_mfma_f32_16x16x32_bf16 v[12:15], v[192:195], v[224:227], v[12:15]
    v_mfma_f32_16x16x32_bf16 v[16:19], v[196:199], v[224:227], v[16:19]
    v_mfma_f32_16x16x32_bf16 v[20:23], v[200:203], v[224:227], v[20:23]
    s_waitcnt lgkmcnt(6)
    v_mfma_f32_16x16x32_bf16 v[84:87], v[204:207], v[220:223], v[84:87]
    s_waitcnt lgkmcnt(3)
    v_mfma_f32_16x16x32_bf16 v[88:91], v[208:211], v[220:223], v[88:91]
    s_waitcnt lgkmcnt(1)
    s_barrier
    v_mfma_f32_16x16x32_bf16 v[92:95], v[212:215], v[220:223], v[92:95]
    ds_read_b128 v[220:223], v239 offset:22528
    v_mfma_f32_16x16x32_bf16 v[96:99], v[204:207], v[224:227], v[96:99]
    v_mfma_f32_16x16x32_bf16 v[100:103], v[208:211], v[224:227], v[100:103]
    ds_read_b64_tr_b16 v[168:169], v232 offset:12288
    v_mfma_f32_16x16x32_bf16 v[104:107], v[212:215], v[224:227], v[104:107]
    ds_read_b128 v[224:227], v239 offset:24576
    v_mfma_f32_16x16x32_bf16 v[24:27], v[192:195], v[228:231], v[24:27]
    v_mfma_f32_16x16x32_bf16 v[28:31], v[196:199], v[228:231], v[28:31]
    ds_read_b64_tr_b16 v[170:171], v232 offset:13824
    v_mfma_f32_16x16x32_bf16 v[32:35], v[200:203], v[228:231], v[32:35]
    v_mfma_f32_16x16x32_bf16 v[108:111], v[204:207], v[228:231], v[108:111]
    v_mfma_f32_16x16x32_bf16 v[112:115], v[208:211], v[228:231], v[112:115]
    ds_read_b64_tr_b16 v[172:173], v233 offset:12288
    v_mfma_f32_16x16x32_bf16 v[116:119], v[212:215], v[228:231], v[116:119]
    ds_read_b128 v[228:231], v239 offset:26624
    s_waitcnt lgkmcnt(6)
    v_mfma_f32_16x16x32_bf16 v[36:39], v[192:195], v[216:219], v[36:39]
    v_mfma_f32_16x16x32_bf16 v[40:43], v[196:199], v[216:219], v[40:43]
    ds_read_b64_tr_b16 v[174:175], v233 offset:13824
    v_mfma_f32_16x16x32_bf16 v[44:47], v[200:203], v[216:219], v[44:47]
    v_mfma_f32_16x16x32_bf16 v[120:123], v[204:207], v[216:219], v[120:123]
    v_mfma_f32_16x16x32_bf16 v[124:127], v[208:211], v[216:219], v[124:127]
    ds_read_b64_tr_b16 v[176:177], v234 offset:12288
    v_mfma_f32_16x16x32_bf16 v[128:131], v[212:215], v[216:219], v[128:131]
    ds_read_b128 v[216:219], v238 offset:28672
    s_waitcnt lgkmcnt(8)
    v_mfma_f32_16x16x32_bf16 v[48:51], v[192:195], v[220:223], v[48:51]
    v_mfma_f32_16x16x32_bf16 v[52:55], v[196:199], v[220:223], v[52:55]
    ds_read_b64_tr_b16 v[178:179], v234 offset:13824
    v_mfma_f32_16x16x32_bf16 v[56:59], v[200:203], v[220:223], v[56:59]
    v_mfma_f32_16x16x32_bf16 v[132:135], v[204:207], v[220:223], v[132:135]
    v_mfma_f32_16x16x32_bf16 v[136:139], v[208:211], v[220:223], v[136:139]
    s_waitcnt lgkmcnt(0)
    s_barrier
    v_mfma_f32_16x16x32_bf16 v[140:143], v[212:215], v[220:223], v[140:143]
    ds_read_b128 v[220:223], v238 offset:30720
    v_mfma_f32_16x16x32_bf16 v[60:63], v[192:195], v[224:227], v[60:63]
    ds_read_b64_tr_b16 v[180:181], v232 offset:24576
    v_mfma_f32_16x16x32_bf16 v[64:67], v[196:199], v[224:227], v[64:67]
    v_mfma_f32_16x16x32_bf16 v[68:71], v[200:203], v[224:227], v[68:71]
    ds_read_b64_tr_b16 v[182:183], v232 offset:26112
    v_mfma_f32_16x16x32_bf16 v[144:147], v[204:207], v[224:227], v[144:147]
    v_mfma_f32_16x16x32_bf16 v[148:151], v[208:211], v[224:227], v[148:151]
    ds_read_b64_tr_b16 v[184:185], v233 offset:24576
    v_mfma_f32_16x16x32_bf16 v[152:155], v[212:215], v[224:227], v[152:155]
    ds_read_b128 v[224:227], v238 offset:32768
    v_mfma_f32_16x16x32_bf16 v[72:75], v[192:195], v[228:231], v[72:75]
    ds_read_b64_tr_b16 v[186:187], v233 offset:26112
    v_mfma_f32_16x16x32_bf16 v[76:79], v[196:199], v[228:231], v[76:79]
    v_mfma_f32_16x16x32_bf16 v[80:83], v[200:203], v[228:231], v[80:83]
    ds_read_b64_tr_b16 v[188:189], v234 offset:24576
    v_mfma_f32_16x16x32_bf16 v[156:159], v[204:207], v[228:231], v[156:159]
    v_mfma_f32_16x16x32_bf16 v[160:163], v[208:211], v[228:231], v[160:163]
    ds_read_b64_tr_b16 v[190:191], v234 offset:26112
    v_mfma_f32_16x16x32_bf16 v[164:167], v[212:215], v[228:231], v[164:167]
    ds_read_b128 v[228:231], v238 offset:34816
    v_mfma_f32_16x16x32_bf16 v[0:3], v[168:171], v[216:219], v[0:3]
    v_mfma_f32_16x16x32_bf16 v[4:7], v[172:175], v[216:219], v[4:7]
    v_mfma_f32_16x16x32_bf16 v[8:11], v[176:179], v[216:219], v[8:11]
    s_waitcnt lgkmcnt(8)
    v_mfma_f32_16x16x32_bf16 v[12:15], v[168:171], v[220:223], v[12:15]
    v_mfma_f32_16x16x32_bf16 v[16:19], v[172:175], v[220:223], v[16:19]
    v_mfma_f32_16x16x32_bf16 v[20:23], v[176:179], v[220:223], v[20:23]
    s_waitcnt lgkmcnt(6)
    v_mfma_f32_16x16x32_bf16 v[84:87], v[180:183], v[216:219], v[84:87]
    s_waitcnt lgkmcnt(3)
    v_mfma_f32_16x16x32_bf16 v[88:91], v[184:187], v[216:219], v[88:91]
    s_waitcnt lgkmcnt(1)
    s_barrier
    v_mfma_f32_16x16x32_bf16 v[92:95], v[188:191], v[216:219], v[92:95]
    ds_read_b128 v[216:219], v238 offset:36864
    v_mfma_f32_16x16x32_bf16 v[96:99], v[180:183], v[220:223], v[96:99]
    v_mfma_f32_16x16x32_bf16 v[100:103], v[184:187], v[220:223], v[100:103]
    ds_read_b64_tr_b16 v[192:193], v235 offset:12288
    v_mfma_f32_16x16x32_bf16 v[104:107], v[188:191], v[220:223], v[104:107]
    ds_read_b128 v[220:223], v238 offset:38912
    v_mfma_f32_16x16x32_bf16 v[24:27], v[168:171], v[224:227], v[24:27]
    v_mfma_f32_16x16x32_bf16 v[28:31], v[172:175], v[224:227], v[28:31]
    ds_read_b64_tr_b16 v[194:195], v235 offset:13824
    v_mfma_f32_16x16x32_bf16 v[32:35], v[176:179], v[224:227], v[32:35]
    v_mfma_f32_16x16x32_bf16 v[108:111], v[180:183], v[224:227], v[108:111]
    v_mfma_f32_16x16x32_bf16 v[112:115], v[184:187], v[224:227], v[112:115]
    ds_read_b64_tr_b16 v[196:197], v236 offset:12288
    v_mfma_f32_16x16x32_bf16 v[116:119], v[188:191], v[224:227], v[116:119]
    ds_read_b128 v[224:227], v238 offset:40960
    s_waitcnt lgkmcnt(6)
    v_mfma_f32_16x16x32_bf16 v[36:39], v[168:171], v[228:231], v[36:39]
    v_mfma_f32_16x16x32_bf16 v[40:43], v[172:175], v[228:231], v[40:43]
    ds_read_b64_tr_b16 v[198:199], v236 offset:13824
    v_mfma_f32_16x16x32_bf16 v[44:47], v[176:179], v[228:231], v[44:47]
    v_mfma_f32_16x16x32_bf16 v[120:123], v[180:183], v[228:231], v[120:123]
    v_mfma_f32_16x16x32_bf16 v[124:127], v[184:187], v[228:231], v[124:127]
    ds_read_b64_tr_b16 v[200:201], v237 offset:12288
    v_mfma_f32_16x16x32_bf16 v[128:131], v[188:191], v[228:231], v[128:131]
    ds_read_b128 v[228:231], v239 offset:28672
    s_waitcnt lgkmcnt(8)
    v_mfma_f32_16x16x32_bf16 v[48:51], v[168:171], v[216:219], v[48:51]
    v_mfma_f32_16x16x32_bf16 v[52:55], v[172:175], v[216:219], v[52:55]
    ds_read_b64_tr_b16 v[202:203], v237 offset:13824
    v_mfma_f32_16x16x32_bf16 v[56:59], v[176:179], v[216:219], v[56:59]
    v_mfma_f32_16x16x32_bf16 v[132:135], v[180:183], v[216:219], v[132:135]
    v_mfma_f32_16x16x32_bf16 v[136:139], v[184:187], v[216:219], v[136:139]
    s_waitcnt lgkmcnt(0)
    s_barrier
    v_mfma_f32_16x16x32_bf16 v[140:143], v[188:191], v[216:219], v[140:143]
    ds_read_b128 v[216:219], v239 offset:30720
    v_mfma_f32_16x16x32_bf16 v[60:63], v[168:171], v[220:223], v[60:63]
    ds_read_b64_tr_b16 v[204:205], v235 offset:24576
    v_mfma_f32_16x16x32_bf16 v[64:67], v[172:175], v[220:223], v[64:67]
    v_mfma_f32_16x16x32_bf16 v[68:71], v[176:179], v[220:223], v[68:71]
    ds_read_b64_tr_b16 v[206:207], v235 offset:26112
    v_mfma_f32_16x16x32_bf16 v[144:147], v[180:183], v[220:223], v[144:147]
    v_mfma_f32_16x16x32_bf16 v[148:151], v[184:187], v[220:223], v[148:151]
    ds_read_b64_tr_b16 v[208:209], v236 offset:24576
    v_mfma_f32_16x16x32_bf16 v[152:155], v[188:191], v[220:223], v[152:155]
    ds_read_b128 v[220:223], v239 offset:32768
    v_mfma_f32_16x16x32_bf16 v[72:75], v[168:171], v[224:227], v[72:75]
    ds_read_b64_tr_b16 v[210:211], v236 offset:26112
    v_mfma_f32_16x16x32_bf16 v[76:79], v[172:175], v[224:227], v[76:79]
    v_mfma_f32_16x16x32_bf16 v[80:83], v[176:179], v[224:227], v[80:83]
    ds_read_b64_tr_b16 v[212:213], v237 offset:24576
    v_mfma_f32_16x16x32_bf16 v[156:159], v[180:183], v[224:227], v[156:159]
    v_mfma_f32_16x16x32_bf16 v[160:163], v[184:187], v[224:227], v[160:163]
    ds_read_b64_tr_b16 v[214:215], v237 offset:26112
    v_mfma_f32_16x16x32_bf16 v[164:167], v[188:191], v[224:227], v[164:167]
    ds_read_b128 v[224:227], v239 offset:34816
    v_add_u32 v238, 145408, v238
    v_mfma_f32_16x16x32_bf16 v[0:3], v[192:195], v[228:231], v[0:3]
    v_mfma_f32_16x16x32_bf16 v[4:7], v[196:199], v[228:231], v[4:7]
    v_mfma_f32_16x16x32_bf16 v[8:11], v[200:203], v[228:231], v[8:11]
    s_waitcnt lgkmcnt(8)
    v_mfma_f32_16x16x32_bf16 v[12:15], v[192:195], v[216:219], v[12:15]
    v_mfma_f32_16x16x32_bf16 v[16:19], v[196:199], v[216:219], v[16:19]
    v_mfma_f32_16x16x32_bf16 v[20:23], v[200:203], v[216:219], v[20:23]
    s_waitcnt lgkmcnt(6)
    v_mfma_f32_16x16x32_bf16 v[84:87], v[204:207], v[228:231], v[84:87]
    s_waitcnt lgkmcnt(3)
    v_mfma_f32_16x16x32_bf16 v[88:91], v[208:211], v[228:231], v[88:91]
    s_waitcnt lgkmcnt(1)
    s_barrier
    v_mfma_f32_16x16x32_bf16 v[92:95], v[212:215], v[228:231], v[92:95]
    ds_read_b128 v[228:231], v239 offset:36864
    v_mfma_f32_16x16x32_bf16 v[96:99], v[204:207], v[216:219], v[96:99]
    v_mfma_f32_16x16x32_bf16 v[100:103], v[208:211], v[216:219], v[100:103]
    ds_read_b64_tr_b16 v[168:169], v232 offset:12288
    v_mfma_f32_16x16x32_bf16 v[104:107], v[212:215], v[216:219], v[104:107]
    ds_read_b128 v[216:219], v239 offset:38912
    v_mfma_f32_16x16x32_bf16 v[24:27], v[192:195], v[220:223], v[24:27]
    v_mfma_f32_16x16x32_bf16 v[28:31], v[196:199], v[220:223], v[28:31]
    ds_read_b64_tr_b16 v[170:171], v232 offset:13824
    v_mfma_f32_16x16x32_bf16 v[32:35], v[200:203], v[220:223], v[32:35]
    v_mfma_f32_16x16x32_bf16 v[108:111], v[204:207], v[220:223], v[108:111]
    v_mfma_f32_16x16x32_bf16 v[112:115], v[208:211], v[220:223], v[112:115]
    ds_read_b64_tr_b16 v[172:173], v233 offset:12288
    v_mfma_f32_16x16x32_bf16 v[116:119], v[212:215], v[220:223], v[116:119]
    ds_read_b128 v[220:223], v239 offset:40960
    s_waitcnt lgkmcnt(6)
    v_mfma_f32_16x16x32_bf16 v[36:39], v[192:195], v[224:227], v[36:39]
    v_mfma_f32_16x16x32_bf16 v[40:43], v[196:199], v[224:227], v[40:43]
    ds_read_b64_tr_b16 v[174:175], v233 offset:13824
    v_mfma_f32_16x16x32_bf16 v[44:47], v[200:203], v[224:227], v[44:47]
    v_mfma_f32_16x16x32_bf16 v[120:123], v[204:207], v[224:227], v[120:123]
    v_mfma_f32_16x16x32_bf16 v[124:127], v[208:211], v[224:227], v[124:127]
    ds_read_b64_tr_b16 v[176:177], v234 offset:12288
    v_mfma_f32_16x16x32_bf16 v[128:131], v[212:215], v[224:227], v[128:131]
    ds_read_b128 v[224:227], v238 offset:0
    s_waitcnt lgkmcnt(8)
    v_mfma_f32_16x16x32_bf16 v[48:51], v[192:195], v[228:231], v[48:51]
    v_mfma_f32_16x16x32_bf16 v[52:55], v[196:199], v[228:231], v[52:55]
    ds_read_b64_tr_b16 v[178:179], v234 offset:13824
    v_mfma_f32_16x16x32_bf16 v[56:59], v[200:203], v[228:231], v[56:59]
    v_mfma_f32_16x16x32_bf16 v[132:135], v[204:207], v[228:231], v[132:135]
    v_mfma_f32_16x16x32_bf16 v[136:139], v[208:211], v[228:231], v[136:139]
    s_waitcnt lgkmcnt(0)
    s_barrier
    v_mfma_f32_16x16x32_bf16 v[140:143], v[212:215], v[228:231], v[140:143]
    ds_read_b128 v[228:231], v238 offset:2048
    v_mfma_f32_16x16x32_bf16 v[60:63], v[192:195], v[216:219], v[60:63]
    ds_read_b64_tr_b16 v[180:181], v232 offset:24576
    v_mfma_f32_16x16x32_bf16 v[64:67], v[196:199], v[216:219], v[64:67]
    v_mfma_f32_16x16x32_bf16 v[68:71], v[200:203], v[216:219], v[68:71]
    ds_read_b64_tr_b16 v[182:183], v232 offset:26112
    v_mfma_f32_16x16x32_bf16 v[144:147], v[204:207], v[216:219], v[144:147]
    v_mfma_f32_16x16x32_bf16 v[148:151], v[208:211], v[216:219], v[148:151]
    ds_read_b64_tr_b16 v[184:185], v233 offset:24576
    v_mfma_f32_16x16x32_bf16 v[152:155], v[212:215], v[216:219], v[152:155]
    ds_read_b128 v[216:219], v238 offset:4096
    v_mfma_f32_16x16x32_bf16 v[72:75], v[192:195], v[220:223], v[72:75]
    ds_read_b64_tr_b16 v[186:187], v233 offset:26112
    v_mfma_f32_16x16x32_bf16 v[76:79], v[196:199], v[220:223], v[76:79]
    v_mfma_f32_16x16x32_bf16 v[80:83], v[200:203], v[220:223], v[80:83]
    ds_read_b64_tr_b16 v[188:189], v234 offset:24576
    v_mfma_f32_16x16x32_bf16 v[156:159], v[204:207], v[220:223], v[156:159]
    v_mfma_f32_16x16x32_bf16 v[160:163], v[208:211], v[220:223], v[160:163]
    ds_read_b64_tr_b16 v[190:191], v234 offset:26112
    v_mfma_f32_16x16x32_bf16 v[164:167], v[212:215], v[220:223], v[164:167]
    ds_read_b128 v[220:223], v238 offset:6144
    v_add_u32 v239, 145408, v239
    v_mfma_f32_16x16x32_bf16 v[0:3], v[168:171], v[224:227], v[0:3]
    v_mfma_f32_16x16x32_bf16 v[4:7], v[172:175], v[224:227], v[4:7]
    v_mfma_f32_16x16x32_bf16 v[8:11], v[176:179], v[224:227], v[8:11]
    s_waitcnt lgkmcnt(8)
    v_mfma_f32_16x16x32_bf16 v[12:15], v[168:171], v[228:231], v[12:15]
    v_mfma_f32_16x16x32_bf16 v[16:19], v[172:175], v[228:231], v[16:19]
    v_mfma_f32_16x16x32_bf16 v[20:23], v[176:179], v[228:231], v[20:23]
    s_waitcnt lgkmcnt(6)
    v_mfma_f32_16x16x32_bf16 v[84:87], v[180:183], v[224:227], v[84:87]
    s_waitcnt lgkmcnt(3)
    v_mfma_f32_16x16x32_bf16 v[88:91], v[184:187], v[224:227], v[88:91]
    s_waitcnt lgkmcnt(1)
    s_barrier
    v_mfma_f32_16x16x32_bf16 v[92:95], v[188:191], v[224:227], v[92:95]
    ds_read_b128 v[224:227], v238 offset:8192
    v_mfma_f32_16x16x32_bf16 v[96:99], v[180:183], v[228:231], v[96:99]
    v_mfma_f32_16x16x32_bf16 v[100:103], v[184:187], v[228:231], v[100:103]
    ds_read_b64_tr_b16 v[192:193], v235 offset:12288
    v_mfma_f32_16x16x32_bf16 v[104:107], v[188:191], v[228:231], v[104:107]
    ds_read_b128 v[228:231], v238 offset:10240
    v_mfma_f32_16x16x32_bf16 v[24:27], v[168:171], v[216:219], v[24:27]
    v_mfma_f32_16x16x32_bf16 v[28:31], v[172:175], v[216:219], v[28:31]
    ds_read_b64_tr_b16 v[194:195], v235 offset:13824
    v_mfma_f32_16x16x32_bf16 v[32:35], v[176:179], v[216:219], v[32:35]
    v_mfma_f32_16x16x32_bf16 v[108:111], v[180:183], v[216:219], v[108:111]
    v_mfma_f32_16x16x32_bf16 v[112:115], v[184:187], v[216:219], v[112:115]
    ds_read_b64_tr_b16 v[196:197], v236 offset:12288
    v_mfma_f32_16x16x32_bf16 v[116:119], v[188:191], v[216:219], v[116:119]
    ds_read_b128 v[216:219], v238 offset:12288
    s_waitcnt lgkmcnt(6)
    v_mfma_f32_16x16x32_bf16 v[36:39], v[168:171], v[220:223], v[36:39]
    v_mfma_f32_16x16x32_bf16 v[40:43], v[172:175], v[220:223], v[40:43]
    ds_read_b64_tr_b16 v[198:199], v236 offset:13824
    v_mfma_f32_16x16x32_bf16 v[44:47], v[176:179], v[220:223], v[44:47]
    v_mfma_f32_16x16x32_bf16 v[120:123], v[180:183], v[220:223], v[120:123]
    v_mfma_f32_16x16x32_bf16 v[124:127], v[184:187], v[220:223], v[124:127]
    ds_read_b64_tr_b16 v[200:201], v237 offset:12288
    v_mfma_f32_16x16x32_bf16 v[128:131], v[188:191], v[220:223], v[128:131]
    ds_read_b128 v[220:223], v239 offset:0
    s_waitcnt lgkmcnt(8)
    v_mfma_f32_16x16x32_bf16 v[48:51], v[168:171], v[224:227], v[48:51]
    v_mfma_f32_16x16x32_bf16 v[52:55], v[172:175], v[224:227], v[52:55]
    ds_read_b64_tr_b16 v[202:203], v237 offset:13824
    v_mfma_f32_16x16x32_bf16 v[56:59], v[176:179], v[224:227], v[56:59]
    v_mfma_f32_16x16x32_bf16 v[132:135], v[180:183], v[224:227], v[132:135]
    v_mfma_f32_16x16x32_bf16 v[136:139], v[184:187], v[224:227], v[136:139]
    s_waitcnt lgkmcnt(0)
    s_barrier
    s_mul_i32 s65, s56, 3072
    s_lshl_b32 s64, s56, 10
    s_add_u32 m0, s64, 94208
    s_add_u32 s62, s65, 0
    buffer_load_dwordx4 v255, s[32:35], s62 offen offset:0 nt lds
    s_add_u32 m0, s64, 98176
    s_add_u32 s62, s65, 0
    buffer_load_dwordx4 v255, s[32:35], s62 offen offset:128 nt lds
    s_add_u32 m0, s64, 102144
    s_add_u32 s62, s65, 0
    buffer_load_dwordx4 v255, s[32:35], s62 offen offset:256 nt lds
    s_add_u32 m0, s64, 106496
    s_add_u32 s62, s65, 12288
    buffer_load_dwordx4 v255, s[32:35], s62 offen offset:0 nt lds
    s_add_u32 m0, s64, 110464
    s_add_u32 s62, s65, 12288
    buffer_load_dwordx4 v255, s[32:35], s62 offen offset:128 nt lds
    s_add_u32 m0, s64, 114432
    s_add_u32 s62, s65, 12288
    buffer_load_dwordx4 v255, s[32:35], s62 offen offset:256 nt lds
    s_add_u32 m0, s64, 118784
    s_add_u32 s62, s65, 0
    buffer_load_dwordx4 v255, s[36:39], s62 offen offset:0 nt lds
    s_add_u32 m0, s64, 122752
    s_add_u32 s62, s65, 0
    buffer_load_dwordx4 v255, s[36:39], s62 offen offset:128 nt lds
    s_add_u32 m0, s64, 126720
    s_add_u32 s62, s65, 0
    buffer_load_dwordx4 v255, s[36:39], s62 offen offset:256 nt lds
    s_add_u32 m0, s64, 131072
    s_add_u32 s62, s65, 24576
    buffer_load_dwordx4 v255, s[32:35], s62 offen offset:0 nt lds
    s_add_u32 m0, s64, 135040
    s_add_u32 s62, s65, 24576
    buffer_load_dwordx4 v255, s[32:35], s62 offen offset:128 nt lds
    s_add_u32 m0, s64, 139008
    s_add_u32 s62, s65, 24576
    buffer_load_dwordx4 v255, s[32:35], s62 offen offset:256 nt lds
    v_mfma_f32_16x16x32_bf16 v[140:143], v[188:191], v[224:227], v[140:143]
    ds_read_b128 v[224:227], v239 offset:2048
    v_mfma_f32_16x16x32_bf16 v[60:63], v[168:171], v[228:231], v[60:63]
    ds_read_b64_tr_b16 v[204:205], v235 offset:24576
    v_mfma_f32_16x16x32_bf16 v[64:67], v[172:175], v[228:231], v[64:67]
    v_mfma_f32_16x16x32_bf16 v[68:71], v[176:179], v[228:231], v[68:71]
    ds_read_b64_tr_b16 v[206:207], v235 offset:26112
    v_mfma_f32_16x16x32_bf16 v[144:147], v[180:183], v[228:231], v[144:147]
    v_mfma_f32_16x16x32_bf16 v[148:151], v[184:187], v[228:231], v[148:151]
    ds_read_b64_tr_b16 v[208:209], v236 offset:24576
    v_mfma_f32_16x16x32_bf16 v[152:155], v[188:191], v[228:231], v[152:155]
    ds_read_b128 v[228:231], v239 offset:4096
    v_mfma_f32_16x16x32_bf16 v[72:75], v[168:171], v[216:219], v[72:75]
    ds_read_b64_tr_b16 v[210:211], v236 offset:26112
    v_mfma_f32_16x16x32_bf16 v[76:79], v[172:175], v[216:219], v[76:79]
    v_mfma_f32_16x16x32_bf16 v[80:83], v[176:179], v[216:219], v[80:83]
    ds_read_b64_tr_b16 v[212:213], v237 offset:24576
    v_mfma_f32_16x16x32_bf16 v[156:159], v[180:183], v[216:219], v[156:159]
    v_mfma_f32_16x16x32_bf16 v[160:163], v[184:187], v[216:219], v[160:163]
    ds_read_b64_tr_b16 v[214:215], v237 offset:26112
    v_mfma_f32_16x16x32_bf16 v[164:167], v[188:191], v[216:219], v[164:167]
    ds_read_b128 v[216:219], v239 offset:6144
    v_mfma_f32_16x16x32_bf16 v[0:3], v[192:195], v[220:223], v[0:3]
    v_mfma_f32_16x16x32_bf16 v[4:7], v[196:199], v[220:223], v[4:7]
    v_mfma_f32_16x16x32_bf16 v[8:11], v[200:203], v[220:223], v[8:11]
    s_waitcnt lgkmcnt(8)
    v_mfma_f32_16x16x32_bf16 v[12:15], v[192:195], v[224:227], v[12:15]
    v_mfma_f32_16x16x32_bf16 v[16:19], v[196:199], v[224:227], v[16:19]
    s_nop 2
    v_pk_mul_f32 v[0:1], v[0:1], s[66:67]
    v_pk_mul_f32 v[2:3], v[2:3], s[66:67]
    v_cvt_pk_bf16_f32 v0, v0, v1
    v_cvt_pk_bf16_f32 v1, v2, v3
    v_mfma_f32_16x16x32_bf16 v[20:23], v[200:203], v[224:227], v[20:23]
    v_pk_mul_f32 v[4:5], v[4:5], s[66:67]
    v_pk_mul_f32 v[6:7], v[6:7], s[66:67]
    v_cvt_pk_bf16_f32 v4, v4, v5
    v_cvt_pk_bf16_f32 v5, v6, v7
    s_waitcnt lgkmcnt(6)
    v_mfma_f32_16x16x32_bf16 v[84:87], v[204:207], v[220:223], v[84:87]
    v_pk_mul_f32 v[8:9], v[8:9], s[66:67]
    v_pk_mul_f32 v[10:11], v[10:11], s[66:67]
    v_cvt_pk_bf16_f32 v8, v8, v9
    v_cvt_pk_bf16_f32 v9, v10, v11
    s_waitcnt lgkmcnt(3)
    v_mfma_f32_16x16x32_bf16 v[88:91], v[208:211], v[220:223], v[88:91]
    v_pk_mul_f32 v[12:13], v[12:13], s[66:67]
    v_pk_mul_f32 v[14:15], v[14:15], s[66:67]
    v_cvt_pk_bf16_f32 v12, v12, v13
    v_cvt_pk_bf16_f32 v13, v14, v15
    s_waitcnt lgkmcnt(1)
    v_mfma_f32_16x16x32_bf16 v[92:95], v[212:215], v[220:223], v[92:95]
    ds_read_b128 v[220:223], v239 offset:8192
    v_pk_mul_f32 v[16:17], v[16:17], s[66:67]
    v_pk_mul_f32 v[18:19], v[18:19], s[66:67]
    v_cvt_pk_bf16_f32 v16, v16, v17
    v_cvt_pk_bf16_f32 v17, v18, v19
    v_mfma_f32_16x16x32_bf16 v[96:99], v[204:207], v[224:227], v[96:99]
    v_pk_mul_f32 v[20:21], v[20:21], s[66:67]
    v_pk_mul_f32 v[22:23], v[22:23], s[66:67]
    v_cvt_pk_bf16_f32 v20, v20, v21
    v_cvt_pk_bf16_f32 v21, v22, v23
    v_mfma_f32_16x16x32_bf16 v[100:103], v[208:211], v[224:227], v[100:103]
    v_pk_mul_f32 v[84:85], v[84:85], s[66:67]
    v_pk_mul_f32 v[86:87], v[86:87], s[66:67]
    v_cvt_pk_bf16_f32 v84, v84, v85
    v_cvt_pk_bf16_f32 v85, v86, v87
    v_mfma_f32_16x16x32_bf16 v[104:107], v[212:215], v[224:227], v[104:107]
    ds_read_b128 v[224:227], v239 offset:10240
    v_pk_mul_f32 v[88:89], v[88:89], s[66:67]
    v_pk_mul_f32 v[90:91], v[90:91], s[66:67]
    v_cvt_pk_bf16_f32 v88, v88, v89
    v_cvt_pk_bf16_f32 v89, v90, v91
    v_mfma_f32_16x16x32_bf16 v[24:27], v[192:195], v[228:231], v[24:27]
    v_pk_mul_f32 v[92:93], v[92:93], s[66:67]
    v_pk_mul_f32 v[94:95], v[94:95], s[66:67]
    v_cvt_pk_bf16_f32 v92, v92, v93
    v_cvt_pk_bf16_f32 v93, v94, v95
    v_mfma_f32_16x16x32_bf16 v[28:31], v[196:199], v[228:231], v[28:31]
    v_pk_mul_f32 v[96:97], v[96:97], s[66:67]
    v_pk_mul_f32 v[98:99], v[98:99], s[66:67]
    v_cvt_pk_bf16_f32 v96, v96, v97
    v_cvt_pk_bf16_f32 v97, v98, v99
    v_mfma_f32_16x16x32_bf16 v[32:35], v[200:203], v[228:231], v[32:35]
    v_pk_mul_f32 v[100:101], v[100:101], s[66:67]
    v_pk_mul_f32 v[102:103], v[102:103], s[66:67]
    v_cvt_pk_bf16_f32 v100, v100, v101
    v_cvt_pk_bf16_f32 v101, v102, v103
    v_mfma_f32_16x16x32_bf16 v[108:111], v[204:207], v[228:231], v[108:111]
    v_pk_mul_f32 v[104:105], v[104:105], s[66:67]
    v_pk_mul_f32 v[106:107], v[106:107], s[66:67]
    v_cvt_pk_bf16_f32 v104, v104, v105
    v_cvt_pk_bf16_f32 v105, v106, v107
    v_mfma_f32_16x16x32_bf16 v[112:115], v[208:211], v[228:231], v[112:115]
    v_pk_mul_f32 v[24:25], v[24:25], s[66:67]
    v_pk_mul_f32 v[26:27], v[26:27], s[66:67]
    v_cvt_pk_bf16_f32 v24, v24, v25
    v_cvt_pk_bf16_f32 v25, v26, v27
    v_mfma_f32_16x16x32_bf16 v[116:119], v[212:215], v[228:231], v[116:119]
    ds_read_b128 v[228:231], v239 offset:12288
    v_pk_mul_f32 v[28:29], v[28:29], s[66:67]
    v_pk_mul_f32 v[30:31], v[30:31], s[66:67]
    v_cvt_pk_bf16_f32 v28, v28, v29
    v_cvt_pk_bf16_f32 v29, v30, v31
    s_waitcnt lgkmcnt(3)
    v_mfma_f32_16x16x32_bf16 v[36:39], v[192:195], v[216:219], v[36:39]
    v_pk_mul_f32 v[32:33], v[32:33], s[66:67]
    v_pk_mul_f32 v[34:35], v[34:35], s[66:67]
    v_cvt_pk_bf16_f32 v32, v32, v33
    v_cvt_pk_bf16_f32 v33, v34, v35
    v_mfma_f32_16x16x32_bf16 v[40:43], v[196:199], v[216:219], v[40:43]
    v_pk_mul_f32 v[108:109], v[108:109], s[66:67]
    v_pk_mul_f32 v[110:111], v[110:111], s[66:67]
    v_cvt_pk_bf16_f32 v108, v108, v109
    v_cvt_pk_bf16_f32 v109, v110, v111
    v_mfma_f32_16x16x32_bf16 v[44:47], v[200:203], v[216:219], v[44:47]
    v_pk_mul_f32 v[112:113], v[112:113], s[66:67]
    v_pk_mul_f32 v[114:115], v[114:115], s[66:67]
    v_cvt_pk_bf16_f32 v112, v112, v113
    v_cvt_pk_bf16_f32 v113, v114, v115
    v_mfma_f32_16x16x32_bf16 v[120:123], v[204:207], v[216:219], v[120:123]
    v_pk_mul_f32 v[116:117], v[116:117], s[66:67]
    v_pk_mul_f32 v[118:119], v[118:119], s[66:67]
    v_cvt_pk_bf16_f32 v116, v116, v117
    v_cvt_pk_bf16_f32 v117, v118, v119
    v_mfma_f32_16x16x32_bf16 v[124:127], v[208:211], v[216:219], v[124:127]
    v_pk_mul_f32 v[36:37], v[36:37], s[66:67]
    v_pk_mul_f32 v[38:39], v[38:39], s[66:67]
    v_cvt_pk_bf16_f32 v36, v36, v37
    v_cvt_pk_bf16_f32 v37, v38, v39
    v_mfma_f32_16x16x32_bf16 v[128:131], v[212:215], v[216:219], v[128:131]
    v_pk_mul_f32 v[40:41], v[40:41], s[66:67]
    v_pk_mul_f32 v[42:43], v[42:43], s[66:67]
    v_cvt_pk_bf16_f32 v40, v40, v41
    v_cvt_pk_bf16_f32 v41, v42, v43
    s_waitcnt lgkmcnt(2)
    v_mfma_f32_16x16x32_bf16 v[48:51], v[192:195], v[220:223], v[48:51]
    v_pk_mul_f32 v[44:45], v[44:45], s[66:67]
    v_pk_mul_f32 v[46:47], v[46:47], s[66:67]
    v_cvt_pk_bf16_f32 v44, v44, v45
    v_cvt_pk_bf16_f32 v45, v46, v47
    v_mfma_f32_16x16x32_bf16 v[52:55], v[196:199], v[220:223], v[52:55]
    v_pk_mul_f32 v[120:121], v[120:121], s[66:67]
    v_pk_mul_f32 v[122:123], v[122:123], s[66:67]
    v_cvt_pk_bf16_f32 v120, v120, v121
    v_cvt_pk_bf16_f32 v121, v122, v123
    v_mfma_f32_16x16x32_bf16 v[56:59], v[200:203], v[220:223], v[56:59]
    v_pk_mul_f32 v[124:125], v[124:125], s[66:67]
    v_pk_mul_f32 v[126:127], v[126:127], s[66:67]
    v_cvt_pk_bf16_f32 v124, v124, v125
    v_cvt_pk_bf16_f32 v125, v126, v127
    v_mfma_f32_16x16x32_bf16 v[132:135], v[204:207], v[220:223], v[132:135]
    v_pk_mul_f32 v[128:129], v[128:129], s[66:67]
    v_pk_mul_f32 v[130:131], v[130:131], s[66:67]
    v_cvt_pk_bf16_f32 v128, v128, v129
    v_cvt_pk_bf16_f32 v129, v130, v131
    v_mfma_f32_16x16x32_bf16 v[136:139], v[208:211], v[220:223], v[136:139]
    v_pk_mul_f32 v[48:49], v[48:49], s[66:67]
    v_pk_mul_f32 v[50:51], v[50:51], s[66:67]
    v_cvt_pk_bf16_f32 v48, v48, v49
    v_cvt_pk_bf16_f32 v49, v50, v51
    v_mfma_f32_16x16x32_bf16 v[140:143], v[212:215], v[220:223], v[140:143]
    v_pk_mul_f32 v[52:53], v[52:53], s[66:67]
    v_pk_mul_f32 v[54:55], v[54:55], s[66:67]
    v_cvt_pk_bf16_f32 v52, v52, v53
    v_cvt_pk_bf16_f32 v53, v54, v55
    s_waitcnt lgkmcnt(1)
    v_mfma_f32_16x16x32_bf16 v[60:63], v[192:195], v[224:227], v[60:63]
    v_pk_mul_f32 v[56:57], v[56:57], s[66:67]
    v_pk_mul_f32 v[58:59], v[58:59], s[66:67]
    v_cvt_pk_bf16_f32 v56, v56, v57
    v_cvt_pk_bf16_f32 v57, v58, v59
    v_mfma_f32_16x16x32_bf16 v[64:67], v[196:199], v[224:227], v[64:67]
    v_pk_mul_f32 v[132:133], v[132:133], s[66:67]
    v_pk_mul_f32 v[134:135], v[134:135], s[66:67]
    v_cvt_pk_bf16_f32 v132, v132, v133
    v_cvt_pk_bf16_f32 v133, v134, v135
    v_mfma_f32_16x16x32_bf16 v[68:71], v[200:203], v[224:227], v[68:71]
    v_pk_mul_f32 v[136:137], v[136:137], s[66:67]
    v_pk_mul_f32 v[138:139], v[138:139], s[66:67]
    v_cvt_pk_bf16_f32 v136, v136, v137
    v_cvt_pk_bf16_f32 v137, v138, v139
    v_mfma_f32_16x16x32_bf16 v[144:147], v[204:207], v[224:227], v[144:147]
    v_pk_mul_f32 v[140:141], v[140:141], s[66:67]
    v_pk_mul_f32 v[142:143], v[142:143], s[66:67]
    v_cvt_pk_bf16_f32 v140, v140, v141
    v_cvt_pk_bf16_f32 v141, v142, v143
    v_mfma_f32_16x16x32_bf16 v[148:151], v[208:211], v[224:227], v[148:151]
    v_pk_mul_f32 v[60:61], v[60:61], s[66:67]
    v_pk_mul_f32 v[62:63], v[62:63], s[66:67]
    v_cvt_pk_bf16_f32 v60, v60, v61
    v_cvt_pk_bf16_f32 v61, v62, v63
    v_mfma_f32_16x16x32_bf16 v[152:155], v[212:215], v[224:227], v[152:155]
    v_pk_mul_f32 v[64:65], v[64:65], s[66:67]
    v_pk_mul_f32 v[66:67], v[66:67], s[66:67]
    v_cvt_pk_bf16_f32 v64, v64, v65
    v_cvt_pk_bf16_f32 v65, v66, v67
    s_waitcnt lgkmcnt(0)
    v_mfma_f32_16x16x32_bf16 v[72:75], v[192:195], v[228:231], v[72:75]
    v_pk_mul_f32 v[68:69], v[68:69], s[66:67]
    v_pk_mul_f32 v[70:71], v[70:71], s[66:67]
    v_cvt_pk_bf16_f32 v68, v68, v69
    v_cvt_pk_bf16_f32 v69, v70, v71
    v_mfma_f32_16x16x32_bf16 v[76:79], v[196:199], v[228:231], v[76:79]
    v_pk_mul_f32 v[144:145], v[144:145], s[66:67]
    v_pk_mul_f32 v[146:147], v[146:147], s[66:67]
    v_cvt_pk_bf16_f32 v144, v144, v145
    v_cvt_pk_bf16_f32 v145, v146, v147
    v_mfma_f32_16x16x32_bf16 v[80:83], v[200:203], v[228:231], v[80:83]
    v_pk_mul_f32 v[148:149], v[148:149], s[66:67]
    v_pk_mul_f32 v[150:151], v[150:151], s[66:67]
    v_cvt_pk_bf16_f32 v148, v148, v149
    v_cvt_pk_bf16_f32 v149, v150, v151
    v_mfma_f32_16x16x32_bf16 v[156:159], v[204:207], v[228:231], v[156:159]
    v_pk_mul_f32 v[152:153], v[152:153], s[66:67]
    v_pk_mul_f32 v[154:155], v[154:155], s[66:67]
    v_cvt_pk_bf16_f32 v152, v152, v153
    v_cvt_pk_bf16_f32 v153, v154, v155
    v_mfma_f32_16x16x32_bf16 v[160:163], v[208:211], v[228:231], v[160:163]
    v_pk_mul_f32 v[72:73], v[72:73], s[66:67]
    v_pk_mul_f32 v[74:75], v[74:75], s[66:67]
    v_cvt_pk_bf16_f32 v72, v72, v73
    v_cvt_pk_bf16_f32 v73, v74, v75
    v_mfma_f32_16x16x32_bf16 v[164:167], v[212:215], v[228:231], v[164:167]
    v_pk_mul_f32 v[76:77], v[76:77], s[66:67]
    v_pk_mul_f32 v[78:79], v[78:79], s[66:67]
    v_cvt_pk_bf16_f32 v76, v76, v77
    v_cvt_pk_bf16_f32 v77, v78, v79
    v_pk_mul_f32 v[80:81], v[80:81], s[66:67]
    v_pk_mul_f32 v[82:83], v[82:83], s[66:67]
    v_cvt_pk_bf16_f32 v80, v80, v81
    v_cvt_pk_bf16_f32 v81, v82, v83
    v_pk_mul_f32 v[156:157], v[156:157], s[66:67]
    v_pk_mul_f32 v[158:159], v[158:159], s[66:67]
    v_cvt_pk_bf16_f32 v156, v156, v157
    v_cvt_pk_bf16_f32 v157, v158, v159
    v_pk_mul_f32 v[160:161], v[160:161], s[66:67]
    v_pk_mul_f32 v[162:163], v[162:163], s[66:67]
    v_cvt_pk_bf16_f32 v160, v160, v161
    v_cvt_pk_bf16_f32 v161, v162, v163
    v_pk_mul_f32 v[164:165], v[164:165], s[66:67]
    v_pk_mul_f32 v[166:167], v[166:167], s[66:67]
    v_cvt_pk_bf16_f32 v164, v164, v165
    v_cvt_pk_bf16_f32 v165, v166, v167
k1_t1:
    s_mov_b32 s55, 1
    s_mov_b32 s14, 0x01000c0c
    s_mov_b32 s15, 0x03020c0c
    v_mov_b32 v2, v84
    v_mov_b32 v3, v85
    v_mov_b32 v6, v88
    v_mov_b32 v7, v89
    v_mov_b32 v10, v92
    v_mov_b32 v11, v93
    v_mov_b32 v14, v96
    v_mov_b32 v15, v97
    v_mov_b32 v18, v100
    v_mov_b32 v19, v101
    v_mov_b32 v22, v104
    v_mov_b32 v23, v105
    v_mov_b32 v26, v108
    v_mov_b32 v27, v109
    v_mov_b32 v30, v112
    v_mov_b32 v31, v113
    v_mov_b32 v34, v116
    v_mov_b32 v35, v117
    v_mov_b32 v38, v120
    v_mov_b32 v39, v121
    v_mov_b32 v42, v124
    v_mov_b32 v43, v125
    v_mov_b32 v46, v128
    v_mov_b32 v47, v129
    v_mov_b32 v50, v132
    v_mov_b32 v51, v133
    v_mov_b32 v54, v136
    v_mov_b32 v55, v137
    v_mov_b32 v58, v140
    v_mov_b32 v59, v141
    v_mov_b32 v62, v144
    v_mov_b32 v63, v145
    v_mov_b32 v66, v148
    v_mov_b32 v67, v149
    v_mov_b32 v70, v152
    v_mov_b32 v71, v153
    v_mov_b32 v74, v156
    v_mov_b32 v75, v157
    v_mov_b32 v78, v160
    v_mov_b32 v79, v161
    v_mov_b32 v82, v164
    v_mov_b32 v83, v165
    v_subrev_u32 v238, 145408, v238
    v_subrev_u32 v239, 145408, v239
    s_waitcnt vmcnt(10)
    s_barrier
    s_add_u32 m0, s60, 43008
    s_add_u32 s62, s58, 1152
    buffer_load_dwordx4 v243, s[40:43], s62 offen  lds
    buffer_load_dwordx4 v244, s[40:43], s62 offen offset:1024  lds
    buffer_load_dwordx4 v245, s[40:43], s62 offen offset:2048  lds
    s_add_u32 m0, s60, 55296
    s_add_u32 s62, s58, 394368
    buffer_load_dwordx4 v243, s[40:43], s62 offen  lds
    buffer_load_dwordx4 v244, s[40:43], s62 offen offset:1024  lds
    buffer_load_dwordx4 v245, s[40:43], s62 offen offset:2048  lds
    s_add_u32 m0, s64, 143360
    s_add_u32 s62, s65, 12288
    buffer_load_dwordx4 v255, s[36:39], s62 offen nt lds
    s_add_u32 m0, s64, 147328
    s_add_u32 s62, s65, 12288
    buffer_load_dwordx4 v255, s[36:39], s62 offen offset:128 nt lds
    s_add_u32 m0, s64, 151296
    s_add_u32 s62, s65, 12288
    buffer_load_dwordx4 v255, s[36:39], s62 offen offset:256 nt lds
    s_add_u32 m0, s64, 155648
    s_add_u32 s62, s65, 36864
    buffer_load_dwordx4 v255, s[32:35], s62 offen nt lds
    s_barrier
    s_add_u32 m0, s71, 0
    s_add_u32 s63, s70, 0
    buffer_load_dwordx4 v246, s[48:51], s63 offen  lds
    s_add_u32 m0, s71, 4096
    s_add_u32 s63, s70, 40960
    buffer_load_dwordx4 v246, s[48:51], s63 offen  lds
    s_add_u32 m0, s71, 8192
    s_add_u32 s63, s70, 81920
    buffer_load_dwordx4 v246, s[48:51], s63 offen  lds
    s_add_u32 s63, s71, 12288
    s_cmp_ge_u32 s56, 2
    s_cselect_b32 m0, s73, s63
    s_add_u32 s63, s70, 122880
    buffer_load_dwordx4 v246, s[48:51], s63 offen  lds
    s_add_u32 m0, s60, 67584
    s_add_u32 s62, s58, 787584
    buffer_load_dwordx4 v243, s[40:43], s62 offen  lds
    buffer_load_dwordx4 v244, s[40:43], s62 offen offset:1024  lds
    buffer_load_dwordx4 v245, s[40:43], s62 offen offset:2048  lds
    s_add_u32 m0, s71, 14336
    s_add_u32 s63, s70, 128
    buffer_load_dwordx4 v246, s[48:51], s63 offen  lds
    s_add_u32 m0, s71, 18432
    s_add_u32 s63, s70, 41088
    buffer_load_dwordx4 v246, s[48:51], s63 offen  lds
    s_add_u32 m0, s71, 22528
    s_add_u32 s63, s70, 82048
    buffer_load_dwordx4 v246, s[48:51], s63 offen  lds
    s_add_u32 s63, s71, 26624
    s_cmp_ge_u32 s56, 2
    s_cselect_b32 m0, s73, s63
    s_add_u32 s63, s70, 123008
    buffer_load_dwordx4 v246, s[48:51], s63 offen  lds
    s_add_u32 m0, s60, 79872
    s_add_u32 s62, s58, 1180800
    buffer_load_dwordx4 v243, s[40:43], s62 offen  lds
    buffer_load_dwordx4 v244, s[40:43], s62 offen offset:1024  lds
    buffer_load_dwordx4 v245, s[40:43], s62 offen offset:2048  lds
    s_waitcnt vmcnt(31)
    s_barrier
    s_waitcnt vmcnt(24)
    s_add_u32 m0, s64, 94080
    s_add_u32 s62, s65, 36864
    buffer_load_dwordx4 v255, s[32:35], s62 offen offset:128 nt lds
    s_barrier
    s_waitcnt vmcnt(18)
    s_add_u32 m0, s64, 98048
    s_add_u32 s62, s65, 36864
    buffer_load_dwordx4 v255, s[32:35], s62 offen offset:256 nt lds
    s_waitcnt vmcnt(18)
    s_add_u32 m0, s64, 102400
    s_add_u32 s62, s65, 24576
    buffer_load_dwordx4 v255, s[36:39], s62 offen nt lds
    s_waitcnt vmcnt(18)
    s_add_u32 m0, s64, 106368
    s_add_u32 s62, s65, 24576
    buffer_load_dwordx4 v255, s[36:39], s62 offen offset:128 nt lds
    s_waitcnt vmcnt(14)
    s_barrier
    s_add_u32 m0, s64, 110336
    s_add_u32 s62, s65, 24576
    buffer_load_dwordx4 v255, s[36:39], s62 offen offset:256 nt lds
    s_waitcnt vmcnt(4)
    s_add_u32 m0, s64, 114688
    s_add_u32 s62, s65, 49152
    buffer_load_dwordx4 v255, s[32:35], s62 offen nt lds
    s_waitcnt vmcnt(4)
    s_add_u32 m0, s64, 118656
    s_add_u32 s62, s65, 49152
    buffer_load_dwordx4 v255, s[32:35], s62 offen offset:128 nt lds
    ds_read_b64_tr_b16 v[168:169], v235 offset:0
    ds_read_b64_tr_b16 v[170:171], v235 offset:1536
    ds_read_b128 v[216:219], v238 offset:0
    ds_read_b128 v[220:223], v238 offset:2048
    ds_read_b64_tr_b16 v[172:173], v236 offset:0
    ds_read_b64_tr_b16 v[174:175], v236 offset:1536
    ds_read_b64_tr_b16 v[176:177], v237 offset:0
    ds_read_b64_tr_b16 v[178:179], v237 offset:1536
    ds_read_b128 v[224:227], v238 offset:4096
    ds_read_b128 v[228:231], v238 offset:6144
    s_waitcnt lgkmcnt(7)
    v_mfma_f32_16x16x32_bf16 v[84:87], v[168:171], v[216:219], 0
    s_waitcnt lgkmcnt(4)
    v_mfma_f32_16x16x32_bf16 v[88:91], v[172:175], v[216:219], 0
    s_waitcnt lgkmcnt(2)
    v_mfma_f32_16x16x32_bf16 v[92:95], v[176:179], v[216:219], 0
    ds_read_b128 v[216:219], v238 offset:8192
    v_mfma_f32_16x16x32_bf16 v[96:99], v[168:171], v[220:223], 0
    s_barrier
    s_waitcnt vmcnt(4)
    s_add_u32 m0, s64, 122624
    s_add_u32 s62, s65, 49152
    buffer_load_dwordx4 v255, s[32:35], s62 offen offset:256 nt lds
    s_waitcnt vmcnt(4)
    s_add_u32 m0, s64, 126976
    s_add_u32 s62, s65, 36864
    buffer_load_dwordx4 v255, s[36:39], s62 offen nt lds
    s_waitcnt vmcnt(4)
    s_add_u32 m0, s64, 130944
    s_add_u32 s62, s65, 36864
    buffer_load_dwordx4 v255, s[36:39], s62 offen offset:128 nt lds
    s_add_u32 m0, s60, 43008
    s_add_u32 s62, s58, 1574016
    buffer_load_dwordx4 v243, s[40:43], s62 offen  lds
    buffer_load_dwordx4 v244, s[40:43], s62 offen offset:1024  lds
    buffer_load_dwordx4 v245, s[40:43], s62 offen offset:2048  lds
    s_add_u32 m0, s71, 28672
    s_add_u32 s63, s70, 256
    buffer_load_dwordx4 v246, s[48:51], s63 offen  lds
    s_add_u32 m0, s71, 32768
    s_add_u32 s63, s70, 41216
    buffer_load_dwordx4 v246, s[48:51], s63 offen  lds
    s_add_u32 m0, s71, 36864
    s_add_u32 s63, s70, 82176
    buffer_load_dwordx4 v246, s[48:51], s63 offen  lds
    s_add_u32 s63, s71, 40960
    s_cmp_ge_u32 s56, 2
    s_cselect_b32 m0, s73, s63
    s_add_u32 s63, s70, 123136
    buffer_load_dwordx4 v246, s[48:51], s63 offen  lds
    v_mfma_f32_16x16x32_bf16 v[100:103], v[172:175], v[220:223], 0
    v_mfma_f32_16x16x32_bf16 v[104:107], v[176:179], v[220:223], 0
    ds_read_b128 v[220:223], v238 offset:10240
    s_waitcnt lgkmcnt(3)
    v_mfma_f32_16x16x32_bf16 v[108:111], v[168:171], v[224:227], 0
    ds_read_b64_tr_b16 v[192:193], v235 offset:12288
    v_mfma_f32_16x16x32_bf16 v[112:115], v[172:175], v[224:227], 0
    ds_read_b64_tr_b16 v[194:195], v235 offset:13824
    v_mfma_f32_16x16x32_bf16 v[116:119], v[176:179], v[224:227], 0
    ds_read_b128 v[224:227], v238 offset:12288
    s_waitcnt lgkmcnt(5)
    v_mfma_f32_16x16x32_bf16 v[120:123], v[168:171], v[228:231], 0
    ds_read_b64_tr_b16 v[196:197], v236 offset:12288
    v_mfma_f32_16x16x32_bf16 v[124:127], v[172:175], v[228:231], 0
    ds_read_b64_tr_b16 v[198:199], v236 offset:13824
    v_mfma_f32_16x16x32_bf16 v[128:131], v[176:179], v[228:231], 0
    ds_read_b128 v[228:231], v239 offset:0
    s_waitcnt lgkmcnt(7)
    v_mfma_f32_16x16x32_bf16 v[132:135], v[168:171], v[216:219], 0
    ds_read_b64_tr_b16 v[200:201], v237 offset:12288
    v_mfma_f32_16x16x32_bf16 v[136:139], v[172:175], v[216:219], 0
    ds_read_b64_tr_b16 v[202:203], v237 offset:13824
    v_mfma_f32_16x16x32_bf16 v[140:143], v[176:179], v[216:219], 0
    ds_read_b128 v[216:219], v239 offset:2048
    s_waitcnt lgkmcnt(9)
    v_mfma_f32_16x16x32_bf16 v[144:147], v[168:171], v[220:223], 0
    v_mfma_f32_16x16x32_bf16 v[148:151], v[172:175], v[220:223], 0
    v_mfma_f32_16x16x32_bf16 v[152:155], v[176:179], v[220:223], 0
    ds_read_b128 v[220:223], v239 offset:4096
    s_waitcnt lgkmcnt(7)
    v_mfma_f32_16x16x32_bf16 v[156:159], v[168:171], v[224:227], 0
    v_mfma_f32_16x16x32_bf16 v[160:163], v[172:175], v[224:227], 0
    v_mfma_f32_16x16x32_bf16 v[164:167], v[176:179], v[224:227], 0
    ds_read_b128 v[224:227], v239 offset:6144
    s_waitcnt lgkmcnt(5)
    v_mfma_f32_16x16x32_bf16 v[84:87], v[192:195], v[228:231], v[84:87]
    v_mfma_f32_16x16x32_bf16 v[88:91], v[196:199], v[228:231], v[88:91]
    s_waitcnt lgkmcnt(3)
    v_mfma_f32_16x16x32_bf16 v[92:95], v[200:203], v[228:231], v[92:95]
    ds_read_b128 v[228:231], v239 offset:8192
    s_waitcnt lgkmcnt(3)
    v_mfma_f32_16x16x32_bf16 v[96:99], v[192:195], v[216:219], v[96:99]
    s_barrier
    s_waitcnt vmcnt(11)
    s_add_u32 m0, s64, 134912
    s_add_u32 s62, s65, 36864
    buffer_load_dwordx4 v255, s[36:39], s62 offen offset:256 nt lds
    s_waitcnt vmcnt(11)
    s_add_u32 m0, s64, 139264
    s_add_u32 s62, s65, 61440
    buffer_load_dwordx4 v255, s[32:35], s62 offen nt lds
    s_waitcnt vmcnt(11)
    s_add_u32 m0, s64, 143232
    s_add_u32 s62, s65, 61440
    buffer_load_dwordx4 v255, s[32:35], s62 offen offset:128 nt lds
    s_add_u32 m0, s60, 55296
    s_add_u32 s62, s58, 1967232
    buffer_load_dwordx4 v243, s[40:43], s62 offen  lds
    buffer_load_dwordx4 v244, s[40:43], s62 offen offset:1024  lds
    buffer_load_dwordx4 v245, s[40:43], s62 offen offset:2048  lds
    v_mfma_f32_16x16x32_bf16 v[100:103], v[196:199], v[216:219], v[100:103]
    v_mfma_f32_16x16x32_bf16 v[104:107], v[200:203], v[216:219], v[104:107]
    ds_read_b128 v[216:219], v239 offset:10240
    s_waitcnt lgkmcnt(3)
    v_mfma_f32_16x16x32_bf16 v[108:111], v[192:195], v[220:223], v[108:111]
    ds_read_b64_tr_b16 v[168:169], v235 offset:24576
    v_mfma_f32_16x16x32_bf16 v[112:115], v[196:199], v[220:223], v[112:115]
    ds_read_b64_tr_b16 v[170:171], v235 offset:26112
    v_mfma_f32_16x16x32_bf16 v[116:119], v[200:203], v[220:223], v[116:119]
    ds_read_b128 v[220:223], v239 offset:12288
    s_waitcnt lgkmcnt(5)
    v_mfma_f32_16x16x32_bf16 v[120:123], v[192:195], v[224:227], v[120:123]
    ds_read_b64_tr_b16 v[172:173], v236 offset:24576
    v_mfma_f32_16x16x32_bf16 v[124:127], v[196:199], v[224:227], v[124:127]
    ds_read_b64_tr_b16 v[174:175], v236 offset:26112
    v_mfma_f32_16x16x32_bf16 v[128:131], v[200:203], v[224:227], v[128:131]
    ds_read_b128 v[224:227], v238 offset:14336
    s_waitcnt lgkmcnt(7)
    v_mfma_f32_16x16x32_bf16 v[132:135], v[192:195], v[228:231], v[132:135]
    ds_read_b64_tr_b16 v[176:177], v237 offset:24576
    v_mfma_f32_16x16x32_bf16 v[136:139], v[196:199], v[228:231], v[136:139]
    ds_read_b64_tr_b16 v[178:179], v237 offset:26112
    v_mfma_f32_16x16x32_bf16 v[140:143], v[200:203], v[228:231], v[140:143]
    ds_read_b128 v[228:231], v238 offset:16384
    s_waitcnt lgkmcnt(9)
    v_mfma_f32_16x16x32_bf16 v[144:147], v[192:195], v[216:219], v[144:147]
    v_mfma_f32_16x16x32_bf16 v[148:151], v[196:199], v[216:219], v[148:151]
    v_mfma_f32_16x16x32_bf16 v[152:155], v[200:203], v[216:219], v[152:155]
    ds_read_b128 v[216:219], v238 offset:18432
    s_waitcnt lgkmcnt(7)
    v_mfma_f32_16x16x32_bf16 v[156:159], v[192:195], v[220:223], v[156:159]
    v_mfma_f32_16x16x32_bf16 v[160:163], v[196:199], v[220:223], v[160:163]
    v_mfma_f32_16x16x32_bf16 v[164:167], v[200:203], v[220:223], v[164:167]
    ds_read_b128 v[220:223], v238 offset:20480
    s_waitcnt lgkmcnt(5)
    v_mfma_f32_16x16x32_bf16 v[84:87], v[168:171], v[224:227], v[84:87]
    v_mfma_f32_16x16x32_bf16 v[88:91], v[172:175], v[224:227], v[88:91]
    s_waitcnt lgkmcnt(3)
    v_mfma_f32_16x16x32_bf16 v[92:95], v[176:179], v[224:227], v[92:95]
    ds_read_b128 v[224:227], v238 offset:22528
    s_waitcnt lgkmcnt(3)
    v_mfma_f32_16x16x32_bf16 v[96:99], v[168:171], v[228:231], v[96:99]
    s_barrier
    s_waitcnt vmcnt(14)
    s_add_u32 m0, s64, 147200
    s_add_u32 s62, s65, 61440
    buffer_load_dwordx4 v255, s[32:35], s62 offen offset:256 nt lds
    s_waitcnt vmcnt(14)
    s_add_u32 m0, s64, 151552
    s_add_u32 s62, s65, 49152
    buffer_load_dwordx4 v255, s[36:39], s62 offen nt lds
    s_waitcnt vmcnt(7)
    s_add_u32 m0, s64, 155520
    s_add_u32 s62, s65, 49152
    buffer_load_dwordx4 v255, s[36:39], s62 offen offset:128 nt lds
    s_waitcnt vmcnt(7)
    s_add_u32 m0, s64, 93952
    s_add_u32 s62, s65, 49152
    buffer_load_dwordx4 v255, s[36:39], s62 offen offset:256 nt lds
    s_add_u32 m0, s60, 67584
    s_add_u32 s62, s58, 2360448
    buffer_load_dwordx4 v243, s[40:43], s62 offen  lds
    buffer_load_dwordx4 v244, s[40:43], s62 offen offset:1024  lds
    buffer_load_dwordx4 v245, s[40:43], s62 offen offset:2048  lds
    s_add_u32 m0, s71, 0
    s_add_u32 s63, s70, 384
    buffer_load_dwordx4 v246, s[48:51], s63 offen  lds
    s_add_u32 m0, s71, 4096
    s_add_u32 s63, s70, 41344
    buffer_load_dwordx4 v246, s[48:51], s63 offen  lds
    s_add_u32 m0, s71, 8192
    s_add_u32 s63, s70, 82304
    buffer_load_dwordx4 v246, s[48:51], s63 offen  lds
    s_add_u32 s63, s71, 12288
    s_cmp_ge_u32 s56, 2
    s_cselect_b32 m0, s73, s63
    s_add_u32 s63, s70, 123264
    buffer_load_dwordx4 v246, s[48:51], s63 offen  lds
    v_mfma_f32_16x16x32_bf16 v[100:103], v[172:175], v[228:231], v[100:103]
    v_mfma_f32_16x16x32_bf16 v[104:107], v[176:179], v[228:231], v[104:107]
    ds_read_b128 v[228:231], v238 offset:24576
    s_waitcnt lgkmcnt(3)
    v_mfma_f32_16x16x32_bf16 v[108:111], v[168:171], v[216:219], v[108:111]
    ds_read_b64_tr_b16 v[192:193], v235 offset:36864
    v_mfma_f32_16x16x32_bf16 v[112:115], v[172:175], v[216:219], v[112:115]
    ds_read_b64_tr_b16 v[194:195], v235 offset:38400
    v_mfma_f32_16x16x32_bf16 v[116:119], v[176:179], v[216:219], v[116:119]
    ds_read_b128 v[216:219], v238 offset:26624
    s_waitcnt lgkmcnt(5)
    v_mfma_f32_16x16x32_bf16 v[120:123], v[168:171], v[220:223], v[120:123]
    ds_read_b64_tr_b16 v[196:197], v236 offset:36864
    v_mfma_f32_16x16x32_bf16 v[124:127], v[172:175], v[220:223], v[124:127]
    ds_read_b64_tr_b16 v[198:199], v236 offset:38400
    v_mfma_f32_16x16x32_bf16 v[128:131], v[176:179], v[220:223], v[128:131]
    ds_read_b128 v[220:223], v239 offset:14336
    s_waitcnt lgkmcnt(7)
    v_mfma_f32_16x16x32_bf16 v[132:135], v[168:171], v[224:227], v[132:135]
    ds_read_b64_tr_b16 v[200:201], v237 offset:36864
    v_mfma_f32_16x16x32_bf16 v[136:139], v[172:175], v[224:227], v[136:139]
    ds_read_b64_tr_b16 v[202:203], v237 offset:38400
    v_mfma_f32_16x16x32_bf16 v[140:143], v[176:179], v[224:227], v[140:143]
    ds_read_b128 v[224:227], v239 offset:16384
    s_waitcnt lgkmcnt(9)
    v_mfma_f32_16x16x32_bf16 v[144:147], v[168:171], v[228:231], v[144:147]
    v_mfma_f32_16x16x32_bf16 v[148:151], v[172:175], v[228:231], v[148:151]
    v_mfma_f32_16x16x32_bf16 v[152:155], v[176:179], v[228:231], v[152:155]
    ds_read_b128 v[228:231], v239 offset:18432
    s_waitcnt lgkmcnt(7)
    v_mfma_f32_16x16x32_bf16 v[156:159], v[168:171], v[216:219], v[156:159]
    v_mfma_f32_16x16x32_bf16 v[160:163], v[172:175], v[216:219], v[160:163]
    v_mfma_f32_16x16x32_bf16 v[164:167], v[176:179], v[216:219], v[164:167]
    ds_read_b128 v[216:219], v239 offset:20480
    s_waitcnt lgkmcnt(5)
    v_mfma_f32_16x16x32_bf16 v[84:87], v[192:195], v[220:223], v[84:87]
    v_mfma_f32_16x16x32_bf16 v[88:91], v[196:199], v[220:223], v[88:91]
    s_waitcnt lgkmcnt(3)
    v_mfma_f32_16x16x32_bf16 v[92:95], v[200:203], v[220:223], v[92:95]
    ds_read_b128 v[220:223], v239 offset:22528
    s_waitcnt lgkmcnt(3)
    v_mfma_f32_16x16x32_bf16 v[96:99], v[192:195], v[224:227], v[96:99]
    s_barrier
    s_waitcnt vmcnt(14)
    s_add_u32 m0, s64, 98304
    s_add_u32 s62, s65, 73728
    buffer_load_dwordx4 v255, s[32:35], s62 offen nt lds
    s_waitcnt vmcnt(11)
    s_add_u32 m0, s64, 102272
    s_add_u32 s62, s65, 73728
    buffer_load_dwordx4 v255, s[32:35], s62 offen offset:128 nt lds
    s_waitcnt vmcnt(11)
    s_add_u32 m0, s64, 106240
    s_add_u32 s62, s65, 73728
    buffer_load_dwordx4 v255, s[32:35], s62 offen offset:256 nt lds
    s_add_u32 m0, s60, 79872
    s_add_u32 s62, s58, 2753664
    buffer_load_dwordx4 v243, s[40:43], s62 offen  lds
    buffer_load_dwordx4 v244, s[40:43], s62 offen offset:1024  lds
    buffer_load_dwordx4 v245, s[40:43], s62 offen offset:2048  lds
    v_mfma_f32_16x16x32_bf16 v[100:103], v[196:199], v[224:227], v[100:103]
    v_mfma_f32_16x16x32_bf16 v[104:107], v[200:203], v[224:227], v[104:107]
    ds_read_b128 v[224:227], v239 offset:24576
    s_waitcnt lgkmcnt(3)
    v_mfma_f32_16x16x32_bf16 v[108:111], v[192:195], v[228:231], v[108:111]
    ds_read_b64_tr_b16 v[168:169], v235 offset:0
    v_mfma_f32_16x16x32_bf16 v[112:115], v[196:199], v[228:231], v[112:115]
    ds_read_b64_tr_b16 v[170:171], v235 offset:1536
    v_mfma_f32_16x16x32_bf16 v[116:119], v[200:203], v[228:231], v[116:119]
    ds_read_b128 v[228:231], v239 offset:26624
    s_waitcnt lgkmcnt(5)
    v_mfma_f32_16x16x32_bf16 v[120:123], v[192:195], v[216:219], v[120:123]
    ds_read_b64_tr_b16 v[172:173], v236 offset:0
    v_mfma_f32_16x16x32_bf16 v[124:127], v[196:199], v[216:219], v[124:127]
    ds_read_b64_tr_b16 v[174:175], v236 offset:1536
    v_mfma_f32_16x16x32_bf16 v[128:131], v[200:203], v[216:219], v[128:131]
    ds_read_b128 v[216:219], v238 offset:28672
    s_waitcnt lgkmcnt(7)
    v_mfma_f32_16x16x32_bf16 v[132:135], v[192:195], v[220:223], v[132:135]
    ds_read_b64_tr_b16 v[176:177], v237 offset:0
    v_mfma_f32_16x16x32_bf16 v[136:139], v[196:199], v[220:223], v[136:139]
    ds_read_b64_tr_b16 v[178:179], v237 offset:1536
    v_mfma_f32_16x16x32_bf16 v[140:143], v[200:203], v[220:223], v[140:143]
    ds_read_b128 v[220:223], v238 offset:30720
    s_waitcnt lgkmcnt(9)
    v_mfma_f32_16x16x32_bf16 v[144:147], v[192:195], v[224:227], v[144:147]
    v_mfma_f32_16x16x32_bf16 v[148:151], v[196:199], v[224:227], v[148:151]
    v_mfma_f32_16x16x32_bf16 v[152:155], v[200:203], v[224:227], v[152:155]
    ds_read_b128 v[224:227], v238 offset:32768
    s_waitcnt lgkmcnt(7)
    v_mfma_f32_16x16x32_bf16 v[156:159], v[192:195], v[228:231], v[156:159]
    v_mfma_f32_16x16x32_bf16 v[160:163], v[196:199], v[228:231], v[160:163]
    v_mfma_f32_16x16x32_bf16 v[164:167], v[200:203], v[228:231], v[164:167]
    ds_read_b128 v[228:231], v238 offset:34816
    s_waitcnt lgkmcnt(5)
    v_mfma_f32_16x16x32_bf16 v[84:87], v[168:171], v[216:219], v[84:87]
    v_mfma_f32_16x16x32_bf16 v[88:91], v[172:175], v[216:219], v[88:91]
    s_waitcnt lgkmcnt(3)
    v_mfma_f32_16x16x32_bf16 v[92:95], v[176:179], v[216:219], v[92:95]
    ds_read_b128 v[216:219], v238 offset:36864
    s_waitcnt lgkmcnt(3)
    v_mfma_f32_16x16x32_bf16 v[96:99], v[168:171], v[220:223], v[96:99]
    s_barrier
    s_waitcnt vmcnt(14)
    s_add_u32 m0, s64, 110592
    s_add_u32 s62, s65, 61440
    buffer_load_dwordx4 v255, s[36:39], s62 offen nt lds
    s_waitcnt vmcnt(14)
    s_add_u32 m0, s64, 114560
    s_add_u32 s62, s65, 61440
    buffer_load_dwordx4 v255, s[36:39], s62 offen offset:128 nt lds
    s_waitcnt vmcnt(7)
    s_add_u32 m0, s64, 118528
    s_add_u32 s62, s65, 61440
    buffer_load_dwordx4 v255, s[36:39], s62 offen offset:256 nt lds
    s_add_u32 m0, s60, 43008
    s_add_u32 s62, s58, 3146880
    buffer_load_dwordx4 v243, s[40:43], s62 offen  lds
    buffer_load_dwordx4 v244, s[40:43], s62 offen offset:1024  lds
    buffer_load_dwordx4 v245, s[40:43], s62 offen offset:2048  lds
    s_add_u32 m0, s71, 14336
    s_add_u32 s63, s70, 512
    buffer_load_dwordx4 v246, s[48:51], s63 offen  lds
    s_add_u32 m0, s71, 18432
    s_add_u32 s63, s70, 41472
    buffer_load_dwordx4 v246, s[48:51], s63 offen  lds
    s_add_u32 m0, s71, 22528
    s_add_u32 s63, s70, 82432
    buffer_load_dwordx4 v246, s[48:51], s63 offen  lds
    s_add_u32 s63, s71, 26624
    s_cmp_ge_u32 s56, 2
    s_cselect_b32 m0, s73, s63
    s_add_u32 s63, s70, 123392
    buffer_load_dwordx4 v246, s[48:51], s63 offen  lds
    v_mfma_f32_16x16x32_bf16 v[100:103], v[172:175], v[220:223], v[100:103]
    v_mfma_f32_16x16x32_bf16 v[104:107], v[176:179], v[220:223], v[104:107]
    ds_read_b128 v[220:223], v238 offset:38912
    s_waitcnt lgkmcnt(3)
    v_mfma_f32_16x16x32_bf16 v[108:111], v[168:171], v[224:227], v[108:111]
    ds_read_b64_tr_b16 v[192:193], v235 offset:12288
    v_mfma_f32_16x16x32_bf16 v[112:115], v[172:175], v[224:227], v[112:115]
    ds_read_b64_tr_b16 v[194:195], v235 offset:13824
    v_mfma_f32_16x16x32_bf16 v[116:119], v[176:179], v[224:227], v[116:119]
    ds_read_b128 v[224:227], v238 offset:40960
    s_waitcnt lgkmcnt(5)
    v_mfma_f32_16x16x32_bf16 v[120:123], v[168:171], v[228:231], v[120:123]
    ds_read_b64_tr_b16 v[196:197], v236 offset:12288
    v_mfma_f32_16x16x32_bf16 v[124:127], v[172:175], v[228:231], v[124:127]
    ds_read_b64_tr_b16 v[198:199], v236 offset:13824
    v_mfma_f32_16x16x32_bf16 v[128:131], v[176:179], v[228:231], v[128:131]
    ds_read_b128 v[228:231], v239 offset:28672
    s_waitcnt lgkmcnt(7)
    v_mfma_f32_16x16x32_bf16 v[132:135], v[168:171], v[216:219], v[132:135]
    ds_read_b64_tr_b16 v[200:201], v237 offset:12288
    v_mfma_f32_16x16x32_bf16 v[136:139], v[172:175], v[216:219], v[136:139]
    ds_read_b64_tr_b16 v[202:203], v237 offset:13824
    v_mfma_f32_16x16x32_bf16 v[140:143], v[176:179], v[216:219], v[140:143]
    ds_read_b128 v[216:219], v239 offset:30720
    s_waitcnt lgkmcnt(9)
    v_mfma_f32_16x16x32_bf16 v[144:147], v[168:171], v[220:223], v[144:147]
    v_mfma_f32_16x16x32_bf16 v[148:151], v[172:175], v[220:223], v[148:151]
    v_mfma_f32_16x16x32_bf16 v[152:155], v[176:179], v[220:223], v[152:155]
    ds_read_b128 v[220:223], v239 offset:32768
    s_waitcnt lgkmcnt(7)
    v_mfma_f32_16x16x32_bf16 v[156:159], v[168:171], v[224:227], v[156:159]
    v_mfma_f32_16x16x32_bf16 v[160:163], v[172:175], v[224:227], v[160:163]
    v_mfma_f32_16x16x32_bf16 v[164:167], v[176:179], v[224:227], v[164:167]
    ds_read_b128 v[224:227], v239 offset:34816
    s_waitcnt lgkmcnt(5)
    v_mfma_f32_16x16x32_bf16 v[84:87], v[192:195], v[228:231], v[84:87]
    v_mfma_f32_16x16x32_bf16 v[88:91], v[196:199], v[228:231], v[88:91]
    s_waitcnt lgkmcnt(3)
    v_mfma_f32_16x16x32_bf16 v[92:95], v[200:203], v[228:231], v[92:95]
    ds_read_b128 v[228:231], v239 offset:36864
    s_waitcnt lgkmcnt(3)
    v_mfma_f32_16x16x32_bf16 v[96:99], v[192:195], v[216:219], v[96:99]
    s_barrier
    s_waitcnt vmcnt(14)
    s_add_u32 m0, s64, 122880
    s_add_u32 s62, s65, 86016
    buffer_load_dwordx4 v255, s[32:35], s62 offen nt lds
    s_waitcnt vmcnt(14)
    s_add_u32 m0, s64, 126848
    s_add_u32 s62, s65, 86016
    buffer_load_dwordx4 v255, s[32:35], s62 offen offset:128 nt lds
    s_waitcnt vmcnt(11)
    s_add_u32 m0, s64, 130816
    s_add_u32 s62, s65, 86016
    buffer_load_dwordx4 v255, s[32:35], s62 offen offset:256 nt lds
    s_add_u32 m0, s60, 55296
    s_add_u32 s62, s58, 3540096
    buffer_load_dwordx4 v243, s[40:43], s62 offen  lds
    buffer_load_dwordx4 v244, s[40:43], s62 offen offset:1024  lds
    buffer_load_dwordx4 v245, s[40:43], s62 offen offset:2048  lds
    v_mfma_f32_16x16x32_bf16 v[100:103], v[196:199], v[216:219], v[100:103]
    v_mfma_f32_16x16x32_bf16 v[104:107], v[200:203], v[216:219], v[104:107]
    ds_read_b128 v[216:219], v239 offset:38912
    s_waitcnt lgkmcnt(3)
    v_mfma_f32_16x16x32_bf16 v[108:111], v[192:195], v[220:223], v[108:111]
    ds_read_b64_tr_b16 v[168:169], v235 offset:24576
    v_mfma_f32_16x16x32_bf16 v[112:115], v[196:199], v[220:223], v[112:115]
    ds_read_b64_tr_b16 v[170:171], v235 offset:26112
    v_mfma_f32_16x16x32_bf16 v[116:119], v[200:203], v[220:223], v[116:119]
    ds_read_b128 v[220:223], v239 offset:40960
    s_waitcnt lgkmcnt(5)
    v_mfma_f32_16x16x32_bf16 v[120:123], v[192:195], v[224:227], v[120:123]
    ds_read_b64_tr_b16 v[172:173], v236 offset:24576
    v_mfma_f32_16x16x32_bf16 v[124:127], v[196:199], v[224:227], v[124:127]
    ds_read_b64_tr_b16 v[174:175], v236 offset:26112
    v_mfma_f32_16x16x32_bf16 v[128:131], v[200:203], v[224:227], v[128:131]
    ds_read_b128 v[224:227], v238 offset:0
    s_waitcnt lgkmcnt(7)
    v_mfma_f32_16x16x32_bf16 v[132:135], v[192:195], v[228:231], v[132:135]
    ds_read_b64_tr_b16 v[176:177], v237 offset:24576
    v_mfma_f32_16x16x32_bf16 v[136:139], v[196:199], v[228:231], v[136:139]
    ds_read_b64_tr_b16 v[178:179], v237 offset:26112
    v_mfma_f32_16x16x32_bf16 v[140:143], v[200:203], v[228:231], v[140:143]
    ds_read_b128 v[228:231], v238 offset:2048
    s_waitcnt lgkmcnt(9)
    v_mfma_f32_16x16x32_bf16 v[144:147], v[192:195], v[216:219], v[144:147]
    v_mfma_f32_16x16x32_bf16 v[148:151], v[196:199], v[216:219], v[148:151]
    v_mfma_f32_16x16x32_bf16 v[152:155], v[200:203], v[216:219], v[152:155]
    ds_read_b128 v[216:219], v238 offset:4096
    s_waitcnt lgkmcnt(7)
    v_mfma_f32_16x16x32_bf16 v[156:159], v[192:195], v[220:223], v[156:159]
    v_mfma_f32_16x16x32_bf16 v[160:163], v[196:199], v[220:223], v[160:163]
    v_mfma_f32_16x16x32_bf16 v[164:167], v[200:203], v[220:223], v[164:167]
    ds_read_b128 v[220:223], v238 offset:6144
    s_waitcnt lgkmcnt(5)
    v_mfma_f32_16x16x32_bf16 v[84:87], v[168:171], v[224:227], v[84:87]
    v_mfma_f32_16x16x32_bf16 v[88:91], v[172:175], v[224:227], v[88:91]
    s_waitcnt lgkmcnt(3)
    v_mfma_f32_16x16x32_bf16 v[92:95], v[176:179], v[224:227], v[92:95]
    ds_read_b128 v[224:227], v238 offset:8192
    s_waitcnt lgkmcnt(3)
    v_mfma_f32_16x16x32_bf16 v[96:99], v[168:171], v[228:231], v[96:99]
    s_barrier
    s_waitcnt vmcnt(14)
    s_add_u32 m0, s64, 135168
    s_add_u32 s62, s65, 73728
    buffer_load_dwordx4 v255, s[36:39], s62 offen nt lds
    s_waitcnt vmcnt(14)
    s_add_u32 m0, s64, 139136
    s_add_u32 s62, s65, 73728
    buffer_load_dwordx4 v255, s[36:39], s62 offen offset:128 nt lds
    s_waitcnt vmcnt(7)
    s_add_u32 m0, s64, 143104
    s_add_u32 s62, s65, 73728
    buffer_load_dwordx4 v255, s[36:39], s62 offen offset:256 nt lds
    s_add_u32 m0, s60, 67584
    s_add_u32 s62, s58, 3933312
    buffer_load_dwordx4 v243, s[40:43], s62 offen  lds
    buffer_load_dwordx4 v244, s[40:43], s62 offen offset:1024  lds
    buffer_load_dwordx4 v245, s[40:43], s62 offen offset:2048  lds
    s_add_u32 m0, s71, 28672
    s_add_u32 s63, s70, 640
    buffer_load_dwordx4 v246, s[48:51], s63 offen  lds
    s_add_u32 m0, s71, 32768
    s_add_u32 s63, s70, 41600
    buffer_load_dwordx4 v246, s[48:51], s63 offen  lds
    s_add_u32 m0, s71, 36864
    s_add_u32 s63, s70, 82560
    buffer_load_dwordx4 v246, s[48:51], s63 offen  lds
    s_add_u32 s63, s71, 40960
    s_cmp_ge_u32 s56, 2
    s_cselect_b32 m0, s73, s63
    s_add_u32 s63, s70, 123520
    buffer_load_dwordx4 v246, s[48:51], s63 offen  lds
    v_mfma_f32_16x16x32_bf16 v[100:103], v[172:175], v[228:231], v[100:103]
    v_mfma_f32_16x16x32_bf16 v[104:107], v[176:179], v[228:231], v[104:107]
    ds_read_b128 v[228:231], v238 offset:10240
    s_waitcnt lgkmcnt(3)
    v_mfma_f32_16x16x32_bf16 v[108:111], v[168:171], v[216:219], v[108:111]
    ds_read_b64_tr_b16 v[192:193], v235 offset:36864
    v_mfma_f32_16x16x32_bf16 v[112:115], v[172:175], v[216:219], v[112:115]
    ds_read_b64_tr_b16 v[194:195], v235 offset:38400
    v_mfma_f32_16x16x32_bf16 v[116:119], v[176:179], v[216:219], v[116:119]
    ds_read_b128 v[216:219], v238 offset:12288
    s_waitcnt lgkmcnt(5)
    v_mfma_f32_16x16x32_bf16 v[120:123], v[168:171], v[220:223], v[120:123]
    ds_read_b64_tr_b16 v[196:197], v236 offset:36864
    v_mfma_f32_16x16x32_bf16 v[124:127], v[172:175], v[220:223], v[124:127]
    ds_read_b64_tr_b16 v[198:199], v236 offset:38400
    v_mfma_f32_16x16x32_bf16 v[128:131], v[176:179], v[220:223], v[128:131]
    ds_read_b128 v[220:223], v239 offset:0
    s_waitcnt lgkmcnt(7)
    v_mfma_f32_16x16x32_bf16 v[132:135], v[168:171], v[224:227], v[132:135]
    ds_read_b64_tr_b16 v[200:201], v237 offset:36864
    v_mfma_f32_16x16x32_bf16 v[136:139], v[172:175], v[224:227], v[136:139]
    ds_read_b64_tr_b16 v[202:203], v237 offset:38400
    v_mfma_f32_16x16x32_bf16 v[140:143], v[176:179], v[224:227], v[140:143]
    ds_read_b128 v[224:227], v239 offset:2048
    s_waitcnt lgkmcnt(9)
    v_mfma_f32_16x16x32_bf16 v[144:147], v[168:171], v[228:231], v[144:147]
    v_mfma_f32_16x16x32_bf16 v[148:151], v[172:175], v[228:231], v[148:151]
    v_mfma_f32_16x16x32_bf16 v[152:155], v[176:179], v[228:231], v[152:155]
    ds_read_b128 v[228:231], v239 offset:4096
    s_waitcnt lgkmcnt(7)
    v_mfma_f32_16x16x32_bf16 v[156:159], v[168:171], v[216:219], v[156:159]
    v_mfma_f32_16x16x32_bf16 v[160:163], v[172:175], v[216:219], v[160:163]
    v_mfma_f32_16x16x32_bf16 v[164:167], v[176:179], v[216:219], v[164:167]
    ds_read_b128 v[216:219], v239 offset:6144
    s_waitcnt lgkmcnt(5)
    v_mfma_f32_16x16x32_bf16 v[84:87], v[192:195], v[220:223], v[84:87]
    v_mfma_f32_16x16x32_bf16 v[88:91], v[196:199], v[220:223], v[88:91]
    s_waitcnt lgkmcnt(3)
    v_mfma_f32_16x16x32_bf16 v[92:95], v[200:203], v[220:223], v[92:95]
    ds_read_b128 v[220:223], v239 offset:8192
    s_waitcnt lgkmcnt(3)
    v_mfma_f32_16x16x32_bf16 v[96:99], v[192:195], v[224:227], v[96:99]
    s_barrier
    s_waitcnt vmcnt(14)
    s_add_u32 m0, s64, 147456
    s_add_u32 s62, s65, 98304
    buffer_load_dwordx4 v255, s[32:35], s62 offen nt lds
    s_waitcnt vmcnt(14)
    s_add_u32 m0, s64, 151424
    s_add_u32 s62, s65, 98304
    buffer_load_dwordx4 v255, s[32:35], s62 offen offset:128 nt lds
    s_waitcnt vmcnt(11)
    s_add_u32 m0, s64, 155392
    s_add_u32 s62, s65, 98304
    buffer_load_dwordx4 v255, s[32:35], s62 offen offset:256 nt lds
    s_waitcnt vmcnt(11)
    s_add_u32 m0, s64, 94208
    s_add_u32 s62, s65, 86016
    buffer_load_dwordx4 v255, s[36:39], s62 offen nt lds
    s_add_u32 m0, s60, 79872
    s_add_u32 s62, s58, 4326528
    buffer_load_dwordx4 v243, s[40:43], s62 offen  lds
    buffer_load_dwordx4 v244, s[40:43], s62 offen offset:1024  lds
    buffer_load_dwordx4 v245, s[40:43], s62 offen offset:2048  lds
    s_and_b32 s62, s53, 15
    s_lshl_b32 s62, s62, 2
    s_add_u32 s62, s62, s56
    s_mul_i32 s62, s62, 3840
    s_sub_u32 s63, s55, 1
    s_mul_i32 s63, s63, 245760
    s_add_u32 s62, s62, s63
    s_mov_b32 m0, 159744
    v_mbcnt_lo_u32_b32 v212, -1, 0
    v_mbcnt_hi_u32_b32 v212, -1, v212
    v_min_u32 v212, 29, v212
    v_lshlrev_b32 v212, 7, v212
    buffer_load_dword v212, s[44:47], s62 offen  lds
    v_mfma_f32_16x16x32_bf16 v[100:103], v[196:199], v[224:227], v[100:103]
    v_mfma_f32_16x16x32_bf16 v[104:107], v[200:203], v[224:227], v[104:107]
    ds_read_b128 v[224:227], v239 offset:10240
    s_waitcnt lgkmcnt(3)
    v_mfma_f32_16x16x32_bf16 v[108:111], v[192:195], v[228:231], v[108:111]
    ds_read_b64_tr_b16 v[168:169], v235 offset:0
    v_mfma_f32_16x16x32_bf16 v[112:115], v[196:199], v[228:231], v[112:115]
    ds_read_b64_tr_b16 v[170:171], v235 offset:1536
    v_mfma_f32_16x16x32_bf16 v[116:119], v[200:203], v[228:231], v[116:119]
    ds_read_b128 v[228:231], v239 offset:12288
    s_waitcnt lgkmcnt(5)
    v_mfma_f32_16x16x32_bf16 v[120:123], v[192:195], v[216:219], v[120:123]
    ds_read_b64_tr_b16 v[172:173], v236 offset:0
    v_mfma_f32_16x16x32_bf16 v[124:127], v[196:199], v[216:219], v[124:127]
    ds_read_b64_tr_b16 v[174:175], v236 offset:1536
    v_mfma_f32_16x16x32_bf16 v[128:131], v[200:203], v[216:219], v[128:131]
    ds_read_b128 v[216:219], v238 offset:14336
    s_waitcnt lgkmcnt(7)
    v_mfma_f32_16x16x32_bf16 v[132:135], v[192:195], v[220:223], v[132:135]
    ds_read_b64_tr_b16 v[176:177], v237 offset:0
    v_mfma_f32_16x16x32_bf16 v[136:139], v[196:199], v[220:223], v[136:139]
    ds_read_b64_tr_b16 v[178:179], v237 offset:1536
    v_mfma_f32_16x16x32_bf16 v[140:143], v[200:203], v[220:223], v[140:143]
    ds_read_b128 v[220:223], v238 offset:16384
    s_waitcnt lgkmcnt(9)
    v_mfma_f32_16x16x32_bf16 v[144:147], v[192:195], v[224:227], v[144:147]
    v_mfma_f32_16x16x32_bf16 v[148:151], v[196:199], v[224:227], v[148:151]
    v_mfma_f32_16x16x32_bf16 v[152:155], v[200:203], v[224:227], v[152:155]
    ds_read_b128 v[224:227], v238 offset:18432
    s_waitcnt lgkmcnt(7)
    v_mfma_f32_16x16x32_bf16 v[156:159], v[192:195], v[228:231], v[156:159]
    v_mfma_f32_16x16x32_bf16 v[160:163], v[196:199], v[228:231], v[160:163]
    v_mfma_f32_16x16x32_bf16 v[164:167], v[200:203], v[228:231], v[164:167]
    ds_read_b128 v[228:231], v238 offset:20480
    s_waitcnt lgkmcnt(5)
    v_mfma_f32_16x16x32_bf16 v[84:87], v[168:171], v[216:219], v[84:87]
    v_mfma_f32_16x16x32_bf16 v[88:91], v[172:175], v[216:219], v[88:91]
    s_waitcnt lgkmcnt(3)
    v_mfma_f32_16x16x32_bf16 v[92:95], v[176:179], v[216:219], v[92:95]
    ds_read_b128 v[216:219], v238 offset:22528
    s_waitcnt lgkmcnt(3)
    v_mfma_f32_16x16x32_bf16 v[96:99], v[168:171], v[220:223], v[96:99]
    s_barrier
    s_waitcnt vmcnt(15)
    s_add_u32 m0, s64, 98176
    s_add_u32 s62, s65, 86016
    buffer_load_dwordx4 v255, s[36:39], s62 offen offset:128 nt lds
    s_waitcnt vmcnt(8)
    s_add_u32 m0, s64, 102144
    s_add_u32 s62, s65, 86016
    buffer_load_dwordx4 v255, s[36:39], s62 offen offset:256 nt lds
    s_waitcnt vmcnt(8)
    s_add_u32 m0, s64, 106496
    s_add_u32 s62, s65, 110592
    buffer_load_dwordx4 v255, s[32:35], s62 offen nt lds
    s_add_u32 m0, s60, 43008
    s_add_u32 s62, s58, 4719744
    buffer_load_dwordx4 v243, s[40:43], s62 offen  lds
    buffer_load_dwordx4 v244, s[40:43], s62 offen offset:1024  lds
    buffer_load_dwordx4 v245, s[40:43], s62 offen offset:2048  lds
    s_add_u32 m0, s71, 0
    s_add_u32 s63, s70, 768
    buffer_load_dwordx4 v246, s[48:51], s63 offen  lds
    s_add_u32 m0, s71, 4096
    s_add_u32 s63, s70, 41728
    buffer_load_dwordx4 v246, s[48:51], s63 offen  lds
    s_add_u32 m0, s71, 8192
    s_add_u32 s63, s70, 82688
    buffer_load_dwordx4 v246, s[48:51], s63 offen  lds
    s_add_u32 s63, s71, 12288
    s_cmp_ge_u32 s56, 2
    s_cselect_b32 m0, s73, s63
    s_add_u32 s63, s70, 123648
    buffer_load_dwordx4 v246, s[48:51], s63 offen  lds
    v_mfma_f32_16x16x32_bf16 v[100:103], v[172:175], v[220:223], v[100:103]
    v_mfma_f32_16x16x32_bf16 v[104:107], v[176:179], v[220:223], v[104:107]
    ds_read_b128 v[220:223], v238 offset:24576
    s_waitcnt lgkmcnt(3)
    v_mfma_f32_16x16x32_bf16 v[108:111], v[168:171], v[224:227], v[108:111]
    ds_read_b64_tr_b16 v[192:193], v235 offset:12288
    v_mfma_f32_16x16x32_bf16 v[112:115], v[172:175], v[224:227], v[112:115]
    ds_read_b64_tr_b16 v[194:195], v235 offset:13824
    v_mfma_f32_16x16x32_bf16 v[116:119], v[176:179], v[224:227], v[116:119]
    ds_read_b128 v[224:227], v238 offset:26624
    s_waitcnt lgkmcnt(5)
    v_mfma_f32_16x16x32_bf16 v[120:123], v[168:171], v[228:231], v[120:123]
    ds_read_b64_tr_b16 v[196:197], v236 offset:12288
    v_mfma_f32_16x16x32_bf16 v[124:127], v[172:175], v[228:231], v[124:127]
    ds_read_b64_tr_b16 v[198:199], v236 offset:13824
    v_mfma_f32_16x16x32_bf16 v[128:131], v[176:179], v[228:231], v[128:131]
    ds_read_b128 v[228:231], v239 offset:14336
    s_waitcnt lgkmcnt(7)
    v_mfma_f32_16x16x32_bf16 v[132:135], v[168:171], v[216:219], v[132:135]
    ds_read_b64_tr_b16 v[200:201], v237 offset:12288
    v_mfma_f32_16x16x32_bf16 v[136:139], v[172:175], v[216:219], v[136:139]
    ds_read_b64_tr_b16 v[202:203], v237 offset:13824
    v_mfma_f32_16x16x32_bf16 v[140:143], v[176:179], v[216:219], v[140:143]
    ds_read_b128 v[216:219], v239 offset:16384
    s_waitcnt lgkmcnt(9)
    v_mfma_f32_16x16x32_bf16 v[144:147], v[168:171], v[220:223], v[144:147]
    v_mfma_f32_16x16x32_bf16 v[148:151], v[172:175], v[220:223], v[148:151]
    v_mfma_f32_16x16x32_bf16 v[152:155], v[176:179], v[220:223], v[152:155]
    ds_read_b128 v[220:223], v239 offset:18432
    s_waitcnt lgkmcnt(7)
    v_mfma_f32_16x16x32_bf16 v[156:159], v[168:171], v[224:227], v[156:159]
    v_mfma_f32_16x16x32_bf16 v[160:163], v[172:175], v[224:227], v[160:163]
    v_mfma_f32_16x16x32_bf16 v[164:167], v[176:179], v[224:227], v[164:167]
    ds_read_b128 v[224:227], v239 offset:20480
    s_waitcnt lgkmcnt(5)
    v_mfma_f32_16x16x32_bf16 v[84:87], v[192:195], v[228:231], v[84:87]
    v_mfma_f32_16x16x32_bf16 v[88:91], v[196:199], v[228:231], v[88:91]
    s_waitcnt lgkmcnt(3)
    v_mfma_f32_16x16x32_bf16 v[92:95], v[200:203], v[228:231], v[92:95]
    ds_read_b128 v[228:231], v239 offset:22528
    s_waitcnt lgkmcnt(3)
    v_mfma_f32_16x16x32_bf16 v[96:99], v[192:195], v[216:219], v[96:99]
    s_barrier
    s_waitcnt vmcnt(15)
    s_add_u32 m0, s64, 110464
    s_add_u32 s62, s65, 110592
    buffer_load_dwordx4 v255, s[32:35], s62 offen offset:128 nt lds
    s_waitcnt vmcnt(15)
    s_add_u32 m0, s64, 114432
    s_add_u32 s62, s65, 110592
    buffer_load_dwordx4 v255, s[32:35], s62 offen offset:256 nt lds
    s_waitcnt vmcnt(11)
    s_add_u32 m0, s64, 118784
    s_add_u32 s62, s65, 98304
    buffer_load_dwordx4 v255, s[36:39], s62 offen nt lds
    s_add_u32 m0, s60, 55296
    s_add_u32 s62, s58, 5112960
    buffer_load_dwordx4 v243, s[40:43], s62 offen  lds
    buffer_load_dwordx4 v244, s[40:43], s62 offen offset:1024  lds
    buffer_load_dwordx4 v245, s[40:43], s62 offen offset:2048  lds
    v_mfma_f32_16x16x32_bf16 v[100:103], v[196:199], v[216:219], v[100:103]
    v_mfma_f32_16x16x32_bf16 v[104:107], v[200:203], v[216:219], v[104:107]
    ds_read_b128 v[216:219], v239 offset:24576
    s_waitcnt lgkmcnt(3)
    v_mfma_f32_16x16x32_bf16 v[108:111], v[192:195], v[220:223], v[108:111]
    ds_read_b64_tr_b16 v[168:169], v235 offset:24576
    v_mfma_f32_16x16x32_bf16 v[112:115], v[196:199], v[220:223], v[112:115]
    ds_read_b64_tr_b16 v[170:171], v235 offset:26112
    v_mfma_f32_16x16x32_bf16 v[116:119], v[200:203], v[220:223], v[116:119]
    ds_read_b128 v[220:223], v239 offset:26624
    s_waitcnt lgkmcnt(5)
    v_mfma_f32_16x16x32_bf16 v[120:123], v[192:195], v[224:227], v[120:123]
    ds_read_b64_tr_b16 v[172:173], v236 offset:24576
    v_mfma_f32_16x16x32_bf16 v[124:127], v[196:199], v[224:227], v[124:127]
    ds_read_b64_tr_b16 v[174:175], v236 offset:26112
    v_mfma_f32_16x16x32_bf16 v[128:131], v[200:203], v[224:227], v[128:131]
    ds_read_b128 v[224:227], v238 offset:28672
    s_waitcnt lgkmcnt(7)
    v_mfma_f32_16x16x32_bf16 v[132:135], v[192:195], v[228:231], v[132:135]
    ds_read_b64_tr_b16 v[176:177], v237 offset:24576
    v_mfma_f32_16x16x32_bf16 v[136:139], v[196:199], v[228:231], v[136:139]
    ds_read_b64_tr_b16 v[178:179], v237 offset:26112
    v_mfma_f32_16x16x32_bf16 v[140:143], v[200:203], v[228:231], v[140:143]
    ds_read_b128 v[228:231], v238 offset:30720
    s_waitcnt lgkmcnt(9)
    v_mfma_f32_16x16x32_bf16 v[144:147], v[192:195], v[216:219], v[144:147]
    v_mfma_f32_16x16x32_bf16 v[148:151], v[196:199], v[216:219], v[148:151]
    v_mfma_f32_16x16x32_bf16 v[152:155], v[200:203], v[216:219], v[152:155]
    ds_read_b128 v[216:219], v238 offset:32768
    s_waitcnt lgkmcnt(7)
    v_mfma_f32_16x16x32_bf16 v[156:159], v[192:195], v[220:223], v[156:159]
    v_mfma_f32_16x16x32_bf16 v[160:163], v[196:199], v[220:223], v[160:163]
    v_mfma_f32_16x16x32_bf16 v[164:167], v[200:203], v[220:223], v[164:167]
    ds_read_b128 v[220:223], v238 offset:34816
    s_waitcnt lgkmcnt(5)
    v_mfma_f32_16x16x32_bf16 v[84:87], v[168:171], v[224:227], v[84:87]
    v_mfma_f32_16x16x32_bf16 v[88:91], v[172:175], v[224:227], v[88:91]
    s_waitcnt lgkmcnt(3)
    v_mfma_f32_16x16x32_bf16 v[92:95], v[176:179], v[224:227], v[92:95]
    ds_read_b128 v[224:227], v238 offset:36864
    s_waitcnt lgkmcnt(3)
    v_mfma_f32_16x16x32_bf16 v[96:99], v[168:171], v[228:231], v[96:99]
    s_barrier
    s_waitcnt vmcnt(14)
    s_add_u32 m0, s64, 122752
    s_add_u32 s62, s65, 98304
    buffer_load_dwordx4 v255, s[36:39], s62 offen offset:128 nt lds
    s_waitcnt vmcnt(14)
    s_add_u32 m0, s64, 126720
    s_add_u32 s62, s65, 98304
    buffer_load_dwordx4 v255, s[36:39], s62 offen offset:256 nt lds
    s_waitcnt vmcnt(7)
    s_add_u32 m0, s64, 131072
    s_add_u32 s62, s65, 122880
    buffer_load_dwordx4 v255, s[32:35], s62 offen nt lds
    s_add_u32 m0, s60, 67584
    s_add_u32 s62, s58, 5506176
    buffer_load_dwordx4 v243, s[40:43], s62 offen  lds
    buffer_load_dwordx4 v244, s[40:43], s62 offen offset:1024  lds
    buffer_load_dwordx4 v245, s[40:43], s62 offen offset:2048  lds
    s_add_u32 m0, s71, 14336
    s_add_u32 s63, s70, 896
    buffer_load_dwordx4 v246, s[48:51], s63 offen  lds
    s_add_u32 m0, s71, 18432
    s_add_u32 s63, s70, 41856
    buffer_load_dwordx4 v246, s[48:51], s63 offen  lds
    s_add_u32 m0, s71, 22528
    s_add_u32 s63, s70, 82816
    buffer_load_dwordx4 v246, s[48:51], s63 offen  lds
    s_add_u32 s63, s71, 26624
    s_cmp_ge_u32 s56, 2
    s_cselect_b32 m0, s73, s63
    s_add_u32 s63, s70, 123776
    buffer_load_dwordx4 v246, s[48:51], s63 offen  lds
    v_mfma_f32_16x16x32_bf16 v[100:103], v[172:175], v[228:231], v[100:103]
    v_mfma_f32_16x16x32_bf16 v[104:107], v[176:179], v[228:231], v[104:107]
    ds_read_b128 v[228:231], v238 offset:38912
    s_waitcnt lgkmcnt(3)
    v_mfma_f32_16x16x32_bf16 v[108:111], v[168:171], v[216:219], v[108:111]
    ds_read_b64_tr_b16 v[192:193], v235 offset:36864
    v_mfma_f32_16x16x32_bf16 v[112:115], v[172:175], v[216:219], v[112:115]
    ds_read_b64_tr_b16 v[194:195], v235 offset:38400
    v_mfma_f32_16x16x32_bf16 v[116:119], v[176:179], v[216:219], v[116:119]
    ds_read_b128 v[216:219], v238 offset:40960
    s_waitcnt lgkmcnt(5)
    v_mfma_f32_16x16x32_bf16 v[120:123], v[168:171], v[220:223], v[120:123]
    ds_read_b64_tr_b16 v[196:197], v236 offset:36864
    v_mfma_f32_16x16x32_bf16 v[124:127], v[172:175], v[220:223], v[124:127]
    ds_read_b64_tr_b16 v[198:199], v236 offset:38400
    v_mfma_f32_16x16x32_bf16 v[128:131], v[176:179], v[220:223], v[128:131]
    ds_read_b128 v[220:223], v239 offset:28672
    s_waitcnt lgkmcnt(7)
    v_mfma_f32_16x16x32_bf16 v[132:135], v[168:171], v[224:227], v[132:135]
    ds_read_b64_tr_b16 v[200:201], v237 offset:36864
    v_mfma_f32_16x16x32_bf16 v[136:139], v[172:175], v[224:227], v[136:139]
    ds_read_b64_tr_b16 v[202:203], v237 offset:38400
    v_mfma_f32_16x16x32_bf16 v[140:143], v[176:179], v[224:227], v[140:143]
    ds_read_b128 v[224:227], v239 offset:30720
    s_waitcnt lgkmcnt(9)
    v_mfma_f32_16x16x32_bf16 v[144:147], v[168:171], v[228:231], v[144:147]
    v_mfma_f32_16x16x32_bf16 v[148:151], v[172:175], v[228:231], v[148:151]
    v_mfma_f32_16x16x32_bf16 v[152:155], v[176:179], v[228:231], v[152:155]
    ds_read_b128 v[228:231], v239 offset:32768
    s_waitcnt lgkmcnt(7)
    v_mfma_f32_16x16x32_bf16 v[156:159], v[168:171], v[216:219], v[156:159]
    v_mfma_f32_16x16x32_bf16 v[160:163], v[172:175], v[216:219], v[160:163]
    v_mfma_f32_16x16x32_bf16 v[164:167], v[176:179], v[216:219], v[164:167]
    ds_read_b128 v[216:219], v239 offset:34816
    s_waitcnt lgkmcnt(5)
    v_mfma_f32_16x16x32_bf16 v[84:87], v[192:195], v[220:223], v[84:87]
    v_mfma_f32_16x16x32_bf16 v[88:91], v[196:199], v[220:223], v[88:91]
    s_waitcnt lgkmcnt(3)
    v_mfma_f32_16x16x32_bf16 v[92:95], v[200:203], v[220:223], v[92:95]
    ds_read_b128 v[220:223], v239 offset:36864
    s_waitcnt lgkmcnt(3)
    v_mfma_f32_16x16x32_bf16 v[96:99], v[192:195], v[224:227], v[96:99]
    s_barrier
    s_waitcnt vmcnt(14)
    s_add_u32 m0, s64, 135040
    s_add_u32 s62, s65, 122880
    buffer_load_dwordx4 v255, s[32:35], s62 offen offset:128 nt lds
    s_waitcnt vmcnt(14)
    s_add_u32 m0, s64, 139008
    s_add_u32 s62, s65, 122880
    buffer_load_dwordx4 v255, s[32:35], s62 offen offset:256 nt lds
    s_waitcnt vmcnt(11)
    s_add_u32 m0, s64, 143360
    s_add_u32 s62, s65, 110592
    buffer_load_dwordx4 v255, s[36:39], s62 offen nt lds
    s_add_u32 m0, s60, 79872
    s_add_u32 s62, s58, 5899392
    buffer_load_dwordx4 v243, s[40:43], s62 offen  lds
    buffer_load_dwordx4 v244, s[40:43], s62 offen offset:1024  lds
    buffer_load_dwordx4 v245, s[40:43], s62 offen offset:2048  lds
    v_mfma_f32_16x16x32_bf16 v[100:103], v[196:199], v[224:227], v[100:103]
    v_mfma_f32_16x16x32_bf16 v[104:107], v[200:203], v[224:227], v[104:107]
    ds_read_b128 v[224:227], v239 offset:38912
    s_waitcnt lgkmcnt(3)
    v_mfma_f32_16x16x32_bf16 v[108:111], v[192:195], v[228:231], v[108:111]
    ds_read_b64_tr_b16 v[168:169], v235 offset:0
    v_mfma_f32_16x16x32_bf16 v[112:115], v[196:199], v[228:231], v[112:115]
    ds_read_b64_tr_b16 v[170:171], v235 offset:1536
    v_mfma_f32_16x16x32_bf16 v[116:119], v[200:203], v[228:231], v[116:119]
    ds_read_b128 v[228:231], v239 offset:40960
    s_waitcnt lgkmcnt(5)
    v_mfma_f32_16x16x32_bf16 v[120:123], v[192:195], v[216:219], v[120:123]
    ds_read_b64_tr_b16 v[172:173], v236 offset:0
    v_mfma_f32_16x16x32_bf16 v[124:127], v[196:199], v[216:219], v[124:127]
    ds_read_b64_tr_b16 v[174:175], v236 offset:1536
    v_mfma_f32_16x16x32_bf16 v[128:131], v[200:203], v[216:219], v[128:131]
    ds_read_b128 v[216:219], v238 offset:0
    s_waitcnt lgkmcnt(7)
    v_mfma_f32_16x16x32_bf16 v[132:135], v[192:195], v[220:223], v[132:135]
    ds_read_b64_tr_b16 v[176:177], v237 offset:0
    v_mfma_f32_16x16x32_bf16 v[136:139], v[196:199], v[220:223], v[136:139]
    ds_read_b64_tr_b16 v[178:179], v237 offset:1536
    v_mfma_f32_16x16x32_bf16 v[140:143], v[200:203], v[220:223], v[140:143]
    ds_read_b128 v[220:223], v238 offset:2048
    s_waitcnt lgkmcnt(9)
    v_mfma_f32_16x16x32_bf16 v[144:147], v[192:195], v[224:227], v[144:147]
    v_mfma_f32_16x16x32_bf16 v[148:151], v[196:199], v[224:227], v[148:151]
    v_mfma_f32_16x16x32_bf16 v[152:155], v[200:203], v[224:227], v[152:155]
    ds_read_b128 v[224:227], v238 offset:4096
    s_waitcnt lgkmcnt(7)
    v_mfma_f32_16x16x32_bf16 v[156:159], v[192:195], v[228:231], v[156:159]
    v_mfma_f32_16x16x32_bf16 v[160:163], v[196:199], v[228:231], v[160:163]
    v_mfma_f32_16x16x32_bf16 v[164:167], v[200:203], v[228:231], v[164:167]
    ds_read_b128 v[228:231], v238 offset:6144
    s_waitcnt lgkmcnt(5)
    v_mfma_f32_16x16x32_bf16 v[84:87], v[168:171], v[216:219], v[84:87]
    v_mfma_f32_16x16x32_bf16 v[88:91], v[172:175], v[216:219], v[88:91]
    s_waitcnt lgkmcnt(3)
    v_mfma_f32_16x16x32_bf16 v[92:95], v[176:179], v[216:219], v[92:95]
    ds_read_b128 v[216:219], v238 offset:8192
    s_waitcnt lgkmcnt(3)
    v_mfma_f32_16x16x32_bf16 v[96:99], v[168:171], v[220:223], v[96:99]
    s_barrier
    s_waitcnt vmcnt(14)
    s_add_u32 m0, s64, 147328
    s_add_u32 s62, s65, 110592
    buffer_load_dwordx4 v255, s[36:39], s62 offen offset:128 nt lds
    s_waitcnt vmcnt(14)
    s_add_u32 m0, s64, 151296
    s_add_u32 s62, s65, 110592
    buffer_load_dwordx4 v255, s[36:39], s62 offen offset:256 nt lds
    s_waitcnt vmcnt(7)
    s_add_u32 m0, s64, 155648
    s_add_u32 s62, s65, 135168
    buffer_load_dwordx4 v255, s[32:35], s62 offen nt lds
    s_waitcnt vmcnt(7)
    s_add_u32 m0, s64, 94080
    s_add_u32 s62, s65, 135168
    buffer_load_dwordx4 v255, s[32:35], s62 offen offset:128 nt lds
    s_add_u32 m0, s60, 43008
    s_add_u32 s62, s58, 6292608
    buffer_load_dwordx4 v243, s[40:43], s62 offen  lds
    buffer_load_dwordx4 v244, s[40:43], s62 offen offset:1024  lds
    buffer_load_dwordx4 v245, s[40:43], s62 offen offset:2048  lds
    s_add_u32 m0, s71, 28672
    s_add_u32 s63, s70, 1024
    buffer_load_dwordx4 v246, s[48:51], s63 offen  lds
    s_add_u32 m0, s71, 32768
    s_add_u32 s63, s70, 41984
    buffer_load_dwordx4 v246, s[48:51], s63 offen  lds
    s_add_u32 m0, s71, 36864
    s_add_u32 s63, s70, 82944
    buffer_load_dwordx4 v246, s[48:51], s63 offen  lds
    s_add_u32 s63, s71, 40960
    s_cmp_ge_u32 s56, 2
    s_cselect_b32 m0, s73, s63
    s_add_u32 s63, s70, 123904
    buffer_load_dwordx4 v246, s[48:51], s63 offen  lds
    v_mfma_f32_16x16x32_bf16 v[100:103], v[172:175], v[220:223], v[100:103]
    v_mfma_f32_16x16x32_bf16 v[104:107], v[176:179], v[220:223], v[104:107]
    ds_read_b128 v[220:223], v238 offset:10240
    s_waitcnt lgkmcnt(3)
    v_mfma_f32_16x16x32_bf16 v[108:111], v[168:171], v[224:227], v[108:111]
    ds_read_b64_tr_b16 v[192:193], v235 offset:12288
    v_mfma_f32_16x16x32_bf16 v[112:115], v[172:175], v[224:227], v[112:115]
    ds_read_b64_tr_b16 v[194:195], v235 offset:13824
    v_mfma_f32_16x16x32_bf16 v[116:119], v[176:179], v[224:227], v[116:119]
    ds_read_b128 v[224:227], v238 offset:12288
    s_waitcnt lgkmcnt(5)
    v_mfma_f32_16x16x32_bf16 v[120:123], v[168:171], v[228:231], v[120:123]
    ds_read_b64_tr_b16 v[196:197], v236 offset:12288
    v_mfma_f32_16x16x32_bf16 v[124:127], v[172:175], v[228:231], v[124:127]
    ds_read_b64_tr_b16 v[198:199], v236 offset:13824
    v_mfma_f32_16x16x32_bf16 v[128:131], v[176:179], v[228:231], v[128:131]
    ds_read_b128 v[228:231], v239 offset:0
    s_waitcnt lgkmcnt(7)
    v_mfma_f32_16x16x32_bf16 v[132:135], v[168:171], v[216:219], v[132:135]
    ds_read_b64_tr_b16 v[200:201], v237 offset:12288
    v_mfma_f32_16x16x32_bf16 v[136:139], v[172:175], v[216:219], v[136:139]
    ds_read_b64_tr_b16 v[202:203], v237 offset:13824
    v_mfma_f32_16x16x32_bf16 v[140:143], v[176:179], v[216:219], v[140:143]
    ds_read_b128 v[216:219], v239 offset:2048
    s_waitcnt lgkmcnt(9)
    v_mfma_f32_16x16x32_bf16 v[144:147], v[168:171], v[220:223], v[144:147]
    v_mfma_f32_16x16x32_bf16 v[148:151], v[172:175], v[220:223], v[148:151]
    v_mfma_f32_16x16x32_bf16 v[152:155], v[176:179], v[220:223], v[152:155]
    ds_read_b128 v[220:223], v239 offset:4096
    s_waitcnt lgkmcnt(7)
    v_mfma_f32_16x16x32_bf16 v[156:159], v[168:171], v[224:227], v[156:159]
    v_mfma_f32_16x16x32_bf16 v[160:163], v[172:175], v[224:227], v[160:163]
    v_mfma_f32_16x16x32_bf16 v[164:167], v[176:179], v[224:227], v[164:167]
    ds_read_b128 v[224:227], v239 offset:6144
    s_waitcnt lgkmcnt(5)
    v_mfma_f32_16x16x32_bf16 v[84:87], v[192:195], v[228:231], v[84:87]
    v_mfma_f32_16x16x32_bf16 v[88:91], v[196:199], v[228:231], v[88:91]
    s_waitcnt lgkmcnt(3)
    v_mfma_f32_16x16x32_bf16 v[92:95], v[200:203], v[228:231], v[92:95]
    ds_read_b128 v[228:231], v239 offset:8192
    s_waitcnt lgkmcnt(3)
    v_mfma_f32_16x16x32_bf16 v[96:99], v[192:195], v[216:219], v[96:99]
    s_barrier
    s_waitcnt vmcnt(14)
    s_add_u32 m0, s64, 98048
    s_add_u32 s62, s65, 135168
    buffer_load_dwordx4 v255, s[32:35], s62 offen offset:256 nt lds
    s_waitcnt vmcnt(11)
    s_add_u32 m0, s64, 102400
    s_add_u32 s62, s65, 122880
    buffer_load_dwordx4 v255, s[36:39], s62 offen nt lds
    s_waitcnt vmcnt(11)
    s_add_u32 m0, s64, 106368
    s_add_u32 s62, s65, 122880
    buffer_load_dwordx4 v255, s[36:39], s62 offen offset:128 nt lds
    s_add_u32 m0, s60, 55296
    s_add_u32 s62, s58, 6685824
    buffer_load_dwordx4 v243, s[40:43], s62 offen  lds
    buffer_load_dwordx4 v244, s[40:43], s62 offen offset:1024  lds
    buffer_load_dwordx4 v245, s[40:43], s62 offen offset:2048  lds
    v_mfma_f32_16x16x32_bf16 v[100:103], v[196:199], v[216:219], v[100:103]
    v_mfma_f32_16x16x32_bf16 v[104:107], v[200:203], v[216:219], v[104:107]
    ds_read_b128 v[216:219], v239 offset:10240
    s_waitcnt lgkmcnt(3)
    v_mfma_f32_16x16x32_bf16 v[108:111], v[192:195], v[220:223], v[108:111]
    ds_read_b64_tr_b16 v[168:169], v235 offset:24576
    v_mfma_f32_16x16x32_bf16 v[112:115], v[196:199], v[220:223], v[112:115]
    ds_read_b64_tr_b16 v[170:171], v235 offset:26112
    v_mfma_f32_16x16x32_bf16 v[116:119], v[200:203], v[220:223], v[116:119]
    ds_read_b128 v[220:223], v239 offset:12288
    s_waitcnt lgkmcnt(5)
    v_mfma_f32_16x16x32_bf16 v[120:123], v[192:195], v[224:227], v[120:123]
    ds_read_b64_tr_b16 v[172:173], v236 offset:24576
    v_mfma_f32_16x16x32_bf16 v[124:127], v[196:199], v[224:227], v[124:127]
    ds_read_b64_tr_b16 v[174:175], v236 offset:26112
    v_mfma_f32_16x16x32_bf16 v[128:131], v[200:203], v[224:227], v[128:131]
    ds_read_b128 v[224:227], v238 offset:14336
    s_waitcnt lgkmcnt(7)
    v_mfma_f32_16x16x32_bf16 v[132:135], v[192:195], v[228:231], v[132:135]
    ds_read_b64_tr_b16 v[176:177], v237 offset:24576
    v_mfma_f32_16x16x32_bf16 v[136:139], v[196:199], v[228:231], v[136:139]
    ds_read_b64_tr_b16 v[178:179], v237 offset:26112
    v_mfma_f32_16x16x32_bf16 v[140:143], v[200:203], v[228:231], v[140:143]
    ds_read_b128 v[228:231], v238 offset:16384
    s_waitcnt lgkmcnt(9)
    v_mfma_f32_16x16x32_bf16 v[144:147], v[192:195], v[216:219], v[144:147]
    v_mfma_f32_16x16x32_bf16 v[148:151], v[196:199], v[216:219], v[148:151]
    v_mfma_f32_16x16x32_bf16 v[152:155], v[200:203], v[216:219], v[152:155]
    ds_read_b128 v[216:219], v238 offset:18432
    s_waitcnt lgkmcnt(7)
    v_mfma_f32_16x16x32_bf16 v[156:159], v[192:195], v[220:223], v[156:159]
    v_mfma_f32_16x16x32_bf16 v[160:163], v[196:199], v[220:223], v[160:163]
    v_mfma_f32_16x16x32_bf16 v[164:167], v[200:203], v[220:223], v[164:167]
    ds_read_b128 v[220:223], v238 offset:20480
    s_waitcnt lgkmcnt(5)
    v_mfma_f32_16x16x32_bf16 v[84:87], v[168:171], v[224:227], v[84:87]
    v_mfma_f32_16x16x32_bf16 v[88:91], v[172:175], v[224:227], v[88:91]
    s_waitcnt lgkmcnt(3)
    v_mfma_f32_16x16x32_bf16 v[92:95], v[176:179], v[224:227], v[92:95]
    ds_read_b128 v[224:227], v238 offset:22528
    s_waitcnt lgkmcnt(3)
    v_mfma_f32_16x16x32_bf16 v[96:99], v[168:171], v[228:231], v[96:99]
    s_barrier
    s_waitcnt vmcnt(14)
    s_add_u32 m0, s64, 110336
    s_add_u32 s62, s65, 122880
    buffer_load_dwordx4 v255, s[36:39], s62 offen offset:256 nt lds
    s_waitcnt vmcnt(14)
    s_add_u32 m0, s64, 114688
    s_add_u32 s62, s65, 147456
    buffer_load_dwordx4 v255, s[32:35], s62 offen nt lds
    s_waitcnt vmcnt(7)
    s_add_u32 m0, s64, 118656
    s_add_u32 s62, s65, 147456
    buffer_load_dwordx4 v255, s[32:35], s62 offen offset:128 nt lds
    s_add_u32 m0, s60, 67584
    s_add_u32 s62, s58, 7079040
    buffer_load_dwordx4 v243, s[40:43], s62 offen  lds
    buffer_load_dwordx4 v244, s[40:43], s62 offen offset:1024  lds
    buffer_load_dwordx4 v245, s[40:43], s62 offen offset:2048  lds
    s_add_u32 m0, s71, 0
    s_add_u32 s63, s70, 1152
    buffer_load_dwordx4 v246, s[48:51], s63 offen  lds
    s_add_u32 m0, s71, 4096
    s_add_u32 s63, s70, 42112
    buffer_load_dwordx4 v246, s[48:51], s63 offen  lds
    s_add_u32 m0, s71, 8192
    s_add_u32 s63, s70, 83072
    buffer_load_dwordx4 v246, s[48:51], s63 offen  lds
    s_add_u32 s63, s71, 12288
    s_cmp_ge_u32 s56, 2
    s_cselect_b32 m0, s73, s63
    s_add_u32 s63, s70, 124032
    buffer_load_dwordx4 v246, s[48:51], s63 offen  lds
    v_mfma_f32_16x16x32_bf16 v[100:103], v[172:175], v[228:231], v[100:103]
    v_mfma_f32_16x16x32_bf16 v[104:107], v[176:179], v[228:231], v[104:107]
    ds_read_b128 v[228:231], v238 offset:24576
    s_waitcnt lgkmcnt(3)
    v_mfma_f32_16x16x32_bf16 v[108:111], v[168:171], v[216:219], v[108:111]
    ds_read_b64_tr_b16 v[192:193], v235 offset:36864
    v_mfma_f32_16x16x32_bf16 v[112:115], v[172:175], v[216:219], v[112:115]
    ds_read_b64_tr_b16 v[194:195], v235 offset:38400
    v_mfma_f32_16x16x32_bf16 v[116:119], v[176:179], v[216:219], v[116:119]
    ds_read_b128 v[216:219], v238 offset:26624
    s_waitcnt lgkmcnt(5)
    v_mfma_f32_16x16x32_bf16 v[120:123], v[168:171], v[220:223], v[120:123]
    ds_read_b64_tr_b16 v[196:197], v236 offset:36864
    v_mfma_f32_16x16x32_bf16 v[124:127], v[172:175], v[220:223], v[124:127]
    ds_read_b64_tr_b16 v[198:199], v236 offset:38400
    v_mfma_f32_16x16x32_bf16 v[128:131], v[176:179], v[220:223], v[128:131]
    ds_read_b128 v[220:223], v239 offset:14336
    s_waitcnt lgkmcnt(7)
    v_mfma_f32_16x16x32_bf16 v[132:135], v[168:171], v[224:227], v[132:135]
    ds_read_b64_tr_b16 v[200:201], v237 offset:36864
    v_mfma_f32_16x16x32_bf16 v[136:139], v[172:175], v[224:227], v[136:139]
    ds_read_b64_tr_b16 v[202:203], v237 offset:38400
    v_mfma_f32_16x16x32_bf16 v[140:143], v[176:179], v[224:227], v[140:143]
    ds_read_b128 v[224:227], v239 offset:16384
    s_waitcnt lgkmcnt(9)
    v_mfma_f32_16x16x32_bf16 v[144:147], v[168:171], v[228:231], v[144:147]
    v_mfma_f32_16x16x32_bf16 v[148:151], v[172:175], v[228:231], v[148:151]
    v_mfma_f32_16x16x32_bf16 v[152:155], v[176:179], v[228:231], v[152:155]
    ds_read_b128 v[228:231], v239 offset:18432
    s_waitcnt lgkmcnt(7)
    v_mfma_f32_16x16x32_bf16 v[156:159], v[168:171], v[216:219], v[156:159]
    v_mfma_f32_16x16x32_bf16 v[160:163], v[172:175], v[216:219], v[160:163]
    v_mfma_f32_16x16x32_bf16 v[164:167], v[176:179], v[216:219], v[164:167]
    ds_read_b128 v[216:219], v239 offset:20480
    s_waitcnt lgkmcnt(5)
    v_mfma_f32_16x16x32_bf16 v[84:87], v[192:195], v[220:223], v[84:87]
    v_mfma_f32_16x16x32_bf16 v[88:91], v[196:199], v[220:223], v[88:91]
    s_waitcnt lgkmcnt(3)
    v_mfma_f32_16x16x32_bf16 v[92:95], v[200:203], v[220:223], v[92:95]
    ds_read_b128 v[220:223], v239 offset:22528
    s_waitcnt lgkmcnt(3)
    v_mfma_f32_16x16x32_bf16 v[96:99], v[192:195], v[224:227], v[96:99]
    s_barrier
    s_waitcnt vmcnt(14)
    s_add_u32 m0, s64, 122624
    s_add_u32 s62, s65, 147456
    buffer_load_dwordx4 v255, s[32:35], s62 offen offset:256 nt lds
    s_waitcnt vmcnt(14)
    s_add_u32 m0, s64, 126976
    s_add_u32 s62, s65, 135168
    buffer_load_dwordx4 v255, s[36:39], s62 offen nt lds
    s_waitcnt vmcnt(11)
    s_add_u32 m0, s64, 130944
    s_add_u32 s62, s65, 135168
    buffer_load_dwordx4 v255, s[36:39], s62 offen offset:128 nt lds
    s_add_u32 m0, s60, 79872
    s_add_u32 s62, s58, 7472256
    buffer_load_dwordx4 v243, s[40:43], s62 offen  lds
    buffer_load_dwordx4 v244, s[40:43], s62 offen offset:1024  lds
    buffer_load_dwordx4 v245, s[40:43], s62 offen offset:2048  lds
    v_mfma_f32_16x16x32_bf16 v[100:103], v[196:199], v[224:227], v[100:103]
    v_mfma_f32_16x16x32_bf16 v[104:107], v[200:203], v[224:227], v[104:107]
    ds_read_b128 v[224:227], v239 offset:24576
    s_waitcnt lgkmcnt(3)
    v_mfma_f32_16x16x32_bf16 v[108:111], v[192:195], v[228:231], v[108:111]
    ds_read_b64_tr_b16 v[168:169], v235 offset:0
    v_mfma_f32_16x16x32_bf16 v[112:115], v[196:199], v[228:231], v[112:115]
    ds_read_b64_tr_b16 v[170:171], v235 offset:1536
    v_mfma_f32_16x16x32_bf16 v[116:119], v[200:203], v[228:231], v[116:119]
    ds_read_b128 v[228:231], v239 offset:26624
    s_waitcnt lgkmcnt(5)
    v_mfma_f32_16x16x32_bf16 v[120:123], v[192:195], v[216:219], v[120:123]
    ds_read_b64_tr_b16 v[172:173], v236 offset:0
    v_mfma_f32_16x16x32_bf16 v[124:127], v[196:199], v[216:219], v[124:127]
    ds_read_b64_tr_b16 v[174:175], v236 offset:1536
    v_mfma_f32_16x16x32_bf16 v[128:131], v[200:203], v[216:219], v[128:131]
    ds_read_b128 v[216:219], v238 offset:28672
    s_waitcnt lgkmcnt(7)
    v_mfma_f32_16x16x32_bf16 v[132:135], v[192:195], v[220:223], v[132:135]
    ds_read_b64_tr_b16 v[176:177], v237 offset:0
    v_mfma_f32_16x16x32_bf16 v[136:139], v[196:199], v[220:223], v[136:139]
    ds_read_b64_tr_b16 v[178:179], v237 offset:1536
    v_mfma_f32_16x16x32_bf16 v[140:143], v[200:203], v[220:223], v[140:143]
    ds_read_b128 v[220:223], v238 offset:30720
    s_waitcnt lgkmcnt(9)
    v_mfma_f32_16x16x32_bf16 v[144:147], v[192:195], v[224:227], v[144:147]
    v_mfma_f32_16x16x32_bf16 v[148:151], v[196:199], v[224:227], v[148:151]
    v_mfma_f32_16x16x32_bf16 v[152:155], v[200:203], v[224:227], v[152:155]
    ds_read_b128 v[224:227], v238 offset:32768
    s_waitcnt lgkmcnt(7)
    v_mfma_f32_16x16x32_bf16 v[156:159], v[192:195], v[228:231], v[156:159]
    v_mfma_f32_16x16x32_bf16 v[160:163], v[196:199], v[228:231], v[160:163]
    v_mfma_f32_16x16x32_bf16 v[164:167], v[200:203], v[228:231], v[164:167]
    ds_read_b128 v[228:231], v238 offset:34816
    s_waitcnt lgkmcnt(5)
    v_mfma_f32_16x16x32_bf16 v[84:87], v[168:171], v[216:219], v[84:87]
    v_mfma_f32_16x16x32_bf16 v[88:91], v[172:175], v[216:219], v[88:91]
    s_waitcnt lgkmcnt(3)
    v_mfma_f32_16x16x32_bf16 v[92:95], v[176:179], v[216:219], v[92:95]
    ds_read_b128 v[216:219], v238 offset:36864
    s_waitcnt lgkmcnt(3)
    v_mfma_f32_16x16x32_bf16 v[96:99], v[168:171], v[220:223], v[96:99]
    s_barrier
    s_waitcnt vmcnt(14)
    s_add_u32 m0, s64, 134912
    s_add_u32 s62, s65, 135168
    buffer_load_dwordx4 v255, s[36:39], s62 offen offset:256 nt lds
    s_waitcnt vmcnt(14)
    s_add_u32 m0, s64, 139264
    s_add_u32 s62, s65, 159744
    buffer_load_dwordx4 v255, s[32:35], s62 offen nt lds
    s_waitcnt vmcnt(7)
    s_add_u32 m0, s64, 143232
    s_add_u32 s62, s65, 159744
    buffer_load_dwordx4 v255, s[32:35], s62 offen offset:128 nt lds
    v_mfma_f32_16x16x32_bf16 v[100:103], v[172:175], v[220:223], v[100:103]
    v_mfma_f32_16x16x32_bf16 v[104:107], v[176:179], v[220:223], v[104:107]
    ds_read_b128 v[220:223], v238 offset:38912
    s_waitcnt lgkmcnt(3)
    v_mfma_f32_16x16x32_bf16 v[108:111], v[168:171], v[224:227], v[108:111]
    ds_read_b64_tr_b16 v[192:193], v235 offset:12288
    v_mfma_f32_16x16x32_bf16 v[112:115], v[172:175], v[224:227], v[112:115]
    ds_read_b64_tr_b16 v[194:195], v235 offset:13824
    v_mfma_f32_16x16x32_bf16 v[116:119], v[176:179], v[224:227], v[116:119]
    ds_read_b128 v[224:227], v238 offset:40960
    s_waitcnt lgkmcnt(5)
    v_mfma_f32_16x16x32_bf16 v[120:123], v[168:171], v[228:231], v[120:123]
    ds_read_b64_tr_b16 v[196:197], v236 offset:12288
    v_mfma_f32_16x16x32_bf16 v[124:127], v[172:175], v[228:231], v[124:127]
    ds_read_b64_tr_b16 v[198:199], v236 offset:13824
    v_mfma_f32_16x16x32_bf16 v[128:131], v[176:179], v[228:231], v[128:131]
    ds_read_b128 v[228:231], v239 offset:28672
    s_waitcnt lgkmcnt(7)
    v_mfma_f32_16x16x32_bf16 v[132:135], v[168:171], v[216:219], v[132:135]
    ds_read_b64_tr_b16 v[200:201], v237 offset:12288
    v_mfma_f32_16x16x32_bf16 v[136:139], v[172:175], v[216:219], v[136:139]
    ds_read_b64_tr_b16 v[202:203], v237 offset:13824
    v_mfma_f32_16x16x32_bf16 v[140:143], v[176:179], v[216:219], v[140:143]
    ds_read_b128 v[216:219], v239 offset:30720
    s_waitcnt lgkmcnt(9)
    v_mfma_f32_16x16x32_bf16 v[144:147], v[168:171], v[220:223], v[144:147]
    v_mfma_f32_16x16x32_bf16 v[148:151], v[172:175], v[220:223], v[148:151]
    v_mfma_f32_16x16x32_bf16 v[152:155], v[176:179], v[220:223], v[152:155]
    ds_read_b128 v[220:223], v239 offset:32768
    s_waitcnt lgkmcnt(7)
    v_mfma_f32_16x16x32_bf16 v[156:159], v[168:171], v[224:227], v[156:159]
    v_mfma_f32_16x16x32_bf16 v[160:163], v[172:175], v[224:227], v[160:163]
    v_mfma_f32_16x16x32_bf16 v[164:167], v[176:179], v[224:227], v[164:167]
    ds_read_b128 v[224:227], v239 offset:34816
    s_waitcnt lgkmcnt(5)
    v_mfma_f32_16x16x32_bf16 v[84:87], v[192:195], v[228:231], v[84:87]
    v_mfma_f32_16x16x32_bf16 v[88:91], v[196:199], v[228:231], v[88:91]
    s_waitcnt lgkmcnt(3)
    v_mfma_f32_16x16x32_bf16 v[92:95], v[200:203], v[228:231], v[92:95]
    ds_read_b128 v[228:231], v239 offset:36864
    s_waitcnt lgkmcnt(3)
    v_mfma_f32_16x16x32_bf16 v[96:99], v[192:195], v[216:219], v[96:99]
    s_barrier
    s_waitcnt vmcnt(7)
    s_add_u32 m0, s64, 147200
    s_add_u32 s62, s65, 159744
    buffer_load_dwordx4 v255, s[32:35], s62 offen offset:256 nt lds
    s_waitcnt vmcnt(7)
    s_add_u32 m0, s64, 151552
    s_add_u32 s62, s65, 147456
    buffer_load_dwordx4 v255, s[36:39], s62 offen nt lds
    s_waitcnt vmcnt(4)
    s_add_u32 m0, s64, 155520
    s_add_u32 s62, s65, 147456
    buffer_load_dwordx4 v255, s[36:39], s62 offen offset:128 nt lds
    s_waitcnt vmcnt(4)
    s_add_u32 m0, s64, 93952
    s_add_u32 s62, s65, 147456
    buffer_load_dwordx4 v255, s[36:39], s62 offen offset:256 nt lds
    v_mfma_f32_16x16x32_bf16 v[100:103], v[196:199], v[216:219], v[100:103]
    v_mfma_f32_16x16x32_bf16 v[104:107], v[200:203], v[216:219], v[104:107]
    ds_read_b128 v[216:219], v239 offset:38912
    s_waitcnt lgkmcnt(3)
    v_mfma_f32_16x16x32_bf16 v[108:111], v[192:195], v[220:223], v[108:111]
    ds_read_b64_tr_b16 v[168:169], v235 offset:24576
    v_mfma_f32_16x16x32_bf16 v[112:115], v[196:199], v[220:223], v[112:115]
    ds_read_b64_tr_b16 v[170:171], v235 offset:26112
    v_mfma_f32_16x16x32_bf16 v[116:119], v[200:203], v[220:223], v[116:119]
    ds_read_b128 v[220:223], v239 offset:40960
    s_waitcnt lgkmcnt(5)
    v_mfma_f32_16x16x32_bf16 v[120:123], v[192:195], v[224:227], v[120:123]
    ds_read_b64_tr_b16 v[172:173], v236 offset:24576
    v_mfma_f32_16x16x32_bf16 v[124:127], v[196:199], v[224:227], v[124:127]
    ds_read_b64_tr_b16 v[174:175], v236 offset:26112
    v_mfma_f32_16x16x32_bf16 v[128:131], v[200:203], v[224:227], v[128:131]
    ds_read_b128 v[224:227], v238 offset:0
    s_waitcnt lgkmcnt(7)
    v_mfma_f32_16x16x32_bf16 v[132:135], v[192:195], v[228:231], v[132:135]
    ds_read_b64_tr_b16 v[176:177], v237 offset:24576
    v_mfma_f32_16x16x32_bf16 v[136:139], v[196:199], v[228:231], v[136:139]
    ds_read_b64_tr_b16 v[178:179], v237 offset:26112
    v_mfma_f32_16x16x32_bf16 v[140:143], v[200:203], v[228:231], v[140:143]
    ds_read_b128 v[228:231], v238 offset:2048
    s_waitcnt lgkmcnt(9)
    v_mfma_f32_16x16x32_bf16 v[144:147], v[192:195], v[216:219], v[144:147]
    v_mfma_f32_16x16x32_bf16 v[148:151], v[196:199], v[216:219], v[148:151]
    v_mfma_f32_16x16x32_bf16 v[152:155], v[200:203], v[216:219], v[152:155]
    ds_read_b128 v[216:219], v238 offset:4096
    s_waitcnt lgkmcnt(7)
    v_mfma_f32_16x16x32_bf16 v[156:159], v[192:195], v[220:223], v[156:159]
    v_mfma_f32_16x16x32_bf16 v[160:163], v[196:199], v[220:223], v[160:163]
    v_mfma_f32_16x16x32_bf16 v[164:167], v[200:203], v[220:223], v[164:167]
    ds_read_b128 v[220:223], v238 offset:6144
    s_waitcnt lgkmcnt(5)
    v_mfma_f32_16x16x32_bf16 v[84:87], v[168:171], v[224:227], v[84:87]
    v_mfma_f32_16x16x32_bf16 v[88:91], v[172:175], v[224:227], v[88:91]
    s_waitcnt lgkmcnt(3)
    v_mfma_f32_16x16x32_bf16 v[92:95], v[176:179], v[224:227], v[92:95]
    ds_read_b128 v[224:227], v238 offset:8192
    s_waitcnt lgkmcnt(3)
    v_mfma_f32_16x16x32_bf16 v[96:99], v[168:171], v[228:231], v[96:99]
    s_barrier
    s_waitcnt vmcnt(4)
    s_add_u32 m0, s64, 98304
    s_add_u32 s62, s65, 172032
    buffer_load_dwordx4 v255, s[32:35], s62 offen nt lds
    s_waitcnt vmcnt(4)
    s_add_u32 m0, s64, 102272
    s_add_u32 s62, s65, 172032
    buffer_load_dwordx4 v255, s[32:35], s62 offen offset:128 nt lds
    s_waitcnt vmcnt(4)
    s_add_u32 m0, s64, 106240
    s_add_u32 s62, s65, 172032
    buffer_load_dwordx4 v255, s[32:35], s62 offen offset:256 nt lds
    v_mfma_f32_16x16x32_bf16 v[100:103], v[172:175], v[228:231], v[100:103]
    v_mfma_f32_16x16x32_bf16 v[104:107], v[176:179], v[228:231], v[104:107]
    ds_read_b128 v[228:231], v238 offset:10240
    s_waitcnt lgkmcnt(3)
    v_mfma_f32_16x16x32_bf16 v[108:111], v[168:171], v[216:219], v[108:111]
    ds_read_b64_tr_b16 v[192:193], v235 offset:36864
    v_mfma_f32_16x16x32_bf16 v[112:115], v[172:175], v[216:219], v[112:115]
    ds_read_b64_tr_b16 v[194:195], v235 offset:38400
    v_mfma_f32_16x16x32_bf16 v[116:119], v[176:179], v[216:219], v[116:119]
    ds_read_b128 v[216:219], v238 offset:12288
    s_waitcnt lgkmcnt(5)
    v_mfma_f32_16x16x32_bf16 v[120:123], v[168:171], v[220:223], v[120:123]
    ds_read_b64_tr_b16 v[196:197], v236 offset:36864
    v_mfma_f32_16x16x32_bf16 v[124:127], v[172:175], v[220:223], v[124:127]
    ds_read_b64_tr_b16 v[198:199], v236 offset:38400
    v_mfma_f32_16x16x32_bf16 v[128:131], v[176:179], v[220:223], v[128:131]
    ds_read_b128 v[220:223], v239 offset:0
    s_waitcnt lgkmcnt(7)
    v_mfma_f32_16x16x32_bf16 v[132:135], v[168:171], v[224:227], v[132:135]
    ds_read_b64_tr_b16 v[200:201], v237 offset:36864
    v_mfma_f32_16x16x32_bf16 v[136:139], v[172:175], v[224:227], v[136:139]
    ds_read_b64_tr_b16 v[202:203], v237 offset:38400
    v_mfma_f32_16x16x32_bf16 v[140:143], v[176:179], v[224:227], v[140:143]
    ds_read_b128 v[224:227], v239 offset:2048
    s_waitcnt lgkmcnt(9)
    v_mfma_f32_16x16x32_bf16 v[144:147], v[168:171], v[228:231], v[144:147]
    v_mfma_f32_16x16x32_bf16 v[148:151], v[172:175], v[228:231], v[148:151]
    v_mfma_f32_16x16x32_bf16 v[152:155], v[176:179], v[228:231], v[152:155]
    ds_read_b128 v[228:231], v239 offset:4096
    s_waitcnt lgkmcnt(7)
    v_mfma_f32_16x16x32_bf16 v[156:159], v[168:171], v[216:219], v[156:159]
    v_mfma_f32_16x16x32_bf16 v[160:163], v[172:175], v[216:219], v[160:163]
    v_mfma_f32_16x16x32_bf16 v[164:167], v[176:179], v[216:219], v[164:167]
    ds_read_b128 v[216:219], v239 offset:6144
    s_waitcnt lgkmcnt(5)
    v_mfma_f32_16x16x32_bf16 v[84:87], v[192:195], v[220:223], v[84:87]
    v_mfma_f32_16x16x32_bf16 v[88:91], v[196:199], v[220:223], v[88:91]
    s_waitcnt lgkmcnt(3)
    v_mfma_f32_16x16x32_bf16 v[92:95], v[200:203], v[220:223], v[92:95]
    ds_read_b128 v[220:223], v239 offset:8192
    s_waitcnt lgkmcnt(3)
    v_mfma_f32_16x16x32_bf16 v[96:99], v[192:195], v[224:227], v[96:99]
    v_mfma_f32_16x16x32_bf16 v[100:103], v[196:199], v[224:227], v[100:103]
    s_nop 0
    v_pk_mul_f32 v[84:85], v[84:85], s[66:67]
    v_pk_mul_f32 v[86:87], v[86:87], s[66:67]
    v_cvt_pk_bf16_f32 v84, v84, v85
    v_cvt_pk_bf16_f32 v85, v86, v87
    v_mfma_f32_16x16x32_bf16 v[104:107], v[200:203], v[224:227], v[104:107]
    ds_read_b128 v[224:227], v239 offset:10240
    v_pk_mul_f32 v[88:89], v[88:89], s[66:67]
    v_pk_mul_f32 v[90:91], v[90:91], s[66:67]
    v_cvt_pk_bf16_f32 v88, v88, v89
    v_cvt_pk_bf16_f32 v89, v90, v91
    s_waitcnt lgkmcnt(3)
    v_mfma_f32_16x16x32_bf16 v[108:111], v[192:195], v[228:231], v[108:111]
    v_pk_mul_f32 v[92:93], v[92:93], s[66:67]
    v_pk_mul_f32 v[94:95], v[94:95], s[66:67]
    v_cvt_pk_bf16_f32 v92, v92, v93
    v_cvt_pk_bf16_f32 v93, v94, v95
    v_mfma_f32_16x16x32_bf16 v[112:115], v[196:199], v[228:231], v[112:115]
    v_pk_mul_f32 v[96:97], v[96:97], s[66:67]
    v_pk_mul_f32 v[98:99], v[98:99], s[66:67]
    v_cvt_pk_bf16_f32 v96, v96, v97
    v_cvt_pk_bf16_f32 v97, v98, v99
    v_mfma_f32_16x16x32_bf16 v[116:119], v[200:203], v[228:231], v[116:119]
    ds_read_b128 v[228:231], v239 offset:12288
    v_pk_mul_f32 v[100:101], v[100:101], s[66:67]
    v_pk_mul_f32 v[102:103], v[102:103], s[66:67]
    v_cvt_pk_bf16_f32 v100, v100, v101
    v_cvt_pk_bf16_f32 v101, v102, v103
    s_waitcnt lgkmcnt(3)
    v_mfma_f32_16x16x32_bf16 v[120:123], v[192:195], v[216:219], v[120:123]
    v_pk_mul_f32 v[104:105], v[104:105], s[66:67]
    v_pk_mul_f32 v[106:107], v[106:107], s[66:67]
    v_cvt_pk_bf16_f32 v104, v104, v105
    v_cvt_pk_bf16_f32 v105, v106, v107
    v_mfma_f32_16x16x32_bf16 v[124:127], v[196:199], v[216:219], v[124:127]
    v_pk_mul_f32 v[108:109], v[108:109], s[66:67]
    v_pk_mul_f32 v[110:111], v[110:111], s[66:67]
    v_cvt_pk_bf16_f32 v108, v108, v109
    v_cvt_pk_bf16_f32 v109, v110, v111
    v_mfma_f32_16x16x32_bf16 v[128:131], v[200:203], v[216:219], v[128:131]
    v_pk_mul_f32 v[112:113], v[112:113], s[66:67]
    v_pk_mul_f32 v[114:115], v[114:115], s[66:67]
    v_cvt_pk_bf16_f32 v112, v112, v113
    v_cvt_pk_bf16_f32 v113, v114, v115
    s_waitcnt lgkmcnt(2)
    v_mfma_f32_16x16x32_bf16 v[132:135], v[192:195], v[220:223], v[132:135]
    v_pk_mul_f32 v[116:117], v[116:117], s[66:67]
    v_pk_mul_f32 v[118:119], v[118:119], s[66:67]
    v_cvt_pk_bf16_f32 v116, v116, v117
    v_cvt_pk_bf16_f32 v117, v118, v119
    v_mfma_f32_16x16x32_bf16 v[136:139], v[196:199], v[220:223], v[136:139]
    v_pk_mul_f32 v[120:121], v[120:121], s[66:67]
    v_pk_mul_f32 v[122:123], v[122:123], s[66:67]
    v_cvt_pk_bf16_f32 v120, v120, v121
    v_cvt_pk_bf16_f32 v121, v122, v123
    v_mfma_f32_16x16x32_bf16 v[140:143], v[200:203], v[220:223], v[140:143]
    v_pk_mul_f32 v[124:125], v[124:125], s[66:67]
    v_pk_mul_f32 v[126:127], v[126:127], s[66:67]
    v_cvt_pk_bf16_f32 v124, v124, v125
    v_cvt_pk_bf16_f32 v125, v126, v127
    s_waitcnt lgkmcnt(1)
    v_mfma_f32_16x16x32_bf16 v[144:147], v[192:195], v[224:227], v[144:147]
    v_pk_mul_f32 v[128:129], v[128:129], s[66:67]
    v_pk_mul_f32 v[130:131], v[130:131], s[66:67]
    v_cvt_pk_bf16_f32 v128, v128, v129
    v_cvt_pk_bf16_f32 v129, v130, v131
    v_mfma_f32_16x16x32_bf16 v[148:151], v[196:199], v[224:227], v[148:151]
    v_pk_mul_f32 v[132:133], v[132:133], s[66:67]
    v_pk_mul_f32 v[134:135], v[134:135], s[66:67]
    v_cvt_pk_bf16_f32 v132, v132, v133
    v_cvt_pk_bf16_f32 v133, v134, v135
    v_mfma_f32_16x16x32_bf16 v[152:155], v[200:203], v[224:227], v[152:155]
    v_pk_mul_f32 v[136:137], v[136:137], s[66:67]
    v_pk_mul_f32 v[138:139], v[138:139], s[66:67]
    v_cvt_pk_bf16_f32 v136, v136, v137
    v_cvt_pk_bf16_f32 v137, v138, v139
    s_waitcnt lgkmcnt(0)
    v_mfma_f32_16x16x32_bf16 v[156:159], v[192:195], v[228:231], v[156:159]
    v_pk_mul_f32 v[140:141], v[140:141], s[66:67]
    v_pk_mul_f32 v[142:143], v[142:143], s[66:67]
    v_cvt_pk_bf16_f32 v140, v140, v141
    v_cvt_pk_bf16_f32 v141, v142, v143
    v_mfma_f32_16x16x32_bf16 v[160:163], v[196:199], v[228:231], v[160:163]
    v_pk_mul_f32 v[144:145], v[144:145], s[66:67]
    v_pk_mul_f32 v[146:147], v[146:147], s[66:67]
    v_cvt_pk_bf16_f32 v144, v144, v145
    v_cvt_pk_bf16_f32 v145, v146, v147
    v_mfma_f32_16x16x32_bf16 v[164:167], v[200:203], v[228:231], v[164:167]
    v_pk_mul_f32 v[148:149], v[148:149], s[66:67]
    v_pk_mul_f32 v[150:151], v[150:151], s[66:67]
    v_cvt_pk_bf16_f32 v148, v148, v149
    v_cvt_pk_bf16_f32 v149, v150, v151
    v_pk_mul_f32 v[152:153], v[152:153], s[66:67]
    v_pk_mul_f32 v[154:155], v[154:155], s[66:67]
    v_cvt_pk_bf16_f32 v152, v152, v153
    v_cvt_pk_bf16_f32 v153, v154, v155
    v_pk_mul_f32 v[156:157], v[156:157], s[66:67]
    v_pk_mul_f32 v[158:159], v[158:159], s[66:67]
    v_cvt_pk_bf16_f32 v156, v156, v157
    v_cvt_pk_bf16_f32 v157, v158, v159
    v_pk_mul_f32 v[160:161], v[160:161], s[66:67]
    v_pk_mul_f32 v[162:163], v[162:163], s[66:67]
    v_cvt_pk_bf16_f32 v160, v160, v161
    v_cvt_pk_bf16_f32 v161, v162, v163
    v_pk_mul_f32 v[164:165], v[164:165], s[66:67]
    v_pk_mul_f32 v[166:167], v[166:167], s[66:67]
    v_cvt_pk_bf16_f32 v164, v164, v165
    v_cvt_pk_bf16_f32 v165, v166, v167
    s_barrier
    s_waitcnt vmcnt(4)
    s_add_u32 m0, s64, 110592
    s_add_u32 s62, s65, 159744
    buffer_load_dwordx4 v255, s[36:39], s62 offen nt lds
    s_waitcnt vmcnt(4)
    s_add_u32 m0, s64, 114560
    s_add_u32 s62, s65, 159744
    buffer_load_dwordx4 v255, s[36:39], s62 offen offset:128 nt lds
    s_waitcnt vmcnt(4)
    s_add_u32 m0, s64, 118528
    s_add_u32 s62, s65, 159744
    buffer_load_dwordx4 v255, s[36:39], s62 offen offset:256 nt lds
    ds_write_b64 v240, v[84:85] offset:0
    ds_write_b64 v241, v[88:89] offset:0
    ds_write_b64 v242, v[92:93] offset:0
    ds_write_b64 v240, v[96:97] offset:1024
    ds_write_b64 v241, v[100:101] offset:1024
    ds_write_b64 v242, v[104:105] offset:1024
    ds_write_b64 v240, v[108:109] offset:2048
    ds_write_b64 v241, v[112:113] offset:2048
    ds_write_b64 v242, v[116:117] offset:2048
    ds_write_b64 v240, v[120:121] offset:3072
    ds_write_b64 v241, v[124:125] offset:3072
    ds_write_b64 v242, v[128:129] offset:3072
    ds_write_b64 v240, v[132:133] offset:4096
    ds_write_b64 v241, v[136:137] offset:4096
    ds_write_b64 v242, v[140:141] offset:4096
    ds_write_b64 v240, v[144:145] offset:5120
    ds_write_b64 v241, v[148:149] offset:5120
    ds_write_b64 v242, v[152:153] offset:5120
    ds_write_b64 v251, v[156:157] offset:0
    ds_write_b64 v252, v[160:161] offset:0
    ds_write_b64 v253, v[164:165] offset:0
    v_mov_b32 v232, 161024
    v_mov_b32 v234, 0
    v_mov_b32 v235, 0
    ds_write_b64 v232, v[234:235]
    ds_write_b64 v232, v[234:235] offset:8
    s_waitcnt lgkmcnt(0)
    s_barrier
    s_waitcnt vmcnt(4)
    s_add_u32 m0, s64, 122880
    s_add_u32 s62, s65, 184320
    buffer_load_dwordx4 v255, s[32:35], s62 offen nt lds
    s_waitcnt vmcnt(4)
    s_add_u32 m0, s64, 126848
    s_add_u32 s62, s65, 184320
    buffer_load_dwordx4 v255, s[32:35], s62 offen offset:128 nt lds
    s_waitcnt vmcnt(4)
    s_add_u32 m0, s64, 130816
    s_add_u32 s62, s65, 184320
    buffer_load_dwordx4 v255, s[32:35], s62 offen offset:256 nt lds
    s_barrier
    s_waitcnt vmcnt(4)
    s_add_u32 m0, s64, 135168
    s_add_u32 s62, s65, 172032
    buffer_load_dwordx4 v255, s[36:39], s62 offen nt lds
    s_waitcnt vmcnt(4)
    s_add_u32 m0, s64, 139136
    s_add_u32 s62, s65, 172032
    buffer_load_dwordx4 v255, s[36:39], s62 offen offset:128 nt lds
    s_waitcnt vmcnt(4)
    s_add_u32 m0, s64, 143104
    s_add_u32 s62, s65, 172032
    buffer_load_dwordx4 v255, s[36:39], s62 offen offset:256 nt lds
    ds_write_b64 v248, v[0:1] offset:0
    ds_write_b64 v249, v[4:5] offset:0
    ds_write_b64 v250, v[8:9] offset:0
    ds_write_b64 v248, v[12:13] offset:1024
    ds_write_b64 v249, v[16:17] offset:1024
    ds_write_b64 v250, v[20:21] offset:1024
    ds_write_b64 v248, v[24:25] offset:2048
    ds_write_b64 v249, v[28:29] offset:2048
    ds_write_b64 v250, v[32:33] offset:2048
    ds_write_b64 v248, v[36:37] offset:3072
    ds_write_b64 v249, v[40:41] offset:3072
    ds_write_b64 v250, v[44:45] offset:3072
    ds_write_b64 v248, v[48:49] offset:4096
    ds_write_b64 v249, v[52:53] offset:4096
    ds_write_b64 v250, v[56:57] offset:4096
    ds_write_b64 v248, v[60:61] offset:5120
    ds_write_b64 v249, v[64:65] offset:5120
    ds_write_b64 v250, v[68:69] offset:5120
    ds_write_b64 v248, v[72:73] offset:6144
    ds_write_b64 v249, v[76:77] offset:6144
    ds_write_b64 v250, v[80:81] offset:6144
    s_waitcnt lgkmcnt(0)
    s_mul_i32 s59, s56, 10240
    s_lshl_b32 s60, s56, 11
    v_mbcnt_lo_u32_b32 v232, -1, 0
    v_mbcnt_hi_u32_b32 v232, -1, v232
    v_and_b32 v233, 15, v232
    v_lshrrev_b32 v234, 4, v232
    v_lshrrev_b32 v235, 2, v232
    v_and_b32 v236, 3, v235
    v_and_b32 v237, 3, v232
    v_lshrrev_b32 v238, 3, v232
    v_and_b32 v239, 7, v232
    v_lshlrev_b32 v252, 4, v232
    v_lshlrev_b32 v240, 1, v234
    v_xor_b32 v240, v233, v240
    v_lshlrev_b32 v240, 4, v240
    v_mul_u32_u24 v241, 1280, v234
    v_add_u32 v253, v240, v241
    v_xor_b32 v240, 128, v240
    v_add_u32 v240, v240, v241
    v_add_u32 v254, 4096, v240
    s_lshl_b32 s62, s56, 1
    v_and_b32 v240, 7, v235
    v_xor_b32 v240, s62, v240
    v_lshlrev_b32 v240, 5, v240
    v_lshl_add_u32 v240, v235, 8, v240
    v_lshl_add_u32 v240, v237, 3, v240
    v_add_u32 v250, 43008, v240
    v_xor_b32 v251, 32, v250
    v_mov_b32 v112, v2
    v_mov_b32 v113, v3
    v_mov_b32 v114, v6
    v_mov_b32 v115, v7
    v_mov_b32 v116, v10
    v_mov_b32 v117, v11
    v_mov_b32 v118, v14
    v_mov_b32 v119, v15
    v_mov_b32 v120, v18
    v_mov_b32 v121, v19
    v_mov_b32 v122, v22
    v_mov_b32 v123, v23
    v_mov_b32 v124, v26
    v_mov_b32 v125, v27
    v_mov_b32 v126, v30
    v_mov_b32 v127, v31
    v_mov_b32 v128, v34
    v_mov_b32 v129, v35
    v_mov_b32 v130, v38
    v_mov_b32 v131, v39
    v_mov_b32 v132, v42
    v_mov_b32 v133, v43
    v_mov_b32 v134, v46
    v_mov_b32 v135, v47
    v_mov_b32 v136, v50
    v_mov_b32 v137, v51
    v_mov_b32 v138, v54
    v_mov_b32 v139, v55
    v_mov_b32 v236, v58
    v_mov_b32 v237, v59
    v_mov_b32 v238, v62
    v_mov_b32 v239, v63
    v_mov_b32 v240, v66
    v_mov_b32 v241, v67
    v_mov_b32 v242, v70
    v_mov_b32 v243, v71
    v_mov_b32 v244, v74
    v_mov_b32 v245, v75
    v_mov_b32 v246, v78
    v_mov_b32 v247, v79
    v_mov_b32 v248, v82
    v_mov_b32 v249, v83
    s_barrier
    s_waitcnt vmcnt(4)
    s_add_u32 m0, s64, 147456
    s_add_u32 s62, s65, 184320
    buffer_load_dwordx4 v255, s[36:39], s62 offen nt lds
    s_waitcnt vmcnt(4)
    s_add_u32 m0, s64, 151424
    s_add_u32 s62, s65, 184320
    buffer_load_dwordx4 v255, s[36:39], s62 offen offset:128 nt lds
    s_waitcnt vmcnt(4)
    s_add_u32 m0, s64, 155392
    s_add_u32 s62, s65, 184320
    buffer_load_dwordx4 v255, s[36:39], s62 offen offset:256 nt lds
    s_waitcnt vmcnt(4)
    s_add_u32 m0, s64, 94208
    s_add_u32 s62, s65, 196608
    buffer_load_dwordx4 v255, s[32:35], s62 offen nt lds
    s_barrier
    s_waitcnt vmcnt(4)
    s_add_u32 m0, s64, 98176
    s_add_u32 s62, s65, 196608
    buffer_load_dwordx4 v255, s[32:35], s62 offen offset:128 nt lds
    s_waitcnt vmcnt(4)
    s_add_u32 m0, s64, 102144
    s_add_u32 s62, s65, 196608
    buffer_load_dwordx4 v255, s[32:35], s62 offen offset:256 nt lds
    s_waitcnt vmcnt(4)
    s_add_u32 m0, s64, 106496
    s_add_u32 s62, s65, 208896
    buffer_load_dwordx4 v255, s[32:35], s62 offen nt lds
    s_add_u32 m0, s60, 59392
    s_add_u32 s63, s59, 81920
    buffer_load_dwordx4 v253, s[44:47], s63 offen  lds
    buffer_load_dwordx4 v254, s[44:47], s63 offen offset:1024  lds
    s_barrier
    s_waitcnt vmcnt(6)
    s_add_u32 m0, s64, 110464
    s_add_u32 s62, s65, 208896
    buffer_load_dwordx4 v255, s[32:35], s62 offen offset:128 nt lds
    s_waitcnt vmcnt(6)
    s_add_u32 m0, s64, 114432
    s_add_u32 s62, s65, 208896
    buffer_load_dwordx4 v255, s[32:35], s62 offen offset:256 nt lds
    s_waitcnt vmcnt(6)
    s_add_u32 m0, s64, 118784
    s_add_u32 s62, s65, 196608
    buffer_load_dwordx4 v255, s[36:39], s62 offen nt lds
    s_add_u32 m0, s60, 67584
    s_add_u32 s63, s59, 122880
    buffer_load_dwordx4 v253, s[44:47], s63 offen  lds
    buffer_load_dwordx4 v254, s[44:47], s63 offen offset:1024  lds
    s_barrier
    s_waitcnt vmcnt(8)
    s_add_u32 m0, s64, 122752
    s_add_u32 s62, s65, 196608
    buffer_load_dwordx4 v255, s[36:39], s62 offen offset:128 nt lds
    s_waitcnt vmcnt(8)
    s_add_u32 m0, s64, 126720
    s_add_u32 s62, s65, 196608
    buffer_load_dwordx4 v255, s[36:39], s62 offen offset:256 nt lds
    s_waitcnt vmcnt(6)
    s_add_u32 m0, s64, 131072
    s_add_u32 s62, s65, 221184
    buffer_load_dwordx4 v255, s[32:35], s62 offen nt lds
    s_add_u32 m0, s60, 43008
    s_add_u32 s63, s59, 0
    buffer_load_dwordx4 v253, s[44:47], s63 offen  lds
    buffer_load_dwordx4 v254, s[44:47], s63 offen offset:1024  lds
    s_barrier
    s_waitcnt vmcnt(8)
    s_add_u32 m0, s64, 135040
    s_add_u32 s62, s65, 221184
    buffer_load_dwordx4 v255, s[32:35], s62 offen offset:128 nt lds
    s_waitcnt vmcnt(8)
    s_add_u32 m0, s64, 139008
    s_add_u32 s62, s65, 221184
    buffer_load_dwordx4 v255, s[32:35], s62 offen offset:256 nt lds
    s_waitcnt vmcnt(6)
    s_add_u32 m0, s64, 143360
    s_add_u32 s62, s65, 208896
    buffer_load_dwordx4 v255, s[36:39], s62 offen nt lds
    s_add_u32 m0, s60, 51200
    s_add_u32 s63, s59, 40960
    buffer_load_dwordx4 v253, s[44:47], s63 offen  lds
    buffer_load_dwordx4 v254, s[44:47], s63 offen offset:1024  lds
t1_slot:
    s_add_u32 s55, s55, 1
    s_add_u32 s65, s65, 196608
    s_cmp_eq_u32 s55, 2
    s_cselect_b32 s69, 0x0c0c0c0c, s14
    s_cselect_b32 s72, 0x0c0c0c0c, s15
    s_barrier
    s_add_u32 m0, s64, 147328
    s_add_u32 s62, s65, 12288
    buffer_load_dwordx4 v255, s[36:39], s62 offen offset:128 nt lds
    s_add_u32 m0, s64, 151296
    s_add_u32 s62, s65, 12288
    buffer_load_dwordx4 v255, s[36:39], s62 offen offset:256 nt lds
    s_add_u32 m0, s64, 155648
    s_add_u32 s62, s65, 36864
    buffer_load_dwordx4 v255, s[32:35], s62 offen nt lds
    s_and_b32 s62, s53, 15
    s_lshl_b32 s62, s62, 2
    s_add_u32 s62, s62, s56
    s_mul_i32 s62, s62, 3840
    s_sub_u32 s63, s55, 1
    s_mul_i32 s63, s63, 245760
    s_add_u32 s62, s62, s63
    s_mov_b32 m0, 159744
    v_mbcnt_lo_u32_b32 v196, -1, 0
    v_mbcnt_hi_u32_b32 v196, -1, v196
    v_min_u32 v196, 29, v196
    v_lshlrev_b32 v196, 7, v196
    buffer_load_dword v196, s[44:47], s62 offen  lds
    v_perm_b32 v140, v0, v0, s69
    v_perm_b32 v141, v0, v0, s72
    v_perm_b32 v142, v1, v1, s69
    v_perm_b32 v143, v1, v1, s72
    v_perm_b32 v144, v2, v2, s69
    v_perm_b32 v145, v2, v2, s72
    v_perm_b32 v146, v3, v3, s69
    v_perm_b32 v147, v3, v3, s72
    v_perm_b32 v148, v4, v4, s69
    v_perm_b32 v149, v4, v4, s72
    v_perm_b32 v150, v5, v5, s69
    v_perm_b32 v151, v5, v5, s72
    v_perm_b32 v152, v6, v6, s69
    v_perm_b32 v153, v6, v6, s72
    v_perm_b32 v154, v7, v7, s69
    v_perm_b32 v155, v7, v7, s72
    v_perm_b32 v156, v8, v8, s69
    v_perm_b32 v157, v8, v8, s72
    v_perm_b32 v158, v9, v9, s69
    v_perm_b32 v159, v9, v9, s72
    v_perm_b32 v160, v10, v10, s69
    v_perm_b32 v161, v10, v10, s72
    v_perm_b32 v162, v11, v11, s69
    v_perm_b32 v163, v11, v11, s72
    v_perm_b32 v164, v12, v12, s69
    v_perm_b32 v165, v12, v12, s72
    v_perm_b32 v166, v13, v13, s69
    v_perm_b32 v167, v13, v13, s72
    v_perm_b32 v168, v14, v14, s69
    v_perm_b32 v169, v14, v14, s72
    v_perm_b32 v170, v15, v15, s69
    v_perm_b32 v171, v15, v15, s72
    v_perm_b32 v172, v16, v16, s69
    v_perm_b32 v173, v16, v16, s72
    v_perm_b32 v174, v17, v17, s69
    v_perm_b32 v175, v17, v17, s72
    v_perm_b32 v176, v18, v18, s69
    v_perm_b32 v177, v18, v18, s72
    v_perm_b32 v178, v19, v19, s69
    v_perm_b32 v179, v19, v19, s72
    v_perm_b32 v180, v20, v20, s69
    v_perm_b32 v181, v20, v20, s72
    v_perm_b32 v182, v21, v21, s69
    v_perm_b32 v183, v21, v21, s72
    v_perm_b32 v184, v22, v22, s69
    v_perm_b32 v185, v22, v22, s72
    v_perm_b32 v186, v23, v23, s69
    v_perm_b32 v187, v23, v23, s72
    v_perm_b32 v188, v24, v24, s69
    v_perm_b32 v189, v24, v24, s72
    v_perm_b32 v190, v25, v25, s69
    v_perm_b32 v191, v25, v25, s72
    v_perm_b32 v192, v26, v26, s69
    v_perm_b32 v193, v26, v26, s72
    v_perm_b32 v194, v27, v27, s69
    v_perm_b32 v195, v27, v27, s72
    s_waitcnt vmcnt(9)
    s_barrier
    ds_read_b64_tr_b16 v[196:197], v250 offset:0
    ds_read_b64_tr_b16 v[198:199], v250 offset:4096
    ds_read_b128 v[212:215], v252 offset:0
    ds_read_b64_tr_b16 v[200:201], v251 offset:0
    ds_read_b64_tr_b16 v[202:203], v251 offset:4096
    ds_read_b128 v[216:219], v252 offset:1024
    ds_read_b128 v[220:223], v252 offset:2048
    ds_read_b128 v[224:227], v252 offset:3072
    ds_read_b128 v[228:231], v252 offset:4096
    ds_read_b128 v[232:235], v252 offset:5120
    s_waitcnt lgkmcnt(7)
    v_mfma_f32_16x16x32_bf16 v[140:143], v[196:199], v[212:215], v[140:143]
    s_waitcnt lgkmcnt(5)
    v_mfma_f32_16x16x32_bf16 v[144:147], v[200:203], v[212:215], v[144:147]
    ds_read_b128 v[212:215], v252 offset:6144
    s_waitcnt lgkmcnt(5)
    v_mfma_f32_16x16x32_bf16 v[148:151], v[196:199], v[216:219], v[148:151]
    s_waitcnt vmcnt(4)
    s_barrier
    s_add_u32 m0, s64, 94080
    s_add_u32 s62, s65, 36864
    buffer_load_dwordx4 v255, s[32:35], s62 offen offset:128 nt lds
    s_add_u32 m0, s60, 43008
    s_add_u32 s63, s59, 163840
    buffer_load_dwordx4 v253, s[44:47], s63 offen  lds
    buffer_load_dwordx4 v254, s[44:47], s63 offen offset:1024  lds
    v_mfma_f32_16x16x32_bf16 v[152:155], v[200:203], v[216:219], v[152:155]
    ds_read_b128 v[216:219], v252 offset:7168
    s_waitcnt lgkmcnt(5)
    v_mfma_f32_16x16x32_bf16 v[156:159], v[196:199], v[220:223], v[156:159]
    ds_read_b64_tr_b16 v[204:205], v250 offset:8192
    v_mfma_f32_16x16x32_bf16 v[160:163], v[200:203], v[220:223], v[160:163]
    ds_read_b128 v[220:223], v252 offset:8192
    s_waitcnt lgkmcnt(6)
    v_mfma_f32_16x16x32_bf16 v[164:167], v[196:199], v[224:227], v[164:167]
    ds_read_b64_tr_b16 v[206:207], v250 offset:12288
    v_mfma_f32_16x16x32_bf16 v[168:171], v[200:203], v[224:227], v[168:171]
    ds_read_b128 v[224:227], v252 offset:9216
    s_waitcnt lgkmcnt(7)
    v_mfma_f32_16x16x32_bf16 v[172:175], v[196:199], v[228:231], v[172:175]
    ds_read_b64_tr_b16 v[208:209], v251 offset:8192
    v_mfma_f32_16x16x32_bf16 v[176:179], v[200:203], v[228:231], v[176:179]
    ds_read_b128 v[228:231], v252 offset:10240
    s_waitcnt lgkmcnt(8)
    v_mfma_f32_16x16x32_bf16 v[180:183], v[196:199], v[232:235], v[180:183]
    ds_read_b64_tr_b16 v[210:211], v251 offset:12288
    v_mfma_f32_16x16x32_bf16 v[184:187], v[200:203], v[232:235], v[184:187]
    ds_read_b128 v[232:235], v252 offset:11264
    s_waitcnt lgkmcnt(9)
    v_mfma_f32_16x16x32_bf16 v[188:191], v[196:199], v[212:215], v[188:191]
    v_mfma_f32_16x16x32_bf16 v[192:195], v[200:203], v[212:215], v[192:195]
    ds_read_b128 v[212:215], v252 offset:12288
    s_waitcnt lgkmcnt(6)
    v_mfma_f32_16x16x32_bf16 v[140:143], v[204:207], v[216:219], v[140:143]
    s_waitcnt lgkmcnt(2)
    v_mfma_f32_16x16x32_bf16 v[144:147], v[208:211], v[216:219], v[144:147]
    ds_read_b128 v[216:219], v252 offset:13312
    v_mfma_f32_16x16x32_bf16 v[148:151], v[204:207], v[220:223], v[148:151]
    s_barrier
    s_waitcnt vmcnt(6)
    s_add_u32 m0, s64, 98048
    s_add_u32 s62, s65, 36864
    buffer_load_dwordx4 v255, s[32:35], s62 offen offset:256 nt lds
    s_waitcnt vmcnt(6)
    s_add_u32 m0, s64, 102400
    s_add_u32 s62, s65, 24576
    buffer_load_dwordx4 v255, s[36:39], s62 offen nt lds
    s_waitcnt vmcnt(6)
    s_add_u32 m0, s64, 106368
    s_add_u32 s62, s65, 24576
    buffer_load_dwordx4 v255, s[36:39], s62 offen offset:128 nt lds
    s_add_u32 m0, s60, 51200
    s_add_u32 s63, s59, 204800
    buffer_load_dwordx4 v253, s[44:47], s63 offen  lds
    buffer_load_dwordx4 v254, s[44:47], s63 offen offset:1024  lds
    v_mfma_f32_16x16x32_bf16 v[152:155], v[208:211], v[220:223], v[152:155]
    ds_read_b128 v[220:223], v252 offset:14336
    v_mfma_f32_16x16x32_bf16 v[156:159], v[204:207], v[224:227], v[156:159]
    ds_read_b64_tr_b16 v[196:197], v250 offset:16384
    v_mfma_f32_16x16x32_bf16 v[160:163], v[208:211], v[224:227], v[160:163]
    ds_read_b128 v[224:227], v252 offset:15360
    v_mfma_f32_16x16x32_bf16 v[164:167], v[204:207], v[228:231], v[164:167]
    ds_read_b64_tr_b16 v[198:199], v250 offset:20480
    v_mfma_f32_16x16x32_bf16 v[168:171], v[208:211], v[228:231], v[168:171]
    ds_read_b128 v[228:231], v252 offset:16384
    s_waitcnt lgkmcnt(7)
    v_mfma_f32_16x16x32_bf16 v[172:175], v[204:207], v[232:235], v[172:175]
    ds_read_b64_tr_b16 v[200:201], v251 offset:16384
    v_mfma_f32_16x16x32_bf16 v[176:179], v[208:211], v[232:235], v[176:179]
    ds_read_b128 v[232:235], v252 offset:17408
    s_waitcnt lgkmcnt(8)
    v_mfma_f32_16x16x32_bf16 v[180:183], v[204:207], v[212:215], v[180:183]
    ds_read_b64_tr_b16 v[202:203], v251 offset:20480
    v_mfma_f32_16x16x32_bf16 v[184:187], v[208:211], v[212:215], v[184:187]
    ds_read_b128 v[212:215], v252 offset:18432
    s_waitcnt lgkmcnt(9)
    v_mfma_f32_16x16x32_bf16 v[188:191], v[204:207], v[216:219], v[188:191]
    v_mfma_f32_16x16x32_bf16 v[192:195], v[208:211], v[216:219], v[192:195]
    ds_read_b128 v[216:219], v252 offset:19456
    s_waitcnt lgkmcnt(6)
    v_mfma_f32_16x16x32_bf16 v[140:143], v[196:199], v[220:223], v[140:143]
    s_waitcnt lgkmcnt(2)
    v_mfma_f32_16x16x32_bf16 v[144:147], v[200:203], v[220:223], v[144:147]
    ds_read_b128 v[220:223], v252 offset:20480
    v_mfma_f32_16x16x32_bf16 v[148:151], v[196:199], v[224:227], v[148:151]
    s_barrier
    s_waitcnt vmcnt(7)
    s_add_u32 m0, s64, 110336
    s_add_u32 s62, s65, 24576
    buffer_load_dwordx4 v255, s[36:39], s62 offen offset:256 nt lds
    s_waitcnt vmcnt(5)
    s_add_u32 m0, s64, 114688
    s_add_u32 s62, s65, 49152
    buffer_load_dwordx4 v255, s[32:35], s62 offen nt lds
    s_waitcnt vmcnt(5)
    s_add_u32 m0, s64, 118656
    s_add_u32 s62, s65, 49152
    buffer_load_dwordx4 v255, s[32:35], s62 offen offset:128 nt lds
    s_add_u32 m0, s60, 59392
    s_add_u32 s63, s59, 256
    buffer_load_dwordx4 v253, s[44:47], s63 offen  lds
    buffer_load_dwordx4 v254, s[44:47], s63 offen offset:1024  lds
    v_mfma_f32_16x16x32_bf16 v[152:155], v[200:203], v[224:227], v[152:155]
    ds_read_b128 v[224:227], v252 offset:21504
    v_mfma_f32_16x16x32_bf16 v[156:159], v[196:199], v[228:231], v[156:159]
    ds_read_b64_tr_b16 v[204:205], v250 offset:24576
    v_mfma_f32_16x16x32_bf16 v[160:163], v[200:203], v[228:231], v[160:163]
    ds_read_b128 v[228:231], v252 offset:22528
    v_mfma_f32_16x16x32_bf16 v[164:167], v[196:199], v[232:235], v[164:167]
    ds_read_b64_tr_b16 v[206:207], v250 offset:28672
    v_mfma_f32_16x16x32_bf16 v[168:171], v[200:203], v[232:235], v[168:171]
    ds_read_b128 v[232:235], v252 offset:23552
    s_waitcnt lgkmcnt(7)
    v_mfma_f32_16x16x32_bf16 v[172:175], v[196:199], v[212:215], v[172:175]
    ds_read_b64_tr_b16 v[208:209], v251 offset:24576
    v_mfma_f32_16x16x32_bf16 v[176:179], v[200:203], v[212:215], v[176:179]
    ds_read_b128 v[212:215], v252 offset:24576
    s_waitcnt lgkmcnt(8)
    v_mfma_f32_16x16x32_bf16 v[180:183], v[196:199], v[216:219], v[180:183]
    ds_read_b64_tr_b16 v[210:211], v251 offset:28672
    v_mfma_f32_16x16x32_bf16 v[184:187], v[200:203], v[216:219], v[184:187]
    ds_read_b128 v[216:219], v252 offset:25600
    s_waitcnt lgkmcnt(9)
    v_mfma_f32_16x16x32_bf16 v[188:191], v[196:199], v[220:223], v[188:191]
    v_mfma_f32_16x16x32_bf16 v[192:195], v[200:203], v[220:223], v[192:195]
    ds_read_b128 v[220:223], v252 offset:26624
    s_waitcnt lgkmcnt(6)
    v_mfma_f32_16x16x32_bf16 v[140:143], v[204:207], v[224:227], v[140:143]
    s_waitcnt lgkmcnt(2)
    v_mfma_f32_16x16x32_bf16 v[144:147], v[208:211], v[224:227], v[144:147]
    ds_read_b128 v[224:227], v252 offset:27648
    v_mfma_f32_16x16x32_bf16 v[148:151], v[204:207], v[228:231], v[148:151]
    s_barrier
    s_waitcnt vmcnt(7)
    s_add_u32 m0, s64, 122624
    s_add_u32 s62, s65, 49152
    buffer_load_dwordx4 v255, s[32:35], s62 offen offset:256 nt lds
    s_waitcnt vmcnt(5)
    s_add_u32 m0, s64, 126976
    s_add_u32 s62, s65, 36864
    buffer_load_dwordx4 v255, s[36:39], s62 offen nt lds
    s_waitcnt vmcnt(5)
    s_add_u32 m0, s64, 130944
    s_add_u32 s62, s65, 36864
    buffer_load_dwordx4 v255, s[36:39], s62 offen offset:128 nt lds
    s_add_u32 m0, s60, 67584
    s_add_u32 s63, s59, 41216
    buffer_load_dwordx4 v253, s[44:47], s63 offen  lds
    buffer_load_dwordx4 v254, s[44:47], s63 offen offset:1024  lds
    v_mfma_f32_16x16x32_bf16 v[152:155], v[208:211], v[228:231], v[152:155]
    ds_read_b128 v[228:231], v252 offset:28672
    v_mfma_f32_16x16x32_bf16 v[156:159], v[204:207], v[232:235], v[156:159]
    ds_read_b64_tr_b16 v[196:197], v250 offset:0
    v_mfma_f32_16x16x32_bf16 v[160:163], v[208:211], v[232:235], v[160:163]
    ds_read_b128 v[232:235], v252 offset:29696
    v_mfma_f32_16x16x32_bf16 v[164:167], v[204:207], v[212:215], v[164:167]
    ds_read_b64_tr_b16 v[198:199], v250 offset:4096
    v_mfma_f32_16x16x32_bf16 v[168:171], v[208:211], v[212:215], v[168:171]
    ds_read_b128 v[212:215], v252 offset:30720
    s_waitcnt lgkmcnt(7)
    v_mfma_f32_16x16x32_bf16 v[172:175], v[204:207], v[216:219], v[172:175]
    ds_read_b64_tr_b16 v[200:201], v251 offset:0
    v_mfma_f32_16x16x32_bf16 v[176:179], v[208:211], v[216:219], v[176:179]
    ds_read_b128 v[216:219], v252 offset:31744
    s_waitcnt lgkmcnt(8)
    v_mfma_f32_16x16x32_bf16 v[180:183], v[204:207], v[220:223], v[180:183]
    ds_read_b64_tr_b16 v[202:203], v251 offset:4096
    v_mfma_f32_16x16x32_bf16 v[184:187], v[208:211], v[220:223], v[184:187]
    ds_read_b128 v[220:223], v252 offset:32768
    s_waitcnt lgkmcnt(9)
    v_mfma_f32_16x16x32_bf16 v[188:191], v[204:207], v[224:227], v[188:191]
    v_mfma_f32_16x16x32_bf16 v[192:195], v[208:211], v[224:227], v[192:195]
    ds_read_b128 v[224:227], v252 offset:33792
    s_waitcnt lgkmcnt(6)
    v_mfma_f32_16x16x32_bf16 v[140:143], v[196:199], v[228:231], v[140:143]
    s_waitcnt lgkmcnt(2)
    v_mfma_f32_16x16x32_bf16 v[144:147], v[200:203], v[228:231], v[144:147]
    ds_read_b128 v[228:231], v252 offset:34816
    v_mfma_f32_16x16x32_bf16 v[148:151], v[196:199], v[232:235], v[148:151]
    s_barrier
    s_waitcnt vmcnt(7)
    s_add_u32 m0, s64, 134912
    s_add_u32 s62, s65, 36864
    buffer_load_dwordx4 v255, s[36:39], s62 offen offset:256 nt lds
    s_waitcnt vmcnt(5)
    s_add_u32 m0, s64, 139264
    s_add_u32 s62, s65, 61440
    buffer_load_dwordx4 v255, s[32:35], s62 offen nt lds
    s_waitcnt vmcnt(5)
    s_add_u32 m0, s64, 143232
    s_add_u32 s62, s65, 61440
    buffer_load_dwordx4 v255, s[32:35], s62 offen offset:128 nt lds
    s_add_u32 m0, s60, 43008
    s_add_u32 s63, s59, 82176
    buffer_load_dwordx4 v253, s[44:47], s63 offen  lds
    buffer_load_dwordx4 v254, s[44:47], s63 offen offset:1024  lds
    v_mfma_f32_16x16x32_bf16 v[152:155], v[200:203], v[232:235], v[152:155]
    ds_read_b128 v[232:235], v252 offset:35840
    v_mfma_f32_16x16x32_bf16 v[156:159], v[196:199], v[212:215], v[156:159]
    ds_read_b64_tr_b16 v[204:205], v250 offset:8192
    v_mfma_f32_16x16x32_bf16 v[160:163], v[200:203], v[212:215], v[160:163]
    ds_read_b128 v[212:215], v252 offset:36864
    v_mfma_f32_16x16x32_bf16 v[164:167], v[196:199], v[216:219], v[164:167]
    ds_read_b64_tr_b16 v[206:207], v250 offset:12288
    v_mfma_f32_16x16x32_bf16 v[168:171], v[200:203], v[216:219], v[168:171]
    ds_read_b128 v[216:219], v252 offset:37888
    s_waitcnt lgkmcnt(7)
    v_mfma_f32_16x16x32_bf16 v[172:175], v[196:199], v[220:223], v[172:175]
    ds_read_b64_tr_b16 v[208:209], v251 offset:8192
    v_mfma_f32_16x16x32_bf16 v[176:179], v[200:203], v[220:223], v[176:179]
    ds_read_b128 v[220:223], v252 offset:38912
    s_waitcnt lgkmcnt(8)
    v_mfma_f32_16x16x32_bf16 v[180:183], v[196:199], v[224:227], v[180:183]
    ds_read_b64_tr_b16 v[210:211], v251 offset:12288
    v_mfma_f32_16x16x32_bf16 v[184:187], v[200:203], v[224:227], v[184:187]
    ds_read_b128 v[224:227], v252 offset:39936
    s_waitcnt lgkmcnt(9)
    v_mfma_f32_16x16x32_bf16 v[188:191], v[196:199], v[228:231], v[188:191]
    v_mfma_f32_16x16x32_bf16 v[192:195], v[200:203], v[228:231], v[192:195]
    ds_read_b128 v[228:231], v252 offset:40960
    s_waitcnt lgkmcnt(6)
    v_mfma_f32_16x16x32_bf16 v[140:143], v[204:207], v[232:235], v[140:143]
    s_waitcnt lgkmcnt(2)
    v_mfma_f32_16x16x32_bf16 v[144:147], v[208:211], v[232:235], v[144:147]
    ds_read_b128 v[232:235], v252 offset:41984
    v_mfma_f32_16x16x32_bf16 v[148:151], v[204:207], v[212:215], v[148:151]
    s_barrier
    s_waitcnt vmcnt(7)
    s_add_u32 m0, s64, 147200
    s_add_u32 s62, s65, 61440
    buffer_load_dwordx4 v255, s[32:35], s62 offen offset:256 nt lds
    s_waitcnt vmcnt(5)
    s_add_u32 m0, s64, 151552
    s_add_u32 s62, s65, 49152
    buffer_load_dwordx4 v255, s[36:39], s62 offen nt lds
    s_waitcnt vmcnt(5)
    s_add_u32 m0, s64, 155520
    s_add_u32 s62, s65, 49152
    buffer_load_dwordx4 v255, s[36:39], s62 offen offset:128 nt lds
    s_waitcnt vmcnt(5)
    s_add_u32 m0, s64, 93952
    s_add_u32 s62, s65, 49152
    buffer_load_dwordx4 v255, s[36:39], s62 offen offset:256 nt lds
    s_add_u32 m0, s60, 51200
    s_add_u32 s63, s59, 123136
    buffer_load_dwordx4 v253, s[44:47], s63 offen  lds
    buffer_load_dwordx4 v254, s[44:47], s63 offen offset:1024  lds
    v_mfma_f32_16x16x32_bf16 v[152:155], v[208:211], v[212:215], v[152:155]
    ds_read_b128 v[212:215], v252 offset:0
    v_cvt_pk_bf16_f32 v0, v140, v141
    v_cvt_pk_bf16_f32 v1, v142, v143
    v_perm_b32 v140, v28, v28, s69
    v_perm_b32 v141, v28, v28, s72
    v_perm_b32 v142, v29, v29, s69
    v_perm_b32 v143, v29, v29, s72
    v_mfma_f32_16x16x32_bf16 v[156:159], v[204:207], v[216:219], v[156:159]
    ds_read_b64_tr_b16 v[196:197], v250 offset:16384
    v_cvt_pk_bf16_f32 v2, v144, v145
    v_cvt_pk_bf16_f32 v3, v146, v147
    v_perm_b32 v144, v30, v30, s69
    v_perm_b32 v145, v30, v30, s72
    v_perm_b32 v146, v31, v31, s69
    v_perm_b32 v147, v31, v31, s72
    v_mfma_f32_16x16x32_bf16 v[160:163], v[208:211], v[216:219], v[160:163]
    ds_read_b128 v[216:219], v252 offset:1024
    v_cvt_pk_bf16_f32 v4, v148, v149
    v_cvt_pk_bf16_f32 v5, v150, v151
    v_perm_b32 v148, v32, v32, s69
    v_perm_b32 v149, v32, v32, s72
    v_perm_b32 v150, v33, v33, s69
    v_perm_b32 v151, v33, v33, s72
    v_mfma_f32_16x16x32_bf16 v[164:167], v[204:207], v[220:223], v[164:167]
    ds_read_b64_tr_b16 v[198:199], v250 offset:20480
    v_mfma_f32_16x16x32_bf16 v[168:171], v[208:211], v[220:223], v[168:171]
    ds_read_b128 v[220:223], v252 offset:2048
    s_waitcnt lgkmcnt(7)
    v_mfma_f32_16x16x32_bf16 v[172:175], v[204:207], v[224:227], v[172:175]
    ds_read_b64_tr_b16 v[200:201], v251 offset:16384
    v_mfma_f32_16x16x32_bf16 v[176:179], v[208:211], v[224:227], v[176:179]
    ds_read_b128 v[224:227], v252 offset:3072
    s_waitcnt lgkmcnt(8)
    v_mfma_f32_16x16x32_bf16 v[180:183], v[204:207], v[228:231], v[180:183]
    ds_read_b64_tr_b16 v[202:203], v251 offset:20480
    v_mfma_f32_16x16x32_bf16 v[184:187], v[208:211], v[228:231], v[184:187]
    ds_read_b128 v[228:231], v252 offset:4096
    s_waitcnt lgkmcnt(9)
    v_mfma_f32_16x16x32_bf16 v[188:191], v[204:207], v[232:235], v[188:191]
    v_mfma_f32_16x16x32_bf16 v[192:195], v[208:211], v[232:235], v[192:195]
    ds_read_b128 v[232:235], v252 offset:5120
    s_waitcnt lgkmcnt(6)
    v_mfma_f32_16x16x32_bf16 v[140:143], v[196:199], v[212:215], v[140:143]
    s_waitcnt lgkmcnt(2)
    v_mfma_f32_16x16x32_bf16 v[144:147], v[200:203], v[212:215], v[144:147]
    ds_read_b128 v[212:215], v252 offset:6144
    v_mfma_f32_16x16x32_bf16 v[148:151], v[196:199], v[216:219], v[148:151]
    s_barrier
    s_waitcnt vmcnt(5)
    s_add_u32 m0, s64, 98304
    s_add_u32 s62, s65, 73728
    buffer_load_dwordx4 v255, s[32:35], s62 offen nt lds
    s_waitcnt vmcnt(5)
    s_add_u32 m0, s64, 102272
    s_add_u32 s62, s65, 73728
    buffer_load_dwordx4 v255, s[32:35], s62 offen offset:128 nt lds
    s_waitcnt vmcnt(5)
    s_add_u32 m0, s64, 106240
    s_add_u32 s62, s65, 73728
    buffer_load_dwordx4 v255, s[32:35], s62 offen offset:256 nt lds
    s_add_u32 m0, s60, 59392
    s_add_u32 s63, s59, 164096
    buffer_load_dwordx4 v253, s[44:47], s63 offen  lds
    buffer_load_dwordx4 v254, s[44:47], s63 offen offset:1024  lds
    v_cvt_pk_bf16_f32 v6, v152, v153
    v_cvt_pk_bf16_f32 v7, v154, v155
    v_perm_b32 v152, v34, v34, s69
    v_perm_b32 v153, v34, v34, s72
    v_perm_b32 v154, v35, v35, s69
    v_perm_b32 v155, v35, v35, s72
    v_cvt_pk_bf16_f32 v8, v156, v157
    v_cvt_pk_bf16_f32 v9, v158, v159
    v_perm_b32 v156, v36, v36, s69
    v_perm_b32 v157, v36, v36, s72
    v_perm_b32 v158, v37, v37, s69
    v_perm_b32 v159, v37, v37, s72
    v_cvt_pk_bf16_f32 v10, v160, v161
    v_cvt_pk_bf16_f32 v11, v162, v163
    v_perm_b32 v160, v38, v38, s69
    v_perm_b32 v161, v38, v38, s72
    v_perm_b32 v162, v39, v39, s69
    v_perm_b32 v163, v39, v39, s72
    v_cvt_pk_bf16_f32 v12, v164, v165
    v_cvt_pk_bf16_f32 v13, v166, v167
    v_perm_b32 v164, v40, v40, s69
    v_perm_b32 v165, v40, v40, s72
    v_perm_b32 v166, v41, v41, s69
    v_perm_b32 v167, v41, v41, s72
    v_cvt_pk_bf16_f32 v14, v168, v169
    v_cvt_pk_bf16_f32 v15, v170, v171
    v_perm_b32 v168, v42, v42, s69
    v_perm_b32 v169, v42, v42, s72
    v_perm_b32 v170, v43, v43, s69
    v_perm_b32 v171, v43, v43, s72
    v_cvt_pk_bf16_f32 v16, v172, v173
    v_cvt_pk_bf16_f32 v17, v174, v175
    v_perm_b32 v172, v44, v44, s69
    v_perm_b32 v173, v44, v44, s72
    v_perm_b32 v174, v45, v45, s69
    v_perm_b32 v175, v45, v45, s72
    v_cvt_pk_bf16_f32 v18, v176, v177
    v_cvt_pk_bf16_f32 v19, v178, v179
    v_perm_b32 v176, v46, v46, s69
    v_perm_b32 v177, v46, v46, s72
    v_perm_b32 v178, v47, v47, s69
    v_perm_b32 v179, v47, v47, s72
    v_cvt_pk_bf16_f32 v20, v180, v181
    v_cvt_pk_bf16_f32 v21, v182, v183
    v_perm_b32 v180, v48, v48, s69
    v_perm_b32 v181, v48, v48, s72
    v_perm_b32 v182, v49, v49, s69
    v_perm_b32 v183, v49, v49, s72
    v_cvt_pk_bf16_f32 v22, v184, v185
    v_cvt_pk_bf16_f32 v23, v186, v187
    v_perm_b32 v184, v50, v50, s69
    v_perm_b32 v185, v50, v50, s72
    v_perm_b32 v186, v51, v51, s69
    v_perm_b32 v187, v51, v51, s72
    v_cvt_pk_bf16_f32 v24, v188, v189
    v_cvt_pk_bf16_f32 v25, v190, v191
    v_perm_b32 v188, v52, v52, s69
    v_perm_b32 v189, v52, v52, s72
    v_perm_b32 v190, v53, v53, s69
    v_perm_b32 v191, v53, v53, s72
    v_cvt_pk_bf16_f32 v26, v192, v193
    v_cvt_pk_bf16_f32 v27, v194, v195
    v_perm_b32 v192, v54, v54, s69
    v_perm_b32 v193, v54, v54, s72
    v_perm_b32 v194, v55, v55, s69
    v_perm_b32 v195, v55, v55, s72
    v_mfma_f32_16x16x32_bf16 v[152:155], v[200:203], v[216:219], v[152:155]
    ds_read_b128 v[216:219], v252 offset:7168
    v_mfma_f32_16x16x32_bf16 v[156:159], v[196:199], v[220:223], v[156:159]
    ds_read_b64_tr_b16 v[204:205], v250 offset:24576
    v_mfma_f32_16x16x32_bf16 v[160:163], v[200:203], v[220:223], v[160:163]
    ds_read_b128 v[220:223], v252 offset:8192
    v_mfma_f32_16x16x32_bf16 v[164:167], v[196:199], v[224:227], v[164:167]
    ds_read_b64_tr_b16 v[206:207], v250 offset:28672
    v_mfma_f32_16x16x32_bf16 v[168:171], v[200:203], v[224:227], v[168:171]
    ds_read_b128 v[224:227], v252 offset:9216
    s_waitcnt lgkmcnt(7)
    v_mfma_f32_16x16x32_bf16 v[172:175], v[196:199], v[228:231], v[172:175]
    ds_read_b64_tr_b16 v[208:209], v251 offset:24576
    v_mfma_f32_16x16x32_bf16 v[176:179], v[200:203], v[228:231], v[176:179]
    ds_read_b128 v[228:231], v252 offset:10240
    s_waitcnt lgkmcnt(8)
    v_mfma_f32_16x16x32_bf16 v[180:183], v[196:199], v[232:235], v[180:183]
    ds_read_b64_tr_b16 v[210:211], v251 offset:28672
    v_mfma_f32_16x16x32_bf16 v[184:187], v[200:203], v[232:235], v[184:187]
    ds_read_b128 v[232:235], v252 offset:11264
    s_waitcnt lgkmcnt(9)
    v_mfma_f32_16x16x32_bf16 v[188:191], v[196:199], v[212:215], v[188:191]
    v_mfma_f32_16x16x32_bf16 v[192:195], v[200:203], v[212:215], v[192:195]
    ds_read_b128 v[212:215], v252 offset:12288
    s_waitcnt lgkmcnt(6)
    v_mfma_f32_16x16x32_bf16 v[140:143], v[204:207], v[216:219], v[140:143]
    s_waitcnt lgkmcnt(2)
    v_mfma_f32_16x16x32_bf16 v[144:147], v[208:211], v[216:219], v[144:147]
    ds_read_b128 v[216:219], v252 offset:13312
    v_mfma_f32_16x16x32_bf16 v[148:151], v[204:207], v[220:223], v[148:151]
    s_barrier
    s_waitcnt vmcnt(7)
    s_add_u32 m0, s64, 110592
    s_add_u32 s62, s65, 61440
    buffer_load_dwordx4 v255, s[36:39], s62 offen nt lds
    s_waitcnt vmcnt(5)
    s_add_u32 m0, s64, 114560
    s_add_u32 s62, s65, 61440
    buffer_load_dwordx4 v255, s[36:39], s62 offen offset:128 nt lds
    s_waitcnt vmcnt(5)
    s_add_u32 m0, s64, 118528
    s_add_u32 s62, s65, 61440
    buffer_load_dwordx4 v255, s[36:39], s62 offen offset:256 nt lds
    s_add_u32 m0, s60, 67584
    s_add_u32 s63, s59, 205056
    buffer_load_dwordx4 v253, s[44:47], s63 offen  lds
    buffer_load_dwordx4 v254, s[44:47], s63 offen offset:1024  lds
    v_mfma_f32_16x16x32_bf16 v[152:155], v[208:211], v[220:223], v[152:155]
    ds_read_b128 v[220:223], v252 offset:14336
    v_mfma_f32_16x16x32_bf16 v[156:159], v[204:207], v[224:227], v[156:159]
    ds_read_b64_tr_b16 v[196:197], v250 offset:0
    v_mfma_f32_16x16x32_bf16 v[160:163], v[208:211], v[224:227], v[160:163]
    ds_read_b128 v[224:227], v252 offset:15360
    v_mfma_f32_16x16x32_bf16 v[164:167], v[204:207], v[228:231], v[164:167]
    ds_read_b64_tr_b16 v[198:199], v250 offset:4096
    v_mfma_f32_16x16x32_bf16 v[168:171], v[208:211], v[228:231], v[168:171]
    ds_read_b128 v[228:231], v252 offset:16384
    s_waitcnt lgkmcnt(7)
    v_mfma_f32_16x16x32_bf16 v[172:175], v[204:207], v[232:235], v[172:175]
    ds_read_b64_tr_b16 v[200:201], v251 offset:0
    v_mfma_f32_16x16x32_bf16 v[176:179], v[208:211], v[232:235], v[176:179]
    ds_read_b128 v[232:235], v252 offset:17408
    s_waitcnt lgkmcnt(8)
    v_mfma_f32_16x16x32_bf16 v[180:183], v[204:207], v[212:215], v[180:183]
    ds_read_b64_tr_b16 v[202:203], v251 offset:4096
    v_mfma_f32_16x16x32_bf16 v[184:187], v[208:211], v[212:215], v[184:187]
    ds_read_b128 v[212:215], v252 offset:18432
    s_waitcnt lgkmcnt(9)
    v_mfma_f32_16x16x32_bf16 v[188:191], v[204:207], v[216:219], v[188:191]
    v_mfma_f32_16x16x32_bf16 v[192:195], v[208:211], v[216:219], v[192:195]
    ds_read_b128 v[216:219], v252 offset:19456
    s_waitcnt lgkmcnt(6)
    v_mfma_f32_16x16x32_bf16 v[140:143], v[196:199], v[220:223], v[140:143]
    s_waitcnt lgkmcnt(2)
    v_mfma_f32_16x16x32_bf16 v[144:147], v[200:203], v[220:223], v[144:147]
    ds_read_b128 v[220:223], v252 offset:20480
    v_mfma_f32_16x16x32_bf16 v[148:151], v[196:199], v[224:227], v[148:151]
    s_barrier
    s_waitcnt vmcnt(7)
    s_add_u32 m0, s64, 122880
    s_add_u32 s62, s65, 86016
    buffer_load_dwordx4 v255, s[32:35], s62 offen nt lds
    s_waitcnt vmcnt(5)
    s_add_u32 m0, s64, 126848
    s_add_u32 s62, s65, 86016
    buffer_load_dwordx4 v255, s[32:35], s62 offen offset:128 nt lds
    s_waitcnt vmcnt(5)
    s_add_u32 m0, s64, 130816
    s_add_u32 s62, s65, 86016
    buffer_load_dwordx4 v255, s[32:35], s62 offen offset:256 nt lds
    s_add_u32 m0, s60, 43008
    s_add_u32 s63, s59, 512
    buffer_load_dwordx4 v253, s[44:47], s63 offen  lds
    buffer_load_dwordx4 v254, s[44:47], s63 offen offset:1024  lds
    v_mfma_f32_16x16x32_bf16 v[152:155], v[200:203], v[224:227], v[152:155]
    ds_read_b128 v[224:227], v252 offset:21504
    v_mfma_f32_16x16x32_bf16 v[156:159], v[196:199], v[228:231], v[156:159]
    ds_read_b64_tr_b16 v[204:205], v250 offset:8192
    v_mfma_f32_16x16x32_bf16 v[160:163], v[200:203], v[228:231], v[160:163]
    ds_read_b128 v[228:231], v252 offset:22528
    v_mfma_f32_16x16x32_bf16 v[164:167], v[196:199], v[232:235], v[164:167]
    ds_read_b64_tr_b16 v[206:207], v250 offset:12288
    v_mfma_f32_16x16x32_bf16 v[168:171], v[200:203], v[232:235], v[168:171]
    ds_read_b128 v[232:235], v252 offset:23552
    s_waitcnt lgkmcnt(7)
    v_mfma_f32_16x16x32_bf16 v[172:175], v[196:199], v[212:215], v[172:175]
    ds_read_b64_tr_b16 v[208:209], v251 offset:8192
    v_mfma_f32_16x16x32_bf16 v[176:179], v[200:203], v[212:215], v[176:179]
    ds_read_b128 v[212:215], v252 offset:24576
    s_waitcnt lgkmcnt(8)
    v_mfma_f32_16x16x32_bf16 v[180:183], v[196:199], v[216:219], v[180:183]
    ds_read_b64_tr_b16 v[210:211], v251 offset:12288
    v_mfma_f32_16x16x32_bf16 v[184:187], v[200:203], v[216:219], v[184:187]
    ds_read_b128 v[216:219], v252 offset:25600
    s_waitcnt lgkmcnt(9)
    v_mfma_f32_16x16x32_bf16 v[188:191], v[196:199], v[220:223], v[188:191]
    v_mfma_f32_16x16x32_bf16 v[192:195], v[200:203], v[220:223], v[192:195]
    ds_read_b128 v[220:223], v252 offset:26624
    s_waitcnt lgkmcnt(6)
    v_mfma_f32_16x16x32_bf16 v[140:143], v[204:207], v[224:227], v[140:143]
    s_waitcnt lgkmcnt(2)
    v_mfma_f32_16x16x32_bf16 v[144:147], v[208:211], v[224:227], v[144:147]
    ds_read_b128 v[224:227], v252 offset:27648
    v_mfma_f32_16x16x32_bf16 v[148:151], v[204:207], v[228:231], v[148:151]
    s_barrier
    s_waitcnt vmcnt(7)
    s_add_u32 m0, s64, 135168
    s_add_u32 s62, s65, 73728
    buffer_load_dwordx4 v255, s[36:39], s62 offen nt lds
    s_waitcnt vmcnt(5)
    s_add_u32 m0, s64, 139136
    s_add_u32 s62, s65, 73728
    buffer_load_dwordx4 v255, s[36:39], s62 offen offset:128 nt lds
    s_waitcnt vmcnt(5)
    s_add_u32 m0, s64, 143104
    s_add_u32 s62, s65, 73728
    buffer_load_dwordx4 v255, s[36:39], s62 offen offset:256 nt lds
    s_add_u32 m0, s60, 51200
    s_add_u32 s63, s59, 41472
    buffer_load_dwordx4 v253, s[44:47], s63 offen  lds
    buffer_load_dwordx4 v254, s[44:47], s63 offen offset:1024  lds
    v_mfma_f32_16x16x32_bf16 v[152:155], v[208:211], v[228:231], v[152:155]
    ds_read_b128 v[228:231], v252 offset:28672
    v_mfma_f32_16x16x32_bf16 v[156:159], v[204:207], v[232:235], v[156:159]
    ds_read_b64_tr_b16 v[196:197], v250 offset:16384
    v_mfma_f32_16x16x32_bf16 v[160:163], v[208:211], v[232:235], v[160:163]
    ds_read_b128 v[232:235], v252 offset:29696
    v_mfma_f32_16x16x32_bf16 v[164:167], v[204:207], v[212:215], v[164:167]
    ds_read_b64_tr_b16 v[198:199], v250 offset:20480
    v_mfma_f32_16x16x32_bf16 v[168:171], v[208:211], v[212:215], v[168:171]
    ds_read_b128 v[212:215], v252 offset:30720
    s_waitcnt lgkmcnt(7)
    v_mfma_f32_16x16x32_bf16 v[172:175], v[204:207], v[216:219], v[172:175]
    ds_read_b64_tr_b16 v[200:201], v251 offset:16384
    v_mfma_f32_16x16x32_bf16 v[176:179], v[208:211], v[216:219], v[176:179]
    ds_read_b128 v[216:219], v252 offset:31744
    s_waitcnt lgkmcnt(8)
    v_mfma_f32_16x16x32_bf16 v[180:183], v[204:207], v[220:223], v[180:183]
    ds_read_b64_tr_b16 v[202:203], v251 offset:20480
    v_mfma_f32_16x16x32_bf16 v[184:187], v[208:211], v[220:223], v[184:187]
    ds_read_b128 v[220:223], v252 offset:32768
    s_waitcnt lgkmcnt(9)
    v_mfma_f32_16x16x32_bf16 v[188:191], v[204:207], v[224:227], v[188:191]
    v_mfma_f32_16x16x32_bf16 v[192:195], v[208:211], v[224:227], v[192:195]
    ds_read_b128 v[224:227], v252 offset:33792
    s_waitcnt lgkmcnt(6)
    v_mfma_f32_16x16x32_bf16 v[140:143], v[196:199], v[228:231], v[140:143]
    s_waitcnt lgkmcnt(2)
    v_mfma_f32_16x16x32_bf16 v[144:147], v[200:203], v[228:231], v[144:147]
    ds_read_b128 v[228:231], v252 offset:34816
    v_mfma_f32_16x16x32_bf16 v[148:151], v[196:199], v[232:235], v[148:151]
    s_barrier
    s_waitcnt vmcnt(7)
    s_add_u32 m0, s64, 147456
    s_add_u32 s62, s65, 98304
    buffer_load_dwordx4 v255, s[32:35], s62 offen nt lds
    s_waitcnt vmcnt(5)
    s_add_u32 m0, s64, 151424
    s_add_u32 s62, s65, 98304
    buffer_load_dwordx4 v255, s[32:35], s62 offen offset:128 nt lds
    s_waitcnt vmcnt(5)
    s_add_u32 m0, s64, 155392
    s_add_u32 s62, s65, 98304
    buffer_load_dwordx4 v255, s[32:35], s62 offen offset:256 nt lds
    s_waitcnt vmcnt(5)
    s_add_u32 m0, s64, 94208
    s_add_u32 s62, s65, 86016
    buffer_load_dwordx4 v255, s[36:39], s62 offen nt lds
    s_add_u32 m0, s60, 59392
    s_add_u32 s63, s59, 82432
    buffer_load_dwordx4 v253, s[44:47], s63 offen  lds
    buffer_load_dwordx4 v254, s[44:47], s63 offen offset:1024  lds
    v_mfma_f32_16x16x32_bf16 v[152:155], v[200:203], v[232:235], v[152:155]
    ds_read_b128 v[232:235], v252 offset:35840
    v_mfma_f32_16x16x32_bf16 v[156:159], v[196:199], v[212:215], v[156:159]
    ds_read_b64_tr_b16 v[204:205], v250 offset:24576
    v_mfma_f32_16x16x32_bf16 v[160:163], v[200:203], v[212:215], v[160:163]
    ds_read_b128 v[212:215], v252 offset:36864
    v_mfma_f32_16x16x32_bf16 v[164:167], v[196:199], v[216:219], v[164:167]
    ds_read_b64_tr_b16 v[206:207], v250 offset:28672
    v_mfma_f32_16x16x32_bf16 v[168:171], v[200:203], v[216:219], v[168:171]
    ds_read_b128 v[216:219], v252 offset:37888
    s_waitcnt lgkmcnt(7)
    v_mfma_f32_16x16x32_bf16 v[172:175], v[196:199], v[220:223], v[172:175]
    ds_read_b64_tr_b16 v[208:209], v251 offset:24576
    v_mfma_f32_16x16x32_bf16 v[176:179], v[200:203], v[220:223], v[176:179]
    ds_read_b128 v[220:223], v252 offset:38912
    s_waitcnt lgkmcnt(8)
    v_mfma_f32_16x16x32_bf16 v[180:183], v[196:199], v[224:227], v[180:183]
    ds_read_b64_tr_b16 v[210:211], v251 offset:28672
    v_mfma_f32_16x16x32_bf16 v[184:187], v[200:203], v[224:227], v[184:187]
    ds_read_b128 v[224:227], v252 offset:39936
    s_waitcnt lgkmcnt(9)
    v_mfma_f32_16x16x32_bf16 v[188:191], v[196:199], v[228:231], v[188:191]
    v_mfma_f32_16x16x32_bf16 v[192:195], v[200:203], v[228:231], v[192:195]
    ds_read_b128 v[228:231], v252 offset:40960
    s_waitcnt lgkmcnt(6)
    v_mfma_f32_16x16x32_bf16 v[140:143], v[204:207], v[232:235], v[140:143]
    s_waitcnt lgkmcnt(2)
    v_mfma_f32_16x16x32_bf16 v[144:147], v[208:211], v[232:235], v[144:147]
    ds_read_b128 v[232:235], v252 offset:41984
    v_mfma_f32_16x16x32_bf16 v[148:151], v[204:207], v[212:215], v[148:151]
    s_barrier
    s_waitcnt vmcnt(5)
    s_add_u32 m0, s64, 98176
    s_add_u32 s62, s65, 86016
    buffer_load_dwordx4 v255, s[36:39], s62 offen offset:128 nt lds
    s_waitcnt vmcnt(5)
    s_add_u32 m0, s64, 102144
    s_add_u32 s62, s65, 86016
    buffer_load_dwordx4 v255, s[36:39], s62 offen offset:256 nt lds
    s_waitcnt vmcnt(5)
    s_add_u32 m0, s64, 106496
    s_add_u32 s62, s65, 110592
    buffer_load_dwordx4 v255, s[32:35], s62 offen nt lds
    s_add_u32 m0, s60, 67584
    s_add_u32 s63, s59, 123392
    buffer_load_dwordx4 v253, s[44:47], s63 offen  lds
    buffer_load_dwordx4 v254, s[44:47], s63 offen offset:1024  lds
    v_mfma_f32_16x16x32_bf16 v[152:155], v[208:211], v[212:215], v[152:155]
    ds_read_b128 v[212:215], v252 offset:0
    v_cvt_pk_bf16_f32 v28, v140, v141
    v_cvt_pk_bf16_f32 v29, v142, v143
    v_perm_b32 v140, v56, v56, s69
    v_perm_b32 v141, v56, v56, s72
    v_perm_b32 v142, v57, v57, s69
    v_perm_b32 v143, v57, v57, s72
    v_mfma_f32_16x16x32_bf16 v[156:159], v[204:207], v[216:219], v[156:159]
    ds_read_b64_tr_b16 v[196:197], v250 offset:0
    v_cvt_pk_bf16_f32 v30, v144, v145
    v_cvt_pk_bf16_f32 v31, v146, v147
    v_perm_b32 v144, v58, v58, s69
    v_perm_b32 v145, v58, v58, s72
    v_perm_b32 v146, v59, v59, s69
    v_perm_b32 v147, v59, v59, s72
    v_mfma_f32_16x16x32_bf16 v[160:163], v[208:211], v[216:219], v[160:163]
    ds_read_b128 v[216:219], v252 offset:1024
    v_cvt_pk_bf16_f32 v32, v148, v149
    v_cvt_pk_bf16_f32 v33, v150, v151
    v_perm_b32 v148, v60, v60, s69
    v_perm_b32 v149, v60, v60, s72
    v_perm_b32 v150, v61, v61, s69
    v_perm_b32 v151, v61, v61, s72
    v_mfma_f32_16x16x32_bf16 v[164:167], v[204:207], v[220:223], v[164:167]
    ds_read_b64_tr_b16 v[198:199], v250 offset:4096
    v_mfma_f32_16x16x32_bf16 v[168:171], v[208:211], v[220:223], v[168:171]
    ds_read_b128 v[220:223], v252 offset:2048
    s_waitcnt lgkmcnt(7)
    v_mfma_f32_16x16x32_bf16 v[172:175], v[204:207], v[224:227], v[172:175]
    ds_read_b64_tr_b16 v[200:201], v251 offset:0
    v_mfma_f32_16x16x32_bf16 v[176:179], v[208:211], v[224:227], v[176:179]
    ds_read_b128 v[224:227], v252 offset:3072
    s_waitcnt lgkmcnt(8)
    v_mfma_f32_16x16x32_bf16 v[180:183], v[204:207], v[228:231], v[180:183]
    ds_read_b64_tr_b16 v[202:203], v251 offset:4096
    v_mfma_f32_16x16x32_bf16 v[184:187], v[208:211], v[228:231], v[184:187]
    ds_read_b128 v[228:231], v252 offset:4096
    s_waitcnt lgkmcnt(9)
    v_mfma_f32_16x16x32_bf16 v[188:191], v[204:207], v[232:235], v[188:191]
    v_mfma_f32_16x16x32_bf16 v[192:195], v[208:211], v[232:235], v[192:195]
    ds_read_b128 v[232:235], v252 offset:5120
    s_waitcnt lgkmcnt(6)
    v_mfma_f32_16x16x32_bf16 v[140:143], v[196:199], v[212:215], v[140:143]
    s_waitcnt lgkmcnt(2)
    v_mfma_f32_16x16x32_bf16 v[144:147], v[200:203], v[212:215], v[144:147]
    ds_read_b128 v[212:215], v252 offset:6144
    v_mfma_f32_16x16x32_bf16 v[148:151], v[196:199], v[216:219], v[148:151]
    s_barrier
    s_waitcnt vmcnt(7)
    s_add_u32 m0, s64, 110464
    s_add_u32 s62, s65, 110592
    buffer_load_dwordx4 v255, s[32:35], s62 offen offset:128 nt lds
    s_waitcnt vmcnt(5)
    s_add_u32 m0, s64, 114432
    s_add_u32 s62, s65, 110592
    buffer_load_dwordx4 v255, s[32:35], s62 offen offset:256 nt lds
    s_waitcnt vmcnt(5)
    s_add_u32 m0, s64, 118784
    s_add_u32 s62, s65, 98304
    buffer_load_dwordx4 v255, s[36:39], s62 offen nt lds
    s_add_u32 m0, s60, 43008
    s_add_u32 s63, s59, 164352
    buffer_load_dwordx4 v253, s[44:47], s63 offen  lds
    buffer_load_dwordx4 v254, s[44:47], s63 offen offset:1024  lds
    v_cvt_pk_bf16_f32 v34, v152, v153
    v_cvt_pk_bf16_f32 v35, v154, v155
    v_perm_b32 v152, v62, v62, s69
    v_perm_b32 v153, v62, v62, s72
    v_perm_b32 v154, v63, v63, s69
    v_perm_b32 v155, v63, v63, s72
    v_cvt_pk_bf16_f32 v36, v156, v157
    v_cvt_pk_bf16_f32 v37, v158, v159
    v_perm_b32 v156, v64, v64, s69
    v_perm_b32 v157, v64, v64, s72
    v_perm_b32 v158, v65, v65, s69
    v_perm_b32 v159, v65, v65, s72
    v_cvt_pk_bf16_f32 v38, v160, v161
    v_cvt_pk_bf16_f32 v39, v162, v163
    v_perm_b32 v160, v66, v66, s69
    v_perm_b32 v161, v66, v66, s72
    v_perm_b32 v162, v67, v67, s69
    v_perm_b32 v163, v67, v67, s72
    v_cvt_pk_bf16_f32 v40, v164, v165
    v_cvt_pk_bf16_f32 v41, v166, v167
    v_perm_b32 v164, v68, v68, s69
    v_perm_b32 v165, v68, v68, s72
    v_perm_b32 v166, v69, v69, s69
    v_perm_b32 v167, v69, v69, s72
    v_cvt_pk_bf16_f32 v42, v168, v169
    v_cvt_pk_bf16_f32 v43, v170, v171
    v_perm_b32 v168, v70, v70, s69
    v_perm_b32 v169, v70, v70, s72
    v_perm_b32 v170, v71, v71, s69
    v_perm_b32 v171, v71, v71, s72
    v_cvt_pk_bf16_f32 v44, v172, v173
    v_cvt_pk_bf16_f32 v45, v174, v175
    v_perm_b32 v172, v72, v72, s69
    v_perm_b32 v173, v72, v72, s72
    v_perm_b32 v174, v73, v73, s69
    v_perm_b32 v175, v73, v73, s72
    v_cvt_pk_bf16_f32 v46, v176, v177
    v_cvt_pk_bf16_f32 v47, v178, v179
    v_perm_b32 v176, v74, v74, s69
    v_perm_b32 v177, v74, v74, s72
    v_perm_b32 v178, v75, v75, s69
    v_perm_b32 v179, v75, v75, s72
    v_cvt_pk_bf16_f32 v48, v180, v181
    v_cvt_pk_bf16_f32 v49, v182, v183
    v_perm_b32 v180, v76, v76, s69
    v_perm_b32 v181, v76, v76, s72
    v_perm_b32 v182, v77, v77, s69
    v_perm_b32 v183, v77, v77, s72
    v_cvt_pk_bf16_f32 v50, v184, v185
    v_cvt_pk_bf16_f32 v51, v186, v187
    v_perm_b32 v184, v78, v78, s69
    v_perm_b32 v185, v78, v78, s72
    v_perm_b32 v186, v79, v79, s69
    v_perm_b32 v187, v79, v79, s72
    v_cvt_pk_bf16_f32 v52, v188, v189
    v_cvt_pk_bf16_f32 v53, v190, v191
    v_perm_b32 v188, v80, v80, s69
    v_perm_b32 v189, v80, v80, s72
    v_perm_b32 v190, v81, v81, s69
    v_perm_b32 v191, v81, v81, s72
    v_cvt_pk_bf16_f32 v54, v192, v193
    v_cvt_pk_bf16_f32 v55, v194, v195
    v_perm_b32 v192, v82, v82, s69
    v_perm_b32 v193, v82, v82, s72
    v_perm_b32 v194, v83, v83, s69
    v_perm_b32 v195, v83, v83, s72
    v_mfma_f32_16x16x32_bf16 v[152:155], v[200:203], v[216:219], v[152:155]
    ds_read_b128 v[216:219], v252 offset:7168
    v_mfma_f32_16x16x32_bf16 v[156:159], v[196:199], v[220:223], v[156:159]
    ds_read_b64_tr_b16 v[204:205], v250 offset:8192
    v_mfma_f32_16x16x32_bf16 v[160:163], v[200:203], v[220:223], v[160:163]
    ds_read_b128 v[220:223], v252 offset:8192
    v_mfma_f32_16x16x32_bf16 v[164:167], v[196:199], v[224:227], v[164:167]
    ds_read_b64_tr_b16 v[206:207], v250 offset:12288
    v_mfma_f32_16x16x32_bf16 v[168:171], v[200:203], v[224:227], v[168:171]
    ds_read_b128 v[224:227], v252 offset:9216
    s_waitcnt lgkmcnt(7)
    v_mfma_f32_16x16x32_bf16 v[172:175], v[196:199], v[228:231], v[172:175]
    ds_read_b64_tr_b16 v[208:209], v251 offset:8192
    v_mfma_f32_16x16x32_bf16 v[176:179], v[200:203], v[228:231], v[176:179]
    ds_read_b128 v[228:231], v252 offset:10240
    s_waitcnt lgkmcnt(8)
    v_mfma_f32_16x16x32_bf16 v[180:183], v[196:199], v[232:235], v[180:183]
    ds_read_b64_tr_b16 v[210:211], v251 offset:12288
    v_mfma_f32_16x16x32_bf16 v[184:187], v[200:203], v[232:235], v[184:187]
    ds_read_b128 v[232:235], v252 offset:11264
    s_waitcnt lgkmcnt(9)
    v_mfma_f32_16x16x32_bf16 v[188:191], v[196:199], v[212:215], v[188:191]
    v_mfma_f32_16x16x32_bf16 v[192:195], v[200:203], v[212:215], v[192:195]
    ds_read_b128 v[212:215], v252 offset:12288
    s_waitcnt lgkmcnt(6)
    v_mfma_f32_16x16x32_bf16 v[140:143], v[204:207], v[216:219], v[140:143]
    s_waitcnt lgkmcnt(2)
    v_mfma_f32_16x16x32_bf16 v[144:147], v[208:211], v[216:219], v[144:147]
    ds_read_b128 v[216:219], v252 offset:13312
    v_mfma_f32_16x16x32_bf16 v[148:151], v[204:207], v[220:223], v[148:151]
    s_barrier
    s_waitcnt vmcnt(7)
    s_add_u32 m0, s64, 122752
    s_add_u32 s62, s65, 98304
    buffer_load_dwordx4 v255, s[36:39], s62 offen offset:128 nt lds
    s_waitcnt vmcnt(5)
    s_add_u32 m0, s64, 126720
    s_add_u32 s62, s65, 98304
    buffer_load_dwordx4 v255, s[36:39], s62 offen offset:256 nt lds
    s_waitcnt vmcnt(5)
    s_add_u32 m0, s64, 131072
    s_add_u32 s62, s65, 122880
    buffer_load_dwordx4 v255, s[32:35], s62 offen nt lds
    s_add_u32 m0, s60, 51200
    s_add_u32 s63, s59, 205312
    buffer_load_dwordx4 v253, s[44:47], s63 offen  lds
    buffer_load_dwordx4 v254, s[44:47], s63 offen offset:1024  lds
    v_mfma_f32_16x16x32_bf16 v[152:155], v[208:211], v[220:223], v[152:155]
    ds_read_b128 v[220:223], v252 offset:14336
    v_mfma_f32_16x16x32_bf16 v[156:159], v[204:207], v[224:227], v[156:159]
    ds_read_b64_tr_b16 v[196:197], v250 offset:16384
    v_mfma_f32_16x16x32_bf16 v[160:163], v[208:211], v[224:227], v[160:163]
    ds_read_b128 v[224:227], v252 offset:15360
    v_mfma_f32_16x16x32_bf16 v[164:167], v[204:207], v[228:231], v[164:167]
    ds_read_b64_tr_b16 v[198:199], v250 offset:20480
    v_mfma_f32_16x16x32_bf16 v[168:171], v[208:211], v[228:231], v[168:171]
    ds_read_b128 v[228:231], v252 offset:16384
    s_waitcnt lgkmcnt(7)
    v_mfma_f32_16x16x32_bf16 v[172:175], v[204:207], v[232:235], v[172:175]
    ds_read_b64_tr_b16 v[200:201], v251 offset:16384
    v_mfma_f32_16x16x32_bf16 v[176:179], v[208:211], v[232:235], v[176:179]
    ds_read_b128 v[232:235], v252 offset:17408
    s_waitcnt lgkmcnt(8)
    v_mfma_f32_16x16x32_bf16 v[180:183], v[204:207], v[212:215], v[180:183]
    ds_read_b64_tr_b16 v[202:203], v251 offset:20480
    v_mfma_f32_16x16x32_bf16 v[184:187], v[208:211], v[212:215], v[184:187]
    ds_read_b128 v[212:215], v252 offset:18432
    s_waitcnt lgkmcnt(9)
    v_mfma_f32_16x16x32_bf16 v[188:191], v[204:207], v[216:219], v[188:191]
    v_mfma_f32_16x16x32_bf16 v[192:195], v[208:211], v[216:219], v[192:195]
    ds_read_b128 v[216:219], v252 offset:19456
    s_waitcnt lgkmcnt(6)
    v_mfma_f32_16x16x32_bf16 v[140:143], v[196:199], v[220:223], v[140:143]
    s_waitcnt lgkmcnt(2)
    v_mfma_f32_16x16x32_bf16 v[144:147], v[200:203], v[220:223], v[144:147]
    ds_read_b128 v[220:223], v252 offset:20480
    v_mfma_f32_16x16x32_bf16 v[148:151], v[196:199], v[224:227], v[148:151]
    s_barrier
    s_waitcnt vmcnt(7)
    s_add_u32 m0, s64, 135040
    s_add_u32 s62, s65, 122880
    buffer_load_dwordx4 v255, s[32:35], s62 offen offset:128 nt lds
    s_waitcnt vmcnt(5)
    s_add_u32 m0, s64, 139008
    s_add_u32 s62, s65, 122880
    buffer_load_dwordx4 v255, s[32:35], s62 offen offset:256 nt lds
    s_add_u32 m0, s64, 143360
    s_add_u32 s62, s65, 110592
    buffer_load_dwordx4 v255, s[36:39], s62 offen nt lds
    s_add_u32 m0, s60, 59392
    s_add_u32 s63, s59, 768
    buffer_load_dwordx4 v253, s[44:47], s63 offen  lds
    buffer_load_dwordx4 v254, s[44:47], s63 offen offset:1024  lds
    v_mfma_f32_16x16x32_bf16 v[152:155], v[200:203], v[224:227], v[152:155]
    ds_read_b128 v[224:227], v252 offset:21504
    v_mfma_f32_16x16x32_bf16 v[156:159], v[196:199], v[228:231], v[156:159]
    ds_read_b64_tr_b16 v[204:205], v250 offset:24576
    v_mfma_f32_16x16x32_bf16 v[160:163], v[200:203], v[228:231], v[160:163]
    ds_read_b128 v[228:231], v252 offset:22528
    v_mfma_f32_16x16x32_bf16 v[164:167], v[196:199], v[232:235], v[164:167]
    ds_read_b64_tr_b16 v[206:207], v250 offset:28672
    v_mfma_f32_16x16x32_bf16 v[168:171], v[200:203], v[232:235], v[168:171]
    ds_read_b128 v[232:235], v252 offset:23552
    s_waitcnt lgkmcnt(7)
    v_mfma_f32_16x16x32_bf16 v[172:175], v[196:199], v[212:215], v[172:175]
    ds_read_b64_tr_b16 v[208:209], v251 offset:24576
    v_mfma_f32_16x16x32_bf16 v[176:179], v[200:203], v[212:215], v[176:179]
    ds_read_b128 v[212:215], v252 offset:24576
    s_waitcnt lgkmcnt(8)
    v_mfma_f32_16x16x32_bf16 v[180:183], v[196:199], v[216:219], v[180:183]
    ds_read_b64_tr_b16 v[210:211], v251 offset:28672
    v_mfma_f32_16x16x32_bf16 v[184:187], v[200:203], v[216:219], v[184:187]
    ds_read_b128 v[216:219], v252 offset:25600
    s_waitcnt lgkmcnt(9)
    v_mfma_f32_16x16x32_bf16 v[188:191], v[196:199], v[220:223], v[188:191]
    v_mfma_f32_16x16x32_bf16 v[192:195], v[200:203], v[220:223], v[192:195]
    ds_read_b128 v[220:223], v252 offset:26624
    s_waitcnt lgkmcnt(6)
    v_mfma_f32_16x16x32_bf16 v[140:143], v[204:207], v[224:227], v[140:143]
    s_waitcnt lgkmcnt(2)
    v_mfma_f32_16x16x32_bf16 v[144:147], v[208:211], v[224:227], v[144:147]
    ds_read_b128 v[224:227], v252 offset:27648
    v_mfma_f32_16x16x32_bf16 v[148:151], v[204:207], v[228:231], v[148:151]
    s_barrier
    s_waitcnt vmcnt(8)
    s_add_u32 m0, s64, 147328
    s_add_u32 s62, s65, 110592
    buffer_load_dwordx4 v255, s[36:39], s62 offen offset:128 nt lds
    s_waitcnt vmcnt(8)
    s_add_u32 m0, s64, 151296
    s_add_u32 s62, s65, 110592
    buffer_load_dwordx4 v255, s[36:39], s62 offen offset:256 nt lds
    s_waitcnt vmcnt(6)
    s_add_u32 m0, s64, 155648
    s_add_u32 s62, s65, 135168
    buffer_load_dwordx4 v255, s[32:35], s62 offen nt lds
    s_waitcnt vmcnt(6)
    s_add_u32 m0, s64, 94080
    s_add_u32 s62, s65, 135168
    buffer_load_dwordx4 v255, s[32:35], s62 offen offset:128 nt lds
    s_add_u32 m0, s60, 67584
    s_add_u32 s63, s59, 41728
    buffer_load_dwordx4 v253, s[44:47], s63 offen  lds
    buffer_load_dwordx4 v254, s[44:47], s63 offen offset:1024  lds
    v_mfma_f32_16x16x32_bf16 v[152:155], v[208:211], v[228:231], v[152:155]
    ds_read_b128 v[228:231], v252 offset:28672
    v_mfma_f32_16x16x32_bf16 v[156:159], v[204:207], v[232:235], v[156:159]
    ds_read_b64_tr_b16 v[196:197], v250 offset:0
    v_mfma_f32_16x16x32_bf16 v[160:163], v[208:211], v[232:235], v[160:163]
    ds_read_b128 v[232:235], v252 offset:29696
    v_mfma_f32_16x16x32_bf16 v[164:167], v[204:207], v[212:215], v[164:167]
    ds_read_b64_tr_b16 v[198:199], v250 offset:4096
    v_mfma_f32_16x16x32_bf16 v[168:171], v[208:211], v[212:215], v[168:171]
    ds_read_b128 v[212:215], v252 offset:30720
    s_waitcnt lgkmcnt(7)
    v_mfma_f32_16x16x32_bf16 v[172:175], v[204:207], v[216:219], v[172:175]
    ds_read_b64_tr_b16 v[200:201], v251 offset:0
    v_mfma_f32_16x16x32_bf16 v[176:179], v[208:211], v[216:219], v[176:179]
    ds_read_b128 v[216:219], v252 offset:31744
    s_waitcnt lgkmcnt(8)
    v_mfma_f32_16x16x32_bf16 v[180:183], v[204:207], v[220:223], v[180:183]
    ds_read_b64_tr_b16 v[202:203], v251 offset:4096
    v_mfma_f32_16x16x32_bf16 v[184:187], v[208:211], v[220:223], v[184:187]
    ds_read_b128 v[220:223], v252 offset:32768
    s_waitcnt lgkmcnt(9)
    v_mfma_f32_16x16x32_bf16 v[188:191], v[204:207], v[224:227], v[188:191]
    v_mfma_f32_16x16x32_bf16 v[192:195], v[208:211], v[224:227], v[192:195]
    ds_read_b128 v[224:227], v252 offset:33792
    s_waitcnt lgkmcnt(6)
    v_mfma_f32_16x16x32_bf16 v[140:143], v[196:199], v[228:231], v[140:143]
    s_waitcnt lgkmcnt(2)
    v_mfma_f32_16x16x32_bf16 v[144:147], v[200:203], v[228:231], v[144:147]
    ds_read_b128 v[228:231], v252 offset:34816
    v_mfma_f32_16x16x32_bf16 v[148:151], v[196:199], v[232:235], v[148:151]
    s_barrier
    s_waitcnt vmcnt(8)
    s_add_u32 m0, s64, 98048
    s_add_u32 s62, s65, 135168
    buffer_load_dwordx4 v255, s[32:35], s62 offen offset:256 nt lds
    s_waitcnt vmcnt(6)
    s_add_u32 m0, s64, 102400
    s_add_u32 s62, s65, 122880
    buffer_load_dwordx4 v255, s[36:39], s62 offen nt lds
    s_waitcnt vmcnt(6)
    s_add_u32 m0, s64, 106368
    s_add_u32 s62, s65, 122880
    buffer_load_dwordx4 v255, s[36:39], s62 offen offset:128 nt lds
    s_add_u32 m0, s60, 43008
    s_add_u32 s63, s59, 82688
    buffer_load_dwordx4 v253, s[44:47], s63 offen  lds
    buffer_load_dwordx4 v254, s[44:47], s63 offen offset:1024  lds
    v_mfma_f32_16x16x32_bf16 v[152:155], v[200:203], v[232:235], v[152:155]
    ds_read_b128 v[232:235], v252 offset:35840
    v_mfma_f32_16x16x32_bf16 v[156:159], v[196:199], v[212:215], v[156:159]
    ds_read_b64_tr_b16 v[204:205], v250 offset:8192
    v_mfma_f32_16x16x32_bf16 v[160:163], v[200:203], v[212:215], v[160:163]
    ds_read_b128 v[212:215], v252 offset:36864
    v_mfma_f32_16x16x32_bf16 v[164:167], v[196:199], v[216:219], v[164:167]
    ds_read_b64_tr_b16 v[206:207], v250 offset:12288
    v_mfma_f32_16x16x32_bf16 v[168:171], v[200:203], v[216:219], v[168:171]
    ds_read_b128 v[216:219], v252 offset:37888
    s_waitcnt lgkmcnt(7)
    v_mfma_f32_16x16x32_bf16 v[172:175], v[196:199], v[220:223], v[172:175]
    ds_read_b64_tr_b16 v[208:209], v251 offset:8192
    v_mfma_f32_16x16x32_bf16 v[176:179], v[200:203], v[220:223], v[176:179]
    ds_read_b128 v[220:223], v252 offset:38912
    s_waitcnt lgkmcnt(8)
    v_mfma_f32_16x16x32_bf16 v[180:183], v[196:199], v[224:227], v[180:183]
    ds_read_b64_tr_b16 v[210:211], v251 offset:12288
    v_mfma_f32_16x16x32_bf16 v[184:187], v[200:203], v[224:227], v[184:187]
    ds_read_b128 v[224:227], v252 offset:39936
    s_waitcnt lgkmcnt(9)
    v_mfma_f32_16x16x32_bf16 v[188:191], v[196:199], v[228:231], v[188:191]
    v_mfma_f32_16x16x32_bf16 v[192:195], v[200:203], v[228:231], v[192:195]
    ds_read_b128 v[228:231], v252 offset:40960
    s_waitcnt lgkmcnt(6)
    v_mfma_f32_16x16x32_bf16 v[140:143], v[204:207], v[232:235], v[140:143]
    s_waitcnt lgkmcnt(2)
    v_mfma_f32_16x16x32_bf16 v[144:147], v[208:211], v[232:235], v[144:147]
    ds_read_b128 v[232:235], v252 offset:41984
    v_mfma_f32_16x16x32_bf16 v[148:151], v[204:207], v[212:215], v[148:151]
    s_barrier
    s_waitcnt vmcnt(8)
    s_add_u32 m0, s64, 110336
    s_add_u32 s62, s65, 122880
    buffer_load_dwordx4 v255, s[36:39], s62 offen offset:256 nt lds
    s_waitcnt vmcnt(8)
    s_add_u32 m0, s64, 114688
    s_add_u32 s62, s65, 147456
    buffer_load_dwordx4 v255, s[32:35], s62 offen nt lds
    s_waitcnt vmcnt(6)
    s_add_u32 m0, s64, 118656
    s_add_u32 s62, s65, 147456
    buffer_load_dwordx4 v255, s[32:35], s62 offen offset:128 nt lds
    s_add_u32 m0, s60, 51200
    s_add_u32 s63, s59, 123648
    buffer_load_dwordx4 v253, s[44:47], s63 offen  lds
    buffer_load_dwordx4 v254, s[44:47], s63 offen offset:1024  lds
    v_mfma_f32_16x16x32_bf16 v[152:155], v[208:211], v[212:215], v[152:155]
    ds_read_b128 v[212:215], v252 offset:0
    v_cvt_pk_bf16_f32 v56, v140, v141
    v_cvt_pk_bf16_f32 v57, v142, v143
    v_perm_b32 v140, v84, v84, s69
    v_perm_b32 v141, v84, v84, s72
    v_perm_b32 v142, v85, v85, s69
    v_perm_b32 v143, v85, v85, s72
    v_mfma_f32_16x16x32_bf16 v[156:159], v[204:207], v[216:219], v[156:159]
    ds_read_b64_tr_b16 v[196:197], v250 offset:16384
    v_cvt_pk_bf16_f32 v58, v144, v145
    v_cvt_pk_bf16_f32 v59, v146, v147
    v_perm_b32 v144, v86, v86, s69
    v_perm_b32 v145, v86, v86, s72
    v_perm_b32 v146, v87, v87, s69
    v_perm_b32 v147, v87, v87, s72
    v_mfma_f32_16x16x32_bf16 v[160:163], v[208:211], v[216:219], v[160:163]
    ds_read_b128 v[216:219], v252 offset:1024
    v_cvt_pk_bf16_f32 v60, v148, v149
    v_cvt_pk_bf16_f32 v61, v150, v151
    v_perm_b32 v148, v88, v88, s69
    v_perm_b32 v149, v88, v88, s72
    v_perm_b32 v150, v89, v89, s69
    v_perm_b32 v151, v89, v89, s72
    v_mfma_f32_16x16x32_bf16 v[164:167], v[204:207], v[220:223], v[164:167]
    ds_read_b64_tr_b16 v[198:199], v250 offset:20480
    v_mfma_f32_16x16x32_bf16 v[168:171], v[208:211], v[220:223], v[168:171]
    ds_read_b128 v[220:223], v252 offset:2048
    s_waitcnt lgkmcnt(7)
    v_mfma_f32_16x16x32_bf16 v[172:175], v[204:207], v[224:227], v[172:175]
    ds_read_b64_tr_b16 v[200:201], v251 offset:16384
    v_mfma_f32_16x16x32_bf16 v[176:179], v[208:211], v[224:227], v[176:179]
    ds_read_b128 v[224:227], v252 offset:3072
    s_waitcnt lgkmcnt(8)
    v_mfma_f32_16x16x32_bf16 v[180:183], v[204:207], v[228:231], v[180:183]
    ds_read_b64_tr_b16 v[202:203], v251 offset:20480
    v_mfma_f32_16x16x32_bf16 v[184:187], v[208:211], v[228:231], v[184:187]
    ds_read_b128 v[228:231], v252 offset:4096
    s_waitcnt lgkmcnt(9)
    v_mfma_f32_16x16x32_bf16 v[188:191], v[204:207], v[232:235], v[188:191]
    v_mfma_f32_16x16x32_bf16 v[192:195], v[208:211], v[232:235], v[192:195]
    ds_read_b128 v[232:235], v252 offset:5120
    s_waitcnt lgkmcnt(6)
    v_mfma_f32_16x16x32_bf16 v[140:143], v[196:199], v[212:215], v[140:143]
    s_waitcnt lgkmcnt(2)
    v_mfma_f32_16x16x32_bf16 v[144:147], v[200:203], v[212:215], v[144:147]
    ds_read_b128 v[212:215], v252 offset:6144
    v_mfma_f32_16x16x32_bf16 v[148:151], v[196:199], v[216:219], v[148:151]
    s_barrier
    s_waitcnt vmcnt(8)
    s_add_u32 m0, s64, 122624
    s_add_u32 s62, s65, 147456
    buffer_load_dwordx4 v255, s[32:35], s62 offen offset:256 nt lds
    s_waitcnt vmcnt(8)
    s_add_u32 m0, s64, 126976
    s_add_u32 s62, s65, 135168
    buffer_load_dwordx4 v255, s[36:39], s62 offen nt lds
    s_waitcnt vmcnt(6)
    s_add_u32 m0, s64, 130944
    s_add_u32 s62, s65, 135168
    buffer_load_dwordx4 v255, s[36:39], s62 offen offset:128 nt lds
    s_add_u32 m0, s60, 59392
    s_add_u32 s63, s59, 164608
    buffer_load_dwordx4 v253, s[44:47], s63 offen  lds
    buffer_load_dwordx4 v254, s[44:47], s63 offen offset:1024  lds
    v_cvt_pk_bf16_f32 v62, v152, v153
    v_cvt_pk_bf16_f32 v63, v154, v155
    v_perm_b32 v152, v90, v90, s69
    v_perm_b32 v153, v90, v90, s72
    v_perm_b32 v154, v91, v91, s69
    v_perm_b32 v155, v91, v91, s72
    v_cvt_pk_bf16_f32 v64, v156, v157
    v_cvt_pk_bf16_f32 v65, v158, v159
    v_perm_b32 v156, v92, v92, s69
    v_perm_b32 v157, v92, v92, s72
    v_perm_b32 v158, v93, v93, s69
    v_perm_b32 v159, v93, v93, s72
    v_cvt_pk_bf16_f32 v66, v160, v161
    v_cvt_pk_bf16_f32 v67, v162, v163
    v_perm_b32 v160, v94, v94, s69
    v_perm_b32 v161, v94, v94, s72
    v_perm_b32 v162, v95, v95, s69
    v_perm_b32 v163, v95, v95, s72
    v_cvt_pk_bf16_f32 v68, v164, v165
    v_cvt_pk_bf16_f32 v69, v166, v167
    v_perm_b32 v164, v96, v96, s69
    v_perm_b32 v165, v96, v96, s72
    v_perm_b32 v166, v97, v97, s69
    v_perm_b32 v167, v97, v97, s72
    v_cvt_pk_bf16_f32 v70, v168, v169
    v_cvt_pk_bf16_f32 v71, v170, v171
    v_perm_b32 v168, v98, v98, s69
    v_perm_b32 v169, v98, v98, s72
    v_perm_b32 v170, v99, v99, s69
    v_perm_b32 v171, v99, v99, s72
    v_cvt_pk_bf16_f32 v72, v172, v173
    v_cvt_pk_bf16_f32 v73, v174, v175
    v_perm_b32 v172, v100, v100, s69
    v_perm_b32 v173, v100, v100, s72
    v_perm_b32 v174, v101, v101, s69
    v_perm_b32 v175, v101, v101, s72
    v_cvt_pk_bf16_f32 v74, v176, v177
    v_cvt_pk_bf16_f32 v75, v178, v179
    v_perm_b32 v176, v102, v102, s69
    v_perm_b32 v177, v102, v102, s72
    v_perm_b32 v178, v103, v103, s69
    v_perm_b32 v179, v103, v103, s72
    v_cvt_pk_bf16_f32 v76, v180, v181
    v_cvt_pk_bf16_f32 v77, v182, v183
    v_perm_b32 v180, v104, v104, s69
    v_perm_b32 v181, v104, v104, s72
    v_perm_b32 v182, v105, v105, s69
    v_perm_b32 v183, v105, v105, s72
    v_cvt_pk_bf16_f32 v78, v184, v185
    v_cvt_pk_bf16_f32 v79, v186, v187
    v_perm_b32 v184, v106, v106, s69
    v_perm_b32 v185, v106, v106, s72
    v_perm_b32 v186, v107, v107, s69
    v_perm_b32 v187, v107, v107, s72
    v_cvt_pk_bf16_f32 v80, v188, v189
    v_cvt_pk_bf16_f32 v81, v190, v191
    v_perm_b32 v188, v108, v108, s69
    v_perm_b32 v189, v108, v108, s72
    v_perm_b32 v190, v109, v109, s69
    v_perm_b32 v191, v109, v109, s72
    v_cvt_pk_bf16_f32 v82, v192, v193
    v_cvt_pk_bf16_f32 v83, v194, v195
    v_perm_b32 v192, v110, v110, s69
    v_perm_b32 v193, v110, v110, s72
    v_perm_b32 v194, v111, v111, s69
    v_perm_b32 v195, v111, v111, s72
    v_mfma_f32_16x16x32_bf16 v[152:155], v[200:203], v[216:219], v[152:155]
    ds_read_b128 v[216:219], v252 offset:7168
    v_mfma_f32_16x16x32_bf16 v[156:159], v[196:199], v[220:223], v[156:159]
    ds_read_b64_tr_b16 v[204:205], v250 offset:24576
    v_mfma_f32_16x16x32_bf16 v[160:163], v[200:203], v[220:223], v[160:163]
    ds_read_b128 v[220:223], v252 offset:8192
    v_mfma_f32_16x16x32_bf16 v[164:167], v[196:199], v[224:227], v[164:167]
    ds_read_b64_tr_b16 v[206:207], v250 offset:28672
    v_mfma_f32_16x16x32_bf16 v[168:171], v[200:203], v[224:227], v[168:171]
    ds_read_b128 v[224:227], v252 offset:9216
    s_waitcnt lgkmcnt(7)
    v_mfma_f32_16x16x32_bf16 v[172:175], v[196:199], v[228:231], v[172:175]
    ds_read_b64_tr_b16 v[208:209], v251 offset:24576
    v_mfma_f32_16x16x32_bf16 v[176:179], v[200:203], v[228:231], v[176:179]
    ds_read_b128 v[228:231], v252 offset:10240
    s_waitcnt lgkmcnt(8)
    v_mfma_f32_16x16x32_bf16 v[180:183], v[196:199], v[232:235], v[180:183]
    ds_read_b64_tr_b16 v[210:211], v251 offset:28672
    v_mfma_f32_16x16x32_bf16 v[184:187], v[200:203], v[232:235], v[184:187]
    ds_read_b128 v[232:235], v252 offset:11264
    s_waitcnt lgkmcnt(9)
    v_mfma_f32_16x16x32_bf16 v[188:191], v[196:199], v[212:215], v[188:191]
    v_mfma_f32_16x16x32_bf16 v[192:195], v[200:203], v[212:215], v[192:195]
    ds_read_b128 v[212:215], v252 offset:12288
    s_waitcnt lgkmcnt(6)
    v_mfma_f32_16x16x32_bf16 v[140:143], v[204:207], v[216:219], v[140:143]
    s_waitcnt lgkmcnt(2)
    v_mfma_f32_16x16x32_bf16 v[144:147], v[208:211], v[216:219], v[144:147]
    ds_read_b128 v[216:219], v252 offset:13312
    v_mfma_f32_16x16x32_bf16 v[148:151], v[204:207], v[220:223], v[148:151]
    s_barrier
    s_waitcnt vmcnt(8)
    s_add_u32 m0, s64, 134912
    s_add_u32 s62, s65, 135168
    buffer_load_dwordx4 v255, s[36:39], s62 offen offset:256 nt lds
    s_waitcnt vmcnt(8)
    s_add_u32 m0, s64, 139264
    s_add_u32 s62, s65, 159744
    buffer_load_dwordx4 v255, s[32:35], s62 offen nt lds
    s_waitcnt vmcnt(6)
    s_add_u32 m0, s64, 143232
    s_add_u32 s62, s65, 159744
    buffer_load_dwordx4 v255, s[32:35], s62 offen offset:128 nt lds
    s_add_u32 m0, s60, 67584
    s_add_u32 s63, s59, 205568
    buffer_load_dwordx4 v253, s[44:47], s63 offen  lds
    buffer_load_dwordx4 v254, s[44:47], s63 offen offset:1024  lds
    v_mfma_f32_16x16x32_bf16 v[152:155], v[208:211], v[220:223], v[152:155]
    ds_read_b128 v[220:223], v252 offset:14336
    v_mfma_f32_16x16x32_bf16 v[156:159], v[204:207], v[224:227], v[156:159]
    ds_read_b64_tr_b16 v[196:197], v250 offset:0
    v_mfma_f32_16x16x32_bf16 v[160:163], v[208:211], v[224:227], v[160:163]
    ds_read_b128 v[224:227], v252 offset:15360
    v_mfma_f32_16x16x32_bf16 v[164:167], v[204:207], v[228:231], v[164:167]
    ds_read_b64_tr_b16 v[198:199], v250 offset:4096
    v_mfma_f32_16x16x32_bf16 v[168:171], v[208:211], v[228:231], v[168:171]
    ds_read_b128 v[228:231], v252 offset:16384
    s_waitcnt lgkmcnt(7)
    v_mfma_f32_16x16x32_bf16 v[172:175], v[204:207], v[232:235], v[172:175]
    ds_read_b64_tr_b16 v[200:201], v251 offset:0
    v_mfma_f32_16x16x32_bf16 v[176:179], v[208:211], v[232:235], v[176:179]
    ds_read_b128 v[232:235], v252 offset:17408
    s_waitcnt lgkmcnt(8)
    v_mfma_f32_16x16x32_bf16 v[180:183], v[204:207], v[212:215], v[180:183]
    ds_read_b64_tr_b16 v[202:203], v251 offset:4096
    v_mfma_f32_16x16x32_bf16 v[184:187], v[208:211], v[212:215], v[184:187]
    ds_read_b128 v[212:215], v252 offset:18432
    s_waitcnt lgkmcnt(9)
    v_mfma_f32_16x16x32_bf16 v[188:191], v[204:207], v[216:219], v[188:191]
    v_mfma_f32_16x16x32_bf16 v[192:195], v[208:211], v[216:219], v[192:195]
    ds_read_b128 v[216:219], v252 offset:19456
    s_waitcnt lgkmcnt(6)
    v_mfma_f32_16x16x32_bf16 v[140:143], v[196:199], v[220:223], v[140:143]
    s_waitcnt lgkmcnt(2)
    v_mfma_f32_16x16x32_bf16 v[144:147], v[200:203], v[220:223], v[144:147]
    ds_read_b128 v[220:223], v252 offset:20480
    v_mfma_f32_16x16x32_bf16 v[148:151], v[196:199], v[224:227], v[148:151]
    s_barrier
    s_waitcnt vmcnt(8)
    s_add_u32 m0, s64, 147200
    s_add_u32 s62, s65, 159744
    buffer_load_dwordx4 v255, s[32:35], s62 offen offset:256 nt lds
    s_waitcnt vmcnt(8)
    s_add_u32 m0, s64, 151552
    s_add_u32 s62, s65, 147456
    buffer_load_dwordx4 v255, s[36:39], s62 offen nt lds
    s_waitcnt vmcnt(6)
    s_add_u32 m0, s64, 155520
    s_add_u32 s62, s65, 147456
    buffer_load_dwordx4 v255, s[36:39], s62 offen offset:128 nt lds
    s_waitcnt vmcnt(6)
    s_add_u32 m0, s64, 93952
    s_add_u32 s62, s65, 147456
    buffer_load_dwordx4 v255, s[36:39], s62 offen offset:256 nt lds
    s_add_u32 m0, s60, 43008
    s_add_u32 s63, s59, 1024
    buffer_load_dwordx4 v253, s[44:47], s63 offen  lds
    buffer_load_dwordx4 v254, s[44:47], s63 offen offset:1024  lds
    v_mfma_f32_16x16x32_bf16 v[152:155], v[200:203], v[224:227], v[152:155]
    ds_read_b128 v[224:227], v252 offset:21504
    v_mfma_f32_16x16x32_bf16 v[156:159], v[196:199], v[228:231], v[156:159]
    ds_read_b64_tr_b16 v[204:205], v250 offset:8192
    v_mfma_f32_16x16x32_bf16 v[160:163], v[200:203], v[228:231], v[160:163]
    ds_read_b128 v[228:231], v252 offset:22528
    v_mfma_f32_16x16x32_bf16 v[164:167], v[196:199], v[232:235], v[164:167]
    ds_read_b64_tr_b16 v[206:207], v250 offset:12288
    v_mfma_f32_16x16x32_bf16 v[168:171], v[200:203], v[232:235], v[168:171]
    ds_read_b128 v[232:235], v252 offset:23552
    s_waitcnt lgkmcnt(7)
    v_mfma_f32_16x16x32_bf16 v[172:175], v[196:199], v[212:215], v[172:175]
    ds_read_b64_tr_b16 v[208:209], v251 offset:8192
    v_mfma_f32_16x16x32_bf16 v[176:179], v[200:203], v[212:215], v[176:179]
    ds_read_b128 v[212:215], v252 offset:24576
    s_waitcnt lgkmcnt(8)
    v_mfma_f32_16x16x32_bf16 v[180:183], v[196:199], v[216:219], v[180:183]
    ds_read_b64_tr_b16 v[210:211], v251 offset:12288
    v_mfma_f32_16x16x32_bf16 v[184:187], v[200:203], v[216:219], v[184:187]
    ds_read_b128 v[216:219], v252 offset:25600
    s_waitcnt lgkmcnt(9)
    v_mfma_f32_16x16x32_bf16 v[188:191], v[196:199], v[220:223], v[188:191]
    v_mfma_f32_16x16x32_bf16 v[192:195], v[200:203], v[220:223], v[192:195]
    ds_read_b128 v[220:223], v252 offset:26624
    s_waitcnt lgkmcnt(6)
    v_mfma_f32_16x16x32_bf16 v[140:143], v[204:207], v[224:227], v[140:143]
    s_waitcnt lgkmcnt(2)
    v_mfma_f32_16x16x32_bf16 v[144:147], v[208:211], v[224:227], v[144:147]
    ds_read_b128 v[224:227], v252 offset:27648
    v_mfma_f32_16x16x32_bf16 v[148:151], v[204:207], v[228:231], v[148:151]
    s_barrier
    s_waitcnt vmcnt(8)
    s_add_u32 m0, s64, 98304
    s_add_u32 s62, s65, 172032
    buffer_load_dwordx4 v255, s[32:35], s62 offen nt lds
    s_waitcnt vmcnt(6)
    s_add_u32 m0, s64, 102272
    s_add_u32 s62, s65, 172032
    buffer_load_dwordx4 v255, s[32:35], s62 offen offset:128 nt lds
    s_waitcnt vmcnt(6)
    s_add_u32 m0, s64, 106240
    s_add_u32 s62, s65, 172032
    buffer_load_dwordx4 v255, s[32:35], s62 offen offset:256 nt lds
    s_add_u32 m0, s60, 51200
    s_add_u32 s63, s59, 41984
    buffer_load_dwordx4 v253, s[44:47], s63 offen  lds
    buffer_load_dwordx4 v254, s[44:47], s63 offen offset:1024  lds
    v_mfma_f32_16x16x32_bf16 v[152:155], v[208:211], v[228:231], v[152:155]
    ds_read_b128 v[228:231], v252 offset:28672
    v_mfma_f32_16x16x32_bf16 v[156:159], v[204:207], v[232:235], v[156:159]
    ds_read_b64_tr_b16 v[196:197], v250 offset:16384
    v_mfma_f32_16x16x32_bf16 v[160:163], v[208:211], v[232:235], v[160:163]
    ds_read_b128 v[232:235], v252 offset:29696
    v_mfma_f32_16x16x32_bf16 v[164:167], v[204:207], v[212:215], v[164:167]
    ds_read_b64_tr_b16 v[198:199], v250 offset:20480
    v_mfma_f32_16x16x32_bf16 v[168:171], v[208:211], v[212:215], v[168:171]
    ds_read_b128 v[212:215], v252 offset:30720
    s_waitcnt lgkmcnt(7)
    v_mfma_f32_16x16x32_bf16 v[172:175], v[204:207], v[216:219], v[172:175]
    ds_read_b64_tr_b16 v[200:201], v251 offset:16384
    v_mfma_f32_16x16x32_bf16 v[176:179], v[208:211], v[216:219], v[176:179]
    ds_read_b128 v[216:219], v252 offset:31744
    s_waitcnt lgkmcnt(8)
    v_mfma_f32_16x16x32_bf16 v[180:183], v[204:207], v[220:223], v[180:183]
    ds_read_b64_tr_b16 v[202:203], v251 offset:20480
    v_mfma_f32_16x16x32_bf16 v[184:187], v[208:211], v[220:223], v[184:187]
    ds_read_b128 v[220:223], v252 offset:32768
    s_waitcnt lgkmcnt(9)
    v_mfma_f32_16x16x32_bf16 v[188:191], v[204:207], v[224:227], v[188:191]
    v_mfma_f32_16x16x32_bf16 v[192:195], v[208:211], v[224:227], v[192:195]
    ds_read_b128 v[224:227], v252 offset:33792
    s_waitcnt lgkmcnt(6)
    v_mfma_f32_16x16x32_bf16 v[140:143], v[196:199], v[228:231], v[140:143]
    s_waitcnt lgkmcnt(2)
    v_mfma_f32_16x16x32_bf16 v[144:147], v[200:203], v[228:231], v[144:147]
    ds_read_b128 v[228:231], v252 offset:34816
    v_mfma_f32_16x16x32_bf16 v[148:151], v[196:199], v[232:235], v[148:151]
    s_barrier
    s_waitcnt vmcnt(8)
    s_add_u32 m0, s64, 110592
    s_add_u32 s62, s65, 159744
    buffer_load_dwordx4 v255, s[36:39], s62 offen nt lds
    s_waitcnt vmcnt(8)
    s_add_u32 m0, s64, 114560
    s_add_u32 s62, s65, 159744
    buffer_load_dwordx4 v255, s[36:39], s62 offen offset:128 nt lds
    s_waitcnt vmcnt(6)
    s_add_u32 m0, s64, 118528
    s_add_u32 s62, s65, 159744
    buffer_load_dwordx4 v255, s[36:39], s62 offen offset:256 nt lds
    s_add_u32 m0, s60, 59392
    s_add_u32 s63, s59, 82944
    buffer_load_dwordx4 v253, s[44:47], s63 offen  lds
    buffer_load_dwordx4 v254, s[44:47], s63 offen offset:1024  lds
    v_mfma_f32_16x16x32_bf16 v[152:155], v[200:203], v[232:235], v[152:155]
    ds_read_b128 v[232:235], v252 offset:35840
    v_mfma_f32_16x16x32_bf16 v[156:159], v[196:199], v[212:215], v[156:159]
    ds_read_b64_tr_b16 v[204:205], v250 offset:24576
    v_mfma_f32_16x16x32_bf16 v[160:163], v[200:203], v[212:215], v[160:163]
    ds_read_b128 v[212:215], v252 offset:36864
    v_mfma_f32_16x16x32_bf16 v[164:167], v[196:199], v[216:219], v[164:167]
    ds_read_b64_tr_b16 v[206:207], v250 offset:28672
    v_mfma_f32_16x16x32_bf16 v[168:171], v[200:203], v[216:219], v[168:171]
    ds_read_b128 v[216:219], v252 offset:37888
    s_waitcnt lgkmcnt(7)
    v_mfma_f32_16x16x32_bf16 v[172:175], v[196:199], v[220:223], v[172:175]
    ds_read_b64_tr_b16 v[208:209], v251 offset:24576
    v_mfma_f32_16x16x32_bf16 v[176:179], v[200:203], v[220:223], v[176:179]
    ds_read_b128 v[220:223], v252 offset:38912
    s_waitcnt lgkmcnt(8)
    v_mfma_f32_16x16x32_bf16 v[180:183], v[196:199], v[224:227], v[180:183]
    ds_read_b64_tr_b16 v[210:211], v251 offset:28672
    v_mfma_f32_16x16x32_bf16 v[184:187], v[200:203], v[224:227], v[184:187]
    ds_read_b128 v[224:227], v252 offset:39936
    s_waitcnt lgkmcnt(9)
    v_mfma_f32_16x16x32_bf16 v[188:191], v[196:199], v[228:231], v[188:191]
    v_mfma_f32_16x16x32_bf16 v[192:195], v[200:203], v[228:231], v[192:195]
    ds_read_b128 v[228:231], v252 offset:40960
    s_waitcnt lgkmcnt(6)
    v_mfma_f32_16x16x32_bf16 v[140:143], v[204:207], v[232:235], v[140:143]
    s_waitcnt lgkmcnt(2)
    v_mfma_f32_16x16x32_bf16 v[144:147], v[208:211], v[232:235], v[144:147]
    ds_read_b128 v[232:235], v252 offset:41984
    v_mfma_f32_16x16x32_bf16 v[148:151], v[204:207], v[212:215], v[148:151]
    s_barrier
    s_waitcnt vmcnt(8)
    s_add_u32 m0, s64, 122880
    s_add_u32 s62, s65, 184320
    buffer_load_dwordx4 v255, s[32:35], s62 offen nt lds
    s_waitcnt vmcnt(8)
    s_add_u32 m0, s64, 126848
    s_add_u32 s62, s65, 184320
    buffer_load_dwordx4 v255, s[32:35], s62 offen offset:128 nt lds
    s_waitcnt vmcnt(6)
    s_add_u32 m0, s64, 130816
    s_add_u32 s62, s65, 184320
    buffer_load_dwordx4 v255, s[32:35], s62 offen offset:256 nt lds
    s_add_u32 m0, s60, 67584
    s_add_u32 s63, s59, 123904
    buffer_load_dwordx4 v253, s[44:47], s63 offen  lds
    buffer_load_dwordx4 v254, s[44:47], s63 offen offset:1024  lds
    v_mfma_f32_16x16x32_bf16 v[152:155], v[208:211], v[212:215], v[152:155]
    ds_read_b128 v[212:215], v252 offset:0
    v_cvt_pk_bf16_f32 v84, v140, v141
    v_cvt_pk_bf16_f32 v85, v142, v143
    v_perm_b32 v140, v112, v112, s69
    v_perm_b32 v141, v112, v112, s72
    v_perm_b32 v142, v113, v113, s69
    v_perm_b32 v143, v113, v113, s72
    v_mfma_f32_16x16x32_bf16 v[156:159], v[204:207], v[216:219], v[156:159]
    ds_read_b64_tr_b16 v[196:197], v250 offset:0
    v_cvt_pk_bf16_f32 v86, v144, v145
    v_cvt_pk_bf16_f32 v87, v146, v147
    v_perm_b32 v144, v114, v114, s69
    v_perm_b32 v145, v114, v114, s72
    v_perm_b32 v146, v115, v115, s69
    v_perm_b32 v147, v115, v115, s72
    v_mfma_f32_16x16x32_bf16 v[160:163], v[208:211], v[216:219], v[160:163]
    ds_read_b128 v[216:219], v252 offset:1024
    v_cvt_pk_bf16_f32 v88, v148, v149
    v_cvt_pk_bf16_f32 v89, v150, v151
    v_perm_b32 v148, v116, v116, s69
    v_perm_b32 v149, v116, v116, s72
    v_perm_b32 v150, v117, v117, s69
    v_perm_b32 v151, v117, v117, s72
    v_mfma_f32_16x16x32_bf16 v[164:167], v[204:207], v[220:223], v[164:167]
    ds_read_b64_tr_b16 v[198:199], v250 offset:4096
    v_mfma_f32_16x16x32_bf16 v[168:171], v[208:211], v[220:223], v[168:171]
    ds_read_b128 v[220:223], v252 offset:2048
    s_waitcnt lgkmcnt(7)
    v_mfma_f32_16x16x32_bf16 v[172:175], v[204:207], v[224:227], v[172:175]
    ds_read_b64_tr_b16 v[200:201], v251 offset:0
    v_mfma_f32_16x16x32_bf16 v[176:179], v[208:211], v[224:227], v[176:179]
    ds_read_b128 v[224:227], v252 offset:3072
    s_waitcnt lgkmcnt(8)
    v_mfma_f32_16x16x32_bf16 v[180:183], v[204:207], v[228:231], v[180:183]
    ds_read_b64_tr_b16 v[202:203], v251 offset:4096
    v_mfma_f32_16x16x32_bf16 v[184:187], v[208:211], v[228:231], v[184:187]
    ds_read_b128 v[228:231], v252 offset:4096
    s_waitcnt lgkmcnt(9)
    v_mfma_f32_16x16x32_bf16 v[188:191], v[204:207], v[232:235], v[188:191]
    v_mfma_f32_16x16x32_bf16 v[192:195], v[208:211], v[232:235], v[192:195]
    ds_read_b128 v[232:235], v252 offset:5120
    s_waitcnt lgkmcnt(6)
    v_mfma_f32_16x16x32_bf16 v[140:143], v[196:199], v[212:215], v[140:143]
    s_waitcnt lgkmcnt(2)
    v_mfma_f32_16x16x32_bf16 v[144:147], v[200:203], v[212:215], v[144:147]
    ds_read_b128 v[212:215], v252 offset:6144
    v_mfma_f32_16x16x32_bf16 v[148:151], v[196:199], v[216:219], v[148:151]
    s_barrier
    s_waitcnt vmcnt(8)
    s_add_u32 m0, s64, 135168
    s_add_u32 s62, s65, 172032
    buffer_load_dwordx4 v255, s[36:39], s62 offen nt lds
    s_waitcnt vmcnt(8)
    s_add_u32 m0, s64, 139136
    s_add_u32 s62, s65, 172032
    buffer_load_dwordx4 v255, s[36:39], s62 offen offset:128 nt lds
    s_waitcnt vmcnt(6)
    s_add_u32 m0, s64, 143104
    s_add_u32 s62, s65, 172032
    buffer_load_dwordx4 v255, s[36:39], s62 offen offset:256 nt lds
    s_add_u32 m0, s60, 43008
    s_add_u32 s63, s59, 164864
    buffer_load_dwordx4 v253, s[44:47], s63 offen  lds
    buffer_load_dwordx4 v254, s[44:47], s63 offen offset:1024  lds
    v_cvt_pk_bf16_f32 v90, v152, v153
    v_cvt_pk_bf16_f32 v91, v154, v155
    v_perm_b32 v152, v118, v118, s69
    v_perm_b32 v153, v118, v118, s72
    v_perm_b32 v154, v119, v119, s69
    v_perm_b32 v155, v119, v119, s72
    v_cvt_pk_bf16_f32 v92, v156, v157
    v_cvt_pk_bf16_f32 v93, v158, v159
    v_perm_b32 v156, v120, v120, s69
    v_perm_b32 v157, v120, v120, s72
    v_perm_b32 v158, v121, v121, s69
    v_perm_b32 v159, v121, v121, s72
    v_cvt_pk_bf16_f32 v94, v160, v161
    v_cvt_pk_bf16_f32 v95, v162, v163
    v_perm_b32 v160, v122, v122, s69
    v_perm_b32 v161, v122, v122, s72
    v_perm_b32 v162, v123, v123, s69
    v_perm_b32 v163, v123, v123, s72
    v_cvt_pk_bf16_f32 v96, v164, v165
    v_cvt_pk_bf16_f32 v97, v166, v167
    v_perm_b32 v164, v124, v124, s69
    v_perm_b32 v165, v124, v124, s72
    v_perm_b32 v166, v125, v125, s69
    v_perm_b32 v167, v125, v125, s72
    v_cvt_pk_bf16_f32 v98, v168, v169
    v_cvt_pk_bf16_f32 v99, v170, v171
    v_perm_b32 v168, v126, v126, s69
    v_perm_b32 v169, v126, v126, s72
    v_perm_b32 v170, v127, v127, s69
    v_perm_b32 v171, v127, v127, s72
    v_cvt_pk_bf16_f32 v100, v172, v173
    v_cvt_pk_bf16_f32 v101, v174, v175
    v_perm_b32 v172, v128, v128, s69
    v_perm_b32 v173, v128, v128, s72
    v_perm_b32 v174, v129, v129, s69
    v_perm_b32 v175, v129, v129, s72
    v_cvt_pk_bf16_f32 v102, v176, v177
    v_cvt_pk_bf16_f32 v103, v178, v179
    v_perm_b32 v176, v130, v130, s69
    v_perm_b32 v177, v130, v130, s72
    v_perm_b32 v178, v131, v131, s69
    v_perm_b32 v179, v131, v131, s72
    v_cvt_pk_bf16_f32 v104, v180, v181
    v_cvt_pk_bf16_f32 v105, v182, v183
    v_perm_b32 v180, v132, v132, s69
    v_perm_b32 v181, v132, v132, s72
    v_perm_b32 v182, v133, v133, s69
    v_perm_b32 v183, v133, v133, s72
    v_cvt_pk_bf16_f32 v106, v184, v185
    v_cvt_pk_bf16_f32 v107, v186, v187
    v_perm_b32 v184, v134, v134, s69
    v_perm_b32 v185, v134, v134, s72
    v_perm_b32 v186, v135, v135, s69
    v_perm_b32 v187, v135, v135, s72
    v_cvt_pk_bf16_f32 v108, v188, v189
    v_cvt_pk_bf16_f32 v109, v190, v191
    v_perm_b32 v188, v136, v136, s69
    v_perm_b32 v189, v136, v136, s72
    v_perm_b32 v190, v137, v137, s69
    v_perm_b32 v191, v137, v137, s72
    v_cvt_pk_bf16_f32 v110, v192, v193
    v_cvt_pk_bf16_f32 v111, v194, v195
    v_perm_b32 v192, v138, v138, s69
    v_perm_b32 v193, v138, v138, s72
    v_perm_b32 v194, v139, v139, s69
    v_perm_b32 v195, v139, v139, s72
    v_mfma_f32_16x16x32_bf16 v[152:155], v[200:203], v[216:219], v[152:155]
    ds_read_b128 v[216:219], v252 offset:7168
    v_mfma_f32_16x16x32_bf16 v[156:159], v[196:199], v[220:223], v[156:159]
    ds_read_b64_tr_b16 v[204:205], v250 offset:8192
    v_mfma_f32_16x16x32_bf16 v[160:163], v[200:203], v[220:223], v[160:163]
    ds_read_b128 v[220:223], v252 offset:8192
    v_mfma_f32_16x16x32_bf16 v[164:167], v[196:199], v[224:227], v[164:167]
    ds_read_b64_tr_b16 v[206:207], v250 offset:12288
    v_mfma_f32_16x16x32_bf16 v[168:171], v[200:203], v[224:227], v[168:171]
    ds_read_b128 v[224:227], v252 offset:9216
    s_waitcnt lgkmcnt(7)
    v_mfma_f32_16x16x32_bf16 v[172:175], v[196:199], v[228:231], v[172:175]
    ds_read_b64_tr_b16 v[208:209], v251 offset:8192
    v_mfma_f32_16x16x32_bf16 v[176:179], v[200:203], v[228:231], v[176:179]
    ds_read_b128 v[228:231], v252 offset:10240
    s_waitcnt lgkmcnt(8)
    v_mfma_f32_16x16x32_bf16 v[180:183], v[196:199], v[232:235], v[180:183]
    ds_read_b64_tr_b16 v[210:211], v251 offset:12288
    v_mfma_f32_16x16x32_bf16 v[184:187], v[200:203], v[232:235], v[184:187]
    ds_read_b128 v[232:235], v252 offset:11264
    s_waitcnt lgkmcnt(9)
    v_mfma_f32_16x16x32_bf16 v[188:191], v[196:199], v[212:215], v[188:191]
    v_mfma_f32_16x16x32_bf16 v[192:195], v[200:203], v[212:215], v[192:195]
    ds_read_b128 v[212:215], v252 offset:12288
    s_waitcnt lgkmcnt(6)
    v_mfma_f32_16x16x32_bf16 v[140:143], v[204:207], v[216:219], v[140:143]
    s_waitcnt lgkmcnt(2)
    v_mfma_f32_16x16x32_bf16 v[144:147], v[208:211], v[216:219], v[144:147]
    ds_read_b128 v[216:219], v252 offset:13312
    v_mfma_f32_16x16x32_bf16 v[148:151], v[204:207], v[220:223], v[148:151]
    s_barrier
    s_waitcnt vmcnt(8)
    s_add_u32 m0, s64, 147456
    s_add_u32 s62, s65, 184320
    buffer_load_dwordx4 v255, s[36:39], s62 offen nt lds
    s_waitcnt vmcnt(8)
    s_add_u32 m0, s64, 151424
    s_add_u32 s62, s65, 184320
    buffer_load_dwordx4 v255, s[36:39], s62 offen offset:128 nt lds
    s_waitcnt vmcnt(6)
    s_add_u32 m0, s64, 155392
    s_add_u32 s62, s65, 184320
    buffer_load_dwordx4 v255, s[36:39], s62 offen offset:256 nt lds
    s_waitcnt vmcnt(6)
    s_add_u32 m0, s64, 94208
    s_add_u32 s62, s65, 196608
    buffer_load_dwordx4 v255, s[32:35], s62 offen nt lds
    s_add_u32 m0, s60, 51200
    s_add_u32 s63, s59, 205824
    buffer_load_dwordx4 v253, s[44:47], s63 offen  lds
    buffer_load_dwordx4 v254, s[44:47], s63 offen offset:1024  lds
    v_mfma_f32_16x16x32_bf16 v[152:155], v[208:211], v[220:223], v[152:155]
    ds_read_b128 v[220:223], v252 offset:14336
    v_mfma_f32_16x16x32_bf16 v[156:159], v[204:207], v[224:227], v[156:159]
    ds_read_b64_tr_b16 v[196:197], v250 offset:16384
    v_mfma_f32_16x16x32_bf16 v[160:163], v[208:211], v[224:227], v[160:163]
    ds_read_b128 v[224:227], v252 offset:15360
    v_mfma_f32_16x16x32_bf16 v[164:167], v[204:207], v[228:231], v[164:167]
    ds_read_b64_tr_b16 v[198:199], v250 offset:20480
    v_mfma_f32_16x16x32_bf16 v[168:171], v[208:211], v[228:231], v[168:171]
    ds_read_b128 v[228:231], v252 offset:16384
    s_waitcnt lgkmcnt(7)
    v_mfma_f32_16x16x32_bf16 v[172:175], v[204:207], v[232:235], v[172:175]
    ds_read_b64_tr_b16 v[200:201], v251 offset:16384
    v_mfma_f32_16x16x32_bf16 v[176:179], v[208:211], v[232:235], v[176:179]
    ds_read_b128 v[232:235], v252 offset:17408
    s_waitcnt lgkmcnt(8)
    v_mfma_f32_16x16x32_bf16 v[180:183], v[204:207], v[212:215], v[180:183]
    ds_read_b64_tr_b16 v[202:203], v251 offset:20480
    v_mfma_f32_16x16x32_bf16 v[184:187], v[208:211], v[212:215], v[184:187]
    ds_read_b128 v[212:215], v252 offset:18432
    s_waitcnt lgkmcnt(9)
    v_mfma_f32_16x16x32_bf16 v[188:191], v[204:207], v[216:219], v[188:191]
    v_mfma_f32_16x16x32_bf16 v[192:195], v[208:211], v[216:219], v[192:195]
    ds_read_b128 v[216:219], v252 offset:19456
    s_waitcnt lgkmcnt(6)
    v_mfma_f32_16x16x32_bf16 v[140:143], v[196:199], v[220:223], v[140:143]
    s_waitcnt lgkmcnt(2)
    v_mfma_f32_16x16x32_bf16 v[144:147], v[200:203], v[220:223], v[144:147]
    ds_read_b128 v[220:223], v252 offset:20480
    v_mfma_f32_16x16x32_bf16 v[148:151], v[196:199], v[224:227], v[148:151]
    s_barrier
    s_waitcnt vmcnt(8)
    s_add_u32 m0, s64, 98176
    s_add_u32 s62, s65, 196608
    buffer_load_dwordx4 v255, s[32:35], s62 offen offset:128 nt lds
    s_waitcnt vmcnt(6)
    s_add_u32 m0, s64, 102144
    s_add_u32 s62, s65, 196608
    buffer_load_dwordx4 v255, s[32:35], s62 offen offset:256 nt lds
    s_waitcnt vmcnt(6)
    s_add_u32 m0, s64, 106496
    s_add_u32 s62, s65, 208896
    buffer_load_dwordx4 v255, s[32:35], s62 offen nt lds
    s_add_u32 s59, s59, 245760
    s_add_u32 m0, s60, 59392
    s_add_u32 s63, s59, 81920
    buffer_load_dwordx4 v253, s[44:47], s63 offen  lds
    buffer_load_dwordx4 v254, s[44:47], s63 offen offset:1024  lds
    v_mfma_f32_16x16x32_bf16 v[152:155], v[200:203], v[224:227], v[152:155]
    ds_read_b128 v[224:227], v252 offset:21504
    v_mfma_f32_16x16x32_bf16 v[156:159], v[196:199], v[228:231], v[156:159]
    ds_read_b64_tr_b16 v[204:205], v250 offset:24576
    v_mfma_f32_16x16x32_bf16 v[160:163], v[200:203], v[228:231], v[160:163]
    ds_read_b128 v[228:231], v252 offset:22528
    v_mfma_f32_16x16x32_bf16 v[164:167], v[196:199], v[232:235], v[164:167]
    ds_read_b64_tr_b16 v[206:207], v250 offset:28672
    v_mfma_f32_16x16x32_bf16 v[168:171], v[200:203], v[232:235], v[168:171]
    ds_read_b128 v[232:235], v252 offset:23552
    s_waitcnt lgkmcnt(7)
    v_mfma_f32_16x16x32_bf16 v[172:175], v[196:199], v[212:215], v[172:175]
    ds_read_b64_tr_b16 v[208:209], v251 offset:24576
    v_mfma_f32_16x16x32_bf16 v[176:179], v[200:203], v[212:215], v[176:179]
    ds_read_b128 v[212:215], v252 offset:24576
    s_waitcnt lgkmcnt(8)
    v_mfma_f32_16x16x32_bf16 v[180:183], v[196:199], v[216:219], v[180:183]
    ds_read_b64_tr_b16 v[210:211], v251 offset:28672
    v_mfma_f32_16x16x32_bf16 v[184:187], v[200:203], v[216:219], v[184:187]
    ds_read_b128 v[216:219], v252 offset:25600
    s_waitcnt lgkmcnt(9)
    v_mfma_f32_16x16x32_bf16 v[188:191], v[196:199], v[220:223], v[188:191]
    v_mfma_f32_16x16x32_bf16 v[192:195], v[200:203], v[220:223], v[192:195]
    ds_read_b128 v[220:223], v252 offset:26624
    s_waitcnt lgkmcnt(6)
    v_mfma_f32_16x16x32_bf16 v[140:143], v[204:207], v[224:227], v[140:143]
    s_waitcnt lgkmcnt(2)
    v_mfma_f32_16x16x32_bf16 v[144:147], v[208:211], v[224:227], v[144:147]
    ds_read_b128 v[224:227], v252 offset:27648
    v_mfma_f32_16x16x32_bf16 v[148:151], v[204:207], v[228:231], v[148:151]
    s_barrier
    s_waitcnt vmcnt(8)
    s_add_u32 m0, s64, 110464
    s_add_u32 s62, s65, 208896
    buffer_load_dwordx4 v255, s[32:35], s62 offen offset:128 nt lds
    s_waitcnt vmcnt(8)
    s_add_u32 m0, s64, 114432
    s_add_u32 s62, s65, 208896
    buffer_load_dwordx4 v255, s[32:35], s62 offen offset:256 nt lds
    s_waitcnt vmcnt(6)
    s_add_u32 m0, s64, 118784
    s_add_u32 s62, s65, 196608
    buffer_load_dwordx4 v255, s[36:39], s62 offen nt lds
    s_add_u32 m0, s60, 67584
    s_add_u32 s63, s59, 122880
    buffer_load_dwordx4 v253, s[44:47], s63 offen  lds
    buffer_load_dwordx4 v254, s[44:47], s63 offen offset:1024  lds
    v_mfma_f32_16x16x32_bf16 v[152:155], v[208:211], v[228:231], v[152:155]
    ds_read_b128 v[228:231], v252 offset:28672
    v_mfma_f32_16x16x32_bf16 v[156:159], v[204:207], v[232:235], v[156:159]
    ds_read_b64_tr_b16 v[196:197], v250 offset:0
    v_mfma_f32_16x16x32_bf16 v[160:163], v[208:211], v[232:235], v[160:163]
    ds_read_b128 v[232:235], v252 offset:29696
    v_mfma_f32_16x16x32_bf16 v[164:167], v[204:207], v[212:215], v[164:167]
    ds_read_b64_tr_b16 v[198:199], v250 offset:4096
    v_mfma_f32_16x16x32_bf16 v[168:171], v[208:211], v[212:215], v[168:171]
    ds_read_b128 v[212:215], v252 offset:30720
    s_waitcnt lgkmcnt(7)
    v_mfma_f32_16x16x32_bf16 v[172:175], v[204:207], v[216:219], v[172:175]
    ds_read_b64_tr_b16 v[200:201], v251 offset:0
    v_mfma_f32_16x16x32_bf16 v[176:179], v[208:211], v[216:219], v[176:179]
    ds_read_b128 v[216:219], v252 offset:31744
    s_waitcnt lgkmcnt(8)
    v_mfma_f32_16x16x32_bf16 v[180:183], v[204:207], v[220:223], v[180:183]
    ds_read_b64_tr_b16 v[202:203], v251 offset:4096
    v_mfma_f32_16x16x32_bf16 v[184:187], v[208:211], v[220:223], v[184:187]
    ds_read_b128 v[220:223], v252 offset:32768
    s_waitcnt lgkmcnt(9)
    v_mfma_f32_16x16x32_bf16 v[188:191], v[204:207], v[224:227], v[188:191]
    v_mfma_f32_16x16x32_bf16 v[192:195], v[208:211], v[224:227], v[192:195]
    ds_read_b128 v[224:227], v252 offset:33792
    s_waitcnt lgkmcnt(6)
    v_mfma_f32_16x16x32_bf16 v[140:143], v[196:199], v[228:231], v[140:143]
    s_waitcnt lgkmcnt(2)
    v_mfma_f32_16x16x32_bf16 v[144:147], v[200:203], v[228:231], v[144:147]
    ds_read_b128 v[228:231], v252 offset:34816
    v_mfma_f32_16x16x32_bf16 v[148:151], v[196:199], v[232:235], v[148:151]
    s_barrier
    s_add_u32 m0, s60, 43008
    s_add_u32 s63, s59, 0
    buffer_load_dwordx4 v253, s[44:47], s63 offen  lds
    buffer_load_dwordx4 v254, s[44:47], s63 offen offset:1024  lds
    s_waitcnt vmcnt(10)
    s_add_u32 m0, s64, 122752
    s_add_u32 s62, s65, 196608
    buffer_load_dwordx4 v255, s[36:39], s62 offen offset:128 nt lds
    s_waitcnt vmcnt(10)
    s_add_u32 m0, s64, 126720
    s_add_u32 s62, s65, 196608
    buffer_load_dwordx4 v255, s[36:39], s62 offen offset:256 nt lds
    s_waitcnt vmcnt(8)
    s_add_u32 m0, s64, 131072
    s_add_u32 s62, s65, 221184
    buffer_load_dwordx4 v255, s[32:35], s62 offen nt lds
    v_mfma_f32_16x16x32_bf16 v[152:155], v[200:203], v[232:235], v[152:155]
    ds_read_b128 v[232:235], v252 offset:35840
    v_mfma_f32_16x16x32_bf16 v[156:159], v[196:199], v[212:215], v[156:159]
    ds_read_b64_tr_b16 v[204:205], v250 offset:8192
    v_mfma_f32_16x16x32_bf16 v[160:163], v[200:203], v[212:215], v[160:163]
    ds_read_b128 v[212:215], v252 offset:36864
    v_mfma_f32_16x16x32_bf16 v[164:167], v[196:199], v[216:219], v[164:167]
    ds_read_b64_tr_b16 v[206:207], v250 offset:12288
    v_mfma_f32_16x16x32_bf16 v[168:171], v[200:203], v[216:219], v[168:171]
    ds_read_b128 v[216:219], v252 offset:37888
    s_waitcnt lgkmcnt(7)
    v_mfma_f32_16x16x32_bf16 v[172:175], v[196:199], v[220:223], v[172:175]
    ds_read_b64_tr_b16 v[208:209], v251 offset:8192
    v_mfma_f32_16x16x32_bf16 v[176:179], v[200:203], v[220:223], v[176:179]
    ds_read_b128 v[220:223], v252 offset:38912
    s_waitcnt lgkmcnt(8)
    v_mfma_f32_16x16x32_bf16 v[180:183], v[196:199], v[224:227], v[180:183]
    ds_read_b64_tr_b16 v[210:211], v251 offset:12288
    v_mfma_f32_16x16x32_bf16 v[184:187], v[200:203], v[224:227], v[184:187]
    ds_read_b128 v[224:227], v252 offset:39936
    s_waitcnt lgkmcnt(9)
    v_mfma_f32_16x16x32_bf16 v[188:191], v[196:199], v[228:231], v[188:191]
    v_mfma_f32_16x16x32_bf16 v[192:195], v[200:203], v[228:231], v[192:195]
    ds_read_b128 v[228:231], v252 offset:40960
    s_waitcnt lgkmcnt(6)
    v_mfma_f32_16x16x32_bf16 v[140:143], v[204:207], v[232:235], v[140:143]
    s_waitcnt lgkmcnt(2)
    v_mfma_f32_16x16x32_bf16 v[144:147], v[208:211], v[232:235], v[144:147]
    ds_read_b128 v[232:235], v252 offset:41984
    v_mfma_f32_16x16x32_bf16 v[148:151], v[204:207], v[212:215], v[148:151]
    v_mfma_f32_16x16x32_bf16 v[152:155], v[208:211], v[212:215], v[152:155]
    v_mfma_f32_16x16x32_bf16 v[156:159], v[204:207], v[216:219], v[156:159]
    v_mfma_f32_16x16x32_bf16 v[160:163], v[208:211], v[216:219], v[160:163]
    v_mfma_f32_16x16x32_bf16 v[164:167], v[204:207], v[220:223], v[164:167]
    v_mfma_f32_16x16x32_bf16 v[168:171], v[208:211], v[220:223], v[168:171]
    s_waitcnt lgkmcnt(2)
    v_mfma_f32_16x16x32_bf16 v[172:175], v[204:207], v[224:227], v[172:175]
    v_mfma_f32_16x16x32_bf16 v[176:179], v[208:211], v[224:227], v[176:179]
    s_waitcnt lgkmcnt(1)
    v_mfma_f32_16x16x32_bf16 v[180:183], v[204:207], v[228:231], v[180:183]
    v_mfma_f32_16x16x32_bf16 v[184:187], v[208:211], v[228:231], v[184:187]
    s_waitcnt lgkmcnt(0)
    v_mfma_f32_16x16x32_bf16 v[188:191], v[204:207], v[232:235], v[188:191]
    v_mfma_f32_16x16x32_bf16 v[192:195], v[208:211], v[232:235], v[192:195]
    s_barrier
    s_add_u32 m0, s60, 51200
    s_add_u32 s63, s59, 40960
    buffer_load_dwordx4 v253, s[44:47], s63 offen  lds
    buffer_load_dwordx4 v254, s[44:47], s63 offen offset:1024  lds
    s_waitcnt vmcnt(10)
    s_add_u32 m0, s64, 135040
    s_add_u32 s62, s65, 221184
    buffer_load_dwordx4 v255, s[32:35], s62 offen offset:128 nt lds
    s_waitcnt vmcnt(10)
    s_add_u32 m0, s64, 139008
    s_add_u32 s62, s65, 221184
    buffer_load_dwordx4 v255, s[32:35], s62 offen offset:256 nt lds
    s_waitcnt vmcnt(6)
    s_add_u32 m0, s64, 143360
    s_add_u32 s62, s65, 208896
    buffer_load_dwordx4 v255, s[36:39], s62 offen nt lds
    s_cmp_lg_u32 s55, 2
    s_cbranch_scc1 t1_noq2
    v_mov_b32 v212, v140
    v_mov_b32 v213, v141
    v_mov_b32 v214, v142
    v_mov_b32 v215, v144
    v_lshrrev_b32 v144, 5, v252
    v_and_b32 v144, 8, v144
    v_add_u32 v144, v144, v252
    s_mul_i32 s62, s56, 3
    s_add_u32 s62, s62, 0
    s_lshr_b32 s63, s62, 1
    s_mul_i32 s63, s63, 7168
    s_and_b32 s62, s62, 1
    s_lshl_b32 s62, s62, 3
    v_xor_b32 v140, s62, v144
    v_add_u32 v140, s63, v140
    s_mul_i32 s62, s56, 3
    s_add_u32 s62, s62, 1
    s_lshr_b32 s63, s62, 1
    s_mul_i32 s63, s63, 7168
    s_and_b32 s62, s62, 1
    s_lshl_b32 s62, s62, 3
    v_xor_b32 v141, s62, v144
    v_add_u32 v141, s63, v141
    s_mul_i32 s62, s56, 3
    s_add_u32 s62, s62, 2
    s_lshr_b32 s63, s62, 1
    s_mul_i32 s63, s63, 7168
    s_and_b32 s62, s62, 1
    s_lshl_b32 s62, s62, 3
    v_xor_b32 v142, s62, v144
    v_add_u32 v142, s63, v142
    ds_write_b64 v140, v[112:113] offset:0
    ds_write_b64 v141, v[114:115] offset:0
    ds_write_b64 v142, v[116:117] offset:0
    ds_write_b64 v140, v[118:119] offset:1024
    ds_write_b64 v141, v[120:121] offset:1024
    ds_write_b64 v142, v[122:123] offset:1024
    ds_write_b64 v140, v[124:125] offset:2048
    ds_write_b64 v141, v[126:127] offset:2048
    ds_write_b64 v142, v[128:129] offset:2048
    ds_write_b64 v140, v[130:131] offset:3072
    ds_write_b64 v141, v[132:133] offset:3072
    ds_write_b64 v142, v[134:135] offset:3072
    ds_write_b64 v140, v[136:137] offset:4096
    ds_write_b64 v141, v[138:139] offset:4096
    ds_write_b64 v142, v[236:237] offset:4096
    ds_write_b64 v140, v[238:239] offset:5120
    ds_write_b64 v141, v[240:241] offset:5120
    ds_write_b64 v142, v[242:243] offset:5120
    ds_write_b64 v140, v[244:245] offset:6144
    ds_write_b64 v141, v[246:247] offset:6144
    ds_write_b64 v142, v[248:249] offset:6144
    s_waitcnt lgkmcnt(0)
    v_mov_b32 v140, v212
    v_mov_b32 v141, v213
    v_mov_b32 v142, v214
    v_mov_b32 v144, v215
t1_noq2:
    v_cvt_pk_bf16_f32 v112, v140, v141
    v_cvt_pk_bf16_f32 v113, v142, v143
    v_cvt_pk_bf16_f32 v114, v144, v145
    v_cvt_pk_bf16_f32 v115, v146, v147
    v_cvt_pk_bf16_f32 v116, v148, v149
    v_cvt_pk_bf16_f32 v117, v150, v151
    v_cvt_pk_bf16_f32 v118, v152, v153
    v_cvt_pk_bf16_f32 v119, v154, v155
    v_cvt_pk_bf16_f32 v120, v156, v157
    v_cvt_pk_bf16_f32 v121, v158, v159
    v_cvt_pk_bf16_f32 v122, v160, v161
    v_cvt_pk_bf16_f32 v123, v162, v163
    v_cvt_pk_bf16_f32 v124, v164, v165
    v_cvt_pk_bf16_f32 v125, v166, v167
    v_cvt_pk_bf16_f32 v126, v168, v169
    v_cvt_pk_bf16_f32 v127, v170, v171
    v_cvt_pk_bf16_f32 v128, v172, v173
    v_cvt_pk_bf16_f32 v129, v174, v175
    v_cvt_pk_bf16_f32 v130, v176, v177
    v_cvt_pk_bf16_f32 v131, v178, v179
    v_cvt_pk_bf16_f32 v132, v180, v181
    v_cvt_pk_bf16_f32 v133, v182, v183
    v_cvt_pk_bf16_f32 v134, v184, v185
    v_cvt_pk_bf16_f32 v135, v186, v187
    v_cvt_pk_bf16_f32 v136, v188, v189
    v_cvt_pk_bf16_f32 v137, v190, v191
    v_cvt_pk_bf16_f32 v138, v192, v193
    v_cvt_pk_bf16_f32 v139, v194, v195
    s_cmp_lg_u32 s55, 4
    s_cbranch_scc1 t1_slot
t1_last:
    s_setprio 1
    s_mov_b32 s55, 5
    s_lshl_b32 s62, s56, 10
    s_add_u32 s62, s62, 126976
    v_add_u32 v249, s62, v252
    v_perm_b32 v140, v0, v0, s69
    v_perm_b32 v141, v0, v0, s72
    v_perm_b32 v142, v1, v1, s69
    v_perm_b32 v143, v1, v1, s72
    v_perm_b32 v144, v2, v2, s69
    v_perm_b32 v145, v2, v2, s72
    v_perm_b32 v146, v3, v3, s69
    v_perm_b32 v147, v3, v3, s72
    v_perm_b32 v148, v4, v4, s69
    v_perm_b32 v149, v4, v4, s72
    v_perm_b32 v150, v5, v5, s69
    v_perm_b32 v151, v5, v5, s72
    v_perm_b32 v152, v6, v6, s69
    v_perm_b32 v153, v6, v6, s72
    v_perm_b32 v154, v7, v7, s69
    v_perm_b32 v155, v7, v7, s72
    v_perm_b32 v156, v8, v8, s69
    v_perm_b32 v157, v8, v8, s72
    v_perm_b32 v158, v9, v9, s69
    v_perm_b32 v159, v9, v9, s72
    v_perm_b32 v160, v10, v10, s69
    v_perm_b32 v161, v10, v10, s72
    v_perm_b32 v162, v11, v11, s69
    v_perm_b32 v163, v11, v11, s72
    v_perm_b32 v164, v12, v12, s69
    v_perm_b32 v165, v12, v12, s72
    v_perm_b32 v166, v13, v13, s69
    v_perm_b32 v167, v13, v13, s72
    v_perm_b32 v168, v14, v14, s69
    v_perm_b32 v169, v14, v14, s72
    v_perm_b32 v170, v15, v15, s69
    v_perm_b32 v171, v15, v15, s72
    v_perm_b32 v172, v16, v16, s69
    v_perm_b32 v173, v16, v16, s72
    v_perm_b32 v174, v17, v17, s69
    v_perm_b32 v175, v17, v17, s72
    v_perm_b32 v176, v18, v18, s69
    v_perm_b32 v177, v18, v18, s72
    v_perm_b32 v178, v19, v19, s69
    v_perm_b32 v179, v19, v19, s72
    v_perm_b32 v180, v20, v20, s69
    v_perm_b32 v181, v20, v20, s72
    v_perm_b32 v182, v21, v21, s69
    v_perm_b32 v183, v21, v21, s72
    v_perm_b32 v184, v22, v22, s69
    v_perm_b32 v185, v22, v22, s72
    v_perm_b32 v186, v23, v23, s69
    v_perm_b32 v187, v23, v23, s72
    v_perm_b32 v188, v24, v24, s69
    v_perm_b32 v189, v24, v24, s72
    v_perm_b32 v190, v25, v25, s69
    v_perm_b32 v191, v25, v25, s72
    v_perm_b32 v192, v26, v26, s69
    v_perm_b32 v193, v26, v26, s72
    v_perm_b32 v194, v27, v27, s69
    v_perm_b32 v195, v27, v27, s72
    s_waitcnt vmcnt(0)
    s_barrier
    s_add_u32 m0, s60, 75776
    s_add_u32 s63, s59, 163840
    buffer_load_dwordx4 v253, s[44:47], s63 offen  lds
    buffer_load_dwordx4 v254, s[44:47], s63 offen offset:1024  lds
    s_add_u32 m0, s60, 83968
    s_add_u32 s63, s59, 204800
    buffer_load_dwordx4 v253, s[44:47], s63 offen  lds
    buffer_load_dwordx4 v254, s[44:47], s63 offen offset:1024  lds
    ds_write_b128 v249, v[84:87] offset:0
    ds_write_b128 v249, v[88:91] offset:4096
    ds_write_b128 v249, v[92:95] offset:8192
    ds_write_b128 v249, v[96:99] offset:12288
    ds_write_b128 v249, v[100:103] offset:16384
    ds_write_b128 v249, v[104:107] offset:20480
    ds_write_b128 v249, v[108:111] offset:24576
    s_waitcnt lgkmcnt(0)
    s_barrier
    ds_read_b64_tr_b16 v[196:197], v250 offset:0
    ds_read_b64_tr_b16 v[198:199], v250 offset:4096
    ds_read_b128 v[212:215], v252 offset:0
    ds_read_b64_tr_b16 v[200:201], v251 offset:0
    ds_read_b64_tr_b16 v[202:203], v251 offset:4096
    ds_read_b128 v[216:219], v252 offset:1024
    ds_read_b128 v[220:223], v252 offset:2048
    ds_read_b128 v[224:227], v252 offset:3072
    ds_read_b128 v[228:231], v252 offset:4096
    ds_read_b128 v[232:235], v252 offset:5120
    s_waitcnt lgkmcnt(7)
    v_mfma_f32_16x16x32_bf16 v[140:143], v[196:199], v[212:215], v[140:143]
    s_waitcnt lgkmcnt(5)
    v_mfma_f32_16x16x32_bf16 v[144:147], v[200:203], v[212:215], v[144:147]
    ds_read_b128 v[212:215], v252 offset:6144
    s_waitcnt lgkmcnt(5)
    v_mfma_f32_16x16x32_bf16 v[148:151], v[196:199], v[216:219], v[148:151]
    s_barrier
    s_add_u32 m0, s60, 43008
    s_add_u32 s63, s59, 256
    buffer_load_dwordx4 v253, s[44:47], s63 offen  lds
    buffer_load_dwordx4 v254, s[44:47], s63 offen offset:1024  lds
    v_mfma_f32_16x16x32_bf16 v[152:155], v[200:203], v[216:219], v[152:155]
    ds_read_b128 v[216:219], v252 offset:7168
    s_waitcnt lgkmcnt(5)
    v_mfma_f32_16x16x32_bf16 v[156:159], v[196:199], v[220:223], v[156:159]
    ds_read_b64_tr_b16 v[204:205], v250 offset:8192
    v_mfma_f32_16x16x32_bf16 v[160:163], v[200:203], v[220:223], v[160:163]
    ds_read_b128 v[220:223], v252 offset:8192
    s_waitcnt lgkmcnt(6)
    v_mfma_f32_16x16x32_bf16 v[164:167], v[196:199], v[224:227], v[164:167]
    ds_read_b64_tr_b16 v[206:207], v250 offset:12288
    v_mfma_f32_16x16x32_bf16 v[168:171], v[200:203], v[224:227], v[168:171]
    ds_read_b128 v[224:227], v252 offset:9216
    s_waitcnt lgkmcnt(7)
    v_mfma_f32_16x16x32_bf16 v[172:175], v[196:199], v[228:231], v[172:175]
    ds_read_b64_tr_b16 v[208:209], v251 offset:8192
    v_mfma_f32_16x16x32_bf16 v[176:179], v[200:203], v[228:231], v[176:179]
    ds_read_b128 v[228:231], v252 offset:10240
    s_waitcnt lgkmcnt(8)
    v_mfma_f32_16x16x32_bf16 v[180:183], v[196:199], v[232:235], v[180:183]
    ds_read_b64_tr_b16 v[210:211], v251 offset:12288
    v_mfma_f32_16x16x32_bf16 v[184:187], v[200:203], v[232:235], v[184:187]
    ds_read_b128 v[232:235], v252 offset:11264
    s_waitcnt lgkmcnt(9)
    v_mfma_f32_16x16x32_bf16 v[188:191], v[196:199], v[212:215], v[188:191]
    v_mfma_f32_16x16x32_bf16 v[192:195], v[200:203], v[212:215], v[192:195]
    ds_read_b128 v[212:215], v252 offset:12288
    s_waitcnt lgkmcnt(6)
    v_mfma_f32_16x16x32_bf16 v[140:143], v[204:207], v[216:219], v[140:143]
    s_waitcnt lgkmcnt(2)
    v_mfma_f32_16x16x32_bf16 v[144:147], v[208:211], v[216:219], v[144:147]
    ds_read_b128 v[216:219], v252 offset:13312
    v_mfma_f32_16x16x32_bf16 v[148:151], v[204:207], v[220:223], v[148:151]
    s_barrier
    s_add_u32 m0, s60, 51200
    s_add_u32 s63, s59, 41216
    buffer_load_dwordx4 v253, s[44:47], s63 offen  lds
    buffer_load_dwordx4 v254, s[44:47], s63 offen offset:1024  lds
    v_mfma_f32_16x16x32_bf16 v[152:155], v[208:211], v[220:223], v[152:155]
    ds_read_b128 v[220:223], v252 offset:14336
    v_mfma_f32_16x16x32_bf16 v[156:159], v[204:207], v[224:227], v[156:159]
    ds_read_b64_tr_b16 v[196:197], v250 offset:16384
    ds_write_b128 v249, v[112:115] offset:0
    ds_write_b128 v249, v[116:119] offset:4096
    ds_write_b128 v249, v[120:123] offset:8192
    ds_write_b128 v249, v[124:127] offset:12288
    ds_write_b128 v249, v[128:131] offset:16384
    ds_write_b128 v249, v[132:135] offset:20480
    ds_write_b128 v249, v[136:139] offset:24576
    v_mfma_f32_16x16x32_bf16 v[160:163], v[208:211], v[224:227], v[160:163]
    ds_read_b128 v[224:227], v252 offset:15360
    v_mfma_f32_16x16x32_bf16 v[164:167], v[204:207], v[228:231], v[164:167]
    ds_read_b64_tr_b16 v[198:199], v250 offset:20480
    v_mfma_f32_16x16x32_bf16 v[168:171], v[208:211], v[228:231], v[168:171]
    ds_read_b128 v[228:231], v252 offset:16384
    s_waitcnt lgkmcnt(14)
    v_mfma_f32_16x16x32_bf16 v[172:175], v[204:207], v[232:235], v[172:175]
    ds_read_b64_tr_b16 v[200:201], v251 offset:16384
    v_mfma_f32_16x16x32_bf16 v[176:179], v[208:211], v[232:235], v[176:179]
    ds_read_b128 v[232:235], v252 offset:17408
    s_waitcnt lgkmcnt(15)
    v_mfma_f32_16x16x32_bf16 v[180:183], v[204:207], v[212:215], v[180:183]
    ds_read_b64_tr_b16 v[202:203], v251 offset:20480
    v_mfma_f32_16x16x32_bf16 v[184:187], v[208:211], v[212:215], v[184:187]
    ds_read_b128 v[212:215], v252 offset:18432
    s_waitcnt lgkmcnt(15)
    v_mfma_f32_16x16x32_bf16 v[188:191], v[204:207], v[216:219], v[188:191]
    v_mfma_f32_16x16x32_bf16 v[192:195], v[208:211], v[216:219], v[192:195]
    ds_read_b128 v[216:219], v252 offset:19456
    s_waitcnt lgkmcnt(6)
    v_mfma_f32_16x16x32_bf16 v[140:143], v[196:199], v[220:223], v[140:143]
    s_waitcnt lgkmcnt(2)
    v_mfma_f32_16x16x32_bf16 v[144:147], v[200:203], v[220:223], v[144:147]
    ds_read_b128 v[220:223], v252 offset:20480
    v_mfma_f32_16x16x32_bf16 v[148:151], v[196:199], v[224:227], v[148:151]
    s_barrier
    s_add_u32 m0, s60, 59392
    s_add_u32 s63, s59, 82176
    buffer_load_dwordx4 v253, s[44:47], s63 offen  lds
    buffer_load_dwordx4 v254, s[44:47], s63 offen offset:1024  lds
    v_mfma_f32_16x16x32_bf16 v[152:155], v[200:203], v[224:227], v[152:155]
    ds_read_b128 v[224:227], v252 offset:21504
    v_mfma_f32_16x16x32_bf16 v[156:159], v[196:199], v[228:231], v[156:159]
    ds_read_b64_tr_b16 v[204:205], v250 offset:24576
    v_mfma_f32_16x16x32_bf16 v[160:163], v[200:203], v[228:231], v[160:163]
    ds_read_b128 v[228:231], v252 offset:22528
    v_mfma_f32_16x16x32_bf16 v[164:167], v[196:199], v[232:235], v[164:167]
    ds_read_b64_tr_b16 v[206:207], v250 offset:28672
    v_mfma_f32_16x16x32_bf16 v[168:171], v[200:203], v[232:235], v[168:171]
    ds_read_b128 v[232:235], v252 offset:23552
    s_waitcnt lgkmcnt(7)
    v_mfma_f32_16x16x32_bf16 v[172:175], v[196:199], v[212:215], v[172:175]
    ds_read_b64_tr_b16 v[208:209], v251 offset:24576
    v_mfma_f32_16x16x32_bf16 v[176:179], v[200:203], v[212:215], v[176:179]
    ds_read_b128 v[212:215], v252 offset:24576
    s_waitcnt lgkmcnt(8)
    v_mfma_f32_16x16x32_bf16 v[180:183], v[196:199], v[216:219], v[180:183]
    ds_read_b64_tr_b16 v[210:211], v251 offset:28672
    v_mfma_f32_16x16x32_bf16 v[184:187], v[200:203], v[216:219], v[184:187]
    ds_read_b128 v[216:219], v252 offset:25600
    s_waitcnt lgkmcnt(9)
    v_mfma_f32_16x16x32_bf16 v[188:191], v[196:199], v[220:223], v[188:191]
    v_mfma_f32_16x16x32_bf16 v[192:195], v[200:203], v[220:223], v[192:195]
    ds_read_b128 v[220:223], v252 offset:26624
    s_waitcnt lgkmcnt(6)
    v_mfma_f32_16x16x32_bf16 v[140:143], v[204:207], v[224:227], v[140:143]
    s_waitcnt lgkmcnt(2)
    v_mfma_f32_16x16x32_bf16 v[144:147], v[208:211], v[224:227], v[144:147]
    ds_read_b128 v[224:227], v252 offset:27648
    v_mfma_f32_16x16x32_bf16 v[148:151], v[204:207], v[228:231], v[148:151]
    s_waitcnt vmcnt(8)
    s_barrier
    s_add_u32 m0, s60, 67584
    s_add_u32 s63, s59, 123136
    buffer_load_dwordx4 v253, s[44:47], s63 offen  lds
    buffer_load_dwordx4 v254, s[44:47], s63 offen offset:1024  lds
    v_mfma_f32_16x16x32_bf16 v[152:155], v[208:211], v[228:231], v[152:155]
    ds_read_b128 v[228:231], v252 offset:28672
    v_mfma_f32_16x16x32_bf16 v[156:159], v[204:207], v[232:235], v[156:159]
    ds_read_b64_tr_b16 v[196:197], v250 offset:32768
    v_mfma_f32_16x16x32_bf16 v[160:163], v[208:211], v[232:235], v[160:163]
    ds_read_b128 v[232:235], v252 offset:29696
    v_mfma_f32_16x16x32_bf16 v[164:167], v[204:207], v[212:215], v[164:167]
    ds_read_b64_tr_b16 v[198:199], v250 offset:36864
    v_mfma_f32_16x16x32_bf16 v[168:171], v[208:211], v[212:215], v[168:171]
    ds_read_b128 v[212:215], v252 offset:30720
    s_waitcnt lgkmcnt(7)
    v_mfma_f32_16x16x32_bf16 v[172:175], v[204:207], v[216:219], v[172:175]
    ds_read_b64_tr_b16 v[200:201], v251 offset:32768
    v_mfma_f32_16x16x32_bf16 v[176:179], v[208:211], v[216:219], v[176:179]
    ds_read_b128 v[216:219], v252 offset:31744
    s_waitcnt lgkmcnt(8)
    v_mfma_f32_16x16x32_bf16 v[180:183], v[204:207], v[220:223], v[180:183]
    ds_read_b64_tr_b16 v[202:203], v251 offset:36864
    v_mfma_f32_16x16x32_bf16 v[184:187], v[208:211], v[220:223], v[184:187]
    ds_read_b128 v[220:223], v252 offset:32768
    s_waitcnt lgkmcnt(9)
    v_mfma_f32_16x16x32_bf16 v[188:191], v[204:207], v[224:227], v[188:191]
    v_mfma_f32_16x16x32_bf16 v[192:195], v[208:211], v[224:227], v[192:195]
    ds_read_b128 v[224:227], v252 offset:33792
    s_waitcnt lgkmcnt(6)
    v_mfma_f32_16x16x32_bf16 v[140:143], v[196:199], v[228:231], v[140:143]
    s_waitcnt lgkmcnt(2)
    v_mfma_f32_16x16x32_bf16 v[144:147], v[200:203], v[228:231], v[144:147]
    ds_read_b128 v[228:231], v252 offset:34816
    v_mfma_f32_16x16x32_bf16 v[148:151], v[196:199], v[232:235], v[148:151]
    s_waitcnt vmcnt(8)
    s_barrier
    s_add_u32 m0, s60, 75776
    s_add_u32 s63, s59, 164096
    buffer_load_dwordx4 v253, s[44:47], s63 offen  lds
    buffer_load_dwordx4 v254, s[44:47], s63 offen offset:1024  lds
    v_mfma_f32_16x16x32_bf16 v[152:155], v[200:203], v[232:235], v[152:155]
    ds_read_b128 v[232:235], v252 offset:35840
    v_mfma_f32_16x16x32_bf16 v[156:159], v[196:199], v[212:215], v[156:159]
    ds_read_b64_tr_b16 v[204:205], v250 offset:40960
    v_mfma_f32_16x16x32_bf16 v[160:163], v[200:203], v[212:215], v[160:163]
    ds_read_b128 v[212:215], v252 offset:36864
    v_mfma_f32_16x16x32_bf16 v[164:167], v[196:199], v[216:219], v[164:167]
    ds_read_b64_tr_b16 v[206:207], v250 offset:45056
    v_mfma_f32_16x16x32_bf16 v[168:171], v[200:203], v[216:219], v[168:171]
    ds_read_b128 v[216:219], v252 offset:37888
    s_waitcnt lgkmcnt(7)
    v_mfma_f32_16x16x32_bf16 v[172:175], v[196:199], v[220:223], v[172:175]
    ds_read_b64_tr_b16 v[208:209], v251 offset:40960
    v_mfma_f32_16x16x32_bf16 v[176:179], v[200:203], v[220:223], v[176:179]
    ds_read_b128 v[220:223], v252 offset:38912
    s_waitcnt lgkmcnt(8)
    v_mfma_f32_16x16x32_bf16 v[180:183], v[196:199], v[224:227], v[180:183]
    ds_read_b64_tr_b16 v[210:211], v251 offset:45056
    v_mfma_f32_16x16x32_bf16 v[184:187], v[200:203], v[224:227], v[184:187]
    ds_read_b128 v[224:227], v252 offset:39936
    s_waitcnt lgkmcnt(9)
    v_mfma_f32_16x16x32_bf16 v[188:191], v[196:199], v[228:231], v[188:191]
    v_mfma_f32_16x16x32_bf16 v[192:195], v[200:203], v[228:231], v[192:195]
    ds_read_b128 v[228:231], v252 offset:40960
    s_waitcnt lgkmcnt(6)
    v_mfma_f32_16x16x32_bf16 v[140:143], v[204:207], v[232:235], v[140:143]
    s_waitcnt lgkmcnt(2)
    v_mfma_f32_16x16x32_bf16 v[144:147], v[208:211], v[232:235], v[144:147]
    ds_read_b128 v[232:235], v252 offset:41984
    v_mfma_f32_16x16x32_bf16 v[148:151], v[204:207], v[212:215], v[148:151]
    s_waitcnt vmcnt(8)
    s_barrier
    s_add_u32 m0, s60, 83968
    s_add_u32 s63, s59, 205056
    buffer_load_dwordx4 v253, s[44:47], s63 offen  lds
    buffer_load_dwordx4 v254, s[44:47], s63 offen offset:1024  lds
    v_mfma_f32_16x16x32_bf16 v[152:155], v[208:211], v[212:215], v[152:155]
    ds_read_b128 v[212:215], v252 offset:0
    v_cvt_pk_bf16_f32 v0, v140, v141
    v_cvt_pk_bf16_f32 v1, v142, v143
    v_perm_b32 v140, v28, v28, s69
    v_perm_b32 v141, v28, v28, s72
    v_perm_b32 v142, v29, v29, s69
    v_perm_b32 v143, v29, v29, s72
    v_mfma_f32_16x16x32_bf16 v[156:159], v[204:207], v[216:219], v[156:159]
    ds_read_b64_tr_b16 v[196:197], v250 offset:0
    v_cvt_pk_bf16_f32 v2, v144, v145
    v_cvt_pk_bf16_f32 v3, v146, v147
    v_perm_b32 v144, v30, v30, s69
    v_perm_b32 v145, v30, v30, s72
    v_perm_b32 v146, v31, v31, s69
    v_perm_b32 v147, v31, v31, s72
    s_mov_b32 s61, 0
    s_cmp_lg_u32 s54, 0
    s_cbranch_scc1 op_k0
    s_mov_b32 s61, 0x100000
    ds_write_b128 v249, v[0:3] offset:0
op_k0:
    buffer_store_dwordx4 v[0:3], v252, s[76:79], s61 offen offset:0 sc1
    v_mfma_f32_16x16x32_bf16 v[160:163], v[208:211], v[216:219], v[160:163]
    ds_read_b128 v[216:219], v252 offset:1024
    v_cvt_pk_bf16_f32 v4, v148, v149
    v_cvt_pk_bf16_f32 v5, v150, v151
    v_perm_b32 v148, v32, v32, s69
    v_perm_b32 v149, v32, v32, s72
    v_perm_b32 v150, v33, v33, s69
    v_perm_b32 v151, v33, v33, s72
    v_mfma_f32_16x16x32_bf16 v[164:167], v[204:207], v[220:223], v[164:167]
    ds_read_b64_tr_b16 v[198:199], v250 offset:4096
    v_cvt_pk_bf16_f32 v6, v152, v153
    v_cvt_pk_bf16_f32 v7, v154, v155
    v_perm_b32 v152, v34, v34, s69
    v_perm_b32 v153, v34, v34, s72
    v_perm_b32 v154, v35, v35, s69
    v_perm_b32 v155, v35, v35, s72
    s_mov_b32 s61, 0
    s_cmp_lg_u32 s54, 1
    s_cbranch_scc1 op_k1
    s_mov_b32 s61, 0x100000
    ds_write_b128 v249, v[4:7] offset:0
op_k1:
    buffer_store_dwordx4 v[4:7], v252, s[76:79], s61 offen offset:1024 sc1
    v_mfma_f32_16x16x32_bf16 v[168:171], v[208:211], v[220:223], v[168:171]
    ds_read_b128 v[220:223], v252 offset:2048
    v_cvt_pk_bf16_f32 v8, v156, v157
    v_cvt_pk_bf16_f32 v9, v158, v159
    v_perm_b32 v156, v36, v36, s69
    v_perm_b32 v157, v36, v36, s72
    v_perm_b32 v158, v37, v37, s69
    v_perm_b32 v159, v37, v37, s72
    s_waitcnt lgkmcnt(7)
    v_mfma_f32_16x16x32_bf16 v[172:175], v[204:207], v[224:227], v[172:175]
    ds_read_b64_tr_b16 v[200:201], v251 offset:0
    v_cvt_pk_bf16_f32 v10, v160, v161
    v_cvt_pk_bf16_f32 v11, v162, v163
    v_perm_b32 v160, v38, v38, s69
    v_perm_b32 v161, v38, v38, s72
    v_perm_b32 v162, v39, v39, s69
    v_perm_b32 v163, v39, v39, s72
    s_mov_b32 s61, 0
    s_cmp_lg_u32 s54, 2
    s_cbranch_scc1 op_k2
    s_mov_b32 s61, 0x100000
    ds_write_b128 v249, v[8:11] offset:0
op_k2:
    buffer_store_dwordx4 v[8:11], v252, s[76:79], s61 offen offset:2048 sc1
    v_mfma_f32_16x16x32_bf16 v[176:179], v[208:211], v[224:227], v[176:179]
    ds_read_b128 v[224:227], v252 offset:3072
    v_cvt_pk_bf16_f32 v12, v164, v165
    v_cvt_pk_bf16_f32 v13, v166, v167
    v_perm_b32 v164, v40, v40, s69
    v_perm_b32 v165, v40, v40, s72
    v_perm_b32 v166, v41, v41, s69
    v_perm_b32 v167, v41, v41, s72
    s_waitcnt lgkmcnt(8)
    v_mfma_f32_16x16x32_bf16 v[180:183], v[204:207], v[228:231], v[180:183]
    ds_read_b64_tr_b16 v[202:203], v251 offset:4096
    v_cvt_pk_bf16_f32 v14, v168, v169
    v_cvt_pk_bf16_f32 v15, v170, v171
    v_perm_b32 v168, v42, v42, s69
    v_perm_b32 v169, v42, v42, s72
    v_perm_b32 v170, v43, v43, s69
    v_perm_b32 v171, v43, v43, s72
    s_mov_b32 s61, 0
    s_cmp_lg_u32 s54, 3
    s_cbranch_scc1 op_k3
    s_mov_b32 s61, 0x100000
    ds_write_b128 v249, v[12:15] offset:0
op_k3:
    buffer_store_dwordx4 v[12:15], v252, s[76:79], s61 offen offset:3072 sc1
    v_mfma_f32_16x16x32_bf16 v[184:187], v[208:211], v[228:231], v[184:187]
    ds_read_b128 v[228:231], v252 offset:4096
    v_cvt_pk_bf16_f32 v16, v172, v173
    v_cvt_pk_bf16_f32 v17, v174, v175
    v_perm_b32 v172, v44, v44, s69
    v_perm_b32 v173, v44, v44, s72
    v_perm_b32 v174, v45, v45, s69
    v_perm_b32 v175, v45, v45, s72
    s_waitcnt lgkmcnt(9)
    v_mfma_f32_16x16x32_bf16 v[188:191], v[204:207], v[232:235], v[188:191]
    v_cvt_pk_bf16_f32 v18, v176, v177
    v_cvt_pk_bf16_f32 v19, v178, v179
    v_perm_b32 v176, v46, v46, s69
    v_perm_b32 v177, v46, v46, s72
    v_perm_b32 v178, v47, v47, s69
    v_perm_b32 v179, v47, v47, s72
    s_mov_b32 s61, 4096
    s_cmp_lg_u32 s54, 4
    s_cbranch_scc1 op_k4
    s_mov_b32 s61, 0x100000
    ds_write_b128 v249, v[16:19] offset:0
op_k4:
    buffer_store_dwordx4 v[16:19], v252, s[76:79], s61 offen offset:0 sc1
    v_mfma_f32_16x16x32_bf16 v[192:195], v[208:211], v[232:235], v[192:195]
    ds_read_b128 v[232:235], v252 offset:5120
    v_cvt_pk_bf16_f32 v20, v180, v181
    v_cvt_pk_bf16_f32 v21, v182, v183
    v_perm_b32 v180, v48, v48, s69
    v_perm_b32 v181, v48, v48, s72
    v_perm_b32 v182, v49, v49, s69
    v_perm_b32 v183, v49, v49, s72
    s_waitcnt lgkmcnt(6)
    v_mfma_f32_16x16x32_bf16 v[140:143], v[196:199], v[212:215], v[140:143]
    v_cvt_pk_bf16_f32 v22, v184, v185
    v_cvt_pk_bf16_f32 v23, v186, v187
    v_perm_b32 v184, v50, v50, s69
    v_perm_b32 v185, v50, v50, s72
    v_perm_b32 v186, v51, v51, s69
    v_perm_b32 v187, v51, v51, s72
    s_mov_b32 s61, 4096
    s_cmp_lg_u32 s54, 5
    s_cbranch_scc1 op_k5
    s_mov_b32 s61, 0x100000
    ds_write_b128 v249, v[20:23] offset:0
op_k5:
    buffer_store_dwordx4 v[20:23], v252, s[76:79], s61 offen offset:1024 sc1
    s_waitcnt lgkmcnt(2)
    v_mfma_f32_16x16x32_bf16 v[144:147], v[200:203], v[212:215], v[144:147]
    ds_read_b128 v[212:215], v252 offset:6144
    v_cvt_pk_bf16_f32 v24, v188, v189
    v_cvt_pk_bf16_f32 v25, v190, v191
    v_perm_b32 v188, v52, v52, s69
    v_perm_b32 v189, v52, v52, s72
    v_perm_b32 v190, v53, v53, s69
    v_perm_b32 v191, v53, v53, s72
    v_mfma_f32_16x16x32_bf16 v[148:151], v[196:199], v[216:219], v[148:151]
    v_cvt_pk_bf16_f32 v26, v192, v193
    v_cvt_pk_bf16_f32 v27, v194, v195
    v_perm_b32 v192, v54, v54, s69
    v_perm_b32 v193, v54, v54, s72
    v_perm_b32 v194, v55, v55, s69
    v_perm_b32 v195, v55, v55, s72
    s_mov_b32 s61, 4096
    s_cmp_lg_u32 s54, 6
    s_cbranch_scc1 op_k6
    s_mov_b32 s61, 0x100000
    ds_write_b128 v249, v[24:27] offset:0
op_k6:
    buffer_store_dwordx4 v[24:27], v252, s[76:79], s61 offen offset:2048 sc1
    s_waitcnt vmcnt(15)
    s_barrier
    s_add_u32 m0, s60, 43008
    s_add_u32 s63, s59, 512
    buffer_load_dwordx4 v253, s[44:47], s63 offen  lds
    buffer_load_dwordx4 v254, s[44:47], s63 offen offset:1024  lds
    v_mfma_f32_16x16x32_bf16 v[152:155], v[200:203], v[216:219], v[152:155]
    ds_read_b128 v[216:219], v252 offset:7168
    v_mfma_f32_16x16x32_bf16 v[156:159], v[196:199], v[220:223], v[156:159]
    ds_read_b64_tr_b16 v[204:205], v250 offset:8192
    v_mfma_f32_16x16x32_bf16 v[160:163], v[200:203], v[220:223], v[160:163]
    ds_read_b128 v[220:223], v252 offset:8192
    v_mfma_f32_16x16x32_bf16 v[164:167], v[196:199], v[224:227], v[164:167]
    ds_read_b64_tr_b16 v[206:207], v250 offset:12288
    v_mfma_f32_16x16x32_bf16 v[168:171], v[200:203], v[224:227], v[168:171]
    ds_read_b128 v[224:227], v252 offset:9216
    s_waitcnt lgkmcnt(7)
    v_mfma_f32_16x16x32_bf16 v[172:175], v[196:199], v[228:231], v[172:175]
    ds_read_b64_tr_b16 v[208:209], v251 offset:8192
    v_mfma_f32_16x16x32_bf16 v[176:179], v[200:203], v[228:231], v[176:179]
    ds_read_b128 v[228:231], v252 offset:10240
    s_waitcnt lgkmcnt(8)
    v_mfma_f32_16x16x32_bf16 v[180:183], v[196:199], v[232:235], v[180:183]
    ds_read_b64_tr_b16 v[210:211], v251 offset:12288
    v_mfma_f32_16x16x32_bf16 v[184:187], v[200:203], v[232:235], v[184:187]
    ds_read_b128 v[232:235], v252 offset:11264
    s_waitcnt lgkmcnt(9)
    v_mfma_f32_16x16x32_bf16 v[188:191], v[196:199], v[212:215], v[188:191]
    v_mfma_f32_16x16x32_bf16 v[192:195], v[200:203], v[212:215], v[192:195]
    ds_read_b128 v[212:215], v252 offset:12288
    s_waitcnt lgkmcnt(6)
    v_mfma_f32_16x16x32_bf16 v[140:143], v[204:207], v[216:219], v[140:143]
    s_waitcnt lgkmcnt(2)
    v_mfma_f32_16x16x32_bf16 v[144:147], v[208:211], v[216:219], v[144:147]
    ds_read_b128 v[216:219], v252 offset:13312
    v_mfma_f32_16x16x32_bf16 v[148:151], v[204:207], v[220:223], v[148:151]
    s_waitcnt vmcnt(15)
    s_barrier
    s_add_u32 m0, s60, 51200
    s_add_u32 s63, s59, 41472
    buffer_load_dwordx4 v253, s[44:47], s63 offen  lds
    buffer_load_dwordx4 v254, s[44:47], s63 offen offset:1024  lds
    v_mfma_f32_16x16x32_bf16 v[152:155], v[208:211], v[220:223], v[152:155]
    ds_read_b128 v[220:223], v252 offset:14336
    v_mfma_f32_16x16x32_bf16 v[156:159], v[204:207], v[224:227], v[156:159]
    ds_read_b64_tr_b16 v[196:197], v250 offset:16384
    v_mfma_f32_16x16x32_bf16 v[160:163], v[208:211], v[224:227], v[160:163]
    ds_read_b128 v[224:227], v252 offset:15360
    v_mfma_f32_16x16x32_bf16 v[164:167], v[204:207], v[228:231], v[164:167]
    ds_read_b64_tr_b16 v[198:199], v250 offset:20480
    v_mfma_f32_16x16x32_bf16 v[168:171], v[208:211], v[228:231], v[168:171]
    ds_read_b128 v[228:231], v252 offset:16384
    s_waitcnt lgkmcnt(7)
    v_mfma_f32_16x16x32_bf16 v[172:175], v[204:207], v[232:235], v[172:175]
    ds_read_b64_tr_b16 v[200:201], v251 offset:16384
    v_mfma_f32_16x16x32_bf16 v[176:179], v[208:211], v[232:235], v[176:179]
    ds_read_b128 v[232:235], v252 offset:17408
    s_waitcnt lgkmcnt(8)
    v_mfma_f32_16x16x32_bf16 v[180:183], v[204:207], v[212:215], v[180:183]
    ds_read_b64_tr_b16 v[202:203], v251 offset:20480
    v_mfma_f32_16x16x32_bf16 v[184:187], v[208:211], v[212:215], v[184:187]
    ds_read_b128 v[212:215], v252 offset:18432
    s_waitcnt lgkmcnt(9)
    v_mfma_f32_16x16x32_bf16 v[188:191], v[204:207], v[216:219], v[188:191]
    v_mfma_f32_16x16x32_bf16 v[192:195], v[208:211], v[216:219], v[192:195]
    ds_read_b128 v[216:219], v252 offset:19456
    s_waitcnt lgkmcnt(6)
    v_mfma_f32_16x16x32_bf16 v[140:143], v[196:199], v[220:223], v[140:143]
    s_waitcnt lgkmcnt(2)
    v_mfma_f32_16x16x32_bf16 v[144:147], v[200:203], v[220:223], v[144:147]
    ds_read_b128 v[220:223], v252 offset:20480
    v_mfma_f32_16x16x32_bf16 v[148:151], v[196:199], v[224:227], v[148:151]
    s_waitcnt vmcnt(15)
    s_barrier
    s_add_u32 m0, s60, 59392
    s_add_u32 s63, s59, 82432
    buffer_load_dwordx4 v253, s[44:47], s63 offen  lds
    buffer_load_dwordx4 v254, s[44:47], s63 offen offset:1024  lds
    v_mfma_f32_16x16x32_bf16 v[152:155], v[200:203], v[224:227], v[152:155]
    ds_read_b128 v[224:227], v252 offset:21504
    v_mfma_f32_16x16x32_bf16 v[156:159], v[196:199], v[228:231], v[156:159]
    ds_read_b64_tr_b16 v[204:205], v250 offset:24576
    v_mfma_f32_16x16x32_bf16 v[160:163], v[200:203], v[228:231], v[160:163]
    ds_read_b128 v[228:231], v252 offset:22528
    v_mfma_f32_16x16x32_bf16 v[164:167], v[196:199], v[232:235], v[164:167]
    ds_read_b64_tr_b16 v[206:207], v250 offset:28672
    v_mfma_f32_16x16x32_bf16 v[168:171], v[200:203], v[232:235], v[168:171]
    ds_read_b128 v[232:235], v252 offset:23552
    s_waitcnt lgkmcnt(7)
    v_mfma_f32_16x16x32_bf16 v[172:175], v[196:199], v[212:215], v[172:175]
    ds_read_b64_tr_b16 v[208:209], v251 offset:24576
    v_mfma_f32_16x16x32_bf16 v[176:179], v[200:203], v[212:215], v[176:179]
    ds_read_b128 v[212:215], v252 offset:24576
    s_waitcnt lgkmcnt(8)
    v_mfma_f32_16x16x32_bf16 v[180:183], v[196:199], v[216:219], v[180:183]
    ds_read_b64_tr_b16 v[210:211], v251 offset:28672
    v_mfma_f32_16x16x32_bf16 v[184:187], v[200:203], v[216:219], v[184:187]
    ds_read_b128 v[216:219], v252 offset:25600
    s_waitcnt lgkmcnt(9)
    v_mfma_f32_16x16x32_bf16 v[188:191], v[196:199], v[220:223], v[188:191]
    v_mfma_f32_16x16x32_bf16 v[192:195], v[200:203], v[220:223], v[192:195]
    ds_read_b128 v[220:223], v252 offset:26624
    s_waitcnt lgkmcnt(6)
    v_mfma_f32_16x16x32_bf16 v[140:143], v[204:207], v[224:227], v[140:143]
    s_waitcnt lgkmcnt(2)
    v_mfma_f32_16x16x32_bf16 v[144:147], v[208:211], v[224:227], v[144:147]
    ds_read_b128 v[224:227], v252 offset:27648
    v_mfma_f32_16x16x32_bf16 v[148:151], v[204:207], v[228:231], v[148:151]
    s_waitcnt vmcnt(15)
    s_barrier
    s_add_u32 m0, s60, 67584
    s_add_u32 s63, s59, 123392
    buffer_load_dwordx4 v253, s[44:47], s63 offen  lds
    buffer_load_dwordx4 v254, s[44:47], s63 offen offset:1024  lds
    v_mfma_f32_16x16x32_bf16 v[152:155], v[208:211], v[228:231], v[152:155]
    ds_read_b128 v[228:231], v252 offset:28672
    v_mfma_f32_16x16x32_bf16 v[156:159], v[204:207], v[232:235], v[156:159]
    ds_read_b64_tr_b16 v[196:197], v250 offset:32768
    v_mfma_f32_16x16x32_bf16 v[160:163], v[208:211], v[232:235], v[160:163]
    ds_read_b128 v[232:235], v252 offset:29696
    v_mfma_f32_16x16x32_bf16 v[164:167], v[204:207], v[212:215], v[164:167]
    ds_read_b64_tr_b16 v[198:199], v250 offset:36864
    v_mfma_f32_16x16x32_bf16 v[168:171], v[208:211], v[212:215], v[168:171]
    ds_read_b128 v[212:215], v252 offset:30720
    s_waitcnt lgkmcnt(7)
    v_mfma_f32_16x16x32_bf16 v[172:175], v[204:207], v[216:219], v[172:175]
    ds_read_b64_tr_b16 v[200:201], v251 offset:32768
    v_mfma_f32_16x16x32_bf16 v[176:179], v[208:211], v[216:219], v[176:179]
    ds_read_b128 v[216:219], v252 offset:31744
    s_waitcnt lgkmcnt(8)
    v_mfma_f32_16x16x32_bf16 v[180:183], v[204:207], v[220:223], v[180:183]
    ds_read_b64_tr_b16 v[202:203], v251 offset:36864
    v_mfma_f32_16x16x32_bf16 v[184:187], v[208:211], v[220:223], v[184:187]
    ds_read_b128 v[220:223], v252 offset:32768
    s_waitcnt lgkmcnt(9)
    v_mfma_f32_16x16x32_bf16 v[188:191], v[204:207], v[224:227], v[188:191]
    v_mfma_f32_16x16x32_bf16 v[192:195], v[208:211], v[224:227], v[192:195]
    ds_read_b128 v[224:227], v252 offset:33792
    s_waitcnt lgkmcnt(6)
    v_mfma_f32_16x16x32_bf16 v[140:143], v[196:199], v[228:231], v[140:143]
    s_waitcnt lgkmcnt(2)
    v_mfma_f32_16x16x32_bf16 v[144:147], v[200:203], v[228:231], v[144:147]
    ds_read_b128 v[228:231], v252 offset:34816
    v_mfma_f32_16x16x32_bf16 v[148:151], v[196:199], v[232:235], v[148:151]
    s_waitcnt vmcnt(15)
    s_barrier
    s_add_u32 m0, s60, 75776
    s_add_u32 s63, s59, 164352
    buffer_load_dwordx4 v253, s[44:47], s63 offen  lds
    buffer_load_dwordx4 v254, s[44:47], s63 offen offset:1024  lds
    v_mfma_f32_16x16x32_bf16 v[152:155], v[200:203], v[232:235], v[152:155]
    ds_read_b128 v[232:235], v252 offset:35840
    v_mfma_f32_16x16x32_bf16 v[156:159], v[196:199], v[212:215], v[156:159]
    ds_read_b64_tr_b16 v[204:205], v250 offset:40960
    v_mfma_f32_16x16x32_bf16 v[160:163], v[200:203], v[212:215], v[160:163]
    ds_read_b128 v[212:215], v252 offset:36864
    v_mfma_f32_16x16x32_bf16 v[164:167], v[196:199], v[216:219], v[164:167]
    ds_read_b64_tr_b16 v[206:207], v250 offset:45056
    v_mfma_f32_16x16x32_bf16 v[168:171], v[200:203], v[216:219], v[168:171]
    ds_read_b128 v[216:219], v252 offset:37888
    s_waitcnt lgkmcnt(7)
    v_mfma_f32_16x16x32_bf16 v[172:175], v[196:199], v[220:223], v[172:175]
    ds_read_b64_tr_b16 v[208:209], v251 offset:40960
    v_mfma_f32_16x16x32_bf16 v[176:179], v[200:203], v[220:223], v[176:179]
    ds_read_b128 v[220:223], v252 offset:38912
    s_waitcnt lgkmcnt(8)
    v_mfma_f32_16x16x32_bf16 v[180:183], v[196:199], v[224:227], v[180:183]
    ds_read_b64_tr_b16 v[210:211], v251 offset:45056
    v_mfma_f32_16x16x32_bf16 v[184:187], v[200:203], v[224:227], v[184:187]
    ds_read_b128 v[224:227], v252 offset:39936
    s_waitcnt lgkmcnt(9)
    v_mfma_f32_16x16x32_bf16 v[188:191], v[196:199], v[228:231], v[188:191]
    v_mfma_f32_16x16x32_bf16 v[192:195], v[200:203], v[228:231], v[192:195]
    ds_read_b128 v[228:231], v252 offset:40960
    s_waitcnt lgkmcnt(6)
    v_mfma_f32_16x16x32_bf16 v[140:143], v[204:207], v[232:235], v[140:143]
    s_waitcnt lgkmcnt(2)
    v_mfma_f32_16x16x32_bf16 v[144:147], v[208:211], v[232:235], v[144:147]
    ds_read_b128 v[232:235], v252 offset:41984
    v_mfma_f32_16x16x32_bf16 v[148:151], v[204:207], v[212:215], v[148:151]
    s_waitcnt vmcnt(8)
    s_barrier
    s_add_u32 m0, s60, 83968
    s_add_u32 s63, s59, 205312
    buffer_load_dwordx4 v253, s[44:47], s63 offen  lds
    buffer_load_dwordx4 v254, s[44:47], s63 offen offset:1024  lds
    v_mfma_f32_16x16x32_bf16 v[152:155], v[208:211], v[212:215], v[152:155]
    ds_read_b128 v[212:215], v252 offset:0
    v_cvt_pk_bf16_f32 v28, v140, v141
    v_cvt_pk_bf16_f32 v29, v142, v143
    v_perm_b32 v140, v56, v56, s69
    v_perm_b32 v141, v56, v56, s72
    v_perm_b32 v142, v57, v57, s69
    v_perm_b32 v143, v57, v57, s72
    v_mfma_f32_16x16x32_bf16 v[156:159], v[204:207], v[216:219], v[156:159]
    ds_read_b64_tr_b16 v[196:197], v250 offset:0
    v_cvt_pk_bf16_f32 v30, v144, v145
    v_cvt_pk_bf16_f32 v31, v146, v147
    v_perm_b32 v144, v58, v58, s69
    v_perm_b32 v145, v58, v58, s72
    v_perm_b32 v146, v59, v59, s69
    v_perm_b32 v147, v59, v59, s72
    s_mov_b32 s61, 4096
    s_cmp_lg_u32 s54, 7
    s_cbranch_scc1 op_k7
    s_mov_b32 s61, 0x100000
    ds_write_b128 v249, v[28:31] offset:0
op_k7:
    buffer_store_dwordx4 v[28:31], v252, s[76:79], s61 offen offset:3072 sc1
    v_mfma_f32_16x16x32_bf16 v[160:163], v[208:211], v[216:219], v[160:163]
    ds_read_b128 v[216:219], v252 offset:1024
    v_cvt_pk_bf16_f32 v32, v148, v149
    v_cvt_pk_bf16_f32 v33, v150, v151
    v_perm_b32 v148, v60, v60, s69
    v_perm_b32 v149, v60, v60, s72
    v_perm_b32 v150, v61, v61, s69
    v_perm_b32 v151, v61, v61, s72
    v_mfma_f32_16x16x32_bf16 v[164:167], v[204:207], v[220:223], v[164:167]
    ds_read_b64_tr_b16 v[198:199], v250 offset:4096
    v_cvt_pk_bf16_f32 v34, v152, v153
    v_cvt_pk_bf16_f32 v35, v154, v155
    v_perm_b32 v152, v62, v62, s69
    v_perm_b32 v153, v62, v62, s72
    v_perm_b32 v154, v63, v63, s69
    v_perm_b32 v155, v63, v63, s72
    s_mov_b32 s61, 8192
    s_cmp_lg_u32 s54, 0
    s_cbranch_scc1 op_k8
    s_mov_b32 s61, 0x100000
    ds_write_b128 v249, v[32:35] offset:4096
op_k8:
    buffer_store_dwordx4 v[32:35], v252, s[76:79], s61 offen offset:0 sc1
    v_mfma_f32_16x16x32_bf16 v[168:171], v[208:211], v[220:223], v[168:171]
    ds_read_b128 v[220:223], v252 offset:2048
    v_cvt_pk_bf16_f32 v36, v156, v157
    v_cvt_pk_bf16_f32 v37, v158, v159
    v_perm_b32 v156, v64, v64, s69
    v_perm_b32 v157, v64, v64, s72
    v_perm_b32 v158, v65, v65, s69
    v_perm_b32 v159, v65, v65, s72
    s_waitcnt lgkmcnt(7)
    v_mfma_f32_16x16x32_bf16 v[172:175], v[204:207], v[224:227], v[172:175]
    ds_read_b64_tr_b16 v[200:201], v251 offset:0
    v_cvt_pk_bf16_f32 v38, v160, v161
    v_cvt_pk_bf16_f32 v39, v162, v163
    v_perm_b32 v160, v66, v66, s69
    v_perm_b32 v161, v66, v66, s72
    v_perm_b32 v162, v67, v67, s69
    v_perm_b32 v163, v67, v67, s72
    s_mov_b32 s61, 8192
    s_cmp_lg_u32 s54, 1
    s_cbranch_scc1 op_k9
    s_mov_b32 s61, 0x100000
    ds_write_b128 v249, v[36:39] offset:4096
op_k9:
    buffer_store_dwordx4 v[36:39], v252, s[76:79], s61 offen offset:1024 sc1
    v_mfma_f32_16x16x32_bf16 v[176:179], v[208:211], v[224:227], v[176:179]
    ds_read_b128 v[224:227], v252 offset:3072
    v_cvt_pk_bf16_f32 v40, v164, v165
    v_cvt_pk_bf16_f32 v41, v166, v167
    v_perm_b32 v164, v68, v68, s69
    v_perm_b32 v165, v68, v68, s72
    v_perm_b32 v166, v69, v69, s69
    v_perm_b32 v167, v69, v69, s72
    s_waitcnt lgkmcnt(8)
    v_mfma_f32_16x16x32_bf16 v[180:183], v[204:207], v[228:231], v[180:183]
    ds_read_b64_tr_b16 v[202:203], v251 offset:4096
    v_cvt_pk_bf16_f32 v42, v168, v169
    v_cvt_pk_bf16_f32 v43, v170, v171
    v_perm_b32 v168, v70, v70, s69
    v_perm_b32 v169, v70, v70, s72
    v_perm_b32 v170, v71, v71, s69
    v_perm_b32 v171, v71, v71, s72
    s_mov_b32 s61, 8192
    s_cmp_lg_u32 s54, 2
    s_cbranch_scc1 op_k10
    s_mov_b32 s61, 0x100000
    ds_write_b128 v249, v[40:43] offset:4096
op_k10:
    buffer_store_dwordx4 v[40:43], v252, s[76:79], s61 offen offset:2048 sc1
    v_mfma_f32_16x16x32_bf16 v[184:187], v[208:211], v[228:231], v[184:187]
    ds_read_b128 v[228:231], v252 offset:4096
    v_cvt_pk_bf16_f32 v44, v172, v173
    v_cvt_pk_bf16_f32 v45, v174, v175
    v_perm_b32 v172, v72, v72, s69
    v_perm_b32 v173, v72, v72, s72
    v_perm_b32 v174, v73, v73, s69
    v_perm_b32 v175, v73, v73, s72
    s_waitcnt lgkmcnt(9)
    v_mfma_f32_16x16x32_bf16 v[188:191], v[204:207], v[232:235], v[188:191]
    v_cvt_pk_bf16_f32 v46, v176, v177
    v_cvt_pk_bf16_f32 v47, v178, v179
    v_perm_b32 v176, v74, v74, s69
    v_perm_b32 v177, v74, v74, s72
    v_perm_b32 v178, v75, v75, s69
    v_perm_b32 v179, v75, v75, s72
    s_mov_b32 s61, 8192
    s_cmp_lg_u32 s54, 3
    s_cbranch_scc1 op_k11
    s_mov_b32 s61, 0x100000
    ds_write_b128 v249, v[44:47] offset:4096
op_k11:
    buffer_store_dwordx4 v[44:47], v252, s[76:79], s61 offen offset:3072 sc1
    v_mfma_f32_16x16x32_bf16 v[192:195], v[208:211], v[232:235], v[192:195]
    ds_read_b128 v[232:235], v252 offset:5120
    v_cvt_pk_bf16_f32 v48, v180, v181
    v_cvt_pk_bf16_f32 v49, v182, v183
    v_perm_b32 v180, v76, v76, s69
    v_perm_b32 v181, v76, v76, s72
    v_perm_b32 v182, v77, v77, s69
    v_perm_b32 v183, v77, v77, s72
    s_waitcnt lgkmcnt(6)
    v_mfma_f32_16x16x32_bf16 v[140:143], v[196:199], v[212:215], v[140:143]
    v_cvt_pk_bf16_f32 v50, v184, v185
    v_cvt_pk_bf16_f32 v51, v186, v187
    v_perm_b32 v184, v78, v78, s69
    v_perm_b32 v185, v78, v78, s72
    v_perm_b32 v186, v79, v79, s69
    v_perm_b32 v187, v79, v79, s72
    s_mov_b32 s61, 12288
    s_cmp_lg_u32 s54, 4
    s_cbranch_scc1 op_k12
    s_mov_b32 s61, 0x100000
    ds_write_b128 v249, v[48:51] offset:4096
op_k12:
    buffer_store_dwordx4 v[48:51], v252, s[76:79], s61 offen offset:0 sc1
    s_waitcnt lgkmcnt(2)
    v_mfma_f32_16x16x32_bf16 v[144:147], v[200:203], v[212:215], v[144:147]
    ds_read_b128 v[212:215], v252 offset:6144
    v_cvt_pk_bf16_f32 v52, v188, v189
    v_cvt_pk_bf16_f32 v53, v190, v191
    v_perm_b32 v188, v80, v80, s69
    v_perm_b32 v189, v80, v80, s72
    v_perm_b32 v190, v81, v81, s69
    v_perm_b32 v191, v81, v81, s72
    v_mfma_f32_16x16x32_bf16 v[148:151], v[196:199], v[216:219], v[148:151]
    v_cvt_pk_bf16_f32 v54, v192, v193
    v_cvt_pk_bf16_f32 v55, v194, v195
    v_perm_b32 v192, v82, v82, s69
    v_perm_b32 v193, v82, v82, s72
    v_perm_b32 v194, v83, v83, s69
    v_perm_b32 v195, v83, v83, s72
    s_mov_b32 s61, 12288
    s_cmp_lg_u32 s54, 5
    s_cbranch_scc1 op_k13
    s_mov_b32 s61, 0x100000
    ds_write_b128 v249, v[52:55] offset:4096
op_k13:
    buffer_store_dwordx4 v[52:55], v252, s[76:79], s61 offen offset:1024 sc1
    s_waitcnt vmcnt(15)
    s_barrier
    v_mfma_f32_16x16x32_bf16 v[152:155], v[200:203], v[216:219], v[152:155]
    ds_read_b128 v[216:219], v252 offset:7168
    v_mfma_f32_16x16x32_bf16 v[156:159], v[196:199], v[220:223], v[156:159]
    ds_read_b64_tr_b16 v[204:205], v250 offset:8192
    v_mfma_f32_16x16x32_bf16 v[160:163], v[200:203], v[220:223], v[160:163]
    ds_read_b128 v[220:223], v252 offset:8192
    v_mfma_f32_16x16x32_bf16 v[164:167], v[196:199], v[224:227], v[164:167]
    ds_read_b64_tr_b16 v[206:207], v250 offset:12288
    v_mfma_f32_16x16x32_bf16 v[168:171], v[200:203], v[224:227], v[168:171]
    ds_read_b128 v[224:227], v252 offset:9216
    s_waitcnt lgkmcnt(7)
    v_mfma_f32_16x16x32_bf16 v[172:175], v[196:199], v[228:231], v[172:175]
    ds_read_b64_tr_b16 v[208:209], v251 offset:8192
    v_mfma_f32_16x16x32_bf16 v[176:179], v[200:203], v[228:231], v[176:179]
    ds_read_b128 v[228:231], v252 offset:10240
    s_waitcnt lgkmcnt(8)
    v_mfma_f32_16x16x32_bf16 v[180:183], v[196:199], v[232:235], v[180:183]
    ds_read_b64_tr_b16 v[210:211], v251 offset:12288
    v_mfma_f32_16x16x32_bf16 v[184:187], v[200:203], v[232:235], v[184:187]
    ds_read_b128 v[232:235], v252 offset:11264
    s_waitcnt lgkmcnt(9)
    v_mfma_f32_16x16x32_bf16 v[188:191], v[196:199], v[212:215], v[188:191]
    v_mfma_f32_16x16x32_bf16 v[192:195], v[200:203], v[212:215], v[192:195]
    ds_read_b128 v[212:215], v252 offset:12288
    s_waitcnt lgkmcnt(6)
    v_mfma_f32_16x16x32_bf16 v[140:143], v[204:207], v[216:219], v[140:143]
    s_waitcnt lgkmcnt(2)
    v_mfma_f32_16x16x32_bf16 v[144:147], v[208:211], v[216:219], v[144:147]
    ds_read_b128 v[216:219], v252 offset:13312
    v_mfma_f32_16x16x32_bf16 v[148:151], v[204:207], v[220:223], v[148:151]
    s_waitcnt vmcnt(13)
    s_barrier
    v_mfma_f32_16x16x32_bf16 v[152:155], v[208:211], v[220:223], v[152:155]
    ds_read_b128 v[220:223], v252 offset:14336
    v_mfma_f32_16x16x32_bf16 v[156:159], v[204:207], v[224:227], v[156:159]
    ds_read_b64_tr_b16 v[196:197], v250 offset:16384
    v_mfma_f32_16x16x32_bf16 v[160:163], v[208:211], v[224:227], v[160:163]
    ds_read_b128 v[224:227], v252 offset:15360
    v_mfma_f32_16x16x32_bf16 v[164:167], v[204:207], v[228:231], v[164:167]
    ds_read_b64_tr_b16 v[198:199], v250 offset:20480
    v_mfma_f32_16x16x32_bf16 v[168:171], v[208:211], v[228:231], v[168:171]
    ds_read_b128 v[228:231], v252 offset:16384
    s_waitcnt lgkmcnt(7)
    v_mfma_f32_16x16x32_bf16 v[172:175], v[204:207], v[232:235], v[172:175]
    ds_read_b64_tr_b16 v[200:201], v251 offset:16384
    v_mfma_f32_16x16x32_bf16 v[176:179], v[208:211], v[232:235], v[176:179]
    ds_read_b128 v[232:235], v252 offset:17408
    s_waitcnt lgkmcnt(8)
    v_mfma_f32_16x16x32_bf16 v[180:183], v[204:207], v[212:215], v[180:183]
    ds_read_b64_tr_b16 v[202:203], v251 offset:20480
    v_mfma_f32_16x16x32_bf16 v[184:187], v[208:211], v[212:215], v[184:187]
    ds_read_b128 v[212:215], v252 offset:18432
    s_waitcnt lgkmcnt(9)
    v_mfma_f32_16x16x32_bf16 v[188:191], v[204:207], v[216:219], v[188:191]
    v_mfma_f32_16x16x32_bf16 v[192:195], v[208:211], v[216:219], v[192:195]
    ds_read_b128 v[216:219], v252 offset:19456
    s_waitcnt lgkmcnt(6)
    v_mfma_f32_16x16x32_bf16 v[140:143], v[196:199], v[220:223], v[140:143]
    s_waitcnt lgkmcnt(2)
    v_mfma_f32_16x16x32_bf16 v[144:147], v[200:203], v[220:223], v[144:147]
    ds_read_b128 v[220:223], v252 offset:20480
    v_mfma_f32_16x16x32_bf16 v[148:151], v[196:199], v[224:227], v[148:151]
    s_waitcnt vmcnt(11)
    s_barrier
    v_mfma_f32_16x16x32_bf16 v[152:155], v[200:203], v[224:227], v[152:155]
    ds_read_b128 v[224:227], v252 offset:21504
    v_mfma_f32_16x16x32_bf16 v[156:159], v[196:199], v[228:231], v[156:159]
    ds_read_b64_tr_b16 v[204:205], v250 offset:24576
    v_mfma_f32_16x16x32_bf16 v[160:163], v[200:203], v[228:231], v[160:163]
    ds_read_b128 v[228:231], v252 offset:22528
    v_mfma_f32_16x16x32_bf16 v[164:167], v[196:199], v[232:235], v[164:167]
    ds_read_b64_tr_b16 v[206:207], v250 offset:28672
    v_mfma_f32_16x16x32_bf16 v[168:171], v[200:203], v[232:235], v[168:171]
    ds_read_b128 v[232:235], v252 offset:23552
    s_waitcnt lgkmcnt(7)
    v_mfma_f32_16x16x32_bf16 v[172:175], v[196:199], v[212:215], v[172:175]
    ds_read_b64_tr_b16 v[208:209], v251 offset:24576
    v_mfma_f32_16x16x32_bf16 v[176:179], v[200:203], v[212:215], v[176:179]
    ds_read_b128 v[212:215], v252 offset:24576
    s_waitcnt lgkmcnt(8)
    v_mfma_f32_16x16x32_bf16 v[180:183], v[196:199], v[216:219], v[180:183]
    ds_read_b64_tr_b16 v[210:211], v251 offset:28672
    v_mfma_f32_16x16x32_bf16 v[184:187], v[200:203], v[216:219], v[184:187]
    ds_read_b128 v[216:219], v252 offset:25600
    s_waitcnt lgkmcnt(9)
    v_mfma_f32_16x16x32_bf16 v[188:191], v[196:199], v[220:223], v[188:191]
    v_mfma_f32_16x16x32_bf16 v[192:195], v[200:203], v[220:223], v[192:195]
    ds_read_b128 v[220:223], v252 offset:26624
    s_waitcnt lgkmcnt(6)
    v_mfma_f32_16x16x32_bf16 v[140:143], v[204:207], v[224:227], v[140:143]
    s_waitcnt lgkmcnt(2)
    v_mfma_f32_16x16x32_bf16 v[144:147], v[208:211], v[224:227], v[144:147]
    ds_read_b128 v[224:227], v252 offset:27648
    v_mfma_f32_16x16x32_bf16 v[148:151], v[204:207], v[228:231], v[148:151]
    s_waitcnt vmcnt(9)
    s_barrier
    v_mfma_f32_16x16x32_bf16 v[152:155], v[208:211], v[228:231], v[152:155]
    ds_read_b128 v[228:231], v252 offset:28672
    v_mfma_f32_16x16x32_bf16 v[156:159], v[204:207], v[232:235], v[156:159]
    ds_read_b64_tr_b16 v[196:197], v250 offset:32768
    v_mfma_f32_16x16x32_bf16 v[160:163], v[208:211], v[232:235], v[160:163]
    ds_read_b128 v[232:235], v252 offset:29696
    v_mfma_f32_16x16x32_bf16 v[164:167], v[204:207], v[212:215], v[164:167]
    ds_read_b64_tr_b16 v[198:199], v250 offset:36864
    v_mfma_f32_16x16x32_bf16 v[168:171], v[208:211], v[212:215], v[168:171]
    ds_read_b128 v[212:215], v252 offset:30720
    s_waitcnt lgkmcnt(7)
    v_mfma_f32_16x16x32_bf16 v[172:175], v[204:207], v[216:219], v[172:175]
    ds_read_b64_tr_b16 v[200:201], v251 offset:32768
    v_mfma_f32_16x16x32_bf16 v[176:179], v[208:211], v[216:219], v[176:179]
    ds_read_b128 v[216:219], v252 offset:31744
    s_waitcnt lgkmcnt(8)
    v_mfma_f32_16x16x32_bf16 v[180:183], v[204:207], v[220:223], v[180:183]
    ds_read_b64_tr_b16 v[202:203], v251 offset:36864
    v_mfma_f32_16x16x32_bf16 v[184:187], v[208:211], v[220:223], v[184:187]
    ds_read_b128 v[220:223], v252 offset:32768
    s_waitcnt lgkmcnt(9)
    v_mfma_f32_16x16x32_bf16 v[188:191], v[204:207], v[224:227], v[188:191]
    v_mfma_f32_16x16x32_bf16 v[192:195], v[208:211], v[224:227], v[192:195]
    ds_read_b128 v[224:227], v252 offset:33792
    s_waitcnt lgkmcnt(6)
    v_mfma_f32_16x16x32_bf16 v[140:143], v[196:199], v[228:231], v[140:143]
    s_waitcnt lgkmcnt(2)
    v_mfma_f32_16x16x32_bf16 v[144:147], v[200:203], v[228:231], v[144:147]
    ds_read_b128 v[228:231], v252 offset:34816
    v_mfma_f32_16x16x32_bf16 v[148:151], v[196:199], v[232:235], v[148:151]
    s_waitcnt vmcnt(7)
    s_barrier
    v_mfma_f32_16x16x32_bf16 v[152:155], v[200:203], v[232:235], v[152:155]
    ds_read_b128 v[232:235], v252 offset:35840
    v_mfma_f32_16x16x32_bf16 v[156:159], v[196:199], v[212:215], v[156:159]
    ds_read_b64_tr_b16 v[204:205], v250 offset:40960
    v_mfma_f32_16x16x32_bf16 v[160:163], v[200:203], v[212:215], v[160:163]
    ds_read_b128 v[212:215], v252 offset:36864
    v_mfma_f32_16x16x32_bf16 v[164:167], v[196:199], v[216:219], v[164:167]
    ds_read_b64_tr_b16 v[206:207], v250 offset:45056
    v_mfma_f32_16x16x32_bf16 v[168:171], v[200:203], v[216:219], v[168:171]
    ds_read_b128 v[216:219], v252 offset:37888
    s_waitcnt lgkmcnt(7)
    v_mfma_f32_16x16x32_bf16 v[172:175], v[196:199], v[220:223], v[172:175]
    ds_read_b64_tr_b16 v[208:209], v251 offset:40960
    v_mfma_f32_16x16x32_bf16 v[176:179], v[200:203], v[220:223], v[176:179]
    ds_read_b128 v[220:223], v252 offset:38912
    s_waitcnt lgkmcnt(8)
    v_mfma_f32_16x16x32_bf16 v[180:183], v[196:199], v[224:227], v[180:183]
    ds_read_b64_tr_b16 v[210:211], v251 offset:45056
    v_mfma_f32_16x16x32_bf16 v[184:187], v[200:203], v[224:227], v[184:187]
    ds_read_b128 v[224:227], v252 offset:39936
    s_waitcnt lgkmcnt(9)
    v_mfma_f32_16x16x32_bf16 v[188:191], v[196:199], v[228:231], v[188:191]
    v_mfma_f32_16x16x32_bf16 v[192:195], v[200:203], v[228:231], v[192:195]
    ds_read_b128 v[228:231], v252 offset:40960
    s_waitcnt lgkmcnt(6)
    v_mfma_f32_16x16x32_bf16 v[140:143], v[204:207], v[232:235], v[140:143]
    s_waitcnt lgkmcnt(2)
    v_mfma_f32_16x16x32_bf16 v[144:147], v[208:211], v[232:235], v[144:147]
    ds_read_b128 v[232:235], v252 offset:41984
    v_mfma_f32_16x16x32_bf16 v[148:151], v[204:207], v[212:215], v[148:151]
    v_mfma_f32_16x16x32_bf16 v[152:155], v[208:211], v[212:215], v[152:155]
    s_nop 2
    v_cvt_pk_bf16_f32 v56, v140, v141
    v_cvt_pk_bf16_f32 v57, v142, v143
    v_mfma_f32_16x16x32_bf16 v[156:159], v[204:207], v[216:219], v[156:159]
    v_cvt_pk_bf16_f32 v58, v144, v145
    v_cvt_pk_bf16_f32 v59, v146, v147
    s_mov_b32 s61, 12288
    s_cmp_lg_u32 s54, 6
    s_cbranch_scc1 op_k14
    s_mov_b32 s61, 0x100000
    ds_write_b128 v249, v[56:59] offset:4096
op_k14:
    buffer_store_dwordx4 v[56:59], v252, s[76:79], s61 offen offset:2048 sc1
    v_mfma_f32_16x16x32_bf16 v[160:163], v[208:211], v[216:219], v[160:163]
    v_cvt_pk_bf16_f32 v60, v148, v149
    v_cvt_pk_bf16_f32 v61, v150, v151
    v_mfma_f32_16x16x32_bf16 v[164:167], v[204:207], v[220:223], v[164:167]
    v_cvt_pk_bf16_f32 v62, v152, v153
    v_cvt_pk_bf16_f32 v63, v154, v155
    s_mov_b32 s61, 12288
    s_cmp_lg_u32 s54, 7
    s_cbranch_scc1 op_k15
    s_mov_b32 s61, 0x100000
    ds_write_b128 v249, v[60:63] offset:4096
op_k15:
    buffer_store_dwordx4 v[60:63], v252, s[76:79], s61 offen offset:3072 sc1
    v_mfma_f32_16x16x32_bf16 v[168:171], v[208:211], v[220:223], v[168:171]
    v_cvt_pk_bf16_f32 v64, v156, v157
    v_cvt_pk_bf16_f32 v65, v158, v159
    s_waitcnt lgkmcnt(2)
    v_mfma_f32_16x16x32_bf16 v[172:175], v[204:207], v[224:227], v[172:175]
    v_cvt_pk_bf16_f32 v66, v160, v161
    v_cvt_pk_bf16_f32 v67, v162, v163
    s_mov_b32 s61, 16384
    s_cmp_lg_u32 s54, 0
    s_cbranch_scc1 op_k16
    s_mov_b32 s61, 0x100000
    ds_write_b128 v249, v[64:67] offset:8192
op_k16:
    buffer_store_dwordx4 v[64:67], v252, s[76:79], s61 offen offset:0 sc1
    v_mfma_f32_16x16x32_bf16 v[176:179], v[208:211], v[224:227], v[176:179]
    v_cvt_pk_bf16_f32 v68, v164, v165
    v_cvt_pk_bf16_f32 v69, v166, v167
    s_waitcnt lgkmcnt(1)
    v_mfma_f32_16x16x32_bf16 v[180:183], v[204:207], v[228:231], v[180:183]
    v_cvt_pk_bf16_f32 v70, v168, v169
    v_cvt_pk_bf16_f32 v71, v170, v171
    s_mov_b32 s61, 16384
    s_cmp_lg_u32 s54, 1
    s_cbranch_scc1 op_k17
    s_mov_b32 s61, 0x100000
    ds_write_b128 v249, v[68:71] offset:8192
op_k17:
    buffer_store_dwordx4 v[68:71], v252, s[76:79], s61 offen offset:1024 sc1
    v_mfma_f32_16x16x32_bf16 v[184:187], v[208:211], v[228:231], v[184:187]
    v_cvt_pk_bf16_f32 v72, v172, v173
    v_cvt_pk_bf16_f32 v73, v174, v175
    s_waitcnt lgkmcnt(0)
    v_mfma_f32_16x16x32_bf16 v[188:191], v[204:207], v[232:235], v[188:191]
    v_cvt_pk_bf16_f32 v74, v176, v177
    v_cvt_pk_bf16_f32 v75, v178, v179
    s_mov_b32 s61, 16384
    s_cmp_lg_u32 s54, 2
    s_cbranch_scc1 op_k18
    s_mov_b32 s61, 0x100000
    ds_write_b128 v249, v[72:75] offset:8192
op_k18:
    buffer_store_dwordx4 v[72:75], v252, s[76:79], s61 offen offset:2048 sc1
    v_mfma_f32_16x16x32_bf16 v[192:195], v[208:211], v[232:235], v[192:195]
    v_cvt_pk_bf16_f32 v76, v180, v181
    v_cvt_pk_bf16_f32 v77, v182, v183
    v_cvt_pk_bf16_f32 v78, v184, v185
    v_cvt_pk_bf16_f32 v79, v186, v187
    s_mov_b32 s61, 16384
    s_cmp_lg_u32 s54, 3
    s_cbranch_scc1 op_k19
    s_mov_b32 s61, 0x100000
    ds_write_b128 v249, v[76:79] offset:8192
op_k19:
    buffer_store_dwordx4 v[76:79], v252, s[76:79], s61 offen offset:3072 sc1
    v_cvt_pk_bf16_f32 v80, v188, v189
    v_cvt_pk_bf16_f32 v81, v190, v191
    v_cvt_pk_bf16_f32 v82, v192, v193
    v_cvt_pk_bf16_f32 v83, v194, v195
    s_mov_b32 s61, 20480
    s_cmp_lg_u32 s54, 4
    s_cbranch_scc1 op_k20
    s_mov_b32 s61, 0x100000
    ds_write_b128 v249, v[80:83] offset:8192
op_k20:
    buffer_store_dwordx4 v[80:83], v252, s[76:79], s61 offen offset:0 sc1
t1_exit:
k1_final:
    s_waitcnt vmcnt(0) lgkmcnt(0)
    s_barrier
    s_and_b32 s4, s2, 7
    s_cmp_lt_u32 s4, 4
    s_cselect_b32 s4, 0, 16
    s_add_u32 s4, s4, s53
    v_mbcnt_lo_u32_b32 v2, -1, 0
    v_mbcnt_hi_u32_b32 v2, -1, v2
    s_cmp_gt_u32 s52, 1
    s_cbranch_scc1 k1_fw
    s_mov_b32 s8, s26
    s_mov_b32 s9, s27
    s_mov_b32 s10, 256
    s_mov_b32 s11, 0x20000
    s_lshl_b32 s62, s4, 2
    v_mov_b32 v3, 0
    v_mov_b32 v4, 1
    s_cmp_eq_u32 s52, 0
    s_cbranch_scc1 k1_w0
    s_mov_b64 exec, 1
    buffer_atomic_add v4, v3, s[8:11], s62 offen offset:128 sc0 sc1
    s_waitcnt vmcnt(0)
    v_readfirstlane_b32 s63, v4
    s_nop 0
    s_and_b32 s61, s63, 0xff
    s_bfe_u32 s63, s63, 0x80008
    s_cmp_eq_u32 s61, 7
    s_cselect_b32 s63, s63, 0
    v_mov_b32 v4, s63
    ds_write_b32 v3, v4 offset:4
    s_waitcnt lgkmcnt(0)
    s_mov_b64 exec, -1
    s_branch k1_fw
k1_w0:
    s_lshl_b32 s5, 1, s54
    s_lshl_b32 s63, s4, 10
    s_add_u32 s63, s63, 0
    s_add_u32 s32, s28, s63
    s_addc_u32 s33, s29, 0
    s_mov_b32 s34, 1024
    s_mov_b32 s35, 0x20000
    s_lshl_b32 s63, s54, 7
    s_mov_b64 exec, 1
    buffer_store_dword v4, v3, s[32:35], s63 offen sc1
    s_mov_b64 exec, 0xff
    v_lshlrev_b32 v5, 7, v2
    s_mov_b32 s57, 0
k1_poll:
    buffer_load_dword v6, v3, s[8:11], s62 offen sc1
    buffer_load_dword v4, v5, s[32:35], 0 offen sc1
    s_waitcnt vmcnt(1)
    v_cmp_ne_u32 vcc, 8, v6
    s_cbranch_vccnz k1_again
k1_poll2:
    s_waitcnt vmcnt(0)
    v_cmp_ne_u32 vcc, 1, v4
    s_cbranch_vccz k1_go
    s_add_u32 s57, s57, 1
    s_cmp_lt_u32 s57, 8000
    s_cbranch_scc0 k1_late
    buffer_load_dword v4, v5, s[32:35], 0 offen sc1
    s_branch k1_poll2
k1_again:
    s_waitcnt vmcnt(0)
    s_add_u32 s57, s57, 1
    s_cmp_lt_u32 s57, 8000
    s_cbranch_scc1 k1_poll
k1_late:
    s_mov_b64 exec, -1
    s_lshl_b32 s63, s4, 3
    s_add_u32 s63, s63, s54
    s_mul_i32 s63, s63, 143360
    s_add_u32 s63, s63, 1048576
    s_add_u32 s32, s28, s63
    s_addc_u32 s33, s29, 0
    s_mov_b32 s34, 143360
    s_mov_b32 s35, 0x20000
    v_lshlrev_b32 v5, 4, v2
    v_add_u32 v6, 126976, v5
    ds_read_b128 v[8:11], v6 offset:0
    ds_read_b128 v[12:15], v6 offset:1024
    ds_read_b128 v[16:19], v6 offset:2048
    ds_read_b128 v[20:23], v6 offset:3072
    s_waitcnt lgkmcnt(0)
    s_add_u32 s63, s54, 0
    s_cmp_lt_u32 s63, 35
    s_cselect_b32 s63, s63, 0x1000
    s_add_u32 s63, s63, 0
    s_lshl_b32 s63, s63, 10
    buffer_store_dwordx4 v[8:11], v5, s[32:35], s63 offen sc1
    s_add_u32 s63, s54, 0
    s_cmp_lt_u32 s63, 35
    s_cselect_b32 s63, s63, 0x1000
    s_add_u32 s63, s63, 35
    s_lshl_b32 s63, s63, 10
    buffer_store_dwordx4 v[12:15], v5, s[32:35], s63 offen sc1
    s_add_u32 s63, s54, 0
    s_cmp_lt_u32 s63, 35
    s_cselect_b32 s63, s63, 0x1000
    s_add_u32 s63, s63, 70
    s_lshl_b32 s63, s63, 10
    buffer_store_dwordx4 v[16:19], v5, s[32:35], s63 offen sc1
    s_add_u32 s63, s54, 0
    s_cmp_lt_u32 s63, 35
    s_cselect_b32 s63, s63, 0x1000
    s_add_u32 s63, s63, 105
    s_lshl_b32 s63, s63, 10
    buffer_store_dwordx4 v[20:23], v5, s[32:35], s63 offen sc1
    ds_read_b128 v[24:27], v6 offset:4096
    ds_read_b128 v[28:31], v6 offset:5120
    ds_read_b128 v[32:35], v6 offset:6144
    ds_read_b128 v[36:39], v6 offset:7168
    s_waitcnt lgkmcnt(0)
    s_add_u32 s63, s54, 8
    s_cmp_lt_u32 s63, 35
    s_cselect_b32 s63, s63, 0x1000
    s_add_u32 s63, s63, 0
    s_lshl_b32 s63, s63, 10
    buffer_store_dwordx4 v[24:27], v5, s[32:35], s63 offen sc1
    s_add_u32 s63, s54, 8
    s_cmp_lt_u32 s63, 35
    s_cselect_b32 s63, s63, 0x1000
    s_add_u32 s63, s63, 35
    s_lshl_b32 s63, s63, 10
    buffer_store_dwordx4 v[28:31], v5, s[32:35], s63 offen sc1
    s_add_u32 s63, s54, 8
    s_cmp_lt_u32 s63, 35
    s_cselect_b32 s63, s63, 0x1000
    s_add_u32 s63, s63, 70
    s_lshl_b32 s63, s63, 10
    buffer_store_dwordx4 v[32:35], v5, s[32:35], s63 offen sc1
    s_add_u32 s63, s54, 8
    s_cmp_lt_u32 s63, 35
    s_cselect_b32 s63, s63, 0x1000
    s_add_u32 s63, s63, 105
    s_lshl_b32 s63, s63, 10
    buffer_store_dwordx4 v[36:39], v5, s[32:35], s63 offen sc1
    ds_read_b128 v[40:43], v6 offset:8192
    ds_read_b128 v[44:47], v6 offset:9216
    ds_read_b128 v[48:51], v6 offset:10240
    ds_read_b128 v[52:55], v6 offset:11264
    s_waitcnt lgkmcnt(0)
    s_add_u32 s63, s54, 16
    s_cmp_lt_u32 s63, 35
    s_cselect_b32 s63, s63, 0x1000
    s_add_u32 s63, s63, 0
    s_lshl_b32 s63, s63, 10
    buffer_store_dwordx4 v[40:43], v5, s[32:35], s63 offen sc1
    s_add_u32 s63, s54, 16
    s_cmp_lt_u32 s63, 35
    s_cselect_b32 s63, s63, 0x1000
    s_add_u32 s63, s63, 35
    s_lshl_b32 s63, s63, 10
    buffer_store_dwordx4 v[44:47], v5, s[32:35], s63 offen sc1
    s_add_u32 s63, s54, 16
    s_cmp_lt_u32 s63, 35
    s_cselect_b32 s63, s63, 0x1000
    s_add_u32 s63, s63, 70
    s_lshl_b32 s63, s63, 10
    buffer_store_dwordx4 v[48:51], v5, s[32:35], s63 offen sc1
    s_add_u32 s63, s54, 16
    s_cmp_lt_u32 s63, 35
    s_cselect_b32 s63, s63, 0x1000
    s_add_u32 s63, s63, 105
    s_lshl_b32 s63, s63, 10
    buffer_store_dwordx4 v[52:55], v5, s[32:35], s63 offen sc1
    ds_read_b128 v[56:59], v6 offset:12288
    ds_read_b128 v[60:63], v6 offset:13312
    ds_read_b128 v[64:67], v6 offset:14336
    ds_read_b128 v[68:71], v6 offset:15360
    s_waitcnt lgkmcnt(0)
    s_add_u32 s63, s54, 24
    s_cmp_lt_u32 s63, 35
    s_cselect_b32 s63, s63, 0x1000
    s_add_u32 s63, s63, 0
    s_lshl_b32 s63, s63, 10
    buffer_store_dwordx4 v[56:59], v5, s[32:35], s63 offen sc1
    s_add_u32 s63, s54, 24
    s_cmp_lt_u32 s63, 35
    s_cselect_b32 s63, s63, 0x1000
    s_add_u32 s63, s63, 35
    s_lshl_b32 s63, s63, 10
    buffer_store_dwordx4 v[60:63], v5, s[32:35], s63 offen sc1
    s_add_u32 s63, s54, 24
    s_cmp_lt_u32 s63, 35
    s_cselect_b32 s63, s63, 0x1000
    s_add_u32 s63, s63, 70
    s_lshl_b32 s63, s63, 10
    buffer_store_dwordx4 v[64:67], v5, s[32:35], s63 offen sc1
    s_add_u32 s63, s54, 24
    s_cmp_lt_u32 s63, 35
    s_cselect_b32 s63, s63, 0x1000
    s_add_u32 s63, s63, 105
    s_lshl_b32 s63, s63, 10
    buffer_store_dwordx4 v[68:71], v5, s[32:35], s63 offen sc1
    ds_read_b128 v[72:75], v6 offset:16384
    ds_read_b128 v[76:79], v6 offset:17408
    ds_read_b128 v[80:83], v6 offset:18432
    ds_read_b128 v[84:87], v6 offset:19456
    s_waitcnt lgkmcnt(0)
    s_add_u32 s63, s54, 32
    s_cmp_lt_u32 s63, 35
    s_cselect_b32 s63, s63, 0x1000
    s_add_u32 s63, s63, 0
    s_lshl_b32 s63, s63, 10
    buffer_store_dwordx4 v[72:75], v5, s[32:35], s63 offen sc1
    s_add_u32 s63, s54, 32
    s_cmp_lt_u32 s63, 35
    s_cselect_b32 s63, s63, 0x1000
    s_add_u32 s63, s63, 35
    s_lshl_b32 s63, s63, 10
    buffer_store_dwordx4 v[76:79], v5, s[32:35], s63 offen sc1
    s_add_u32 s63, s54, 32
    s_cmp_lt_u32 s63, 35
    s_cselect_b32 s63, s63, 0x1000
    s_add_u32 s63, s63, 70
    s_lshl_b32 s63, s63, 10
    buffer_store_dwordx4 v[80:83], v5, s[32:35], s63 offen sc1
    s_add_u32 s63, s54, 32
    s_cmp_lt_u32 s63, 35
    s_cselect_b32 s63, s63, 0x1000
    s_add_u32 s63, s63, 105
    s_lshl_b32 s63, s63, 10
    buffer_store_dwordx4 v[84:87], v5, s[32:35], s63 offen sc1
    s_waitcnt vmcnt(0)
    s_mov_b64 exec, 1
    s_lshl_b32 s63, s5, 8
    v_mov_b32 v4, s63
    buffer_atomic_or v4, v3, s[8:11], s62 offen offset:128 sc0 sc1
    s_waitcnt vmcnt(0)
    v_readfirstlane_b32 s63, v4
    s_nop 0
    s_and_b32 s63, s63, 0xff
    s_cmp_eq_u32 s63, 8
    s_cselect_b32 s5, s5, 0
k1_go:
    s_mov_b64 exec, 1
    v_mov_b32 v4, s5
    ds_write_b32 v3, v4
    s_waitcnt lgkmcnt(0)
    s_mov_b64 exec, -1
k1_fw:
    s_mul_i32 s62, s4, 1146880
    s_add_u32 s62, s62, 1048576
    s_add_u32 s32, s28, s62
    s_addc_u32 s33, s29, 0
    s_mov_b32 s34, 1146880
    s_mov_b32 s35, 0x20000
    s_mul_i32 s62, s53, 286720
    s_lshr_b32 s63, s4, 4
    s_mul_i32 s63, s63, 1280
    s_add_u32 s62, s62, s63
    s_add_u32 s36, s24, s62
    s_addc_u32 s37, s25, 0
    s_sub_u32 s38, 286720, s63
    s_mov_b32 s39, 0x20000
    v_lshlrev_b32 v3, 4, v2
    v_and_b32 v4, 15, v2
    v_lshrrev_b32 v5, 4, v2
    v_mul_u32_u24 v6, 272, v4
    v_lshl_add_u32 v6, v5, 3, v6
    s_mul_i32 s63, s74, 13056
    s_add_u32 s63, s63, 2048
    s_lshl_b32 s62, s56, 6
    s_add_u32 s62, s62, s63
    v_add_u32 v6, s62, v6
    s_mul_i32 s62, s56, 1088
    s_add_u32 s62, s62, s63
    v_mul_u32_u24 v7, 272, v5
    v_lshl_add_u32 v7, v4, 4, v7
    v_add_u32 v7, s62, v7
    v_mul_u32_u24 v5, 2560, v5
    v_lshl_add_u32 v4, v4, 4, v5
    v_mov_b32 v5, 0
    s_barrier
    ds_read_b64 v[8:9], v5
    s_waitcnt lgkmcnt(0)
    v_or_b32 v5, v8, v9
    s_nop 0
    v_readfirstlane_b32 s5, v5
k1_slice:
    s_nop 0
    s_cmp_eq_u32 s5, 0
    s_cbranch_scc1 k1_done
    s_ff1_i32_b32 s6, s5
    s_bitset0_b32 s5, s6
    s_cmp_eq_u32 s6, s54
    s_cselect_b32 s15, s54, 8
    s_cselect_b32 s16, -1, 0
    s_lshl_b32 s7, s74, 3
    s_add_u32 s7, s7, s6
    s_add_u32 s62, s7, 0
    s_mul_i32 s63, s56, 35
    s_add_u32 s63, s63, s62
    s_lshl_b32 s63, s63, 10
    s_cmp_lt_u32 s62, 35
    s_cselect_b32 s63, s63, 1146880
    s_cmp_eq_u32 s15, 0
    s_cselect_b32 s61, 1146880, s63
    buffer_load_dwordx4 v[8:11], v3, s[32:35], s61 offen sc1
    s_add_u32 s63, s63, 143360
    s_cmp_eq_u32 s15, 1
    s_cselect_b32 s61, 1146880, s63
    buffer_load_dwordx4 v[12:15], v3, s[32:35], s61 offen sc1
    s_add_u32 s63, s63, 143360
    s_cmp_eq_u32 s15, 2
    s_cselect_b32 s61, 1146880, s63
    buffer_load_dwordx4 v[16:19], v3, s[32:35], s61 offen sc1
    s_add_u32 s63, s63, 143360
    s_cmp_eq_u32 s15, 3
    s_cselect_b32 s61, 1146880, s63
    buffer_load_dwordx4 v[20:23], v3, s[32:35], s61 offen sc1
    s_add_u32 s63, s63, 143360
    s_cmp_eq_u32 s15, 4
    s_cselect_b32 s61, 1146880, s63
    buffer_load_dwordx4 v[24:27], v3, s[32:35], s61 offen sc1
    s_add_u32 s63, s63, 143360
    s_cmp_eq_u32 s15, 5
    s_cselect_b32 s61, 1146880, s63
    buffer_load_dwordx4 v[28:31], v3, s[32:35], s61 offen sc1
    s_add_u32 s63, s63, 143360
    s_cmp_eq_u32 s15, 6
    s_cselect_b32 s61, 1146880, s63
    buffer_load_dwordx4 v[32:35], v3, s[32:35], s61 offen sc1
    s_add_u32 s63, s63, 143360
    s_cmp_eq_u32 s15, 7
    s_cselect_b32 s61, 1146880, s63
    buffer_load_dwordx4 v[36:39], v3, s[32:35], s61 offen sc1
    s_mul_i32 s63, s62, 37
    s_lshr_b32 s63, s63, 8
    s_mul_i32 s61, s63, 7
    s_sub_u32 s61, s62, s61
    s_lshl_b32 s63, s63, 8
    s_mul_i32 s61, s61, 40960
    s_add_u32 s63, s63, s61
    s_mul_i32 s61, s56, 10240
    s_add_u32 s63, s63, s61
    s_cmp_lt_u32 s62, 35
    s_cselect_b32 s12, s63, 0x1000000
    s_add_u32 s62, s7, 16
    s_mul_i32 s63, s56, 35
    s_add_u32 s63, s63, s62
    s_lshl_b32 s63, s63, 10
    s_cmp_lt_u32 s62, 35
    s_cselect_b32 s63, s63, 1146880
    s_cmp_eq_u32 s15, 0
    s_cselect_b32 s61, 1146880, s63
    buffer_load_dwordx4 v[40:43], v3, s[32:35], s61 offen sc1
    s_add_u32 s63, s63, 143360
    s_cmp_eq_u32 s15, 1
    s_cselect_b32 s61, 1146880, s63
    buffer_load_dwordx4 v[44:47], v3, s[32:35], s61 offen sc1
    s_add_u32 s63, s63, 143360
    s_cmp_eq_u32 s15, 2
    s_cselect_b32 s61, 1146880, s63
    buffer_load_dwordx4 v[48:51], v3, s[32:35], s61 offen sc1
    s_add_u32 s63, s63, 143360
    s_cmp_eq_u32 s15, 3
    s_cselect_b32 s61, 1146880, s63
    buffer_load_dwordx4 v[52:55], v3, s[32:35], s61 offen sc1
    s_add_u32 s63, s63, 143360
    s_cmp_eq_u32 s15, 4
    s_cselect_b32 s61, 1146880, s63
    buffer_load_dwordx4 v[56:59], v3, s[32:35], s61 offen sc1
    s_add_u32 s63, s63, 143360
    s_cmp_eq_u32 s15, 5
    s_cselect_b32 s61, 1146880, s63
    buffer_load_dwordx4 v[60:63], v3, s[32:35], s61 offen sc1
    s_add_u32 s63, s63, 143360
    s_cmp_eq_u32 s15, 6
    s_cselect_b32 s61, 1146880, s63
    buffer_load_dwordx4 v[64:67], v3, s[32:35], s61 offen sc1
    s_add_u32 s63, s63, 143360
    s_cmp_eq_u32 s15, 7
    s_cselect_b32 s61, 1146880, s63
    buffer_load_dwordx4 v[68:71], v3, s[32:35], s61 offen sc1
    s_mul_i32 s63, s62, 37
    s_lshr_b32 s63, s63, 8
    s_mul_i32 s61, s63, 7
    s_sub_u32 s61, s62, s61
    s_lshl_b32 s63, s63, 8
    s_mul_i32 s61, s61, 40960
    s_add_u32 s63, s63, s61
    s_mul_i32 s61, s56, 10240
    s_add_u32 s63, s63, s61
    s_cmp_lt_u32 s62, 35
    s_cselect_b32 s13, s63, 0x1000000
    s_add_u32 s62, s7, 32
    s_mul_i32 s63, s56, 35
    s_add_u32 s63, s63, s62
    s_lshl_b32 s63, s63, 10
    s_cmp_lt_u32 s62, 35
    s_cselect_b32 s63, s63, 1146880
    s_cmp_eq_u32 s15, 0
    s_cselect_b32 s61, 1146880, s63
    buffer_load_dwordx4 v[72:75], v3, s[32:35], s61 offen sc1
    s_add_u32 s63, s63, 143360
    s_cmp_eq_u32 s15, 1
    s_cselect_b32 s61, 1146880, s63
    buffer_load_dwordx4 v[76:79], v3, s[32:35], s61 offen sc1
    s_add_u32 s63, s63, 143360
    s_cmp_eq_u32 s15, 2
    s_cselect_b32 s61, 1146880, s63
    buffer_load_dwordx4 v[80:83], v3, s[32:35], s61 offen sc1
    s_add_u32 s63, s63, 143360
    s_cmp_eq_u32 s15, 3
    s_cselect_b32 s61, 1146880, s63
    buffer_load_dwordx4 v[84:87], v3, s[32:35], s61 offen sc1
    s_add_u32 s63, s63, 143360
    s_cmp_eq_u32 s15, 4
    s_cselect_b32 s61, 1146880, s63
    buffer_load_dwordx4 v[88:91], v3, s[32:35], s61 offen sc1
    s_add_u32 s63, s63, 143360
    s_cmp_eq_u32 s15, 5
    s_cselect_b32 s61, 1146880, s63
    buffer_load_dwordx4 v[92:95], v3, s[32:35], s61 offen sc1
    s_add_u32 s63, s63, 143360
    s_cmp_eq_u32 s15, 6
    s_cselect_b32 s61, 1146880, s63
    buffer_load_dwordx4 v[96:99], v3, s[32:35], s61 offen sc1
    s_add_u32 s63, s63, 143360
    s_cmp_eq_u32 s15, 7
    s_cselect_b32 s61, 1146880, s63
    buffer_load_dwordx4 v[100:103], v3, s[32:35], s61 offen sc1
    s_mul_i32 s63, s62, 37
    s_lshr_b32 s63, s63, 8
    s_mul_i32 s61, s63, 7
    s_sub_u32 s61, s62, s61
    s_lshl_b32 s63, s63, 8
    s_mul_i32 s61, s61, 40960
    s_add_u32 s63, s63, s61
    s_mul_i32 s61, s56, 10240
    s_add_u32 s63, s63, s61
    s_cmp_lt_u32 s62, 35
    s_cselect_b32 s14, s63, 0x1000000
    s_lshl_b32 s62, s74, 12
    s_lshl_b32 s63, s56, 10
    s_add_u32 s62, s62, s63
    s_add_u32 s62, s62, 126976
    v_add_u32 v140, s62, v3
    ds_read_b128 v[144:147], v140 offset:0
    ds_read_b128 v[148:151], v140 offset:8192
    ds_read_b128 v[152:155], v140 offset:16384
    s_waitcnt lgkmcnt(0)
    v_and_b32 v144, s16, v144
    v_and_b32 v145, s16, v145
    v_and_b32 v146, s16, v146
    v_and_b32 v147, s16, v147
    v_and_b32 v148, s16, v148
    v_and_b32 v149, s16, v149
    v_and_b32 v150, s16, v150
    v_and_b32 v151, s16, v151
    v_and_b32 v152, s16, v152
    v_and_b32 v153, s16, v153
    v_and_b32 v154, s16, v154
    v_and_b32 v155, s16, v155
    v_lshlrev_b32 v104, 16, v144
    v_and_b32 v105, 0xffff0000, v144
    v_lshlrev_b32 v106, 16, v145
    v_and_b32 v107, 0xffff0000, v145
    v_lshlrev_b32 v108, 16, v146
    v_and_b32 v109, 0xffff0000, v146
    v_lshlrev_b32 v110, 16, v147
    v_and_b32 v111, 0xffff0000, v147
    s_waitcnt vmcnt(23)
    v_lshlrev_b32 v112, 16, v8
    v_and_b32 v113, 0xffff0000, v8
    v_add_f32 v104, v104, v112
    v_add_f32 v105, v105, v113
    v_lshlrev_b32 v112, 16, v9
    v_and_b32 v113, 0xffff0000, v9
    v_add_f32 v106, v106, v112
    v_add_f32 v107, v107, v113
    v_lshlrev_b32 v112, 16, v10
    v_and_b32 v113, 0xffff0000, v10
    v_add_f32 v108, v108, v112
    v_add_f32 v109, v109, v113
    v_lshlrev_b32 v112, 16, v11
    v_and_b32 v113, 0xffff0000, v11
    v_add_f32 v110, v110, v112
    v_add_f32 v111, v111, v113
    s_waitcnt vmcnt(22)
    v_lshlrev_b32 v112, 16, v12
    v_and_b32 v113, 0xffff0000, v12
    v_add_f32 v104, v104, v112
    v_add_f32 v105, v105, v113
    v_lshlrev_b32 v112, 16, v13
    v_and_b32 v113, 0xffff0000, v13
    v_add_f32 v106, v106, v112
    v_add_f32 v107, v107, v113
    v_lshlrev_b32 v112, 16, v14
    v_and_b32 v113, 0xffff0000, v14
    v_add_f32 v108, v108, v112
    v_add_f32 v109, v109, v113
    v_lshlrev_b32 v112, 16, v15
    v_and_b32 v113, 0xffff0000, v15
    v_add_f32 v110, v110, v112
    v_add_f32 v111, v111, v113
    s_waitcnt vmcnt(21)
    v_lshlrev_b32 v112, 16, v16
    v_and_b32 v113, 0xffff0000, v16
    v_add_f32 v104, v104, v112
    v_add_f32 v105, v105, v113
    v_lshlrev_b32 v112, 16, v17
    v_and_b32 v113, 0xffff0000, v17
    v_add_f32 v106, v106, v112
    v_add_f32 v107, v107, v113
    v_lshlrev_b32 v112, 16, v18
    v_and_b32 v113, 0xffff0000, v18
    v_add_f32 v108, v108, v112
    v_add_f32 v109, v109, v113
    v_lshlrev_b32 v112, 16, v19
    v_and_b32 v113, 0xffff0000, v19
    v_add_f32 v110, v110, v112
    v_add_f32 v111, v111, v113
    s_waitcnt vmcnt(20)
    v_lshlrev_b32 v112, 16, v20
    v_and_b32 v113, 0xffff0000, v20
    v_add_f32 v104, v104, v112
    v_add_f32 v105, v105, v113
    v_lshlrev_b32 v112, 16, v21
    v_and_b32 v113, 0xffff0000, v21
    v_add_f32 v106, v106, v112
    v_add_f32 v107, v107, v113
    v_lshlrev_b32 v112, 16, v22
    v_and_b32 v113, 0xffff0000, v22
    v_add_f32 v108, v108, v112
    v_add_f32 v109, v109, v113
    v_lshlrev_b32 v112, 16, v23
    v_and_b32 v113, 0xffff0000, v23
    v_add_f32 v110, v110, v112
    v_add_f32 v111, v111, v113
    s_waitcnt vmcnt(19)
    v_lshlrev_b32 v112, 16, v24
    v_and_b32 v113, 0xffff0000, v24
    v_add_f32 v104, v104, v112
    v_add_f32 v105, v105, v113
    v_lshlrev_b32 v112, 16, v25
    v_and_b32 v113, 0xffff0000, v25
    v_add_f32 v106, v106, v112
    v_add_f32 v107, v107, v113
    v_lshlrev_b32 v112, 16, v26
    v_and_b32 v113, 0xffff0000, v26
    v_add_f32 v108, v108, v112
    v_add_f32 v109, v109, v113
    v_lshlrev_b32 v112, 16, v27
    v_and_b32 v113, 0xffff0000, v27
    v_add_f32 v110, v110, v112
    v_add_f32 v111, v111, v113
    s_waitcnt vmcnt(18)
    v_lshlrev_b32 v112, 16, v28
    v_and_b32 v113, 0xffff0000, v28
    v_add_f32 v104, v104, v112
    v_add_f32 v105, v105, v113
    v_lshlrev_b32 v112, 16, v29
    v_and_b32 v113, 0xffff0000, v29
    v_add_f32 v106, v106, v112
    v_add_f32 v107, v107, v113
    v_lshlrev_b32 v112, 16, v30
    v_and_b32 v113, 0xffff0000, v30
    v_add_f32 v108, v108, v112
    v_add_f32 v109, v109, v113
    v_lshlrev_b32 v112, 16, v31
    v_and_b32 v113, 0xffff0000, v31
    v_add_f32 v110, v110, v112
    v_add_f32 v111, v111, v113
    s_waitcnt vmcnt(17)
    v_lshlrev_b32 v112, 16, v32
    v_and_b32 v113, 0xffff0000, v32
    v_add_f32 v104, v104, v112
    v_add_f32 v105, v105, v113
    v_lshlrev_b32 v112, 16, v33
    v_and_b32 v113, 0xffff0000, v33
    v_add_f32 v106, v106, v112
    v_add_f32 v107, v107, v113
    v_lshlrev_b32 v112, 16, v34
    v_and_b32 v113, 0xffff0000, v34
    v_add_f32 v108, v108, v112
    v_add_f32 v109, v109, v113
    v_lshlrev_b32 v112, 16, v35
    v_and_b32 v113, 0xffff0000, v35
    v_add_f32 v110, v110, v112
    v_add_f32 v111, v111, v113
    s_waitcnt vmcnt(16)
    v_lshlrev_b32 v112, 16, v36
    v_and_b32 v113, 0xffff0000, v36
    v_add_f32 v104, v104, v112
    v_add_f32 v105, v105, v113
    v_lshlrev_b32 v112, 16, v37
    v_and_b32 v113, 0xffff0000, v37
    v_add_f32 v106, v106, v112
    v_add_f32 v107, v107, v113
    v_lshlrev_b32 v112, 16, v38
    v_and_b32 v113, 0xffff0000, v38
    v_add_f32 v108, v108, v112
    v_add_f32 v109, v109, v113
    v_lshlrev_b32 v112, 16, v39
    v_and_b32 v113, 0xffff0000, v39
    v_add_f32 v110, v110, v112
    v_add_f32 v111, v111, v113
    v_cvt_pk_bf16_f32 v116, v104, v105
    v_cvt_pk_bf16_f32 v117, v106, v107
    v_cvt_pk_bf16_f32 v118, v108, v109
    v_cvt_pk_bf16_f32 v119, v110, v111
    ds_write_b64 v6, v[116:117] offset:0
    ds_write_b64 v6, v[118:119] offset:32
    v_lshlrev_b32 v104, 16, v148
    v_and_b32 v105, 0xffff0000, v148
    v_lshlrev_b32 v106, 16, v149
    v_and_b32 v107, 0xffff0000, v149
    v_lshlrev_b32 v108, 16, v150
    v_and_b32 v109, 0xffff0000, v150
    v_lshlrev_b32 v110, 16, v151
    v_and_b32 v111, 0xffff0000, v151
    s_waitcnt vmcnt(15)
    v_lshlrev_b32 v112, 16, v40
    v_and_b32 v113, 0xffff0000, v40
    v_add_f32 v104, v104, v112
    v_add_f32 v105, v105, v113
    v_lshlrev_b32 v112, 16, v41
    v_and_b32 v113, 0xffff0000, v41
    v_add_f32 v106, v106, v112
    v_add_f32 v107, v107, v113
    v_lshlrev_b32 v112, 16, v42
    v_and_b32 v113, 0xffff0000, v42
    v_add_f32 v108, v108, v112
    v_add_f32 v109, v109, v113
    v_lshlrev_b32 v112, 16, v43
    v_and_b32 v113, 0xffff0000, v43
    v_add_f32 v110, v110, v112
    v_add_f32 v111, v111, v113
    s_waitcnt vmcnt(14)
    v_lshlrev_b32 v112, 16, v44
    v_and_b32 v113, 0xffff0000, v44
    v_add_f32 v104, v104, v112
    v_add_f32 v105, v105, v113
    v_lshlrev_b32 v112, 16, v45
    v_and_b32 v113, 0xffff0000, v45
    v_add_f32 v106, v106, v112
    v_add_f32 v107, v107, v113
    v_lshlrev_b32 v112, 16, v46
    v_and_b32 v113, 0xffff0000, v46
    v_add_f32 v108, v108, v112
    v_add_f32 v109, v109, v113
    v_lshlrev_b32 v112, 16, v47
    v_and_b32 v113, 0xffff0000, v47
    v_add_f32 v110, v110, v112
    v_add_f32 v111, v111, v113
    s_waitcnt vmcnt(13)
    v_lshlrev_b32 v112, 16, v48
    v_and_b32 v113, 0xffff0000, v48
    v_add_f32 v104, v104, v112
    v_add_f32 v105, v105, v113
    v_lshlrev_b32 v112, 16, v49
    v_and_b32 v113, 0xffff0000, v49
    v_add_f32 v106, v106, v112
    v_add_f32 v107, v107, v113
    v_lshlrev_b32 v112, 16, v50
    v_and_b32 v113, 0xffff0000, v50
    v_add_f32 v108, v108, v112
    v_add_f32 v109, v109, v113
    v_lshlrev_b32 v112, 16, v51
    v_and_b32 v113, 0xffff0000, v51
    v_add_f32 v110, v110, v112
    v_add_f32 v111, v111, v113
    s_waitcnt vmcnt(12)
    v_lshlrev_b32 v112, 16, v52
    v_and_b32 v113, 0xffff0000, v52
    v_add_f32 v104, v104, v112
    v_add_f32 v105, v105, v113
    v_lshlrev_b32 v112, 16, v53
    v_and_b32 v113, 0xffff0000, v53
    v_add_f32 v106, v106, v112
    v_add_f32 v107, v107, v113
    v_lshlrev_b32 v112, 16, v54
    v_and_b32 v113, 0xffff0000, v54
    v_add_f32 v108, v108, v112
    v_add_f32 v109, v109, v113
    v_lshlrev_b32 v112, 16, v55
    v_and_b32 v113, 0xffff0000, v55
    v_add_f32 v110, v110, v112
    v_add_f32 v111, v111, v113
    s_waitcnt vmcnt(11)
    v_lshlrev_b32 v112, 16, v56
    v_and_b32 v113, 0xffff0000, v56
    v_add_f32 v104, v104, v112
    v_add_f32 v105, v105, v113
    v_lshlrev_b32 v112, 16, v57
    v_and_b32 v113, 0xffff0000, v57
    v_add_f32 v106, v106, v112
    v_add_f32 v107, v107, v113
    v_lshlrev_b32 v112, 16, v58
    v_and_b32 v113, 0xffff0000, v58
    v_add_f32 v108, v108, v112
    v_add_f32 v109, v109, v113
    v_lshlrev_b32 v112, 16, v59
    v_and_b32 v113, 0xffff0000, v59
    v_add_f32 v110, v110, v112
    v_add_f32 v111, v111, v113
    s_waitcnt vmcnt(10)
    v_lshlrev_b32 v112, 16, v60
    v_and_b32 v113, 0xffff0000, v60
    v_add_f32 v104, v104, v112
    v_add_f32 v105, v105, v113
    v_lshlrev_b32 v112, 16, v61
    v_and_b32 v113, 0xffff0000, v61
    v_add_f32 v106, v106, v112
    v_add_f32 v107, v107, v113
    v_lshlrev_b32 v112, 16, v62
    v_and_b32 v113, 0xffff0000, v62
    v_add_f32 v108, v108, v112
    v_add_f32 v109, v109, v113
    v_lshlrev_b32 v112, 16, v63
    v_and_b32 v113, 0xffff0000, v63
    v_add_f32 v110, v110, v112
    v_add_f32 v111, v111, v113
    s_waitcnt vmcnt(9)
    v_lshlrev_b32 v112, 16, v64
    v_and_b32 v113, 0xffff0000, v64
    v_add_f32 v104, v104, v112
    v_add_f32 v105, v105, v113
    v_lshlrev_b32 v112, 16, v65
    v_and_b32 v113, 0xffff0000, v65
    v_add_f32 v106, v106, v112
    v_add_f32 v107, v107, v113
    v_lshlrev_b32 v112, 16, v66
    v_and_b32 v113, 0xffff0000, v66
    v_add_f32 v108, v108, v112
    v_add_f32 v109, v109, v113
    v_lshlrev_b32 v112, 16, v67
    v_and_b32 v113, 0xffff0000, v67
    v_add_f32 v110, v110, v112
    v_add_f32 v111, v111, v113
    s_waitcnt vmcnt(8)
    v_lshlrev_b32 v112, 16, v68
    v_and_b32 v113, 0xffff0000, v68
    v_add_f32 v104, v104, v112
    v_add_f32 v105, v105, v113
    v_lshlrev_b32 v112, 16, v69
    v_and_b32 v113, 0xffff0000, v69
    v_add_f32 v106, v106, v112
    v_add_f32 v107, v107, v113
    v_lshlrev_b32 v112, 16, v70
    v_and_b32 v113, 0xffff0000, v70
    v_add_f32 v108, v108, v112
    v_add_f32 v109, v109, v113
    v_lshlrev_b32 v112, 16, v71
    v_and_b32 v113, 0xffff0000, v71
    v_add_f32 v110, v110, v112
    v_add_f32 v111, v111, v113
    v_cvt_pk_bf16_f32 v120, v104, v105
    v_cvt_pk_bf16_f32 v121, v106, v107
    v_cvt_pk_bf16_f32 v122, v108, v109
    v_cvt_pk_bf16_f32 v123, v110, v111
    ds_write_b64 v6, v[120:121] offset:4352
    ds_write_b64 v6, v[122:123] offset:4384
    v_lshlrev_b32 v104, 16, v152
    v_and_b32 v105, 0xffff0000, v152
    v_lshlrev_b32 v106, 16, v153
    v_and_b32 v107, 0xffff0000, v153
    v_lshlrev_b32 v108, 16, v154
    v_and_b32 v109, 0xffff0000, v154
    v_lshlrev_b32 v110, 16, v155
    v_and_b32 v111, 0xffff0000, v155
    s_waitcnt vmcnt(7)
    v_lshlrev_b32 v112, 16, v72
    v_and_b32 v113, 0xffff0000, v72
    v_add_f32 v104, v104, v112
    v_add_f32 v105, v105, v113
    v_lshlrev_b32 v112, 16, v73
    v_and_b32 v113, 0xffff0000, v73
    v_add_f32 v106, v106, v112
    v_add_f32 v107, v107, v113
    v_lshlrev_b32 v112, 16, v74
    v_and_b32 v113, 0xffff0000, v74
    v_add_f32 v108, v108, v112
    v_add_f32 v109, v109, v113
    v_lshlrev_b32 v112, 16, v75
    v_and_b32 v113, 0xffff0000, v75
    v_add_f32 v110, v110, v112
    v_add_f32 v111, v111, v113
    s_waitcnt vmcnt(6)
    v_lshlrev_b32 v112, 16, v76
    v_and_b32 v113, 0xffff0000, v76
    v_add_f32 v104, v104, v112
    v_add_f32 v105, v105, v113
    v_lshlrev_b32 v112, 16, v77
    v_and_b32 v113, 0xffff0000, v77
    v_add_f32 v106, v106, v112
    v_add_f32 v107, v107, v113
    v_lshlrev_b32 v112, 16, v78
    v_and_b32 v113, 0xffff0000, v78
    v_add_f32 v108, v108, v112
    v_add_f32 v109, v109, v113
    v_lshlrev_b32 v112, 16, v79
    v_and_b32 v113, 0xffff0000, v79
    v_add_f32 v110, v110, v112
    v_add_f32 v111, v111, v113
    s_waitcnt vmcnt(5)
    v_lshlrev_b32 v112, 16, v80
    v_and_b32 v113, 0xffff0000, v80
    v_add_f32 v104, v104, v112
    v_add_f32 v105, v105, v113
    v_lshlrev_b32 v112, 16, v81
    v_and_b32 v113, 0xffff0000, v81
    v_add_f32 v106, v106, v112
    v_add_f32 v107, v107, v113
    v_lshlrev_b32 v112, 16, v82
    v_and_b32 v113, 0xffff0000, v82
    v_add_f32 v108, v108, v112
    v_add_f32 v109, v109, v113
    v_lshlrev_b32 v112, 16, v83
    v_and_b32 v113, 0xffff0000, v83
    v_add_f32 v110, v110, v112
    v_add_f32 v111, v111, v113
    s_waitcnt vmcnt(4)
    v_lshlrev_b32 v112, 16, v84
    v_and_b32 v113, 0xffff0000, v84
    v_add_f32 v104, v104, v112
    v_add_f32 v105, v105, v113
    v_lshlrev_b32 v112, 16, v85
    v_and_b32 v113, 0xffff0000, v85
    v_add_f32 v106, v106, v112
    v_add_f32 v107, v107, v113
    v_lshlrev_b32 v112, 16, v86
    v_and_b32 v113, 0xffff0000, v86
    v_add_f32 v108, v108, v112
    v_add_f32 v109, v109, v113
    v_lshlrev_b32 v112, 16, v87
    v_and_b32 v113, 0xffff0000, v87
    v_add_f32 v110, v110, v112
    v_add_f32 v111, v111, v113
    s_waitcnt vmcnt(3)
    v_lshlrev_b32 v112, 16, v88
    v_and_b32 v113, 0xffff0000, v88
    v_add_f32 v104, v104, v112
    v_add_f32 v105, v105, v113
    v_lshlrev_b32 v112, 16, v89
    v_and_b32 v113, 0xffff0000, v89
    v_add_f32 v106, v106, v112
    v_add_f32 v107, v107, v113
    v_lshlrev_b32 v112, 16, v90
    v_and_b32 v113, 0xffff0000, v90
    v_add_f32 v108, v108, v112
    v_add_f32 v109, v109, v113
    v_lshlrev_b32 v112, 16, v91
    v_and_b32 v113, 0xffff0000, v91
    v_add_f32 v110, v110, v112
    v_add_f32 v111, v111, v113
    s_waitcnt vmcnt(2)
    v_lshlrev_b32 v112, 16, v92
    v_and_b32 v113, 0xffff0000, v92
    v_add_f32 v104, v104, v112
    v_add_f32 v105, v105, v113
    v_lshlrev_b32 v112, 16, v93
    v_and_b32 v113, 0xffff0000, v93
    v_add_f32 v106, v106, v112
    v_add_f32 v107, v107, v113
    v_lshlrev_b32 v112, 16, v94
    v_and_b32 v113, 0xffff0000, v94
    v_add_f32 v108, v108, v112
    v_add_f32 v109, v109, v113
    v_lshlrev_b32 v112, 16, v95
    v_and_b32 v113, 0xffff0000, v95
    v_add_f32 v110, v110, v112
    v_add_f32 v111, v111, v113
    s_waitcnt vmcnt(1)
    v_lshlrev_b32 v112, 16, v96
    v_and_b32 v113, 0xffff0000, v96
    v_add_f32 v104, v104, v112
    v_add_f32 v105, v105, v113
    v_lshlrev_b32 v112, 16, v97
    v_and_b32 v113, 0xffff0000, v97
    v_add_f32 v106, v106, v112
    v_add_f32 v107, v107, v113
    v_lshlrev_b32 v112, 16, v98
    v_and_b32 v113, 0xffff0000, v98
    v_add_f32 v108, v108, v112
    v_add_f32 v109, v109, v113
    v_lshlrev_b32 v112, 16, v99
    v_and_b32 v113, 0xffff0000, v99
    v_add_f32 v110, v110, v112
    v_add_f32 v111, v111, v113
    s_waitcnt vmcnt(0)
    v_lshlrev_b32 v112, 16, v100
    v_and_b32 v113, 0xffff0000, v100
    v_add_f32 v104, v104, v112
    v_add_f32 v105, v105, v113
    v_lshlrev_b32 v112, 16, v101
    v_and_b32 v113, 0xffff0000, v101
    v_add_f32 v106, v106, v112
    v_add_f32 v107, v107, v113
    v_lshlrev_b32 v112, 16, v102
    v_and_b32 v113, 0xffff0000, v102
    v_add_f32 v108, v108, v112
    v_add_f32 v109, v109, v113
    v_lshlrev_b32 v112, 16, v103
    v_and_b32 v113, 0xffff0000, v103
    v_add_f32 v110, v110, v112
    v_add_f32 v111, v111, v113
    v_cvt_pk_bf16_f32 v124, v104, v105
    v_cvt_pk_bf16_f32 v125, v106, v107
    v_cvt_pk_bf16_f32 v126, v108, v109
    v_cvt_pk_bf16_f32 v127, v110, v111
    ds_write_b64 v6, v[124:125] offset:8704
    ds_write_b64 v6, v[126:127] offset:8736
    s_waitcnt lgkmcnt(0)
    s_barrier
    ds_read_b128 v[128:131], v7 offset:0
    ds_read_b128 v[132:135], v7 offset:4352
    ds_read_b128 v[136:139], v7 offset:8704
    s_waitcnt lgkmcnt(2)
    buffer_store_dwordx4 v[128:131], v4, s[36:39], s12 offen
    s_waitcnt lgkmcnt(1)
    buffer_store_dwordx4 v[132:135], v4, s[36:39], s13 offen
    s_waitcnt lgkmcnt(0)
    buffer_store_dwordx4 v[136:139], v4, s[36:39], s14 offen
    s_barrier
    s_branch k1_slice
k1_done:
k1_end:
    s_endpgm
.section .rodata,"a"
.p2align 6
.amdhsa_kernel concat_heads__mha_block_cached__gqa_block_cached__near_ridge_kernel
  .amdhsa_next_free_vgpr 256
  .amdhsa_next_free_sgpr 102
  .amdhsa_accum_offset 256
  .amdhsa_group_segment_fixed_size 0
  .amdhsa_kernarg_size 104
  .amdhsa_user_sgpr_count 2
  .amdhsa_user_sgpr_kernarg_segment_ptr 1
  .amdhsa_system_sgpr_workgroup_id_x 1
.end_amdhsa_kernel
```
